```python
import torch

def _softmax(x, axis=-1):
    return torch.softmax(x, dim=axis)
def _gelu(x):
    return torch.nn.functional.gelu(x, approximate="tanh")
def _silu(x):
    return torch.nn.functional.silu(x)
def _sigmoid(x):
    return torch.sigmoid(x)
def _layernorm(x, axis=-1, eps=1e-5):
    m = x.mean(dim=axis, keepdim=True)
    v = x.var(dim=axis, keepdim=True, unbiased=False)
    return (x - m) / torch.sqrt(v + eps)
def _scatter_add(tgt, idx, src, axis=0):
    return tgt.clone().index_add_(axis, idx, src)
def _segment_sum(src, seg, n):
    out = torch.zeros((n,) + src.shape[1:], dtype=src.dtype)
    return out.index_add_(0, seg, src)
def _pad(x, pw):
    flat = tuple(v for pair in reversed(pw) for v in pair)
    return torch.nn.functional.pad(x, flat)

kernel_name = 'recurrent_scan__sliding_block_cached__swiglu_ffn__prompt'

def setup_inputs():

    _w = (lambda a: (lambda t: t.to(torch.bfloat16) if t.is_floating_point() else t)(torch.as_tensor(a)))
    def _A_setup():
        B, Sq, D = 1, 2048, 576
        Hq, Hkv, Sk, Dh = 32, 16, 2048, 128
        assert Hq % Hkv == 0, (Hq, Hkv)
        return {
            "x": _w((lambda *s: torch.randn(*s, dtype=torch.bfloat16) * 0.05)(B, Sq, D)),
            "k_cache": _w((lambda *s: torch.randn(*s, dtype=torch.bfloat16) * 0.8)(B, Hkv, Sk, Dh)),
            "v_cache": _w((lambda *s: torch.randn(*s, dtype=torch.bfloat16) * 0.2)(B, Hkv, Sk, Dh)),
            "wq": _w((lambda *s: torch.randn(*s, dtype=torch.bfloat16) * 0.8)(D, Hq * Dh) * (D ** -0.5)),
            "wo": _w((lambda *s: torch.randn(*s, dtype=torch.bfloat16) * 0.2)(Hq * Dh, D) * ((Hq * Dh) ** -0.5)),
        }
    _A_in = _A_setup()

    def _B_setup():
        B, S, D, F = 1, 2048, 576, 4608
        return {
            "x": _w((lambda *s: torch.randn(*s, dtype=torch.bfloat16) * 0.05)(B, S, D)),
            "w_gate": _w((lambda *s: torch.randn(*s, dtype=torch.bfloat16) * 0.1)(D, F)),
            "w_up": _w((lambda *s: torch.randn(*s, dtype=torch.bfloat16) * 0.1)(D, F)),
            "w_down": _w((lambda *s: torch.randn(*s, dtype=torch.bfloat16) * 0.1)(F, D)),
        }
    _B_in = _B_setup()

    return {
        "A_x": _A_in["x"],
        "A_k_cache": _A_in["k_cache"],
        "A_v_cache": _A_in["v_cache"],
        "A_wq": _A_in["wq"],
        "A_wo": _A_in["wo"],
        "B_x": _B_in["x"],
        "B_w_gate": _B_in["w_gate"],
        "B_w_up": _B_in["w_up"],
        "B_w_down": _B_in["w_down"],
    }

def reference(A_x, A_k_cache, A_v_cache, A_wq, A_wo, B_x, B_w_gate, B_w_up, B_w_down):
    def _A_ref(x, k_cache, v_cache, wq, wo):
        B, Sq, D = x.shape
        Hq, Dh = 32, 128
        Hkv, Sk = k_cache.shape[1], k_cache.shape[2]
        W = min(4096, max(256, Sk // 4))
        rep = Hq // Hkv
        q = (lambda x, *d: x.permute(*d))((x @ wq).reshape(B, Sq, Hq, Dh), 0, 2, 1, 3)
        k = (lambda x, n, axis: torch.repeat_interleave(x, n, dim=axis))(k_cache[:, :, Sk - W:, :], rep, axis=1)
        v = (lambda x, n, axis: torch.repeat_interleave(x, n, dim=axis))(v_cache[:, :, Sk - W:, :], rep, axis=1)
        scores = torch.einsum("bhqd,bhkd->bhqk", q, k) * (Dh ** -0.5)
        p = _softmax(scores, axis=-1)
        o = torch.einsum("bhqk,bhkd->bhqd", p, v)
        return (lambda x, *d: x.permute(*d))(o, 0, 2, 1, 3).reshape(B, Sq, Hq * Dh) @ wo

    def _B_ref(x, w_gate, w_up, w_down):
        g = _silu(x @ w_gate)
        u = x @ w_up
        return (g * u) @ w_down

    x = A_x
    xn = _layernorm(x, axis=-1)
    s = _A_ref(xn, A_k_cache, A_v_cache, A_wq, A_wo)
    g = _silu(_B_ref(xn, B_w_gate, B_w_up, B_w_down))
    return x + s * g
```

```asm
; @launch grid=(256,1,1) block=(256,1,1) lds=163840
.amdgcn_target "amdgcn-amd-amdhsa--gfx950"
.text
.macro mm r:vararg
v_mfma_f32_16x16x32_bf16 \r
.endm
.macro dt r:vararg
ds_read_b64_tr_b16 \r
.endm
.macro cv r:vararg
v_cvt_pk_bf16_f32 \r
.endm
.macro bl r:vararg
buffer_load_dwordx4 \r
.endm
.macro ar r:vararg
v_accvgpr_read_b32 \r
.endm
.globl recurrent_scan__sliding_block_cached__swiglu_ffn__prompt_kernel
.p2align 8
.type recurrent_scan__sliding_block_cached__swiglu_ffn__prompt_kernel,@function
recurrent_scan__sliding_block_cached__swiglu_ffn__prompt_kernel:
s_cmp_ge_u32 s2,256
s_cbranch_scc0 L_go
s_endpgm
L_go:
s_load_dwordx2 s[98:99],s[0:1],88
s_load_dwordx4 s[92:95],s[0:1],24
s_load_dwordx4 s[88:91],s[0:1],8
s_load_dwordx4 s[76:79],s[0:1],48
s_load_dwordx2 s[96:97],s[0:1],64
s_load_dwordx2 s[64:65],s[0:1],0
s_load_dwordx2 s[66:67],s[0:1],72
s_getpc_b64 s[58:59]
L_pc:
s_sub_u32 s58,s58,L_pc-recurrent_scan__sliding_block_cached__swiglu_ffn__prompt_kernel
s_subb_u32 s59,s59,0
s_lshr_b32 s100,s2,3
s_mul_i32 s100,s100,48
v_min_u32 v216,143,v0
v_add_u32 v217,s100,v216
v_cmp_gt_u32 vcc,96,v216
s_mov_b32 s100,(L_code_end-recurrent_scan__sliding_block_cached__swiglu_ffn__prompt_kernel)/128
s_nop 0
v_cndmask_b32 v216,v217,v216,vcc
v_min_u32 v216,s100,v216
v_lshlrev_b32 v216,7,v216
global_load_dword v217,v216,s[58:59]
v_lshrrev_b32 v1,6,v0
v_and_b32 v40,63,v0
s_nop 0
v_readfirstlane_b32 s3,v1
s_and_b32 s6,s2,7
s_lshr_b32 s7,s2,3
s_and_b32 s4,s6,1
s_lshl_b32 s4,s4,2
s_and_b32 s72,s7,3
s_add_u32 s4,s4,s72
s_lshr_b32 s5,s6,1
s_lshl_b32 s5,s5,3
s_lshr_b32 s72,s7,2
s_add_u32 s5,s5,s72
s_lshl_b32 s36,s3,10
s_and_b32 s6,s5,1
s_lshr_b32 s7,s5,1
v_lshlrev_b32 v2,4,v40
s_lshl_b32 s100,s3,4
s_lshl_b32 s100,s3,3
v_lshrrev_b32 v41,3,v40
v_add_u32 v41,s100,v41
s_movk_i32 s101,9216
v_mul_lo_u32 v42,v41,s101
v_bfe_u32 v43,v41,1,1
v_bfe_u32 v44,v41,3,1
v_lshl_add_u32 v43,v44,1,v43
v_bfe_u32 v44,v40,1,2
v_xor_b32 v43,v43,v44
v_lshl_add_u32 v42,v43,5,v42
v_and_b32 v43,1,v40
v_lshl_add_u32 v24,v43,4,v42
s_lshl_b32 s58,s4,4
s_lshl_b32 s59,s3,2
s_add_u32 s60,s58,s59
s_add_u32 s100,s60,0
s_mul_i32 s38,s100,18432
s_add_u32 s100,s60,1
s_mul_i32 s39,s100,18432
s_add_u32 s100,s60,2
s_mul_i32 s40,s100,18432
s_add_u32 s100,s60,3
s_mul_i32 s41,s100,18432
s_lshr_b32 s100,s5,3
s_mul_i32 s100,s100,2304
s_and_b32 s101,s5,7
s_lshl_b32 s63,s101,8
s_add_u32 s52,s100,s63
s_lshr_b32 s101,s101,1
s_lshl_b32 s101,s101,6
s_add_u32 s53,s100,s101
s_add_u32 s53,s53,2048
v_and_b32 v218,7,v40
v_lshrrev_b32 v215,3,v40
s_movk_i32 s100,1152
v_mul_lo_u32 v219,v218,s100
v_lshl_add_u32 v219,v215,4,v219
s_waitcnt lgkmcnt(0)
s_mov_b32 s8,s98
s_and_b32 s9,s99,0xffff
s_mov_b32 s10,67108864
s_mov_b32 s11,0x20000
s_lshl_b32 s73,s4,14
s_add_u32 s73,s73,3149824
s_mov_b32 s32,s64
s_and_b32 s33,s65,0xffff
s_mov_b32 s34,2359296
s_mov_b32 s35,0x20000
s_cmp_eq_u32 s3,3
s_cselect_b32 s62,0x10000000,0
s_lshl_b32 s100,s4,5
s_add_u32 s100,s100,s5
s_mul_i32 s100,s100,9216
s_mul_i32 s101,s3,384
s_add_u32 s100,s100,s101
s_add_u32 s100,s100,s62
bl v[96:99],v219,s[32:35],s100 offen offset:0
bl v[100:103],v219,s[32:35],s100 offen offset:128
bl v[104:107],v219,s[32:35],s100 offen offset:256
s_sub_u32 s100,s73,128
buffer_load_dword v1,off,s[8:11],s100 sc1
s_mov_b32 s12,s76
s_and_b32 s13,s77,0xffff
s_mov_b32 s14,5308416
s_mov_b32 s15,0x20000
s_mov_b32 s16,s78
s_and_b32 s17,s79,0xffff
s_mov_b32 s18,5308416
s_mov_b32 s19,0x20000
s_mov_b32 s76,s96
s_mov_b32 s77,s97
v_lshrrev_b32 v219,2,v215
v_lshlrev_b32 v219,10,v219
v_and_b32 v216,3,v215
v_lshl_add_u32 v219,v216,8,v219
v_lshl_add_u32 v219,v218,4,v219
s_lshl_b32 s100,s4,4
s_lshr_b32 s101,s5,1
s_add_u32 s100,s100,s101
s_mul_i32 s61,s100,18432
s_lshl_b32 s100,s6,7
s_add_u32 s61,s61,s100
s_mul_i32 s100,s3,6144
s_add_u32 s61,s61,s100
s_add_u32 s61,s61,s62
s_add_u32 m0,s36,0
s_add_u32 s56,s52,0
bl v24,s[12:15],s56 offen lds
s_add_u32 m0,s36,4096
s_nop 0
bl v24,s[16:19],s56 offen lds
s_add_u32 m0,s36,65536
s_add_u32 s57,s52,294912
bl v24,s[12:15],s57 offen lds
s_add_u32 m0,s36,69632
s_nop 0
bl v24,s[16:19],s57 offen lds
s_add_u32 m0,s36,8192
s_add_u32 s58,s52,589824
bl v24,s[12:15],s58 offen lds
s_add_u32 m0,s36,12288
s_nop 0
bl v24,s[16:19],s58 offen lds
s_add_u32 m0,s36,73728
s_add_u32 s59,s52,884736
bl v24,s[12:15],s59 offen lds
s_add_u32 m0,s36,77824
s_nop 0
bl v24,s[16:19],s59 offen lds
s_mov_b32 s20,s92
s_and_b32 s21,s93,0xffff
s_mov_b32 s22,4718592
s_mov_b32 s23,0x20000
s_and_b32 s100,s4,3
s_mul_i32 s100,s100,96
s_add_u32 s100,s100,128
v_subrev_u32 v221,96,v0
v_mov_b32 v222,0x8000
v_cmp_gt_u32 vcc,96,v0
s_movk_i32 s101,9216
s_mul_i32 s100,s100,s101
v_cndmask_b32 v223,v222,v0,vcc
v_cmp_gt_u32 vcc,96,v221
v_mul_lo_u32 v223,v223,s101
s_add_u32 s100,s100,s52
v_cndmask_b32 v221,v222,v221,vcc
v_mul_lo_u32 v221,v221,s101
buffer_load_dword v217,v223,s[12:15],s100 offen
buffer_load_dword v217,v221,s[16:19],s100 offen
s_lshl_b32 s100,s5,7
s_add_u32 s92,s100,s73
s_lshl_b32 s100,s3,2
s_add_u32 s92,s92,s100
s_add_u32 s92,s92,s62
s_lshl_b32 s100,s3,10
s_add_u32 s93,s73,s100
v_min_u32 v220,2,v215
v_lshlrev_b32 v220,2,v220
v_lshlrev_b32 v3,7,v218
v_add_u32 v220,v220,v3
s_lshl_b32 s100,s3,6
v_lshlrev_b32 v216,3,v218
v_add_u32 v216,147456,v216
v_add_u32 v223,s100,v216
s_waitcnt vmcnt(13)
v_lshlrev_b32 v108,16,v96
v_and_b32 v109,0xffff0000,v96
v_lshlrev_b32 v110,16,v97
v_and_b32 v111,0xffff0000,v97
v_lshlrev_b32 v112,16,v98
v_and_b32 v113,0xffff0000,v98
v_lshlrev_b32 v114,16,v99
v_and_b32 v115,0xffff0000,v99
v_pk_add_f32 v[132:133],v[108:109],v[110:111]
v_pk_add_f32 v[134:135],v[112:113],v[114:115]
s_waitcnt vmcnt(12)
v_lshlrev_b32 v116,16,v100
v_and_b32 v117,0xffff0000,v100
v_lshlrev_b32 v118,16,v101
v_and_b32 v119,0xffff0000,v101
v_lshlrev_b32 v120,16,v102
v_and_b32 v121,0xffff0000,v102
v_lshlrev_b32 v122,16,v103
v_and_b32 v123,0xffff0000,v103
v_pk_add_f32 v[132:133],v[132:133],v[116:117]
v_pk_add_f32 v[134:135],v[134:135],v[118:119]
v_pk_add_f32 v[132:133],v[132:133],v[120:121]
v_pk_add_f32 v[134:135],v[134:135],v[122:123]
s_waitcnt vmcnt(11)
v_lshlrev_b32 v124,16,v104
v_and_b32 v125,0xffff0000,v104
v_lshlrev_b32 v126,16,v105
v_and_b32 v127,0xffff0000,v105
v_lshlrev_b32 v128,16,v106
v_and_b32 v129,0xffff0000,v106
v_lshlrev_b32 v130,16,v107
v_and_b32 v131,0xffff0000,v107
v_pk_add_f32 v[132:133],v[132:133],v[124:125]
v_pk_add_f32 v[134:135],v[134:135],v[126:127]
v_pk_add_f32 v[132:133],v[132:133],v[128:129]
v_pk_add_f32 v[134:135],v[134:135],v[130:131]
v_pk_add_f32 v[132:133],v[132:133],v[134:135]
s_nop 0
v_add_f32 v132,v132,v133
s_nop 1
v_add_f32_dpp v132,v132,v132 row_ror:8 row_mask:0xf bank_mask:0xf
v_mov_b32 v133,v132
s_nop 1
v_permlane16_swap_b32 v132,v133
s_nop 1
v_add_f32 v132,v132,v133
v_mov_b32 v133,v132
s_nop 1
v_permlane32_swap_b32 v132,v133
s_nop 1
v_add_f32 v132,v132,v133
v_mul_f32 v136,0xbbaaaaab,v132
v_pk_add_f32 v[108:109],v[108:109],v[136:137] op_sel_hi:[1,0]
v_pk_add_f32 v[110:111],v[110:111],v[136:137] op_sel_hi:[1,0]
v_pk_add_f32 v[112:113],v[112:113],v[136:137] op_sel_hi:[1,0]
v_pk_add_f32 v[114:115],v[114:115],v[136:137] op_sel_hi:[1,0]
v_pk_add_f32 v[116:117],v[116:117],v[136:137] op_sel_hi:[1,0]
v_pk_add_f32 v[118:119],v[118:119],v[136:137] op_sel_hi:[1,0]
v_pk_add_f32 v[120:121],v[120:121],v[136:137] op_sel_hi:[1,0]
v_pk_add_f32 v[122:123],v[122:123],v[136:137] op_sel_hi:[1,0]
v_pk_add_f32 v[124:125],v[124:125],v[136:137] op_sel_hi:[1,0]
v_pk_add_f32 v[126:127],v[126:127],v[136:137] op_sel_hi:[1,0]
v_pk_add_f32 v[128:129],v[128:129],v[136:137] op_sel_hi:[1,0]
v_pk_add_f32 v[130:131],v[130:131],v[136:137] op_sel_hi:[1,0]
v_pk_mul_f32 v[132:133],v[108:109],v[108:109]
v_pk_mul_f32 v[134:135],v[110:111],v[110:111]
v_pk_fma_f32 v[132:133],v[112:113],v[112:113],v[132:133]
v_pk_fma_f32 v[134:135],v[114:115],v[114:115],v[134:135]
v_pk_fma_f32 v[132:133],v[116:117],v[116:117],v[132:133]
v_pk_fma_f32 v[134:135],v[118:119],v[118:119],v[134:135]
v_pk_fma_f32 v[132:133],v[120:121],v[120:121],v[132:133]
v_pk_fma_f32 v[134:135],v[122:123],v[122:123],v[134:135]
v_pk_fma_f32 v[132:133],v[124:125],v[124:125],v[132:133]
v_pk_fma_f32 v[134:135],v[126:127],v[126:127],v[134:135]
v_pk_fma_f32 v[132:133],v[128:129],v[128:129],v[132:133]
v_pk_fma_f32 v[134:135],v[130:131],v[130:131],v[134:135]
v_pk_add_f32 v[132:133],v[132:133],v[134:135]
s_nop 0
v_add_f32 v137,v132,v133
s_nop 1
v_add_f32_dpp v137,v137,v137 row_ror:8 row_mask:0xf bank_mask:0xf
v_mov_b32 v133,v137
s_nop 1
v_permlane16_swap_b32 v137,v133
s_nop 1
v_add_f32 v137,v137,v133
v_mov_b32 v133,v137
s_nop 1
v_permlane32_swap_b32 v137,v133
s_nop 1
v_add_f32 v137,v137,v133
ds_write_b64 v223,v[136:137]
s_waitcnt lgkmcnt(0)
s_barrier
ds_read_b64 v[138:139],v216 offset:0
ds_read_b64 v[140:141],v216 offset:64
ds_read_b64 v[142:143],v216 offset:128
s_waitcnt lgkmcnt(0)
v_add_f32 v132,v138,v140
v_add_f32 v133,v139,v141
v_add_f32 v132,v132,v142
v_add_f32 v133,v133,v143
v_mul_f32 v132,0x3eaaaaab,v132
v_mul_f32 v133,0x3baaaaab,v133
v_sub_f32 v138,v138,v132
v_sub_f32 v140,v140,v132
v_sub_f32 v142,v142,v132
v_fmac_f32 v133,v138,v138
v_fmac_f32 v133,v140,v140
v_fmac_f32 v133,v142,v142
v_mul_f32 v133,0x3eaaaaab,v133
cv v132,v133,v132
v_and_b32 v138,0xffff0000,v132
v_lshlrev_b32 v132,16,v132
v_sub_f32 v136,v138,v136
v_add_f32 v132,0x3727c5ac,v132
cv v132,v132,v132
v_lshlrev_b32 v132,16,v132
v_sqrt_f32 v132,v132
s_nop 0
cv v132,v132,v132
v_lshlrev_b32 v132,16,v132
v_rcp_f32 v134,v132
v_pk_add_f32 v[108:109],v[108:109],v[136:137] op_sel_hi:[1,0]
v_pk_add_f32 v[110:111],v[110:111],v[136:137] op_sel_hi:[1,0]
v_pk_add_f32 v[112:113],v[112:113],v[136:137] op_sel_hi:[1,0]
v_pk_add_f32 v[114:115],v[114:115],v[136:137] op_sel_hi:[1,0]
v_pk_add_f32 v[116:117],v[116:117],v[136:137] op_sel_hi:[1,0]
v_pk_add_f32 v[118:119],v[118:119],v[136:137] op_sel_hi:[1,0]
v_pk_add_f32 v[120:121],v[120:121],v[136:137] op_sel_hi:[1,0]
v_pk_add_f32 v[122:123],v[122:123],v[136:137] op_sel_hi:[1,0]
v_pk_add_f32 v[124:125],v[124:125],v[136:137] op_sel_hi:[1,0]
v_pk_add_f32 v[126:127],v[126:127],v[136:137] op_sel_hi:[1,0]
v_pk_add_f32 v[128:129],v[128:129],v[136:137] op_sel_hi:[1,0]
v_pk_add_f32 v[130:131],v[130:131],v[136:137] op_sel_hi:[1,0]
cv v96,v108,v109
cv v97,v110,v111
cv v98,v112,v113
cv v99,v114,v115
v_lshlrev_b32 v108,16,v96
v_and_b32 v109,0xffff0000,v96
v_lshlrev_b32 v110,16,v97
v_and_b32 v111,0xffff0000,v97
v_lshlrev_b32 v112,16,v98
v_and_b32 v113,0xffff0000,v98
v_lshlrev_b32 v114,16,v99
v_and_b32 v115,0xffff0000,v99
v_pk_mul_f32 v[108:109],v[108:109],v[134:135] op_sel_hi:[1,0]
v_pk_mul_f32 v[110:111],v[110:111],v[134:135] op_sel_hi:[1,0]
v_pk_mul_f32 v[112:113],v[112:113],v[134:135] op_sel_hi:[1,0]
v_pk_mul_f32 v[114:115],v[114:115],v[134:135] op_sel_hi:[1,0]
cv v96,v108,v109
cv v97,v110,v111
cv v98,v112,v113
cv v99,v114,v115
buffer_store_dwordx4 v[96:99],v219,s[8:11],s61 offen offset:0 sc1
cv v100,v116,v117
cv v101,v118,v119
cv v102,v120,v121
cv v103,v122,v123
v_lshlrev_b32 v116,16,v100
v_and_b32 v117,0xffff0000,v100
v_lshlrev_b32 v118,16,v101
v_and_b32 v119,0xffff0000,v101
v_lshlrev_b32 v120,16,v102
v_and_b32 v121,0xffff0000,v102
v_lshlrev_b32 v122,16,v103
v_and_b32 v123,0xffff0000,v103
v_pk_mul_f32 v[116:117],v[116:117],v[134:135] op_sel_hi:[1,0]
v_pk_mul_f32 v[118:119],v[118:119],v[134:135] op_sel_hi:[1,0]
v_pk_mul_f32 v[120:121],v[120:121],v[134:135] op_sel_hi:[1,0]
v_pk_mul_f32 v[122:123],v[122:123],v[134:135] op_sel_hi:[1,0]
cv v100,v116,v117
cv v101,v118,v119
cv v102,v120,v121
cv v103,v122,v123
buffer_store_dwordx4 v[100:103],v219,s[8:11],s61 offen offset:2048 sc1
cv v104,v124,v125
cv v105,v126,v127
cv v106,v128,v129
cv v107,v130,v131
v_lshlrev_b32 v124,16,v104
v_and_b32 v125,0xffff0000,v104
v_lshlrev_b32 v126,16,v105
v_and_b32 v127,0xffff0000,v105
v_lshlrev_b32 v128,16,v106
v_and_b32 v129,0xffff0000,v106
v_lshlrev_b32 v130,16,v107
v_and_b32 v131,0xffff0000,v107
v_pk_mul_f32 v[124:125],v[124:125],v[134:135] op_sel_hi:[1,0]
v_pk_mul_f32 v[126:127],v[126:127],v[134:135] op_sel_hi:[1,0]
v_pk_mul_f32 v[128:129],v[128:129],v[134:135] op_sel_hi:[1,0]
v_pk_mul_f32 v[130:131],v[130:131],v[134:135] op_sel_hi:[1,0]
cv v104,v124,v125
cv v105,v126,v127
cv v106,v128,v129
cv v107,v130,v131
s_add_u32 s61,s61,4096
buffer_store_dwordx4 v[104:107],v219,s[8:11],s61 offen offset:0 sc1
s_add_u32 m0,s36,16384
s_add_u32 s56,s52,1179648
bl v24,s[12:15],s56 offen lds
s_add_u32 m0,s36,20480
s_nop 0
bl v24,s[16:19],s56 offen lds
s_add_u32 m0,s36,81920
s_add_u32 s57,s52,1474560
bl v24,s[12:15],s57 offen lds
s_add_u32 m0,s36,86016
s_nop 0
bl v24,s[16:19],s57 offen lds
s_add_u32 m0,s36,24576
s_add_u32 s58,s52,1769472
bl v24,s[12:15],s58 offen lds
s_add_u32 m0,s36,28672
s_nop 0
bl v24,s[16:19],s58 offen lds
s_add_u32 m0,s36,90112
s_add_u32 s59,s52,2064384
bl v24,s[12:15],s59 offen lds
s_add_u32 m0,s36,94208
s_nop 0
bl v24,s[16:19],s59 offen lds
s_waitcnt vmcnt(8)
v_add_u32 v1,1,v1
buffer_store_dword v1,off,s[8:11],s92 sc1
v_lshrrev_b32 v41,4,v40
v_bfe_u32 v42,v40,2,2
v_and_b32 v43,3,v40
v_lshl_add_u32 v44,v41,3,v42
v_lshlrev_b32 v45,7,v44
v_lshl_add_u32 v45,v43,3,v45
v_lshrrev_b32 v46,1,v42
v_and_b32 v47,1,v41
v_lshl_add_u32 v46,v47,1,v46
v_lshl_add_u32 v16,v46,5,v45
v_xor_b32 v17,32,v16
v_xor_b32 v18,64,v16
v_xor_b32 v19,96,v16
v_add_u32 v20,0x10000,v16
v_add_u32 v21,0x10000,v17
v_add_u32 v22,0x10000,v18
v_add_u32 v23,0x10000,v19
s_or_b32 s101,s5,s3
s_sub_u32 s0,s73,128
s_cmp_eq_u32 s101,0
s_cselect_b32 s0,s0,0x10000000
s_mov_b32 s24,s88
s_and_b32 s25,s89,0xffff
s_mov_b32 s26,8388608
s_mov_b32 s27,0x20000
s_mov_b32 s28,s90
s_and_b32 s29,s91,0xffff
s_mov_b32 s30,8388608
s_mov_b32 s31,0x20000
s_lshl_b32 s37,s3,11
s_lshl_b32 s54,s5,8
s_lshr_b32 s88,s52,6
s_lshr_b32 s89,s53,6
s_sub_u32 s89,s89,s88
s_lshl_b32 s46,s89,10
s_add_u32 s100,s60,0
s_mul_i32 s100,s100,272
s_add_u32 s101,s100,s88
s_lshl_b32 s101,s101,10
s_add_u32 s42,s101,4325376
s_lshl_b32 s101,s5,2
s_add_u32 s101,s101,s100
s_lshl_b32 s101,s101,10
s_add_u32 s48,s101,4194304
s_add_u32 s100,s60,1
s_mul_i32 s100,s100,272
s_add_u32 s101,s100,s88
s_lshl_b32 s101,s101,10
s_add_u32 s43,s101,4325376
s_lshl_b32 s101,s5,2
s_add_u32 s101,s101,s100
s_lshl_b32 s101,s101,10
s_add_u32 s49,s101,4194304
s_add_u32 s100,s60,2
s_mul_i32 s100,s100,272
s_add_u32 s101,s100,s88
s_lshl_b32 s101,s101,10
s_add_u32 s44,s101,4325376
s_lshl_b32 s101,s5,2
s_add_u32 s101,s101,s100
s_lshl_b32 s101,s101,10
s_add_u32 s50,s101,4194304
s_add_u32 s100,s60,3
s_mul_i32 s100,s100,272
s_add_u32 s101,s100,s88
s_lshl_b32 s101,s101,10
s_add_u32 s45,s101,4325376
s_lshl_b32 s101,s5,2
s_add_u32 s101,s101,s100
s_lshl_b32 s101,s101,10
s_add_u32 s51,s101,4194304
s_mul_i32 s55,s7,524288
s_add_u32 s55,s55,393216
s_lshr_b32 s88,s5,3
s_and_b32 s89,s5,7
s_and_b32 s72,s5,1
s_lshr_b32 s90,s89,1
s_mul_i32 s100,s88,32
s_mul_i32 s101,s88,36
s_add_u32 s91,s101,128
s_cmp_eq_u32 s72,0
s_cselect_b32 s32,s94,s76
s_cselect_b32 s33,s95,s77
s_mov_b32 s34,5308416
s_cselect_b32 s34,4718592,s34
s_cselect_b32 s101,s100,s101
s_cselect_b32 s91,s100,s91
s_cselect_b32 s69,s89,0
s_cselect_b32 s76,20,16
s_add_u32 s61,s89,2
s_and_b32 s61,s61,7
s_lshl_b32 s62,s61,20
s_add_u32 s61,s89,4
s_and_b32 s61,s61,7
s_lshl_b32 s61,s61,24
s_or_b32 s62,s62,s61
s_add_u32 s61,s89,6
s_and_b32 s61,s61,7
s_lshl_b32 s61,s61,28
s_or_b32 s62,s62,s61
s_or_b32 s62,s62,0x75310
s_mov_b32 s96,s94
s_and_b32 s97,s95,0xffff
s_mov_b32 s98,4718592
s_mov_b32 s99,0x20000
s_cmp_eq_u32 s72,0
s_cselect_b32 s81,s62,0x87654321
s_mov_b32 s61,0xbfb8aa3b
s_mov_b32 s62,0x3e0293ee
s_and_b32 s33,s33,0xffff
s_mov_b32 s35,0x20000
s_mul_i32 s100,s60,272
s_add_u32 s100,s100,s91
s_lshl_b32 s100,s100,10
s_add_u32 s68,s100,4194304
s_add_u32 s101,s101,s3
s_mul_i32 s101,s101,36864
s_mul_i32 s100,s90,288
s_add_u32 s70,s101,s100
s_mul_i32 s71,s3,9216
s_sub_u32 s83,s101,s71
s_mul_i32 s100,s71,3
s_sub_u32 s83,s83,s100
s_and_b32 s100,s4,3
s_lshl_b32 s100,s100,2
s_add_u32 s100,s100,s90
s_lshl_b32 s47,s100,10
s_mul_i32 s101,s100,82944
s_add_u32 s83,s83,s101
s_mul_i32 s101,s100,73728
s_mul_i32 s100,s88,1179648
s_add_u32 s82,s100,s101
s_lshl_b32 s100,s72,2
s_add_u32 s7,s88,s100
s_lshl_b32 s101,s90,8
s_add_u32 s75,s73,s101
s_lshl_b32 s100,s89,2
s_lshl_b32 s101,s5,7
s_add_u32 s74,s73,s101
s_cmp_eq_u32 s3,0
s_cselect_b32 s74,s74,0x10000000
s_lshl_b32 s101,s88,10
s_add_u32 s73,s73,s101
s_add_u32 s76,s76,s73
s_lshl_b32 s100,s4,2
s_add_u32 s80,s100,s90
s_lshl_b32 s100,s80,3
s_add_u32 s100,s100,s7
s_lshl_b32 s100,s100,2
s_add_u32 s100,s100,s3
s_mul_i32 s100,s100,18432
s_add_u32 s77,s100,46137344
s_add_u32 s78,s77,1024
s_mov_b32 s100,238609295
s_movk_i32 s101,1152
v_add_u32 v41,0,v40
v_mul_hi_u32 v42,v41,s100
v_mul_u32_u24 v43,18,v42
v_sub_u32 v43,v41,v43
v_mul_lo_u32 v42,v42,s101
v_lshl_add_u32 v48,v43,4,v42
v_add_u32 v41,64,v40
v_mul_hi_u32 v42,v41,s100
v_mul_u32_u24 v43,18,v42
v_sub_u32 v43,v41,v43
v_mul_lo_u32 v42,v42,s101
v_lshl_add_u32 v49,v43,4,v42
v_add_u32 v41,128,v40
v_mul_hi_u32 v42,v41,s100
v_mul_u32_u24 v43,18,v42
v_sub_u32 v43,v41,v43
v_mul_lo_u32 v42,v42,s101
v_lshl_add_u32 v50,v43,4,v42
v_add_u32 v41,192,v40
v_mul_hi_u32 v42,v41,s100
v_mul_u32_u24 v43,18,v42
v_sub_u32 v43,v41,v43
v_mul_lo_u32 v42,v42,s101
v_lshl_add_u32 v51,v43,4,v42
v_add_u32 v41,256,v40
v_mul_hi_u32 v42,v41,s100
v_mul_u32_u24 v43,18,v42
v_sub_u32 v43,v41,v43
v_mul_lo_u32 v42,v42,s101
v_lshl_add_u32 v52,v43,4,v42
v_add_u32 v41,320,v40
v_mul_hi_u32 v42,v41,s100
v_mul_u32_u24 v43,18,v42
v_sub_u32 v43,v41,v43
v_mul_lo_u32 v42,v42,s101
v_lshl_add_u32 v53,v43,4,v42
v_add_u32 v41,384,v40
v_mul_hi_u32 v42,v41,s100
v_mul_u32_u24 v43,18,v42
v_sub_u32 v43,v41,v43
v_mul_lo_u32 v42,v42,s101
v_lshl_add_u32 v54,v43,4,v42
v_add_u32 v41,448,v40
v_mul_hi_u32 v42,v41,s100
v_mul_u32_u24 v43,18,v42
v_sub_u32 v43,v41,v43
v_mul_lo_u32 v42,v42,s101
v_lshl_add_u32 v55,v43,4,v42
v_add_u32 v41,512,v40
v_mul_hi_u32 v42,v41,s100
v_mul_u32_u24 v43,18,v42
v_sub_u32 v43,v41,v43
v_mul_lo_u32 v42,v42,s101
v_lshl_add_u32 v56,v43,4,v42
v_lshrrev_b32 v42,2,v40
s_movk_i32 s101,288
v_mul_lo_u32 v42,v42,s101
v_and_b32 v43,3,v40
v_lshl_add_u32 v42,v43,3,v42
v_add_u32 v57,16384,v42
v_add_u32 v58,81920,v42
v_add_u32 v59,147456,v42
v_add_u32 v60,0,v2
v_add_u32 v61,278528,v2
v_add_u32 v62,557056,v2
v_add_u32 v63,835584,v2
v_lshlrev_b32 v7,6,v0
v_add_u32 v7,131072,v7
ds_write_b128 v7,v[48:51] offset:0
ds_write_b128 v7,v[52:55] offset:16
ds_write_b128 v7,v[56:59] offset:32
ds_write_b128 v7,v[60:63] offset:48
s_lshl_b32 s100,s3,4
v_lshrrev_b32 v41,3,v40
v_add_u32 v42,s100,v41
v_lshlrev_b32 v42,13,v42
v_lshrrev_b32 v43,2,v40
v_lshrrev_b32 v44,1,v41
v_xor_b32 v43,v43,v44
v_and_b32 v43,1,v43
v_lshl_add_u32 v42,v43,6,v42
v_and_b32 v43,3,v40
v_lshl_add_u32 v5,v43,4,v42
v_add_u32 v6,0x10000,v5
s_lshl_b32 s100,s3,4
v_lshrrev_b32 v41,2,v40
v_add_u32 v42,s100,v41
s_movk_i32 s101,9216
v_mul_lo_u32 v42,v42,s101
v_lshrrev_b32 v43,1,v40
v_lshrrev_b32 v44,3,v41
v_xor_b32 v43,v43,v44
v_and_b32 v43,1,v43
v_lshl_add_u32 v42,v43,5,v42
v_and_b32 v43,1,v40
v_lshl_add_u32 v4,v43,4,v42
v_lshrrev_b32 v41,4,v40
v_bfe_u32 v42,v40,2,2
v_and_b32 v43,3,v40
v_lshl_add_u32 v44,v41,3,v42
v_lshlrev_b32 v45,6,v44
v_lshl_add_u32 v45,v43,3,v45
v_and_b32 v46,1,v41
v_lshl_add_u32 v8,v46,5,v45
v_xor_b32 v9,32,v8
v_add_u32 v10,0x10000,v8
v_add_u32 v11,0x10000,v9
v_lshlrev_b32 v45,7,v44
v_lshl_add_u32 v45,v43,4,v45
v_lshrrev_b32 v46,1,v42
v_lshl_add_u32 v12,v46,6,v45
v_xor_b32 v13,64,v12
v_add_u32 v14,0x10000,v12
v_add_u32 v15,0x10000,v13
v_min_u32 v41,143,v0
s_movk_i32 s101,9216
v_mul_lo_u32 v25,v41,s101
s_waitcnt lgkmcnt(0)
buffer_load_dword v216,v220,s[8:11],s93 offen sc1
s_add_u32 m0,s36,32768
s_add_u32 s56,s52,2359296
bl v24,s[12:15],s56 offen lds
s_add_u32 m0,s36,36864
s_nop 0
bl v24,s[16:19],s56 offen lds
s_add_u32 m0,s36,98304
s_add_u32 s57,s52,2654208
bl v24,s[12:15],s57 offen lds
s_add_u32 m0,s36,102400
s_nop 0
bl v24,s[16:19],s57 offen lds
s_add_u32 m0,s36,40960
s_add_u32 s58,s52,2949120
bl v24,s[12:15],s58 offen lds
s_add_u32 m0,s36,45056
s_nop 0
bl v24,s[16:19],s58 offen lds
s_add_u32 m0,s36,106496
s_add_u32 s59,s52,3244032
bl v24,s[12:15],s59 offen lds
s_add_u32 m0,s36,110592
s_nop 0
bl v24,s[16:19],s59 offen lds
s_add_u32 m0,s36,49152
s_add_u32 s56,s52,3538944
bl v24,s[12:15],s56 offen lds
s_add_u32 m0,s36,53248
s_nop 0
bl v24,s[16:19],s56 offen lds
s_add_u32 m0,s36,114688
s_add_u32 s57,s52,3833856
bl v24,s[12:15],s57 offen lds
s_add_u32 m0,s36,118784
s_nop 0
bl v24,s[16:19],s57 offen lds
s_add_u32 m0,s36,57344
s_add_u32 s58,s52,4128768
bl v24,s[12:15],s58 offen lds
s_add_u32 m0,s36,61440
s_nop 0
bl v24,s[16:19],s58 offen lds
s_add_u32 m0,s36,122880
s_add_u32 s59,s52,4423680
bl v24,s[12:15],s59 offen lds
s_add_u32 m0,s36,126976
s_nop 0
bl v24,s[16:19],s59 offen lds
s_waitcnt vmcnt(16)
v_cmp_ne_u32 vcc,v1,v216
s_nop 1
s_cbranch_vccnz L_spin_ln
L_ok_ln:
s_add_u32 s56,s38,0
bl a[0:3],v2,s[8:11],s56 offen offset:0 sc1
s_add_u32 s57,s39,0
bl a[4:7],v2,s[8:11],s57 offen offset:0 sc1
s_add_u32 s58,s40,0
bl a[8:11],v2,s[8:11],s58 offen offset:0 sc1
s_add_u32 s59,s41,0
bl a[12:15],v2,s[8:11],s59 offen offset:0 sc1
s_add_u32 s56,s38,0
bl a[16:19],v2,s[8:11],s56 offen offset:1024 sc1
s_add_u32 s57,s39,0
bl a[20:23],v2,s[8:11],s57 offen offset:1024 sc1
s_add_u32 s58,s40,0
bl a[24:27],v2,s[8:11],s58 offen offset:1024 sc1
s_add_u32 s59,s41,0
bl a[28:31],v2,s[8:11],s59 offen offset:1024 sc1
s_add_u32 s56,s38,0
bl a[32:35],v2,s[8:11],s56 offen offset:2048 sc1
s_add_u32 s57,s39,0
bl a[36:39],v2,s[8:11],s57 offen offset:2048 sc1
s_add_u32 s58,s40,0
bl a[40:43],v2,s[8:11],s58 offen offset:2048 sc1
s_add_u32 s59,s41,0
bl a[44:47],v2,s[8:11],s59 offen offset:2048 sc1
s_add_u32 s56,s38,0
bl a[48:51],v2,s[8:11],s56 offen offset:3072 sc1
s_add_u32 s57,s39,0
bl a[52:55],v2,s[8:11],s57 offen offset:3072 sc1
s_add_u32 s58,s40,0
bl a[56:59],v2,s[8:11],s58 offen offset:3072 sc1
s_add_u32 s59,s41,0
bl a[60:63],v2,s[8:11],s59 offen offset:3072 sc1
s_barrier
buffer_store_dword v1,off,s[8:11],s0 sc1
dt v[64:65],v16 offset:0
dt v[66:67],v16 offset:512
dt v[68:69],v20 offset:0
dt v[70:71],v20 offset:512
dt v[72:73],v17 offset:0
dt v[74:75],v17 offset:512
dt v[76:77],v21 offset:0
dt v[78:79],v21 offset:512
s_waitcnt vmcnt(9) lgkmcnt(4)
mm v[96:99],v[64:67],a[0:3],0
s_add_u32 s56,s38,4096
dt v[80:81],v16 offset:4096
mm v[96:99],v[68:71],a[16:19],v[96:99]
bl a[64:67],v2,s[8:11],s56 offen offset:0 sc1
mm v[100:103],v[64:67],a[4:7],0
s_add_u32 s57,s39,4096
dt v[82:83],v16 offset:4608
mm v[100:103],v[68:71],a[20:23],v[100:103]
bl a[68:71],v2,s[8:11],s57 offen offset:0 sc1
mm v[104:107],v[64:67],a[8:11],0
s_add_u32 s58,s40,4096
dt v[84:85],v20 offset:4096
mm v[104:107],v[68:71],a[24:27],v[104:107]
mm v[108:111],v[64:67],a[12:15],0
dt v[86:87],v20 offset:4608
mm v[108:111],v[68:71],a[28:31],v[108:111]
s_waitcnt lgkmcnt(4)
bl a[72:75],v2,s[8:11],s58 offen offset:0 sc1
mm v[112:115],v[72:75],a[0:3],0
dt v[88:89],v17 offset:4096
mm v[112:115],v[76:79],a[16:19],v[112:115]
mm v[116:119],v[72:75],a[4:7],0
dt v[90:91],v17 offset:4608
mm v[116:119],v[76:79],a[20:23],v[116:119]
mm v[120:123],v[72:75],a[8:11],0
s_add_u32 s59,s41,4096
dt v[92:93],v21 offset:4096
mm v[120:123],v[76:79],a[24:27],v[120:123]
bl a[76:79],v2,s[8:11],s59 offen offset:0 sc1
mm v[124:127],v[72:75],a[12:15],0
dt v[94:95],v21 offset:4608
mm v[124:127],v[76:79],a[28:31],v[124:127]
s_waitcnt lgkmcnt(4)
s_add_u32 s56,s38,4096
mm v[128:131],v[80:83],a[0:3],0
dt v[64:65],v18 offset:0
mm v[128:131],v[84:87],a[16:19],v[128:131]
bl a[80:83],v2,s[8:11],s56 offen offset:1024 sc1
mm v[132:135],v[80:83],a[4:7],0
dt v[66:67],v18 offset:512
mm v[132:135],v[84:87],a[20:23],v[132:135]
mm v[136:139],v[80:83],a[8:11],0
dt v[68:69],v22 offset:0
mm v[136:139],v[84:87],a[24:27],v[136:139]
mm v[140:143],v[80:83],a[12:15],0
dt v[70:71],v22 offset:512
mm v[140:143],v[84:87],a[28:31],v[140:143]
s_waitcnt lgkmcnt(4)
mm v[144:147],v[88:91],a[0:3],0
s_add_u32 s57,s39,4096
dt v[72:73],v19 offset:0
mm v[144:147],v[92:95],a[16:19],v[144:147]
bl a[84:87],v2,s[8:11],s57 offen offset:1024 sc1
mm v[148:151],v[88:91],a[4:7],0
dt v[74:75],v19 offset:512
mm v[148:151],v[92:95],a[20:23],v[148:151]
s_add_u32 s58,s40,4096
mm v[152:155],v[88:91],a[8:11],0
dt v[76:77],v23 offset:0
mm v[152:155],v[92:95],a[24:27],v[152:155]
bl a[88:91],v2,s[8:11],s58 offen offset:1024 sc1
mm v[156:159],v[88:91],a[12:15],0
dt v[78:79],v23 offset:512
mm v[156:159],v[92:95],a[28:31],v[156:159]
s_waitcnt lgkmcnt(4)
mm v[160:163],v[64:67],a[0:3],0
dt v[80:81],v18 offset:4096
mm v[160:163],v[68:71],a[16:19],v[160:163]
mm v[164:167],v[64:67],a[4:7],0
dt v[82:83],v18 offset:4608
mm v[164:167],v[68:71],a[20:23],v[164:167]
mm v[168:171],v[64:67],a[8:11],0
s_add_u32 s59,s41,4096
dt v[84:85],v22 offset:4096
mm v[168:171],v[68:71],a[24:27],v[168:171]
bl a[92:95],v2,s[8:11],s59 offen offset:1024 sc1
mm v[172:175],v[64:67],a[12:15],0
s_add_u32 s56,s38,4096
dt v[86:87],v22 offset:4608
mm v[172:175],v[68:71],a[28:31],v[172:175]
s_waitcnt lgkmcnt(4)
bl a[96:99],v2,s[8:11],s56 offen offset:2048 sc1
mm v[176:179],v[72:75],a[0:3],0
s_add_u32 s57,s39,4096
dt v[88:89],v19 offset:4096
mm v[176:179],v[76:79],a[16:19],v[176:179]
mm v[180:183],v[72:75],a[4:7],0
dt v[90:91],v19 offset:4608
mm v[180:183],v[76:79],a[20:23],v[180:183]
bl a[100:103],v2,s[8:11],s57 offen offset:2048 sc1
mm v[184:187],v[72:75],a[8:11],0
dt v[92:93],v23 offset:4096
mm v[184:187],v[76:79],a[24:27],v[184:187]
mm v[188:191],v[72:75],a[12:15],0
dt v[94:95],v23 offset:4608
mm v[188:191],v[76:79],a[28:31],v[188:191]
s_waitcnt lgkmcnt(4)
mm v[192:195],v[80:83],a[0:3],0
s_add_u32 s58,s40,4096
dt v[64:65],v16 offset:8192
mm v[192:195],v[84:87],a[16:19],v[192:195]
bl a[104:107],v2,s[8:11],s58 offen offset:2048 sc1
mm v[196:199],v[80:83],a[4:7],0
dt v[66:67],v16 offset:8704
mm v[196:199],v[84:87],a[20:23],v[196:199]
s_add_u32 s59,s41,4096
mm v[200:203],v[80:83],a[8:11],0
dt v[68:69],v20 offset:8192
mm v[200:203],v[84:87],a[24:27],v[200:203]
bl a[108:111],v2,s[8:11],s59 offen offset:2048 sc1
mm v[204:207],v[80:83],a[12:15],0
dt v[70:71],v20 offset:8704
mm v[204:207],v[84:87],a[28:31],v[204:207]
s_waitcnt lgkmcnt(4)
mm v[208:211],v[88:91],a[0:3],0
dt v[72:73],v17 offset:8192
mm v[208:211],v[92:95],a[16:19],v[208:211]
mm v[212:215],v[88:91],a[4:7],0
dt v[74:75],v17 offset:8704
mm v[212:215],v[92:95],a[20:23],v[212:215]
mm v[216:219],v[88:91],a[8:11],0
s_add_u32 s56,s38,4096
dt v[76:77],v21 offset:8192
mm v[216:219],v[92:95],a[24:27],v[216:219]
bl a[112:115],v2,s[8:11],s56 offen offset:3072 sc1
mm v[220:223],v[88:91],a[12:15],0
s_add_u32 s57,s39,4096
dt v[78:79],v21 offset:8704
mm v[220:223],v[92:95],a[28:31],v[220:223]
s_waitcnt vmcnt(14) lgkmcnt(4)
bl a[116:119],v2,s[8:11],s57 offen offset:3072 sc1
mm v[96:99],v[64:67],a[32:35],v[96:99]
s_add_u32 s58,s40,4096
dt v[80:81],v16 offset:12288
mm v[96:99],v[68:71],a[48:51],v[96:99]
mm v[100:103],v[64:67],a[36:39],v[100:103]
dt v[82:83],v16 offset:12800
mm v[100:103],v[68:71],a[52:55],v[100:103]
bl a[120:123],v2,s[8:11],s58 offen offset:3072 sc1
mm v[104:107],v[64:67],a[40:43],v[104:107]
dt v[84:85],v20 offset:12288
mm v[104:107],v[68:71],a[56:59],v[104:107]
mm v[108:111],v[64:67],a[44:47],v[108:111]
dt v[86:87],v20 offset:12800
mm v[108:111],v[68:71],a[60:63],v[108:111]
s_waitcnt lgkmcnt(4)
mm v[112:115],v[72:75],a[32:35],v[112:115]
s_add_u32 s59,s41,4096
dt v[88:89],v17 offset:12288
mm v[112:115],v[76:79],a[48:51],v[112:115]
bl a[124:127],v2,s[8:11],s59 offen offset:3072 sc1
mm v[116:119],v[72:75],a[36:39],v[116:119]
dt v[90:91],v17 offset:12800
mm v[116:119],v[76:79],a[52:55],v[116:119]
s_add_u32 s56,s38,8192
mm v[120:123],v[72:75],a[40:43],v[120:123]
dt v[92:93],v21 offset:12288
mm v[120:123],v[76:79],a[56:59],v[120:123]
bl a[128:131],v2,s[8:11],s56 offen offset:0 sc1
mm v[124:127],v[72:75],a[44:47],v[124:127]
dt v[94:95],v21 offset:12800
mm v[124:127],v[76:79],a[60:63],v[124:127]
s_waitcnt lgkmcnt(4)
mm v[128:131],v[80:83],a[32:35],v[128:131]
dt v[64:65],v18 offset:8192
mm v[128:131],v[84:87],a[48:51],v[128:131]
mm v[132:135],v[80:83],a[36:39],v[132:135]
dt v[66:67],v18 offset:8704
mm v[132:135],v[84:87],a[52:55],v[132:135]
mm v[136:139],v[80:83],a[40:43],v[136:139]
s_add_u32 s57,s39,8192
dt v[68:69],v22 offset:8192
mm v[136:139],v[84:87],a[56:59],v[136:139]
bl a[132:135],v2,s[8:11],s57 offen offset:0 sc1
mm v[140:143],v[80:83],a[44:47],v[140:143]
dt v[70:71],v22 offset:8704
mm v[140:143],v[84:87],a[60:63],v[140:143]
s_waitcnt lgkmcnt(4)
s_add_u32 s58,s40,8192
mm v[144:147],v[88:91],a[32:35],v[144:147]
dt v[72:73],v19 offset:8192
mm v[144:147],v[92:95],a[48:51],v[144:147]
bl a[136:139],v2,s[8:11],s58 offen offset:0 sc1
mm v[148:151],v[88:91],a[36:39],v[148:151]
dt v[74:75],v19 offset:8704
mm v[148:151],v[92:95],a[52:55],v[148:151]
mm v[152:155],v[88:91],a[40:43],v[152:155]
dt v[76:77],v23 offset:8192
mm v[152:155],v[92:95],a[56:59],v[152:155]
mm v[156:159],v[88:91],a[44:47],v[156:159]
dt v[78:79],v23 offset:8704
mm v[156:159],v[92:95],a[60:63],v[156:159]
s_waitcnt lgkmcnt(4)
mm v[160:163],v[64:67],a[32:35],v[160:163]
s_add_u32 s59,s41,8192
dt v[80:81],v18 offset:12288
mm v[160:163],v[68:71],a[48:51],v[160:163]
bl a[140:143],v2,s[8:11],s59 offen offset:0 sc1
mm v[164:167],v[64:67],a[36:39],v[164:167]
s_add_u32 s56,s38,8192
dt v[82:83],v18 offset:12800
mm v[164:167],v[68:71],a[52:55],v[164:167]
bl a[144:147],v2,s[8:11],s56 offen offset:1024 sc1
mm v[168:171],v[64:67],a[40:43],v[168:171]
dt v[84:85],v22 offset:12288
mm v[168:171],v[68:71],a[56:59],v[168:171]
s_add_u32 s57,s39,8192
mm v[172:175],v[64:67],a[44:47],v[172:175]
dt v[86:87],v22 offset:12800
mm v[172:175],v[68:71],a[60:63],v[172:175]
s_waitcnt lgkmcnt(4)
bl a[148:151],v2,s[8:11],s57 offen offset:1024 sc1
mm v[176:179],v[72:75],a[32:35],v[176:179]
dt v[88:89],v19 offset:12288
mm v[176:179],v[76:79],a[48:51],v[176:179]
s_add_u32 s58,s40,8192
mm v[180:183],v[72:75],a[36:39],v[180:183]
dt v[90:91],v19 offset:12800
mm v[180:183],v[76:79],a[52:55],v[180:183]
bl a[152:155],v2,s[8:11],s58 offen offset:1024 sc1
mm v[184:187],v[72:75],a[40:43],v[184:187]
dt v[92:93],v23 offset:12288
mm v[184:187],v[76:79],a[56:59],v[184:187]
mm v[188:191],v[72:75],a[44:47],v[188:191]
dt v[94:95],v23 offset:12800
mm v[188:191],v[76:79],a[60:63],v[188:191]
s_waitcnt lgkmcnt(4)
mm v[192:195],v[80:83],a[32:35],v[192:195]
s_barrier
dt v[64:65],v16 offset:16384
mm v[192:195],v[84:87],a[48:51],v[192:195]
s_add_u32 s59,s41,8192
bl a[156:159],v2,s[8:11],s59 offen offset:1024 sc1
mm v[196:199],v[80:83],a[36:39],v[196:199]
dt v[66:67],v16 offset:16896
mm v[196:199],v[84:87],a[52:55],v[196:199]
mm v[200:203],v[80:83],a[40:43],v[200:203]
dt v[68:69],v20 offset:16384
mm v[200:203],v[84:87],a[56:59],v[200:203]
mm v[204:207],v[80:83],a[44:47],v[204:207]
dt v[70:71],v20 offset:16896
mm v[204:207],v[84:87],a[60:63],v[204:207]
s_waitcnt lgkmcnt(4)
mm v[208:211],v[88:91],a[32:35],v[208:211]
s_add_u32 m0,s36,0
s_add_u32 s56,s52,4718592
dt v[72:73],v17 offset:16384
mm v[208:211],v[92:95],a[48:51],v[208:211]
bl v24,s[12:15],s56 offen lds
mm v[212:215],v[88:91],a[36:39],v[212:215]
s_add_u32 m0,s36,4096
dt v[74:75],v17 offset:16896
mm v[212:215],v[92:95],a[52:55],v[212:215]
bl v24,s[16:19],s56 offen lds
mm v[216:219],v[88:91],a[40:43],v[216:219]
s_add_u32 s57,s38,8192
dt v[76:77],v21 offset:16384
mm v[216:219],v[92:95],a[56:59],v[216:219]
bl a[160:163],v2,s[8:11],s57 offen offset:2048 sc1
mm v[220:223],v[88:91],a[44:47],v[220:223]
s_add_u32 s58,s39,8192
dt v[78:79],v21 offset:16896
mm v[220:223],v[92:95],a[60:63],v[220:223]
s_waitcnt vmcnt(19) lgkmcnt(4)
bl a[164:167],v2,s[8:11],s58 offen offset:2048 sc1
mm v[96:99],v[64:67],a[64:67],v[96:99]
s_add_u32 s59,s40,8192
dt v[80:81],v16 offset:20480
mm v[96:99],v[68:71],a[80:83],v[96:99]
bl a[168:171],v2,s[8:11],s59 offen offset:2048 sc1
mm v[100:103],v[64:67],a[68:71],v[100:103]
dt v[82:83],v16 offset:20992
mm v[100:103],v[68:71],a[84:87],v[100:103]
mm v[104:107],v[64:67],a[72:75],v[104:107]
s_add_u32 s56,s41,8192
dt v[84:85],v20 offset:20480
mm v[104:107],v[68:71],a[88:91],v[104:107]
bl a[172:175],v2,s[8:11],s56 offen offset:2048 sc1
mm v[108:111],v[64:67],a[76:79],v[108:111]
s_add_u32 m0,s36,65536
s_add_u32 s57,s52,5013504
dt v[86:87],v20 offset:20992
mm v[108:111],v[68:71],a[92:95],v[108:111]
s_waitcnt lgkmcnt(4)
bl v24,s[12:15],s57 offen lds
mm v[112:115],v[72:75],a[64:67],v[112:115]
s_add_u32 m0,s36,69632
dt v[88:89],v17 offset:20480
mm v[112:115],v[76:79],a[80:83],v[112:115]
bl v24,s[16:19],s57 offen lds
mm v[116:119],v[72:75],a[68:71],v[116:119]
s_add_u32 s58,s38,8192
dt v[90:91],v17 offset:20992
mm v[116:119],v[76:79],a[84:87],v[116:119]
bl a[176:179],v2,s[8:11],s58 offen offset:3072 sc1
mm v[120:123],v[72:75],a[72:75],v[120:123]
dt v[92:93],v21 offset:20480
mm v[120:123],v[76:79],a[88:91],v[120:123]
mm v[124:127],v[72:75],a[76:79],v[124:127]
dt v[94:95],v21 offset:20992
mm v[124:127],v[76:79],a[92:95],v[124:127]
s_waitcnt lgkmcnt(4)
mm v[128:131],v[80:83],a[64:67],v[128:131]
s_add_u32 s59,s39,8192
dt v[64:65],v18 offset:16384
mm v[128:131],v[84:87],a[80:83],v[128:131]
bl a[180:183],v2,s[8:11],s59 offen offset:3072 sc1
mm v[132:135],v[80:83],a[68:71],v[132:135]
dt v[66:67],v18 offset:16896
mm v[132:135],v[84:87],a[84:87],v[132:135]
s_add_u32 s56,s40,8192
mm v[136:139],v[80:83],a[72:75],v[136:139]
dt v[68:69],v22 offset:16384
mm v[136:139],v[84:87],a[88:91],v[136:139]
bl a[184:187],v2,s[8:11],s56 offen offset:3072 sc1
mm v[140:143],v[80:83],a[76:79],v[140:143]
dt v[70:71],v22 offset:16896
mm v[140:143],v[84:87],a[92:95],v[140:143]
s_waitcnt lgkmcnt(4)
mm v[144:147],v[88:91],a[64:67],v[144:147]
dt v[72:73],v19 offset:16384
mm v[144:147],v[92:95],a[80:83],v[144:147]
mm v[148:151],v[88:91],a[68:71],v[148:151]
dt v[74:75],v19 offset:16896
mm v[148:151],v[92:95],a[84:87],v[148:151]
mm v[152:155],v[88:91],a[72:75],v[152:155]
s_add_u32 s57,s41,8192
dt v[76:77],v23 offset:16384
mm v[152:155],v[92:95],a[88:91],v[152:155]
bl a[188:191],v2,s[8:11],s57 offen offset:3072 sc1
mm v[156:159],v[88:91],a[76:79],v[156:159]
s_add_u32 s58,s38,12288
dt v[78:79],v23 offset:16896
mm v[156:159],v[92:95],a[92:95],v[156:159]
s_waitcnt lgkmcnt(4)
bl a[192:195],v2,s[8:11],s58 offen offset:0 sc1
mm v[160:163],v[64:67],a[64:67],v[160:163]
s_add_u32 s59,s39,12288
dt v[80:81],v18 offset:20480
mm v[160:163],v[68:71],a[80:83],v[160:163]
mm v[164:167],v[64:67],a[68:71],v[164:167]
dt v[82:83],v18 offset:20992
mm v[164:167],v[68:71],a[84:87],v[164:167]
bl a[196:199],v2,s[8:11],s59 offen offset:0 sc1
mm v[168:171],v[64:67],a[72:75],v[168:171]
dt v[84:85],v22 offset:20480
mm v[168:171],v[68:71],a[88:91],v[168:171]
mm v[172:175],v[64:67],a[76:79],v[172:175]
dt v[86:87],v22 offset:20992
mm v[172:175],v[68:71],a[92:95],v[172:175]
s_waitcnt lgkmcnt(4)
mm v[176:179],v[72:75],a[64:67],v[176:179]
s_add_u32 s56,s40,12288
dt v[88:89],v19 offset:20480
mm v[176:179],v[76:79],a[80:83],v[176:179]
bl a[200:203],v2,s[8:11],s56 offen offset:0 sc1
mm v[180:183],v[72:75],a[68:71],v[180:183]
dt v[90:91],v19 offset:20992
mm v[180:183],v[76:79],a[84:87],v[180:183]
s_add_u32 s57,s41,12288
mm v[184:187],v[72:75],a[72:75],v[184:187]
dt v[92:93],v23 offset:20480
mm v[184:187],v[76:79],a[88:91],v[184:187]
bl a[204:207],v2,s[8:11],s57 offen offset:0 sc1
mm v[188:191],v[72:75],a[76:79],v[188:191]
dt v[94:95],v23 offset:20992
mm v[188:191],v[76:79],a[92:95],v[188:191]
s_waitcnt lgkmcnt(4)
mm v[192:195],v[80:83],a[64:67],v[192:195]
dt v[64:65],v16 offset:24576
mm v[192:195],v[84:87],a[80:83],v[192:195]
mm v[196:199],v[80:83],a[68:71],v[196:199]
dt v[66:67],v16 offset:25088
mm v[196:199],v[84:87],a[84:87],v[196:199]
mm v[200:203],v[80:83],a[72:75],v[200:203]
s_add_u32 s58,s38,12288
dt v[68:69],v20 offset:24576
mm v[200:203],v[84:87],a[88:91],v[200:203]
bl a[208:211],v2,s[8:11],s58 offen offset:1024 sc1
mm v[204:207],v[80:83],a[76:79],v[204:207]
s_add_u32 s59,s39,12288
dt v[70:71],v20 offset:25088
mm v[204:207],v[84:87],a[92:95],v[204:207]
s_waitcnt lgkmcnt(4)
bl a[212:215],v2,s[8:11],s59 offen offset:1024 sc1
mm v[208:211],v[88:91],a[64:67],v[208:211]
s_add_u32 s56,s40,12288
dt v[72:73],v17 offset:24576
mm v[208:211],v[92:95],a[80:83],v[208:211]
mm v[212:215],v[88:91],a[68:71],v[212:215]
dt v[74:75],v17 offset:25088
mm v[212:215],v[92:95],a[84:87],v[212:215]
bl a[216:219],v2,s[8:11],s56 offen offset:1024 sc1
mm v[216:219],v[88:91],a[72:75],v[216:219]
dt v[76:77],v21 offset:24576
mm v[216:219],v[92:95],a[88:91],v[216:219]
mm v[220:223],v[88:91],a[76:79],v[220:223]
dt v[78:79],v21 offset:25088
mm v[220:223],v[92:95],a[92:95],v[220:223]
s_waitcnt vmcnt(27) lgkmcnt(4)
mm v[96:99],v[64:67],a[96:99],v[96:99]
s_add_u32 s57,s41,12288
dt v[80:81],v16 offset:28672
mm v[96:99],v[68:71],a[112:115],v[96:99]
bl a[220:223],v2,s[8:11],s57 offen offset:1024 sc1
mm v[100:103],v[64:67],a[100:103],v[100:103]
dt v[82:83],v16 offset:29184
mm v[100:103],v[68:71],a[116:119],v[100:103]
s_add_u32 s58,s38,12288
mm v[104:107],v[64:67],a[104:107],v[104:107]
dt v[84:85],v20 offset:28672
mm v[104:107],v[68:71],a[120:123],v[104:107]
bl a[224:227],v2,s[8:11],s58 offen offset:2048 sc1
mm v[108:111],v[64:67],a[108:111],v[108:111]
dt v[86:87],v20 offset:29184
mm v[108:111],v[68:71],a[124:127],v[108:111]
s_waitcnt lgkmcnt(4)
mm v[112:115],v[72:75],a[96:99],v[112:115]
dt v[88:89],v17 offset:28672
mm v[112:115],v[76:79],a[112:115],v[112:115]
mm v[116:119],v[72:75],a[100:103],v[116:119]
dt v[90:91],v17 offset:29184
mm v[116:119],v[76:79],a[116:119],v[116:119]
mm v[120:123],v[72:75],a[104:107],v[120:123]
s_add_u32 s59,s39,12288
dt v[92:93],v21 offset:28672
mm v[120:123],v[76:79],a[120:123],v[120:123]
bl a[228:231],v2,s[8:11],s59 offen offset:2048 sc1
mm v[124:127],v[72:75],a[108:111],v[124:127]
dt v[94:95],v21 offset:29184
mm v[124:127],v[76:79],a[124:127],v[124:127]
s_waitcnt lgkmcnt(4)
s_add_u32 s56,s40,12288
mm v[128:131],v[80:83],a[96:99],v[128:131]
dt v[64:65],v18 offset:24576
mm v[128:131],v[84:87],a[112:115],v[128:131]
bl a[232:235],v2,s[8:11],s56 offen offset:2048 sc1
mm v[132:135],v[80:83],a[100:103],v[132:135]
dt v[66:67],v18 offset:25088
mm v[132:135],v[84:87],a[116:119],v[132:135]
mm v[136:139],v[80:83],a[104:107],v[136:139]
dt v[68:69],v22 offset:24576
mm v[136:139],v[84:87],a[120:123],v[136:139]
mm v[140:143],v[80:83],a[108:111],v[140:143]
dt v[70:71],v22 offset:25088
mm v[140:143],v[84:87],a[124:127],v[140:143]
s_waitcnt lgkmcnt(4)
mm v[144:147],v[88:91],a[96:99],v[144:147]
s_add_u32 s57,s41,12288
dt v[72:73],v19 offset:24576
mm v[144:147],v[92:95],a[112:115],v[144:147]
bl a[236:239],v2,s[8:11],s57 offen offset:2048 sc1
mm v[148:151],v[88:91],a[100:103],v[148:151]
s_add_u32 s58,s38,12288
dt v[74:75],v19 offset:25088
mm v[148:151],v[92:95],a[116:119],v[148:151]
bl a[240:243],v2,s[8:11],s58 offen offset:3072 sc1
mm v[152:155],v[88:91],a[104:107],v[152:155]
s_add_u32 s59,s39,12288
dt v[76:77],v23 offset:24576
mm v[152:155],v[92:95],a[120:123],v[152:155]
mm v[156:159],v[88:91],a[108:111],v[156:159]
dt v[78:79],v23 offset:25088
mm v[156:159],v[92:95],a[124:127],v[156:159]
s_waitcnt lgkmcnt(4)
bl a[244:247],v2,s[8:11],s59 offen offset:3072 sc1
mm v[160:163],v[64:67],a[96:99],v[160:163]
dt v[80:81],v18 offset:28672
mm v[160:163],v[68:71],a[112:115],v[160:163]
mm v[164:167],v[64:67],a[100:103],v[164:167]
dt v[82:83],v18 offset:29184
mm v[164:167],v[68:71],a[116:119],v[164:167]
mm v[168:171],v[64:67],a[104:107],v[168:171]
s_add_u32 s56,s40,12288
dt v[84:85],v22 offset:28672
mm v[168:171],v[68:71],a[120:123],v[168:171]
bl a[248:251],v2,s[8:11],s56 offen offset:3072 sc1
mm v[172:175],v[64:67],a[108:111],v[172:175]
dt v[86:87],v22 offset:29184
mm v[172:175],v[68:71],a[124:127],v[172:175]
s_waitcnt lgkmcnt(4)
s_add_u32 s57,s41,12288
mm v[176:179],v[72:75],a[96:99],v[176:179]
dt v[88:89],v19 offset:28672
mm v[176:179],v[76:79],a[112:115],v[176:179]
bl a[252:255],v2,s[8:11],s57 offen offset:3072 sc1
mm v[180:183],v[72:75],a[100:103],v[180:183]
dt v[90:91],v19 offset:29184
mm v[180:183],v[76:79],a[116:119],v[180:183]
mm v[184:187],v[72:75],a[104:107],v[184:187]
dt v[92:93],v23 offset:28672
mm v[184:187],v[76:79],a[120:123],v[184:187]
mm v[188:191],v[72:75],a[108:111],v[188:191]
dt v[94:95],v23 offset:29184
mm v[188:191],v[76:79],a[124:127],v[188:191]
s_waitcnt lgkmcnt(4)
mm v[192:195],v[80:83],a[96:99],v[192:195]
s_barrier
dt v[64:65],v16 offset:32768
mm v[192:195],v[84:87],a[112:115],v[192:195]
s_add_u32 s58,s38,16384
bl v[224:227],v2,s[8:11],s58 offen offset:0 sc1
mm v[196:199],v[80:83],a[100:103],v[196:199]
s_add_u32 s59,s39,16384
dt v[66:67],v16 offset:33280
mm v[196:199],v[84:87],a[116:119],v[196:199]
bl v[228:231],v2,s[8:11],s59 offen offset:0 sc1
mm v[200:203],v[80:83],a[104:107],v[200:203]
dt v[68:69],v20 offset:32768
mm v[200:203],v[84:87],a[120:123],v[200:203]
s_add_u32 s56,s40,16384
mm v[204:207],v[80:83],a[108:111],v[204:207]
dt v[70:71],v20 offset:33280
mm v[204:207],v[84:87],a[124:127],v[204:207]
s_waitcnt lgkmcnt(4)
bl v[232:235],v2,s[8:11],s56 offen offset:0 sc1
mm v[208:211],v[88:91],a[96:99],v[208:211]
dt v[72:73],v17 offset:32768
mm v[208:211],v[92:95],a[112:115],v[208:211]
mm v[212:215],v[88:91],a[100:103],v[212:215]
dt v[74:75],v17 offset:33280
mm v[212:215],v[92:95],a[116:119],v[212:215]
mm v[216:219],v[88:91],a[104:107],v[216:219]
s_add_u32 s57,s41,16384
dt v[76:77],v21 offset:32768
mm v[216:219],v[92:95],a[120:123],v[216:219]
bl v[236:239],v2,s[8:11],s57 offen offset:0 sc1
mm v[220:223],v[88:91],a[108:111],v[220:223]
dt v[78:79],v21 offset:33280
mm v[220:223],v[92:95],a[124:127],v[220:223]
s_waitcnt vmcnt(32) lgkmcnt(4)
s_add_u32 s58,s38,16384
mm v[96:99],v[64:67],a[128:131],v[96:99]
dt v[80:81],v16 offset:36864
mm v[96:99],v[68:71],a[144:147],v[96:99]
bl v[240:243],v2,s[8:11],s58 offen offset:1024 sc1
mm v[100:103],v[64:67],a[132:135],v[100:103]
dt v[82:83],v16 offset:37376
mm v[100:103],v[68:71],a[148:151],v[100:103]
mm v[104:107],v[64:67],a[136:139],v[104:107]
dt v[84:85],v20 offset:36864
mm v[104:107],v[68:71],a[152:155],v[104:107]
mm v[108:111],v[64:67],a[140:143],v[108:111]
dt v[86:87],v20 offset:37376
mm v[108:111],v[68:71],a[156:159],v[108:111]
s_waitcnt lgkmcnt(4)
mm v[112:115],v[72:75],a[128:131],v[112:115]
s_add_u32 s59,s39,16384
dt v[88:89],v17 offset:36864
mm v[112:115],v[76:79],a[144:147],v[112:115]
bl v[244:247],v2,s[8:11],s59 offen offset:1024 sc1
mm v[116:119],v[72:75],a[132:135],v[116:119]
dt v[90:91],v17 offset:37376
mm v[116:119],v[76:79],a[148:151],v[116:119]
s_add_u32 s56,s40,16384
mm v[120:123],v[72:75],a[136:139],v[120:123]
dt v[92:93],v21 offset:36864
mm v[120:123],v[76:79],a[152:155],v[120:123]
bl v[248:251],v2,s[8:11],s56 offen offset:1024 sc1
mm v[124:127],v[72:75],a[140:143],v[124:127]
dt v[94:95],v21 offset:37376
mm v[124:127],v[76:79],a[156:159],v[124:127]
s_waitcnt lgkmcnt(4)
mm v[128:131],v[80:83],a[128:131],v[128:131]
dt v[64:65],v18 offset:32768
mm v[128:131],v[84:87],a[144:147],v[128:131]
mm v[132:135],v[80:83],a[132:135],v[132:135]
dt v[66:67],v18 offset:33280
mm v[132:135],v[84:87],a[148:151],v[132:135]
mm v[136:139],v[80:83],a[136:139],v[136:139]
s_add_u32 s57,s41,16384
dt v[68:69],v22 offset:32768
mm v[136:139],v[84:87],a[152:155],v[136:139]
bl v[252:255],v2,s[8:11],s57 offen offset:1024 sc1
mm v[140:143],v[80:83],a[140:143],v[140:143]
dt v[70:71],v22 offset:33280
mm v[140:143],v[84:87],a[156:159],v[140:143]
s_waitcnt lgkmcnt(4)
mm v[144:147],v[88:91],a[128:131],v[144:147]
dt v[72:73],v19 offset:32768
mm v[144:147],v[92:95],a[144:147],v[144:147]
mm v[148:151],v[88:91],a[132:135],v[148:151]
dt v[74:75],v19 offset:33280
mm v[148:151],v[92:95],a[148:151],v[148:151]
mm v[152:155],v[88:91],a[136:139],v[152:155]
dt v[76:77],v23 offset:32768
mm v[152:155],v[92:95],a[152:155],v[152:155]
mm v[156:159],v[88:91],a[140:143],v[156:159]
dt v[78:79],v23 offset:33280
mm v[156:159],v[92:95],a[156:159],v[156:159]
s_waitcnt lgkmcnt(4)
mm v[160:163],v[64:67],a[128:131],v[160:163]
s_add_u32 m0,s36,8192
s_add_u32 s58,s52,128
dt v[80:81],v18 offset:36864
mm v[160:163],v[68:71],a[144:147],v[160:163]
bl v4,s[12:15],s58 offen lds
mm v[164:167],v[64:67],a[132:135],v[164:167]
dt v[82:83],v18 offset:37376
mm v[164:167],v[68:71],a[148:151],v[164:167]
s_add_u32 m0,s36,12288
mm v[168:171],v[64:67],a[136:139],v[168:171]
dt v[84:85],v22 offset:36864
mm v[168:171],v[68:71],a[152:155],v[168:171]
bl v4,s[16:19],s58 offen lds
mm v[172:175],v[64:67],a[140:143],v[172:175]
dt v[86:87],v22 offset:37376
mm v[172:175],v[68:71],a[156:159],v[172:175]
s_waitcnt lgkmcnt(4)
mm v[176:179],v[72:75],a[128:131],v[176:179]
dt v[88:89],v19 offset:36864
mm v[176:179],v[76:79],a[144:147],v[176:179]
mm v[180:183],v[72:75],a[132:135],v[180:183]
dt v[90:91],v19 offset:37376
mm v[180:183],v[76:79],a[148:151],v[180:183]
mm v[184:187],v[72:75],a[136:139],v[184:187]
dt v[92:93],v23 offset:36864
mm v[184:187],v[76:79],a[152:155],v[184:187]
mm v[188:191],v[72:75],a[140:143],v[188:191]
dt v[94:95],v23 offset:37376
mm v[188:191],v[76:79],a[156:159],v[188:191]
s_waitcnt lgkmcnt(4)
mm v[192:195],v[80:83],a[128:131],v[192:195]
dt v[64:65],v16 offset:40960
mm v[192:195],v[84:87],a[144:147],v[192:195]
mm v[196:199],v[80:83],a[132:135],v[196:199]
dt v[66:67],v16 offset:41472
mm v[196:199],v[84:87],a[148:151],v[196:199]
mm v[200:203],v[80:83],a[136:139],v[200:203]
dt v[68:69],v20 offset:40960
mm v[200:203],v[84:87],a[152:155],v[200:203]
mm v[204:207],v[80:83],a[140:143],v[204:207]
dt v[70:71],v20 offset:41472
mm v[204:207],v[84:87],a[156:159],v[204:207]
s_waitcnt lgkmcnt(4)
mm v[208:211],v[88:91],a[128:131],v[208:211]
s_add_u32 m0,s36,73728
s_add_u32 s59,s52,589952
dt v[72:73],v17 offset:40960
mm v[208:211],v[92:95],a[144:147],v[208:211]
bl v4,s[12:15],s59 offen lds
mm v[212:215],v[88:91],a[132:135],v[212:215]
dt v[74:75],v17 offset:41472
mm v[212:215],v[92:95],a[148:151],v[212:215]
s_add_u32 m0,s36,77824
mm v[216:219],v[88:91],a[136:139],v[216:219]
dt v[76:77],v21 offset:40960
mm v[216:219],v[92:95],a[152:155],v[216:219]
bl v4,s[16:19],s59 offen lds
mm v[220:223],v[88:91],a[140:143],v[220:223]
dt v[78:79],v21 offset:41472
mm v[220:223],v[92:95],a[156:159],v[220:223]
s_waitcnt vmcnt(28) lgkmcnt(4)
mm v[96:99],v[64:67],a[160:163],v[96:99]
dt v[80:81],v16 offset:45056
mm v[96:99],v[68:71],a[176:179],v[96:99]
mm v[100:103],v[64:67],a[164:167],v[100:103]
dt v[82:83],v16 offset:45568
mm v[100:103],v[68:71],a[180:183],v[100:103]
mm v[104:107],v[64:67],a[168:171],v[104:107]
s_add_u32 m0,s36,16384
s_add_u32 s56,s52,1179776
dt v[84:85],v20 offset:45056
mm v[104:107],v[68:71],a[184:187],v[104:107]
bl v4,s[12:15],s56 offen lds
mm v[108:111],v[64:67],a[172:175],v[108:111]
dt v[86:87],v20 offset:45568
mm v[108:111],v[68:71],a[188:191],v[108:111]
s_waitcnt lgkmcnt(4)
s_add_u32 m0,s36,20480
mm v[112:115],v[72:75],a[160:163],v[112:115]
dt v[88:89],v17 offset:45056
mm v[112:115],v[76:79],a[176:179],v[112:115]
bl v4,s[16:19],s56 offen lds
mm v[116:119],v[72:75],a[164:167],v[116:119]
dt v[90:91],v17 offset:45568
mm v[116:119],v[76:79],a[180:183],v[116:119]
mm v[120:123],v[72:75],a[168:171],v[120:123]
dt v[92:93],v21 offset:45056
mm v[120:123],v[76:79],a[184:187],v[120:123]
mm v[124:127],v[72:75],a[172:175],v[124:127]
dt v[94:95],v21 offset:45568
mm v[124:127],v[76:79],a[188:191],v[124:127]
s_waitcnt lgkmcnt(4)
mm v[128:131],v[80:83],a[160:163],v[128:131]
s_barrier
dt v[64:65],v16 offset:49152
mm v[128:131],v[84:87],a[176:179],v[128:131]
mm v[132:135],v[80:83],a[164:167],v[132:135]
dt v[66:67],v16 offset:49664
mm v[132:135],v[84:87],a[180:183],v[132:135]
mm v[136:139],v[80:83],a[168:171],v[136:139]
dt v[68:69],v20 offset:49152
mm v[136:139],v[84:87],a[184:187],v[136:139]
mm v[140:143],v[80:83],a[172:175],v[140:143]
dt v[70:71],v20 offset:49664
mm v[140:143],v[84:87],a[188:191],v[140:143]
s_waitcnt lgkmcnt(4)
mm v[144:147],v[88:91],a[160:163],v[144:147]
dt v[72:73],v17 offset:49152
mm v[144:147],v[92:95],a[176:179],v[144:147]
mm v[148:151],v[88:91],a[164:167],v[148:151]
dt v[74:75],v17 offset:49664
mm v[148:151],v[92:95],a[180:183],v[148:151]
mm v[152:155],v[88:91],a[168:171],v[152:155]
s_add_u32 m0,s36,81920
s_add_u32 s57,s52,1769600
dt v[76:77],v21 offset:49152
mm v[152:155],v[92:95],a[184:187],v[152:155]
bl v4,s[12:15],s57 offen lds
mm v[156:159],v[88:91],a[172:175],v[156:159]
dt v[78:79],v21 offset:49664
mm v[156:159],v[92:95],a[188:191],v[156:159]
s_waitcnt vmcnt(23) lgkmcnt(4)
s_add_u32 m0,s36,86016
mm v[96:99],v[64:67],a[192:195],v[96:99]
dt v[80:81],v16 offset:53248
mm v[96:99],v[68:71],a[208:211],v[96:99]
bl v4,s[16:19],s57 offen lds
mm v[100:103],v[64:67],a[196:199],v[100:103]
dt v[82:83],v16 offset:53760
mm v[100:103],v[68:71],a[212:215],v[100:103]
mm v[104:107],v[64:67],a[200:203],v[104:107]
dt v[84:85],v20 offset:53248
mm v[104:107],v[68:71],a[216:219],v[104:107]
mm v[108:111],v[64:67],a[204:207],v[108:111]
dt v[86:87],v20 offset:53760
mm v[108:111],v[68:71],a[220:223],v[108:111]
s_waitcnt lgkmcnt(4)
mm v[112:115],v[72:75],a[192:195],v[112:115]
dt v[88:89],v17 offset:53248
mm v[112:115],v[76:79],a[208:211],v[112:115]
mm v[116:119],v[72:75],a[196:199],v[116:119]
dt v[90:91],v17 offset:53760
mm v[116:119],v[76:79],a[212:215],v[116:119]
mm v[120:123],v[72:75],a[200:203],v[120:123]
dt v[92:93],v21 offset:53248
mm v[120:123],v[76:79],a[216:219],v[120:123]
mm v[124:127],v[72:75],a[204:207],v[124:127]
dt v[94:95],v21 offset:53760
mm v[124:127],v[76:79],a[220:223],v[124:127]
s_waitcnt lgkmcnt(4)
mm v[128:131],v[80:83],a[192:195],v[128:131]
dt v[64:65],v16 offset:57344
mm v[128:131],v[84:87],a[208:211],v[128:131]
mm v[132:135],v[80:83],a[196:199],v[132:135]
dt v[66:67],v16 offset:57856
mm v[132:135],v[84:87],a[212:215],v[132:135]
mm v[136:139],v[80:83],a[200:203],v[136:139]
s_add_u32 m0,s36,24576
s_add_u32 s58,s52,2359424
dt v[68:69],v20 offset:57344
mm v[136:139],v[84:87],a[216:219],v[136:139]
bl v4,s[12:15],s58 offen lds
mm v[140:143],v[80:83],a[204:207],v[140:143]
dt v[70:71],v20 offset:57856
mm v[140:143],v[84:87],a[220:223],v[140:143]
s_waitcnt lgkmcnt(4)
s_add_u32 m0,s36,28672
mm v[144:147],v[88:91],a[192:195],v[144:147]
dt v[72:73],v17 offset:57344
mm v[144:147],v[92:95],a[208:211],v[144:147]
bl v4,s[16:19],s58 offen lds
mm v[148:151],v[88:91],a[196:199],v[148:151]
dt v[74:75],v17 offset:57856
mm v[148:151],v[92:95],a[212:215],v[148:151]
mm v[152:155],v[88:91],a[200:203],v[152:155]
dt v[76:77],v21 offset:57344
mm v[152:155],v[92:95],a[216:219],v[152:155]
mm v[156:159],v[88:91],a[204:207],v[156:159]
dt v[78:79],v21 offset:57856
mm v[156:159],v[92:95],a[220:223],v[156:159]
s_waitcnt vmcnt(18) lgkmcnt(4)
mm v[96:99],v[64:67],a[224:227],v[96:99]
s_add_u32 m0,s36,90112
s_add_u32 s59,s52,2949248
dt v[80:81],v16 offset:61440
mm v[96:99],v[68:71],a[240:243],v[96:99]
bl v4,s[12:15],s59 offen lds
mm v[100:103],v[64:67],a[228:231],v[100:103]
dt v[82:83],v16 offset:61952
mm v[100:103],v[68:71],a[244:247],v[100:103]
mm v[104:107],v[64:67],a[232:235],v[104:107]
dt v[84:85],v20 offset:61440
mm v[104:107],v[68:71],a[248:251],v[104:107]
s_add_u32 m0,s36,94208
mm v[108:111],v[64:67],a[236:239],v[108:111]
dt v[86:87],v20 offset:61952
mm v[108:111],v[68:71],a[252:255],v[108:111]
s_waitcnt lgkmcnt(4)
bl v4,s[16:19],s59 offen lds
mm v[112:115],v[72:75],a[224:227],v[112:115]
dt v[88:89],v17 offset:61440
mm v[112:115],v[76:79],a[240:243],v[112:115]
mm v[116:119],v[72:75],a[228:231],v[116:119]
dt v[90:91],v17 offset:61952
mm v[116:119],v[76:79],a[244:247],v[116:119]
mm v[120:123],v[72:75],a[232:235],v[120:123]
dt v[92:93],v21 offset:61440
mm v[120:123],v[76:79],a[248:251],v[120:123]
mm v[124:127],v[72:75],a[236:239],v[124:127]
dt v[94:95],v21 offset:61952
mm v[124:127],v[76:79],a[252:255],v[124:127]
s_waitcnt lgkmcnt(4)
mm v[128:131],v[80:83],a[224:227],v[128:131]
s_barrier
dt v[64:65],v16 offset:0
mm v[128:131],v[84:87],a[240:243],v[128:131]
mm v[132:135],v[80:83],a[228:231],v[132:135]
dt v[66:67],v16 offset:512
mm v[132:135],v[84:87],a[244:247],v[132:135]
mm v[136:139],v[80:83],a[232:235],v[136:139]
dt v[68:69],v20 offset:0
mm v[136:139],v[84:87],a[248:251],v[136:139]
mm v[140:143],v[80:83],a[236:239],v[140:143]
dt v[70:71],v20 offset:512
mm v[140:143],v[84:87],a[252:255],v[140:143]
s_waitcnt lgkmcnt(4)
mm v[144:147],v[88:91],a[224:227],v[144:147]
s_add_u32 m0,s36,32768
s_add_u32 s56,s52,3539072
dt v[72:73],v17 offset:0
mm v[144:147],v[92:95],a[240:243],v[144:147]
bl v4,s[12:15],s56 offen lds
mm v[148:151],v[88:91],a[228:231],v[148:151]
dt v[74:75],v17 offset:512
mm v[148:151],v[92:95],a[244:247],v[148:151]
s_add_u32 m0,s36,36864
mm v[152:155],v[88:91],a[232:235],v[152:155]
dt v[76:77],v21 offset:0
mm v[152:155],v[92:95],a[248:251],v[152:155]
bl v4,s[16:19],s56 offen lds
mm v[156:159],v[88:91],a[236:239],v[156:159]
dt v[78:79],v21 offset:512
mm v[156:159],v[92:95],a[252:255],v[156:159]
s_waitcnt vmcnt(14) lgkmcnt(4)
mm v[96:99],v[64:67],v[224:227],v[96:99]
dt v[80:81],v16 offset:4096
mm v[96:99],v[68:71],v[240:243],v[96:99]
mm v[100:103],v[64:67],v[228:231],v[100:103]
dt v[82:83],v16 offset:4608
mm v[100:103],v[68:71],v[244:247],v[100:103]
mm v[104:107],v[64:67],v[232:235],v[104:107]
dt v[84:85],v20 offset:4096
mm v[104:107],v[68:71],v[248:251],v[104:107]
mm v[108:111],v[64:67],v[236:239],v[108:111]
dt v[86:87],v20 offset:4608
mm v[108:111],v[68:71],v[252:255],v[108:111]
s_waitcnt lgkmcnt(4)
mm v[112:115],v[72:75],v[224:227],v[112:115]
dt v[88:89],v17 offset:4096
mm v[112:115],v[76:79],v[240:243],v[112:115]
mm v[116:119],v[72:75],v[228:231],v[116:119]
dt v[90:91],v17 offset:4608
mm v[116:119],v[76:79],v[244:247],v[116:119]
mm v[120:123],v[72:75],v[232:235],v[120:123]
dt v[92:93],v21 offset:4096
mm v[120:123],v[76:79],v[248:251],v[120:123]
mm v[124:127],v[72:75],v[236:239],v[124:127]
dt v[94:95],v21 offset:4608
mm v[124:127],v[76:79],v[252:255],v[124:127]
s_waitcnt lgkmcnt(4)
mm v[128:131],v[80:83],v[224:227],v[128:131]
s_add_u32 m0,s36,98304
s_add_u32 s57,s52,4128896
dt v[64:65],v18 offset:40960
mm v[128:131],v[84:87],v[240:243],v[128:131]
bl v4,s[12:15],s57 offen lds
mm v[132:135],v[80:83],v[228:231],v[132:135]
dt v[66:67],v18 offset:41472
mm v[132:135],v[84:87],v[244:247],v[132:135]
s_add_u32 m0,s36,102400
mm v[136:139],v[80:83],v[232:235],v[136:139]
dt v[68:69],v22 offset:40960
mm v[136:139],v[84:87],v[248:251],v[136:139]
bl v4,s[16:19],s57 offen lds
mm v[140:143],v[80:83],v[236:239],v[140:143]
dt v[70:71],v22 offset:41472
mm v[140:143],v[84:87],v[252:255],v[140:143]
s_waitcnt lgkmcnt(4)
mm v[144:147],v[88:91],v[224:227],v[144:147]
dt v[72:73],v19 offset:40960
mm v[144:147],v[92:95],v[240:243],v[144:147]
mm v[148:151],v[88:91],v[228:231],v[148:151]
dt v[74:75],v19 offset:41472
mm v[148:151],v[92:95],v[244:247],v[148:151]
mm v[152:155],v[88:91],v[232:235],v[152:155]
dt v[76:77],v23 offset:40960
mm v[152:155],v[92:95],v[248:251],v[152:155]
mm v[156:159],v[88:91],v[236:239],v[156:159]
dt v[78:79],v23 offset:41472
mm v[156:159],v[92:95],v[252:255],v[156:159]
s_waitcnt lgkmcnt(4)
mm v[160:163],v[64:67],a[160:163],v[160:163]
dt v[80:81],v18 offset:45056
mm v[160:163],v[68:71],a[176:179],v[160:163]
mm v[164:167],v[64:67],a[164:167],v[164:167]
dt v[82:83],v18 offset:45568
mm v[164:167],v[68:71],a[180:183],v[164:167]
mm v[168:171],v[64:67],a[168:171],v[168:171]
dt v[84:85],v22 offset:45056
mm v[168:171],v[68:71],a[184:187],v[168:171]
mm v[172:175],v[64:67],a[172:175],v[172:175]
dt v[86:87],v22 offset:45568
v_mul_f32 v40,s61,v96
v_mul_f32 v41,s61,v97
mm v[172:175],v[68:71],a[188:191],v[172:175]
s_waitcnt lgkmcnt(4)
v_exp_f32 v40,v40
v_mul_f32 v42,s61,v98
mm v[176:179],v[72:75],a[160:163],v[176:179]
dt v[88:89],v19 offset:45056
v_exp_f32 v41,v41
mm v[176:179],v[76:79],a[176:179],v[176:179]
v_add_f32 v40,1.0,v40
v_mul_f32 v48,v96,v128
v_mul_f32 v43,s61,v99
mm v[180:183],v[72:75],a[164:167],v[180:183]
dt v[90:91],v19 offset:45568
v_exp_f32 v42,v42
mm v[180:183],v[76:79],a[180:183],v[180:183]
v_rcp_f32 v40,v40
v_add_f32 v41,1.0,v41
mm v[184:187],v[72:75],a[168:171],v[184:187]
dt v[92:93],v23 offset:45056
v_mul_f32 v49,v97,v129
v_mul_f32 v44,s61,v112
mm v[184:187],v[76:79],a[184:187],v[184:187]
v_exp_f32 v43,v43
mm v[188:191],v[72:75],a[172:175],v[188:191]
dt v[94:95],v23 offset:45568
v_rcp_f32 v41,v41
mm v[188:191],v[76:79],a[188:191],v[188:191]
s_waitcnt lgkmcnt(4)
v_add_f32 v42,1.0,v42
v_mul_f32 v50,v98,v130
v_mul_f32 v45,s61,v113
mm v[192:195],v[80:83],a[160:163],v[192:195]
dt v[64:65],v18 offset:49152
v_exp_f32 v44,v44
mm v[192:195],v[84:87],a[176:179],v[192:195]
v_rcp_f32 v42,v42
v_add_f32 v43,1.0,v43
mm v[196:199],v[80:83],a[164:167],v[196:199]
dt v[66:67],v18 offset:49664
v_mul_f32 v51,v99,v131
v_mul_f32 v48,v48,v40
mm v[196:199],v[84:87],a[180:183],v[196:199]
v_mul_f32 v46,s61,v114
v_exp_f32 v45,v45
mm v[200:203],v[80:83],a[168:171],v[200:203]
dt v[68:69],v22 offset:49152
v_rcp_f32 v43,v43
mm v[200:203],v[84:87],a[184:187],v[200:203]
v_add_f32 v44,1.0,v44
v_mul_f32 v52,v112,v144
v_mul_f32 v49,v49,v41
mm v[204:207],v[80:83],a[172:175],v[204:207]
dt v[70:71],v22 offset:49664
cv v56,v48,v49
v_mul_f32 v47,s61,v115
mm v[204:207],v[84:87],a[188:191],v[204:207]
s_waitcnt lgkmcnt(4)
v_exp_f32 v46,v46
mm v[208:211],v[88:91],a[160:163],v[208:211]
dt v[72:73],v19 offset:49152
v_rcp_f32 v44,v44
mm v[208:211],v[92:95],a[176:179],v[208:211]
v_add_f32 v45,1.0,v45
v_mul_f32 v53,v113,v145
v_mul_f32 v50,v50,v42
mm v[212:215],v[88:91],a[164:167],v[212:215]
dt v[74:75],v19 offset:49664
v_exp_f32 v47,v47
mm v[212:215],v[92:95],a[180:183],v[212:215]
v_rcp_f32 v45,v45
v_add_f32 v46,1.0,v46
mm v[216:219],v[88:91],a[168:171],v[216:219]
dt v[76:77],v23 offset:49152
v_mul_f32 v54,v114,v146
v_mul_f32 v51,v51,v43
mm v[216:219],v[92:95],a[184:187],v[216:219]
cv v57,v50,v51
v_rcp_f32 v46,v46
mm v[220:223],v[88:91],a[172:175],v[220:223]
dt v[78:79],v23 offset:49664
v_add_f32 v47,1.0,v47
v_mul_f32 v55,v115,v147
mm v[220:223],v[92:95],a[188:191],v[220:223]
s_waitcnt lgkmcnt(4)
v_mul_f32 v52,v52,v44
v_rcp_f32 v47,v47
mm v[160:163],v[64:67],a[192:195],v[160:163]
dt v[80:81],v18 offset:53248
v_mul_f32 v53,v53,v45
cv v58,v52,v53
mm v[160:163],v[68:71],a[208:211],v[160:163]
v_mul_f32 v54,v54,v46
v_mul_f32 v55,v55,v47
cv v59,v54,v55
mm v[164:167],v[64:67],a[196:199],v[164:167]
dt v[82:83],v18 offset:53760
buffer_store_dwordx4 v[56:59],v2,s[8:11],s42 offen offset:0 sc1
mm v[164:167],v[68:71],a[212:215],v[164:167]
v_mul_f32 v40,s61,v100
v_mul_f32 v41,s61,v101
mm v[168:171],v[64:67],a[200:203],v[168:171]
dt v[84:85],v22 offset:53248
v_exp_f32 v40,v40
mm v[168:171],v[68:71],a[216:219],v[168:171]
v_mul_f32 v42,s61,v102
v_exp_f32 v41,v41
mm v[172:175],v[64:67],a[204:207],v[172:175]
dt v[86:87],v22 offset:53760
v_add_f32 v40,1.0,v40
v_mul_f32 v48,v100,v132
mm v[172:175],v[68:71],a[220:223],v[172:175]
s_waitcnt lgkmcnt(4)
v_mul_f32 v43,s61,v103
v_exp_f32 v42,v42
mm v[176:179],v[72:75],a[192:195],v[176:179]
dt v[88:89],v19 offset:53248
v_rcp_f32 v40,v40
mm v[176:179],v[76:79],a[208:211],v[176:179]
v_add_f32 v41,1.0,v41
v_mul_f32 v49,v101,v133
v_mul_f32 v44,s61,v116
mm v[180:183],v[72:75],a[196:199],v[180:183]
dt v[90:91],v19 offset:53760
v_exp_f32 v43,v43
mm v[180:183],v[76:79],a[212:215],v[180:183]
v_rcp_f32 v41,v41
v_add_f32 v42,1.0,v42
mm v[184:187],v[72:75],a[200:203],v[184:187]
dt v[92:93],v23 offset:53248
v_mul_f32 v50,v102,v134
v_mul_f32 v45,s61,v117
mm v[184:187],v[76:79],a[216:219],v[184:187]
v_exp_f32 v44,v44
mm v[188:191],v[72:75],a[204:207],v[188:191]
dt v[94:95],v23 offset:53760
v_rcp_f32 v42,v42
mm v[188:191],v[76:79],a[220:223],v[188:191]
s_waitcnt lgkmcnt(4)
v_add_f32 v43,1.0,v43
v_mul_f32 v51,v103,v135
v_mul_f32 v48,v48,v40
mm v[192:195],v[80:83],a[192:195],v[192:195]
dt v[64:65],v18 offset:57344
v_mul_f32 v46,s61,v118
mm v[192:195],v[84:87],a[208:211],v[192:195]
v_exp_f32 v45,v45
mm v[196:199],v[80:83],a[196:199],v[196:199]
dt v[66:67],v18 offset:57856
v_rcp_f32 v43,v43
mm v[196:199],v[84:87],a[212:215],v[196:199]
v_add_f32 v44,1.0,v44
v_mul_f32 v52,v116,v148
v_mul_f32 v49,v49,v41
mm v[200:203],v[80:83],a[200:203],v[200:203]
dt v[68:69],v22 offset:57344
cv v60,v48,v49
v_mul_f32 v47,s61,v119
mm v[200:203],v[84:87],a[216:219],v[200:203]
v_exp_f32 v46,v46
mm v[204:207],v[80:83],a[204:207],v[204:207]
dt v[70:71],v22 offset:57856
v_rcp_f32 v44,v44
mm v[204:207],v[84:87],a[220:223],v[204:207]
s_waitcnt lgkmcnt(4)
v_add_f32 v45,1.0,v45
v_mul_f32 v53,v117,v149
v_mul_f32 v50,v50,v42
mm v[208:211],v[88:91],a[192:195],v[208:211]
dt v[72:73],v19 offset:57344
v_exp_f32 v47,v47
mm v[208:211],v[92:95],a[208:211],v[208:211]
v_rcp_f32 v45,v45
v_add_f32 v46,1.0,v46
mm v[212:215],v[88:91],a[196:199],v[212:215]
dt v[74:75],v19 offset:57856
v_mul_f32 v54,v118,v150
v_mul_f32 v51,v51,v43
mm v[212:215],v[92:95],a[212:215],v[212:215]
cv v61,v50,v51
v_rcp_f32 v46,v46
mm v[216:219],v[88:91],a[200:203],v[216:219]
dt v[76:77],v23 offset:57344
v_add_f32 v47,1.0,v47
v_mul_f32 v55,v119,v151
mm v[216:219],v[92:95],a[216:219],v[216:219]
v_mul_f32 v52,v52,v44
v_rcp_f32 v47,v47
mm v[220:223],v[88:91],a[204:207],v[220:223]
dt v[78:79],v23 offset:57856
v_mul_f32 v53,v53,v45
cv v62,v52,v53
mm v[220:223],v[92:95],a[220:223],v[220:223]
s_waitcnt lgkmcnt(4)
v_mul_f32 v54,v54,v46
v_mul_f32 v55,v55,v47
cv v63,v54,v55
mm v[160:163],v[64:67],a[224:227],v[160:163]
dt v[80:81],v18 offset:61440
mm v[160:163],v[68:71],a[240:243],v[160:163]
buffer_store_dwordx4 v[60:63],v2,s[8:11],s43 offen offset:0 sc1
v_mul_f32 v40,s61,v104
mm v[164:167],v[64:67],a[228:231],v[164:167]
dt v[82:83],v18 offset:61952
v_mul_f32 v41,s61,v105
mm v[164:167],v[68:71],a[244:247],v[164:167]
v_exp_f32 v40,v40
v_mul_f32 v42,s61,v106
mm v[168:171],v[64:67],a[232:235],v[168:171]
dt v[84:85],v22 offset:61440
v_exp_f32 v41,v41
mm v[168:171],v[68:71],a[248:251],v[168:171]
v_add_f32 v40,1.0,v40
v_mul_f32 v48,v104,v136
v_mul_f32 v43,s61,v107
mm v[172:175],v[64:67],a[236:239],v[172:175]
dt v[86:87],v22 offset:61952
v_exp_f32 v42,v42
mm v[172:175],v[68:71],a[252:255],v[172:175]
s_waitcnt lgkmcnt(4)
v_rcp_f32 v40,v40
v_add_f32 v41,1.0,v41
mm v[176:179],v[72:75],a[224:227],v[176:179]
dt v[88:89],v19 offset:61440
v_mul_f32 v49,v105,v137
v_mul_f32 v44,s61,v120
mm v[176:179],v[76:79],a[240:243],v[176:179]
v_exp_f32 v43,v43
mm v[180:183],v[72:75],a[228:231],v[180:183]
dt v[90:91],v19 offset:61952
v_rcp_f32 v41,v41
mm v[180:183],v[76:79],a[244:247],v[180:183]
v_add_f32 v42,1.0,v42
v_mul_f32 v50,v106,v138
v_mul_f32 v45,s61,v121
mm v[184:187],v[72:75],a[232:235],v[184:187]
dt v[92:93],v23 offset:61440
v_exp_f32 v44,v44
mm v[184:187],v[76:79],a[248:251],v[184:187]
v_rcp_f32 v42,v42
v_add_f32 v43,1.0,v43
mm v[188:191],v[72:75],a[236:239],v[188:191]
dt v[94:95],v23 offset:61952
v_mul_f32 v51,v107,v139
v_mul_f32 v48,v48,v40
mm v[188:191],v[76:79],a[252:255],v[188:191]
s_waitcnt lgkmcnt(4)
v_mul_f32 v46,s61,v122
v_exp_f32 v45,v45
mm v[192:195],v[80:83],a[224:227],v[192:195]
dt v[64:65],v18 offset:0
v_rcp_f32 v43,v43
mm v[192:195],v[84:87],a[240:243],v[192:195]
v_add_f32 v44,1.0,v44
v_mul_f32 v52,v120,v152
v_mul_f32 v49,v49,v41
mm v[196:199],v[80:83],a[228:231],v[196:199]
dt v[66:67],v18 offset:512
cv v56,v48,v49
v_mul_f32 v47,s61,v123
mm v[196:199],v[84:87],a[244:247],v[196:199]
v_exp_f32 v46,v46
mm v[200:203],v[80:83],a[232:235],v[200:203]
dt v[68:69],v22 offset:0
v_rcp_f32 v44,v44
mm v[200:203],v[84:87],a[248:251],v[200:203]
v_add_f32 v45,1.0,v45
v_mul_f32 v53,v121,v153
v_mul_f32 v50,v50,v42
mm v[204:207],v[80:83],a[236:239],v[204:207]
dt v[70:71],v22 offset:512
v_exp_f32 v47,v47
mm v[204:207],v[84:87],a[252:255],v[204:207]
s_waitcnt lgkmcnt(4)
v_rcp_f32 v45,v45
v_add_f32 v46,1.0,v46
mm v[208:211],v[88:91],a[224:227],v[208:211]
dt v[72:73],v19 offset:0
v_mul_f32 v54,v122,v154
v_mul_f32 v51,v51,v43
mm v[208:211],v[92:95],a[240:243],v[208:211]
cv v57,v50,v51
v_rcp_f32 v46,v46
mm v[212:215],v[88:91],a[228:231],v[212:215]
dt v[74:75],v19 offset:512
v_add_f32 v47,1.0,v47
v_mul_f32 v55,v123,v155
mm v[212:215],v[92:95],a[244:247],v[212:215]
v_mul_f32 v52,v52,v44
v_rcp_f32 v47,v47
mm v[216:219],v[88:91],a[232:235],v[216:219]
dt v[76:77],v23 offset:0
v_mul_f32 v53,v53,v45
cv v58,v52,v53
mm v[216:219],v[92:95],a[248:251],v[216:219]
v_mul_f32 v54,v54,v46
v_mul_f32 v55,v55,v47
cv v59,v54,v55
mm v[220:223],v[88:91],a[236:239],v[220:223]
dt v[78:79],v23 offset:512
mm v[220:223],v[92:95],a[252:255],v[220:223]
s_waitcnt lgkmcnt(4)
buffer_store_dwordx4 v[56:59],v2,s[8:11],s44 offen offset:0 sc1
v_mul_f32 v40,s61,v108
mm v[160:163],v[64:67],v[224:227],v[160:163]
dt v[80:81],v18 offset:4096
v_mul_f32 v41,s61,v109
mm v[160:163],v[68:71],v[240:243],v[160:163]
v_exp_f32 v40,v40
v_mul_f32 v42,s61,v110
mm v[164:167],v[64:67],v[228:231],v[164:167]
dt v[82:83],v18 offset:4608
v_exp_f32 v41,v41
mm v[164:167],v[68:71],v[244:247],v[164:167]
v_add_f32 v40,1.0,v40
v_mul_f32 v48,v108,v140
v_mul_f32 v43,s61,v111
mm v[168:171],v[64:67],v[232:235],v[168:171]
dt v[84:85],v22 offset:4096
v_exp_f32 v42,v42
mm v[168:171],v[68:71],v[248:251],v[168:171]
v_rcp_f32 v40,v40
v_add_f32 v41,1.0,v41
mm v[172:175],v[64:67],v[236:239],v[172:175]
dt v[86:87],v22 offset:4608
v_mul_f32 v49,v109,v141
v_mul_f32 v44,s61,v124
mm v[172:175],v[68:71],v[252:255],v[172:175]
s_waitcnt lgkmcnt(4)
v_exp_f32 v43,v43
mm v[176:179],v[72:75],v[224:227],v[176:179]
dt v[88:89],v19 offset:4096
v_rcp_f32 v41,v41
mm v[176:179],v[76:79],v[240:243],v[176:179]
v_add_f32 v42,1.0,v42
v_mul_f32 v50,v110,v142
v_mul_f32 v45,s61,v125
mm v[180:183],v[72:75],v[228:231],v[180:183]
dt v[90:91],v19 offset:4608
v_exp_f32 v44,v44
mm v[180:183],v[76:79],v[244:247],v[180:183]
v_rcp_f32 v42,v42
v_add_f32 v43,1.0,v43
mm v[184:187],v[72:75],v[232:235],v[184:187]
dt v[92:93],v23 offset:4096
v_mul_f32 v51,v111,v143
v_mul_f32 v48,v48,v40
mm v[184:187],v[76:79],v[248:251],v[184:187]
v_mul_f32 v46,s61,v126
v_exp_f32 v45,v45
mm v[188:191],v[72:75],v[236:239],v[188:191]
dt v[94:95],v23 offset:4608
v_rcp_f32 v43,v43
mm v[188:191],v[76:79],v[252:255],v[188:191]
s_waitcnt lgkmcnt(4)
s_waitcnt vmcnt(11)
v_add_f32 v44,1.0,v44
v_mul_f32 v52,v124,v156
mm v[192:195],v[80:83],v[224:227],v[192:195]
s_barrier
dt v[64:65],v8 offset:8192
v_mul_f32 v49,v49,v41
cv v60,v48,v49
mm v[192:195],v[84:87],v[240:243],v[192:195]
s_add_u32 m0,s36,40960
s_add_u32 s58,s52,4718720
v_mul_f32 v47,s61,v127
mm v[196:199],v[80:83],v[228:231],v[196:199]
dt v[66:67],v8 offset:8448
v_exp_f32 v46,v46
mm v[196:199],v[84:87],v[244:247],v[196:199]
bl v4,s[12:15],s58 offen lds
mm v[200:203],v[80:83],v[232:235],v[200:203]
s_add_u32 m0,s36,45056
dt v[68:69],v8 offset:10240
v_rcp_f32 v44,v44
mm v[200:203],v[84:87],v[248:251],v[200:203]
bl v4,s[16:19],s58 offen lds
v_add_f32 v45,1.0,v45
mm v[204:207],v[80:83],v[236:239],v[204:207]
s_add_u32 m0,s36,106496
s_add_u32 s59,s52,192
dt v[70:71],v8 offset:10496
v_mul_f32 v53,v125,v157
mm v[204:207],v[84:87],v[252:255],v[204:207]
s_waitcnt lgkmcnt(4)
bl v4,s[12:15],s59 offen lds
v_mul_f32 v50,v50,v42
mm v[208:211],v[88:91],v[224:227],v[208:211]
s_add_u32 m0,s36,110592
dt v[72:73],v9 offset:8192
v_exp_f32 v47,v47
mm v[208:211],v[92:95],v[240:243],v[208:211]
v_rcp_f32 v45,v45
v_add_f32 v46,1.0,v46
mm v[212:215],v[88:91],v[228:231],v[212:215]
dt v[74:75],v9 offset:8448
v_mul_f32 v54,v126,v158
v_mul_f32 v51,v51,v43
cv v61,v50,v51
v_rcp_f32 v46,v46
v_add_f32 v47,1.0,v47
v_mul_f32 v55,v127,v159
v_mul_f32 v52,v52,v44
v_rcp_f32 v47,v47
v_mul_f32 v53,v53,v45
cv v62,v52,v53
v_mul_f32 v54,v54,v46
v_mul_f32 v55,v55,v47
cv v63,v54,v55
mm v[212:215],v[92:95],v[244:247],v[212:215]
bl v4,s[16:19],s59 offen lds
buffer_store_dwordx4 v[60:63],v2,s[8:11],s45 offen offset:0 sc1
mm v[216:219],v[88:91],v[232:235],v[216:219]
dt v[76:77],v9 offset:10240
mm v[216:219],v[92:95],v[248:251],v[216:219]
mm v[220:223],v[88:91],v[236:239],v[220:223]
dt v[78:79],v9 offset:10496
mm v[220:223],v[92:95],v[252:255],v[220:223]
s_waitcnt lgkmcnt(4)
s_cmp_lg_u32 s72,0
s_cbranch_scc1 L_role_g
mm v[96:99],v[64:67],a[0:3],0
s_add_u32 m0,s36,49152
s_add_u32 s56,s52,590016
dt v[80:81],v8 offset:12288
mm v[96:99],v[68:71],a[16:19],v[96:99]
bl v4,s[12:15],s56 offen lds
mm v[100:103],v[64:67],a[4:7],0
dt v[82:83],v8 offset:12544
mm v[100:103],v[68:71],a[20:23],v[100:103]
mm v[104:107],v[64:67],a[8:11],0
dt v[84:85],v8 offset:14336
mm v[104:107],v[68:71],a[24:27],v[104:107]
mm v[108:111],v[64:67],a[12:15],0
dt v[86:87],v8 offset:14592
v_mul_f32 v40,s61,v160
mm v[108:111],v[68:71],a[28:31],v[108:111]
s_waitcnt lgkmcnt(4)
v_mul_f32 v41,s61,v161
mm v[112:115],v[72:75],a[0:3],0
dt v[88:89],v9 offset:12288
mm v[112:115],v[76:79],a[16:19],v[112:115]
v_exp_f32 v40,v40
mm v[116:119],v[72:75],a[4:7],0
s_add_u32 m0,s36,53248
dt v[90:91],v9 offset:12544
v_mul_f32 v42,s61,v162
mm v[116:119],v[76:79],a[20:23],v[116:119]
v_exp_f32 v41,v41
mm v[120:123],v[72:75],a[8:11],0
dt v[92:93],v9 offset:14336
v_add_f32 v40,1.0,v40
mm v[120:123],v[76:79],a[24:27],v[120:123]
bl v4,s[16:19],s56 offen lds
mm v[124:127],v[72:75],a[12:15],0
dt v[94:95],v9 offset:14592
v_mul_f32 v48,v160,v192
mm v[124:127],v[76:79],a[28:31],v[124:127]
s_waitcnt lgkmcnt(4)
v_mul_f32 v43,s61,v163
mm v[128:131],v[80:83],a[0:3],0
dt v[64:65],v10 offset:8192
mm v[128:131],v[84:87],a[16:19],v[128:131]
v_exp_f32 v42,v42
mm v[132:135],v[80:83],a[4:7],0
dt v[66:67],v10 offset:8448
mm v[132:135],v[84:87],a[20:23],v[132:135]
v_rcp_f32 v40,v40
mm v[136:139],v[80:83],a[8:11],0
dt v[68:69],v10 offset:10240
v_add_f32 v41,1.0,v41
mm v[136:139],v[84:87],a[24:27],v[136:139]
v_mul_f32 v49,v161,v193
v_mul_f32 v44,s61,v176
mm v[140:143],v[80:83],a[12:15],0
s_add_u32 m0,s36,114688
s_add_u32 s57,s52,1179840
dt v[70:71],v10 offset:10496
mm v[140:143],v[84:87],a[28:31],v[140:143]
s_waitcnt lgkmcnt(4)
v_exp_f32 v43,v43
mm v[144:147],v[88:91],a[0:3],0
dt v[72:73],v11 offset:8192
mm v[144:147],v[92:95],a[16:19],v[144:147]
bl v4,s[12:15],s57 offen lds
mm v[148:151],v[88:91],a[4:7],0
dt v[74:75],v11 offset:8448
mm v[148:151],v[92:95],a[20:23],v[148:151]
v_rcp_f32 v41,v41
mm v[152:155],v[88:91],a[8:11],0
dt v[76:77],v11 offset:10240
v_add_f32 v42,1.0,v42
mm v[152:155],v[92:95],a[24:27],v[152:155]
v_mul_f32 v50,v162,v194
v_mul_f32 v45,s61,v177
mm v[156:159],v[88:91],a[12:15],0
dt v[78:79],v11 offset:10496
mm v[156:159],v[92:95],a[28:31],v[156:159]
s_waitcnt lgkmcnt(4)
v_exp_f32 v44,v44
mm v[96:99],v[64:67],a[32:35],v[96:99]
dt v[80:81],v10 offset:12288
mm v[96:99],v[68:71],a[48:51],v[96:99]
v_rcp_f32 v42,v42
mm v[100:103],v[64:67],a[36:39],v[100:103]
dt v[82:83],v10 offset:12544
v_add_f32 v43,1.0,v43
mm v[100:103],v[68:71],a[52:55],v[100:103]
s_add_u32 m0,s36,118784
v_mul_f32 v51,v163,v195
v_mul_f32 v48,v48,v40
mm v[104:107],v[64:67],a[40:43],v[104:107]
dt v[84:85],v10 offset:14336
v_mul_f32 v46,s61,v178
mm v[104:107],v[68:71],a[56:59],v[104:107]
bl v4,s[16:19],s57 offen lds
mm v[108:111],v[64:67],a[44:47],v[108:111]
dt v[86:87],v10 offset:14592
mm v[108:111],v[68:71],a[60:63],v[108:111]
s_waitcnt lgkmcnt(4)
v_exp_f32 v45,v45
mm v[112:115],v[72:75],a[32:35],v[112:115]
dt v[88:89],v11 offset:12288
v_lshrrev_b32 v32,4,v2
mm v[112:115],v[76:79],a[48:51],v[112:115]
v_rcp_f32 v43,v43
mm v[116:119],v[72:75],a[36:39],v[116:119]
dt v[90:91],v11 offset:12544
v_add_f32 v44,1.0,v44
mm v[116:119],v[76:79],a[52:55],v[116:119]
v_mul_f32 v52,v176,v208
v_mul_f32 v49,v49,v41
mm v[120:123],v[72:75],a[40:43],v[120:123]
dt v[92:93],v11 offset:14336
cv v56,v48,v49
mm v[120:123],v[76:79],a[56:59],v[120:123]
v_mul_f32 v47,s61,v179
v_lshrrev_b32 v33,4,v32
mm v[124:127],v[72:75],a[44:47],v[124:127]
dt v[94:95],v11 offset:14592
v_lshrrev_b32 v39,8,v7
mm v[124:127],v[76:79],a[60:63],v[124:127]
s_waitcnt lgkmcnt(4)
s_add_u32 m0,s36,57344
s_add_u32 s58,s52,1769664
mm v[128:131],v[80:83],a[32:35],v[128:131]
dt v[64:65],v8 offset:16384
v_bfe_u32 v39,v39,4,2
mm v[128:131],v[84:87],a[48:51],v[128:131]
bl v4,s[12:15],s58 offen lds
mm v[132:135],v[80:83],a[36:39],v[132:135]
dt v[66:67],v8 offset:16640
mm v[132:135],v[84:87],a[52:55],v[132:135]
v_exp_f32 v46,v46
mm v[136:139],v[80:83],a[40:43],v[136:139]
dt v[68:69],v8 offset:18432
v_lshl_add_u32 v33,v39,3,v33
mm v[136:139],v[84:87],a[56:59],v[136:139]
v_rcp_f32 v44,v44
mm v[140:143],v[80:83],a[44:47],v[140:143]
dt v[70:71],v8 offset:18688
v_add_f32 v45,1.0,v45
mm v[140:143],v[84:87],a[60:63],v[140:143]
s_waitcnt lgkmcnt(4)
v_mul_f32 v53,v177,v209
v_mul_f32 v50,v50,v42
mm v[144:147],v[88:91],a[32:35],v[144:147]
dt v[72:73],v9 offset:16384
v_and_b32 v34,15,v32
mm v[144:147],v[92:95],a[48:51],v[144:147]
v_exp_f32 v47,v47
mm v[148:151],v[88:91],a[36:39],v[148:151]
dt v[74:75],v9 offset:16640
v_xor_b32 v35,v34,v33
mm v[148:151],v[92:95],a[52:55],v[148:151]
s_add_u32 m0,s36,61440
v_rcp_f32 v45,v45
mm v[152:155],v[88:91],a[40:43],v[152:155]
dt v[76:77],v9 offset:18432
v_add_f32 v46,1.0,v46
mm v[152:155],v[92:95],a[56:59],v[152:155]
bl v4,s[16:19],s58 offen lds
mm v[156:159],v[88:91],a[44:47],v[156:159]
dt v[78:79],v9 offset:18688
v_mul_f32 v54,v178,v210
mm v[156:159],v[92:95],a[60:63],v[156:159]
s_waitcnt lgkmcnt(4)
v_mul_f32 v51,v51,v43
cv v57,v50,v51
mm v[96:99],v[64:67],a[64:67],v[96:99]
dt v[80:81],v8 offset:20480
v_and_b32 v35,15,v35
mm v[96:99],v[68:71],a[80:83],v[96:99]
v_rcp_f32 v46,v46
mm v[100:103],v[64:67],a[68:71],v[100:103]
dt v[82:83],v8 offset:20736
v_add_f32 v47,1.0,v47
mm v[100:103],v[68:71],a[84:87],v[100:103]
v_mul_f32 v55,v179,v211
v_mul_f32 v52,v52,v44
mm v[104:107],v[64:67],a[72:75],v[104:107]
dt v[84:85],v8 offset:22528
mm v[104:107],v[68:71],a[88:91],v[104:107]
v_rcp_f32 v47,v47
mm v[108:111],v[64:67],a[76:79],v[108:111]
dt v[86:87],v8 offset:22784
v_mul_f32 v53,v53,v45
mm v[108:111],v[68:71],a[92:95],v[108:111]
s_waitcnt lgkmcnt(4)
s_add_u32 m0,s36,122880
s_add_u32 s59,s52,2359488
mm v[112:115],v[72:75],a[64:67],v[112:115]
dt v[88:89],v9 offset:20480
cv v58,v52,v53
mm v[112:115],v[76:79],a[80:83],v[112:115]
bl v4,s[12:15],s59 offen lds
mm v[116:119],v[72:75],a[68:71],v[116:119]
dt v[90:91],v9 offset:20736
v_mul_f32 v54,v54,v46
mm v[116:119],v[76:79],a[84:87],v[116:119]
v_mul_f32 v55,v55,v47
cv v59,v54,v55
mm v[120:123],v[72:75],a[72:75],v[120:123]
dt v[92:93],v9 offset:22528
v_lshlrev_b32 v35,4,v35
mm v[120:123],v[76:79],a[88:91],v[120:123]
buffer_store_dwordx4 v[56:59],v2,s[8:11],s42 offen offset:1024 sc1
mm v[124:127],v[72:75],a[76:79],v[124:127]
dt v[94:95],v9 offset:22784
v_mul_f32 v40,s61,v164
mm v[124:127],v[76:79],a[92:95],v[124:127]
s_waitcnt lgkmcnt(4)
v_mul_f32 v41,s61,v165
v_lshl_add_u32 v16,v33,8,v35
mm v[128:131],v[80:83],a[64:67],v[128:131]
dt v[64:65],v10 offset:16384
v_lshrrev_b32 v35,1,v34
mm v[128:131],v[84:87],a[80:83],v[128:131]
v_exp_f32 v40,v40
mm v[132:135],v[80:83],a[68:71],v[132:135]
dt v[66:67],v10 offset:16640
v_mul_f32 v42,s61,v166
mm v[132:135],v[84:87],a[84:87],v[132:135]
v_exp_f32 v41,v41
mm v[136:139],v[80:83],a[72:75],v[136:139]
s_add_u32 m0,s36,126976
dt v[68:69],v10 offset:18432
v_add_f32 v40,1.0,v40
mm v[136:139],v[84:87],a[88:91],v[136:139]
v_mul_f32 v48,v164,v196
v_mul_f32 v43,s61,v167
mm v[140:143],v[80:83],a[76:79],v[140:143]
dt v[70:71],v10 offset:18688
mm v[140:143],v[84:87],a[92:95],v[140:143]
s_waitcnt lgkmcnt(4)
bl v4,s[16:19],s59 offen lds
mm v[144:147],v[88:91],a[64:67],v[144:147]
dt v[72:73],v11 offset:16384
v_xor_b32 v35,v35,v33
mm v[144:147],v[92:95],a[80:83],v[144:147]
v_exp_f32 v42,v42
mm v[148:151],v[88:91],a[68:71],v[148:151]
dt v[74:75],v11 offset:16640
v_and_b32 v35,7,v35
mm v[148:151],v[92:95],a[84:87],v[148:151]
v_rcp_f32 v40,v40
mm v[152:155],v[88:91],a[72:75],v[152:155]
dt v[76:77],v11 offset:18432
v_add_f32 v41,1.0,v41
mm v[152:155],v[92:95],a[88:91],v[152:155]
v_mul_f32 v49,v165,v197
v_mul_f32 v44,s61,v180
mm v[156:159],v[88:91],a[76:79],v[156:159]
dt v[78:79],v11 offset:18688
v_lshlrev_b32 v35,5,v35
mm v[156:159],v[92:95],a[92:95],v[156:159]
s_waitcnt lgkmcnt(4)
v_exp_f32 v43,v43
mm v[96:99],v[64:67],a[96:99],v[96:99]
s_getpc_b64 s[0:1]
L_cpf1:
s_add_u32 s100,s47,4096
s_min_u32 s100,s100,L_mid-1024-L_cpf1
s_add_u32 s0,s0,s100
s_addc_u32 s1,s1,0
dt v[80:81],v10 offset:20480
v_and_b32 v36,1,v34
mm v[96:99],v[68:71],a[112:115],v[96:99]
v_rcp_f32 v41,v41
mm v[100:103],v[64:67],a[100:103],v[100:103]
dt v[82:83],v10 offset:20736
v_add_f32 v42,1.0,v42
mm v[100:103],v[68:71],a[116:119],v[100:103]
global_load_dword v0,v3,s[0:1]
mm v[104:107],v[64:67],a[104:107],v[104:107]
dt v[84:85],v10 offset:22528
v_mul_f32 v50,v166,v198
mm v[104:107],v[68:71],a[120:123],v[104:107]
v_mul_f32 v45,s61,v181
mm v[108:111],v[64:67],a[108:111],v[108:111]
dt v[86:87],v10 offset:22784
v_lshl_add_u32 v35,v36,4,v35
mm v[108:111],v[68:71],a[124:127],v[108:111]
s_waitcnt lgkmcnt(4)
v_exp_f32 v44,v44
mm v[112:115],v[72:75],a[96:99],v[112:115]
dt v[88:89],v11 offset:20480
v_lshl_add_u32 v18,v33,8,v35
mm v[112:115],v[76:79],a[112:115],v[112:115]
v_rcp_f32 v42,v42
mm v[116:119],v[72:75],a[100:103],v[116:119]
dt v[90:91],v11 offset:20736
v_add_f32 v43,1.0,v43
mm v[116:119],v[76:79],a[116:119],v[116:119]
v_mul_f32 v51,v167,v199
v_mul_f32 v48,v48,v40
mm v[120:123],v[72:75],a[104:107],v[120:123]
dt v[92:93],v11 offset:22528
v_mul_f32 v46,s61,v182
mm v[120:123],v[76:79],a[120:123],v[120:123]
v_exp_f32 v45,v45
v_rcp_f32 v43,v43
mm v[124:127],v[72:75],a[108:111],v[124:127]
dt v[94:95],v11 offset:22784
v_add_f32 v44,1.0,v44
mm v[124:127],v[76:79],a[124:127],v[124:127]
s_waitcnt lgkmcnt(4)
s_waitcnt vmcnt(18)
v_add_u32 v33,4,v33
mm v[128:131],v[80:83],a[96:99],v[128:131]
s_barrier
dt v[64:65],v8 offset:24576
v_mul_f32 v52,v180,v212
mm v[128:131],v[84:87],a[112:115],v[128:131]
s_add_u32 m0,s36,0
s_add_u32 s56,s52,2949312
v_mul_f32 v49,v49,v41
mm v[132:135],v[80:83],a[100:103],v[132:135]
dt v[66:67],v8 offset:24832
cv v60,v48,v49
mm v[132:135],v[84:87],a[116:119],v[132:135]
bl v4,s[12:15],s56 offen lds
mm v[136:139],v[80:83],a[104:107],v[136:139]
dt v[68:69],v8 offset:26624
mm v[136:139],v[84:87],a[120:123],v[136:139]
v_mul_f32 v47,s61,v183
v_xor_b32 v35,v34,v33
mm v[140:143],v[80:83],a[108:111],v[140:143]
dt v[70:71],v8 offset:26880
v_and_b32 v35,15,v35
mm v[140:143],v[84:87],a[124:127],v[140:143]
s_waitcnt lgkmcnt(4)
v_exp_f32 v46,v46
mm v[144:147],v[88:91],a[96:99],v[144:147]
dt v[72:73],v9 offset:24576
v_lshlrev_b32 v35,4,v35
mm v[144:147],v[92:95],a[112:115],v[144:147]
v_rcp_f32 v44,v44
mm v[148:151],v[88:91],a[100:103],v[148:151]
dt v[74:75],v9 offset:24832
v_add_f32 v45,1.0,v45
mm v[148:151],v[92:95],a[116:119],v[148:151]
s_add_u32 m0,s36,4096
v_mul_f32 v53,v181,v213
v_mul_f32 v50,v50,v42
mm v[152:155],v[88:91],a[104:107],v[152:155]
dt v[76:77],v9 offset:26624
v_lshl_add_u32 v17,v33,8,v35
mm v[152:155],v[92:95],a[120:123],v[152:155]
bl v4,s[16:19],s56 offen lds
mm v[156:159],v[88:91],a[108:111],v[156:159]
dt v[78:79],v9 offset:26880
mm v[156:159],v[92:95],a[124:127],v[156:159]
s_waitcnt lgkmcnt(4)
v_exp_f32 v47,v47
mm v[96:99],v[64:67],a[128:131],v[96:99]
dt v[80:81],v8 offset:28672
v_lshrrev_b32 v35,1,v34
mm v[96:99],v[68:71],a[144:147],v[96:99]
v_rcp_f32 v45,v45
mm v[100:103],v[64:67],a[132:135],v[100:103]
dt v[82:83],v8 offset:28928
v_add_f32 v46,1.0,v46
mm v[100:103],v[68:71],a[148:151],v[100:103]
v_mul_f32 v54,v182,v214
v_mul_f32 v51,v51,v43
mm v[104:107],v[64:67],a[136:139],v[104:107]
dt v[84:85],v8 offset:30720
cv v61,v50,v51
mm v[104:107],v[68:71],a[152:155],v[104:107]
v_rcp_f32 v46,v46
mm v[108:111],v[64:67],a[140:143],v[108:111]
dt v[86:87],v8 offset:30976
v_add_f32 v47,1.0,v47
mm v[108:111],v[68:71],a[156:159],v[108:111]
s_waitcnt lgkmcnt(4)
s_add_u32 m0,s36,65536
s_add_u32 s57,s52,3539136
mm v[112:115],v[72:75],a[128:131],v[112:115]
dt v[88:89],v9 offset:28672
v_mul_f32 v55,v183,v215
mm v[112:115],v[76:79],a[144:147],v[112:115]
bl v4,s[12:15],s57 offen lds
mm v[116:119],v[72:75],a[132:135],v[116:119]
dt v[90:91],v9 offset:28928
v_mul_f32 v52,v52,v44
mm v[116:119],v[76:79],a[148:151],v[116:119]
v_rcp_f32 v47,v47
mm v[120:123],v[72:75],a[136:139],v[120:123]
dt v[92:93],v9 offset:30720
v_mul_f32 v53,v53,v45
mm v[120:123],v[76:79],a[152:155],v[120:123]
cv v62,v52,v53
v_xor_b32 v35,v35,v33
mm v[124:127],v[72:75],a[140:143],v[124:127]
dt v[94:95],v9 offset:30976
v_mul_f32 v54,v54,v46
mm v[124:127],v[76:79],a[156:159],v[124:127]
s_waitcnt lgkmcnt(4)
v_mul_f32 v55,v55,v47
cv v63,v54,v55
mm v[128:131],v[80:83],a[128:131],v[128:131]
dt v[64:65],v10 offset:24576
v_and_b32 v35,7,v35
mm v[128:131],v[84:87],a[144:147],v[128:131]
buffer_store_dwordx4 v[60:63],v2,s[8:11],s43 offen offset:1024 sc1
mm v[132:135],v[80:83],a[132:135],v[132:135]
dt v[66:67],v10 offset:24832
v_mul_f32 v40,s61,v168
mm v[132:135],v[84:87],a[148:151],v[132:135]
v_mul_f32 v41,s61,v169
mm v[136:139],v[80:83],a[136:139],v[136:139]
s_add_u32 m0,s36,69632
dt v[68:69],v10 offset:26624
v_lshlrev_b32 v35,5,v35
mm v[136:139],v[84:87],a[152:155],v[136:139]
v_exp_f32 v40,v40
mm v[140:143],v[80:83],a[140:143],v[140:143]
dt v[70:71],v10 offset:26880
v_mul_f32 v42,s61,v170
mm v[140:143],v[84:87],a[156:159],v[140:143]
s_waitcnt lgkmcnt(4)
bl v4,s[16:19],s57 offen lds
mm v[144:147],v[88:91],a[128:131],v[144:147]
dt v[72:73],v11 offset:24576
v_and_b32 v36,1,v34
mm v[144:147],v[92:95],a[144:147],v[144:147]
v_exp_f32 v41,v41
mm v[148:151],v[88:91],a[132:135],v[148:151]
dt v[74:75],v11 offset:24832
v_add_f32 v40,1.0,v40
mm v[148:151],v[92:95],a[148:151],v[148:151]
v_mul_f32 v48,v168,v200
v_mul_f32 v43,s61,v171
mm v[152:155],v[88:91],a[136:139],v[152:155]
dt v[76:77],v11 offset:26624
v_lshl_add_u32 v35,v36,4,v35
mm v[152:155],v[92:95],a[152:155],v[152:155]
v_exp_f32 v42,v42
mm v[156:159],v[88:91],a[140:143],v[156:159]
dt v[78:79],v11 offset:26880
v_lshl_add_u32 v19,v33,8,v35
mm v[156:159],v[92:95],a[156:159],v[156:159]
s_waitcnt lgkmcnt(4)
v_rcp_f32 v40,v40
mm v[96:99],v[64:67],a[160:163],v[96:99]
dt v[80:81],v10 offset:28672
v_add_f32 v41,1.0,v41
mm v[96:99],v[68:71],a[176:179],v[96:99]
s_add_u32 m0,s36,8192
s_add_u32 s58,s52,4128960
v_mul_f32 v49,v169,v201
mm v[100:103],v[64:67],a[164:167],v[100:103]
dt v[82:83],v10 offset:28928
v_mul_f32 v44,s61,v184
mm v[100:103],v[68:71],a[180:183],v[100:103]
bl v4,s[12:15],s58 offen lds
mm v[104:107],v[64:67],a[168:171],v[104:107]
dt v[84:85],v10 offset:30720
mm v[104:107],v[68:71],a[184:187],v[104:107]
v_exp_f32 v43,v43
mm v[108:111],v[64:67],a[172:175],v[108:111]
dt v[86:87],v10 offset:30976
v_lshrrev_b32 v33,4,v32
mm v[108:111],v[68:71],a[188:191],v[108:111]
s_waitcnt lgkmcnt(4)
v_rcp_f32 v41,v41
mm v[112:115],v[72:75],a[160:163],v[112:115]
dt v[88:89],v11 offset:28672
v_add_f32 v42,1.0,v42
mm v[112:115],v[76:79],a[176:179],v[112:115]
v_mul_f32 v50,v170,v202
v_mul_f32 v45,s61,v185
mm v[116:119],v[72:75],a[164:167],v[116:119]
dt v[90:91],v11 offset:28928
v_bfe_u32 v34,v32,2,2
mm v[116:119],v[76:79],a[180:183],v[116:119]
v_exp_f32 v44,v44
mm v[120:123],v[72:75],a[168:171],v[120:123]
dt v[92:93],v11 offset:30720
v_and_b32 v35,3,v32
mm v[120:123],v[76:79],a[184:187],v[120:123]
s_add_u32 m0,s36,12288
v_rcp_f32 v42,v42
mm v[124:127],v[72:75],a[172:175],v[124:127]
dt v[94:95],v11 offset:30976
v_add_f32 v43,1.0,v43
mm v[124:127],v[76:79],a[188:191],v[124:127]
s_waitcnt lgkmcnt(4)
bl v4,s[16:19],s58 offen lds
mm v[128:131],v[80:83],a[160:163],v[128:131]
dt v[64:65],v8 offset:32768
v_mul_f32 v51,v171,v203
mm v[128:131],v[84:87],a[176:179],v[128:131]
v_mul_f32 v48,v48,v40
v_mul_f32 v46,s61,v186
mm v[132:135],v[80:83],a[164:167],v[132:135]
dt v[66:67],v8 offset:33024
mm v[132:135],v[84:87],a[180:183],v[132:135]
v_exp_f32 v45,v45
mm v[136:139],v[80:83],a[168:171],v[136:139]
dt v[68:69],v8 offset:34816
v_and_b32 v37,15,v32
mm v[136:139],v[84:87],a[184:187],v[136:139]
v_rcp_f32 v43,v43
mm v[140:143],v[80:83],a[172:175],v[140:143]
dt v[70:71],v8 offset:35072
v_add_f32 v44,1.0,v44
mm v[140:143],v[84:87],a[188:191],v[140:143]
s_waitcnt lgkmcnt(4)
v_mul_f32 v52,v184,v216
v_mul_f32 v49,v49,v41
mm v[144:147],v[88:91],a[160:163],v[144:147]
dt v[72:73],v9 offset:32768
cv v56,v48,v49
mm v[144:147],v[92:95],a[176:179],v[144:147]
v_mul_f32 v47,s61,v187
v_xor_b32 v38,v33,v37
mm v[148:151],v[88:91],a[164:167],v[148:151]
s_add_u32 m0,s36,73728
s_add_u32 s59,s52,4718784
dt v[74:75],v9 offset:33024
mm v[148:151],v[92:95],a[180:183],v[148:151]
v_exp_f32 v46,v46
mm v[152:155],v[88:91],a[168:171],v[152:155]
dt v[76:77],v9 offset:34816
v_lshlrev_b32 v38,4,v38
mm v[152:155],v[92:95],a[184:187],v[152:155]
bl v4,s[12:15],s59 offen lds
mm v[156:159],v[88:91],a[172:175],v[156:159]
dt v[78:79],v9 offset:35072
v_lshl_add_u32 v38,v37,8,v38
mm v[156:159],v[92:95],a[188:191],v[156:159]
s_waitcnt lgkmcnt(4)
v_rcp_f32 v44,v44
mm v[96:99],v[64:67],a[192:195],v[96:99]
dt v[80:81],v8 offset:36864
v_add_f32 v45,1.0,v45
mm v[96:99],v[68:71],a[208:211],v[96:99]
v_mul_f32 v53,v185,v217
v_mul_f32 v50,v50,v42
mm v[100:103],v[64:67],a[196:199],v[100:103]
dt v[82:83],v8 offset:37120
mm v[100:103],v[68:71],a[212:215],v[100:103]
v_exp_f32 v47,v47
mm v[104:107],v[64:67],a[200:203],v[104:107]
dt v[84:85],v8 offset:38912
v_add_u32 v20,0x10000,v38
mm v[104:107],v[68:71],a[216:219],v[104:107]
v_rcp_f32 v45,v45
mm v[108:111],v[64:67],a[204:207],v[108:111]
dt v[86:87],v8 offset:39168
v_add_f32 v46,1.0,v46
mm v[108:111],v[68:71],a[220:223],v[108:111]
s_waitcnt lgkmcnt(4)
s_add_u32 m0,s36,77824
v_mul_f32 v54,v186,v218
mm v[112:115],v[72:75],a[192:195],v[112:115]
dt v[88:89],v9 offset:36864
v_mul_f32 v51,v51,v43
mm v[112:115],v[76:79],a[208:211],v[112:115]
bl v4,s[16:19],s59 offen lds
mm v[116:119],v[72:75],a[196:199],v[116:119]
dt v[90:91],v9 offset:37120
cv v57,v50,v51
mm v[116:119],v[76:79],a[212:215],v[116:119]
v_rcp_f32 v46,v46
mm v[120:123],v[72:75],a[200:203],v[120:123]
dt v[92:93],v9 offset:38912
v_add_f32 v47,1.0,v47
mm v[120:123],v[76:79],a[216:219],v[120:123]
v_mul_f32 v55,v187,v219
v_xor_b32 v21,64,v20
mm v[124:127],v[72:75],a[204:207],v[124:127]
dt v[94:95],v9 offset:39168
v_mul_f32 v52,v52,v44
mm v[124:127],v[76:79],a[220:223],v[124:127]
s_waitcnt lgkmcnt(4)
v_rcp_f32 v47,v47
mm v[128:131],v[80:83],a[192:195],v[128:131]
dt v[64:65],v10 offset:32768
v_xor_b32 v22,128,v20
mm v[128:131],v[84:87],a[208:211],v[128:131]
v_mul_f32 v53,v53,v45
cv v58,v52,v53
mm v[132:135],v[80:83],a[196:199],v[132:135]
dt v[66:67],v10 offset:33024
v_mul_f32 v54,v54,v46
mm v[132:135],v[84:87],a[212:215],v[132:135]
s_add_u32 m0,s36,16384
s_add_u32 s56,s53,0
mm v[136:139],v[80:83],a[200:203],v[136:139]
dt v[68:69],v10 offset:34816
v_mul_f32 v55,v55,v47
mm v[136:139],v[84:87],a[216:219],v[136:139]
bl v4,s[12:15],s56 offen lds
mm v[140:143],v[80:83],a[204:207],v[140:143]
dt v[70:71],v10 offset:35072
cv v59,v54,v55
mm v[140:143],v[84:87],a[220:223],v[140:143]
s_waitcnt lgkmcnt(4)
buffer_store_dwordx4 v[56:59],v2,s[8:11],s44 offen offset:1024 sc1
mm v[144:147],v[88:91],a[192:195],v[144:147]
dt v[72:73],v11 offset:32768
v_xor_b32 v23,192,v20
mm v[144:147],v[92:95],a[208:211],v[144:147]
v_mul_f32 v40,s61,v172
v_mul_f32 v41,s61,v173
mm v[148:151],v[88:91],a[196:199],v[148:151]
dt v[74:75],v11 offset:33024
v_lshl_add_u32 v36,v33,2,v34
mm v[148:151],v[92:95],a[212:215],v[148:151]
v_exp_f32 v40,v40
mm v[152:155],v[88:91],a[200:203],v[152:155]
dt v[76:77],v11 offset:34816
v_mul_f32 v42,s61,v174
mm v[152:155],v[92:95],a[216:219],v[152:155]
v_exp_f32 v41,v41
mm v[156:159],v[88:91],a[204:207],v[156:159]
dt v[78:79],v11 offset:35072
v_and_b32 v37,7,v36
mm v[156:159],v[92:95],a[220:223],v[156:159]
s_waitcnt lgkmcnt(4)
v_add_f32 v40,1.0,v40
v_mul_f32 v48,v172,v204
mm v[96:99],v[64:67],a[224:227],v[96:99]
s_add_u32 m0,s36,20480
dt v[80:81],v10 offset:36864
v_mul_f32 v43,s61,v175
mm v[96:99],v[68:71],a[240:243],v[96:99]
v_exp_f32 v42,v42
mm v[100:103],v[64:67],a[228:231],v[100:103]
dt v[82:83],v10 offset:37120
v_lshlrev_b32 v37,5,v37
mm v[100:103],v[68:71],a[244:247],v[100:103]
bl v4,s[16:19],s56 offen lds
mm v[104:107],v[64:67],a[232:235],v[104:107]
dt v[84:85],v10 offset:38912
mm v[104:107],v[68:71],a[248:251],v[104:107]
v_rcp_f32 v40,v40
mm v[108:111],v[64:67],a[236:239],v[108:111]
dt v[86:87],v10 offset:39168
v_add_f32 v41,1.0,v41
mm v[108:111],v[68:71],a[252:255],v[108:111]
s_waitcnt lgkmcnt(4)
v_mul_f32 v49,v173,v205
v_mul_f32 v44,s61,v188
mm v[112:115],v[72:75],a[224:227],v[112:115]
dt v[88:89],v11 offset:36864
v_lshl_add_u32 v37,v36,8,v37
mm v[112:115],v[76:79],a[240:243],v[112:115]
v_exp_f32 v43,v43
mm v[116:119],v[72:75],a[228:231],v[116:119]
dt v[90:91],v11 offset:37120
v_lshl_add_u32 v24,v35,3,v37
mm v[116:119],v[76:79],a[244:247],v[116:119]
v_rcp_f32 v41,v41
mm v[120:123],v[72:75],a[232:235],v[120:123]
dt v[92:93],v11 offset:38912
v_add_f32 v42,1.0,v42
mm v[120:123],v[76:79],a[248:251],v[120:123]
v_mul_f32 v50,v174,v206
v_mul_f32 v45,s61,v189
mm v[124:127],v[72:75],a[236:239],v[124:127]
dt v[94:95],v11 offset:39168
v_xor_b32 v25,32,v24
mm v[124:127],v[76:79],a[252:255],v[124:127]
s_waitcnt lgkmcnt(4)
s_waitcnt vmcnt(18)
mm v[128:131],v[80:83],a[224:227],v[128:131]
s_barrier
dt v[64:65],v8 offset:40960
v_xor_b32 v26,64,v24
mm v[128:131],v[84:87],a[240:243],v[128:131]
s_add_u32 m0,s36,81920
s_add_u32 s57,s53,589824
v_xor_b32 v27,96,v24
mm v[132:135],v[80:83],a[228:231],v[132:135]
dt v[66:67],v8 offset:41216
v_xor_b32 v28,128,v24
mm v[132:135],v[84:87],a[244:247],v[132:135]
bl v4,s[12:15],s57 offen lds
mm v[136:139],v[80:83],a[232:235],v[136:139]
dt v[68:69],v8 offset:43008
v_xor_b32 v29,160,v24
mm v[136:139],v[84:87],a[248:251],v[136:139]
v_exp_f32 v44,v44
mm v[140:143],v[80:83],a[236:239],v[140:143]
dt v[70:71],v8 offset:43264
mm v[140:143],v[84:87],a[252:255],v[140:143]
s_waitcnt lgkmcnt(4)
v_rcp_f32 v42,v42
mm v[144:147],v[88:91],a[224:227],v[144:147]
dt v[72:73],v9 offset:40960
v_add_f32 v43,1.0,v43
mm v[144:147],v[92:95],a[240:243],v[144:147]
v_mul_f32 v51,v175,v207
v_mul_f32 v48,v48,v40
mm v[148:151],v[88:91],a[228:231],v[148:151]
dt v[74:75],v9 offset:41216
v_mul_f32 v46,s61,v190
mm v[148:151],v[92:95],a[244:247],v[148:151]
v_exp_f32 v45,v45
mm v[152:155],v[88:91],a[232:235],v[152:155]
dt v[76:77],v9 offset:43008
v_xor_b32 v30,192,v24
mm v[152:155],v[92:95],a[248:251],v[152:155]
v_rcp_f32 v43,v43
mm v[156:159],v[88:91],a[236:239],v[156:159]
s_add_u32 m0,s36,86016
dt v[78:79],v9 offset:43264
v_add_f32 v44,1.0,v44
mm v[156:159],v[92:95],a[252:255],v[156:159]
s_waitcnt lgkmcnt(4)
v_mul_f32 v52,v188,v220
v_mul_f32 v49,v49,v41
mm v[96:99],v[64:67],v[224:227],v[96:99]
dt v[80:81],v8 offset:45056
cv v60,v48,v49
mm v[96:99],v[68:71],v[240:243],v[96:99]
bl v4,s[16:19],s57 offen lds
mm v[100:103],v[64:67],v[228:231],v[100:103]
dt v[82:83],v8 offset:45312
v_mul_f32 v47,s61,v191
mm v[100:103],v[68:71],v[244:247],v[100:103]
v_exp_f32 v46,v46
mm v[104:107],v[64:67],v[232:235],v[104:107]
dt v[84:85],v8 offset:47104
v_xor_b32 v31,224,v24
mm v[104:107],v[68:71],v[248:251],v[104:107]
v_rcp_f32 v44,v44
mm v[108:111],v[64:67],v[236:239],v[108:111]
dt v[86:87],v8 offset:47360
v_add_f32 v45,1.0,v45
mm v[108:111],v[68:71],v[252:255],v[108:111]
s_waitcnt lgkmcnt(4)
v_mul_f32 v53,v189,v221
v_mul_f32 v50,v50,v42
mm v[112:115],v[72:75],v[224:227],v[112:115]
dt v[88:89],v9 offset:45056
v_lshrrev_b32 v39,6,v7
mm v[112:115],v[76:79],v[240:243],v[112:115]
v_exp_f32 v47,v47
mm v[116:119],v[72:75],v[228:231],v[116:119]
dt v[90:91],v9 offset:45312
mm v[116:119],v[76:79],v[244:247],v[116:119]
v_rcp_f32 v45,v45
mm v[120:123],v[72:75],v[232:235],v[120:123]
dt v[92:93],v9 offset:47104
v_add_f32 v46,1.0,v46
mm v[120:123],v[76:79],v[248:251],v[120:123]
v_mul_f32 v54,v190,v222
v_mul_f32 v51,v51,v43
mm v[124:127],v[72:75],v[236:239],v[124:127]
s_add_u32 m0,s36,24576
s_add_u32 s58,s53,1179648
dt v[94:95],v9 offset:47360
mm v[124:127],v[76:79],v[252:255],v[124:127]
s_waitcnt lgkmcnt(4)
cv v61,v50,v51
v_subrev_u32 v39,2048,v39
mm v[128:131],v[80:83],v[224:227],v[128:131]
dt v[64:65],v10 offset:40960
v_min_u32 v39,143,v39
mm v[128:131],v[84:87],v[240:243],v[128:131]
bl v4,s[12:15],s58 offen lds
mm v[132:135],v[80:83],v[228:231],v[132:135]
dt v[66:67],v10 offset:41216
v_lshlrev_b32 v39,13,v39
mm v[132:135],v[84:87],v[244:247],v[132:135]
v_rcp_f32 v46,v46
mm v[136:139],v[80:83],v[232:235],v[136:139]
dt v[68:69],v10 offset:43008
v_add_f32 v47,1.0,v47
mm v[136:139],v[84:87],v[248:251],v[136:139]
v_mul_f32 v55,v191,v223
v_mul_f32 v52,v52,v44
mm v[140:143],v[80:83],v[236:239],v[140:143]
dt v[70:71],v10 offset:43264
mm v[140:143],v[84:87],v[252:255],v[140:143]
s_waitcnt lgkmcnt(4)
v_rcp_f32 v47,v47
mm v[144:147],v[88:91],v[224:227],v[144:147]
dt v[72:73],v11 offset:40960
v_mul_f32 v53,v53,v45
mm v[144:147],v[92:95],v[240:243],v[144:147]
cv v62,v52,v53
v_mul_f32 v54,v54,v46
mm v[148:151],v[88:91],v[228:231],v[148:151]
dt v[74:75],v11 offset:41216
v_mul_f32 v55,v55,v47
mm v[148:151],v[92:95],v[244:247],v[148:151]
cv v63,v54,v55
buffer_store_dwordx4 v[60:63],v2,s[8:11],s45 offen offset:1024 sc1
mm v[152:155],v[88:91],v[232:235],v[152:155]
dt v[76:77],v11 offset:43008
mm v[152:155],v[92:95],v[248:251],v[152:155]
s_add_u32 m0,s36,28672
mm v[156:159],v[88:91],v[236:239],v[156:159]
dt v[78:79],v11 offset:43264
mm v[156:159],v[92:95],v[252:255],v[156:159]
s_waitcnt lgkmcnt(4)
bl v4,s[16:19],s58 offen lds
mm v[160:163],v[64:67],a[0:3],0
dt v[80:81],v10 offset:45056
mm v[160:163],v[68:71],a[16:19],v[160:163]
mm v[164:167],v[64:67],a[4:7],0
dt v[82:83],v10 offset:45312
mm v[164:167],v[68:71],a[20:23],v[164:167]
mm v[168:171],v[64:67],a[8:11],0
dt v[84:85],v10 offset:47104
mm v[168:171],v[68:71],a[24:27],v[168:171]
mm v[172:175],v[64:67],a[12:15],0
dt v[86:87],v10 offset:47360
v_mul_f32 v40,s61,v96
mm v[172:175],v[68:71],a[28:31],v[172:175]
s_waitcnt lgkmcnt(4)
v_mul_f32 v41,s61,v97
mm v[176:179],v[72:75],a[0:3],0
dt v[88:89],v11 offset:45056
mm v[176:179],v[76:79],a[16:19],v[176:179]
v_exp_f32 v40,v40
mm v[180:183],v[72:75],a[4:7],0
dt v[90:91],v11 offset:45312
v_mul_f32 v42,s61,v98
mm v[180:183],v[76:79],a[20:23],v[180:183]
v_exp_f32 v41,v41
mm v[184:187],v[72:75],a[8:11],0
dt v[92:93],v11 offset:47104
v_add_f32 v40,1.0,v40
mm v[184:187],v[76:79],a[24:27],v[184:187]
s_add_u32 m0,s36,90112
s_add_u32 s59,s53,1769472
v_mul_f32 v48,v96,v128
mm v[188:191],v[72:75],a[12:15],0
dt v[94:95],v11 offset:47360
v_mul_f32 v43,s61,v99
mm v[188:191],v[76:79],a[28:31],v[188:191]
s_waitcnt lgkmcnt(4)
bl v4,s[12:15],s59 offen lds
mm v[192:195],v[80:83],a[0:3],0
dt v[64:65],v8 offset:49152
mm v[192:195],v[84:87],a[16:19],v[192:195]
v_exp_f32 v42,v42
mm v[196:199],v[80:83],a[4:7],0
dt v[66:67],v8 offset:49408
mm v[196:199],v[84:87],a[20:23],v[196:199]
v_rcp_f32 v40,v40
mm v[200:203],v[80:83],a[8:11],0
dt v[68:69],v8 offset:51200
v_add_f32 v41,1.0,v41
mm v[200:203],v[84:87],a[24:27],v[200:203]
v_mul_f32 v49,v97,v129
mm v[204:207],v[80:83],a[12:15],0
dt v[70:71],v8 offset:51456
v_mul_f32 v44,s61,v112
mm v[204:207],v[84:87],a[28:31],v[204:207]
s_waitcnt lgkmcnt(4)
v_exp_f32 v43,v43
mm v[208:211],v[88:91],a[0:3],0
dt v[72:73],v9 offset:49152
mm v[208:211],v[92:95],a[16:19],v[208:211]
v_rcp_f32 v41,v41
mm v[212:215],v[88:91],a[4:7],0
dt v[74:75],v9 offset:49408
v_add_f32 v42,1.0,v42
mm v[212:215],v[92:95],a[20:23],v[212:215]
v_mul_f32 v50,v98,v130
mm v[216:219],v[88:91],a[8:11],0
dt v[76:77],v9 offset:51200
v_mul_f32 v45,s61,v113
mm v[216:219],v[92:95],a[24:27],v[216:219]
s_add_u32 m0,s36,94208
v_exp_f32 v44,v44
mm v[220:223],v[88:91],a[12:15],0
dt v[78:79],v9 offset:51456
mm v[220:223],v[92:95],a[28:31],v[220:223]
s_waitcnt lgkmcnt(4)
bl v4,s[16:19],s59 offen lds
mm v[160:163],v[64:67],a[32:35],v[160:163]
dt v[80:81],v8 offset:53248
mm v[160:163],v[68:71],a[48:51],v[160:163]
v_rcp_f32 v42,v42
mm v[164:167],v[64:67],a[36:39],v[164:167]
dt v[82:83],v8 offset:53504
v_add_f32 v43,1.0,v43
mm v[164:167],v[68:71],a[52:55],v[164:167]
v_mul_f32 v51,v99,v131
v_mul_f32 v48,v48,v40
mm v[168:171],v[64:67],a[40:43],v[168:171]
dt v[84:85],v8 offset:55296
v_mul_f32 v46,s61,v114
mm v[168:171],v[68:71],a[56:59],v[168:171]
v_exp_f32 v45,v45
mm v[172:175],v[64:67],a[44:47],v[172:175]
dt v[86:87],v8 offset:55552
mm v[172:175],v[68:71],a[60:63],v[172:175]
s_waitcnt lgkmcnt(4)
v_rcp_f32 v43,v43
mm v[176:179],v[72:75],a[32:35],v[176:179]
dt v[88:89],v9 offset:53248
mm v[176:179],v[76:79],a[48:51],v[176:179]
v_add_f32 v44,1.0,v44
v_mul_f32 v52,v112,v144
mm v[180:183],v[72:75],a[36:39],v[180:183]
dt v[90:91],v9 offset:53504
mm v[180:183],v[76:79],a[52:55],v[180:183]
v_mul_f32 v49,v49,v41
cv v56,v48,v49
mm v[184:187],v[72:75],a[40:43],v[184:187]
dt v[92:93],v9 offset:55296
v_mul_f32 v47,s61,v115
mm v[184:187],v[76:79],a[56:59],v[184:187]
s_add_u32 m0,s36,32768
s_add_u32 s56,s53,2359296
mm v[188:191],v[72:75],a[44:47],v[188:191]
dt v[94:95],v9 offset:55552
mm v[188:191],v[76:79],a[60:63],v[188:191]
s_waitcnt lgkmcnt(4)
bl v4,s[12:15],s56 offen lds
mm v[192:195],v[80:83],a[32:35],v[192:195]
dt v[64:65],v10 offset:49152
mm v[192:195],v[84:87],a[48:51],v[192:195]
v_exp_f32 v46,v46
mm v[196:199],v[80:83],a[36:39],v[196:199]
dt v[66:67],v10 offset:49408
mm v[196:199],v[84:87],a[52:55],v[196:199]
v_rcp_f32 v44,v44
mm v[200:203],v[80:83],a[40:43],v[200:203]
dt v[68:69],v10 offset:51200
v_add_f32 v45,1.0,v45
mm v[200:203],v[84:87],a[56:59],v[200:203]
v_mul_f32 v53,v113,v145
v_mul_f32 v50,v50,v42
mm v[204:207],v[80:83],a[44:47],v[204:207]
dt v[70:71],v10 offset:51456
mm v[204:207],v[84:87],a[60:63],v[204:207]
s_waitcnt lgkmcnt(4)
v_exp_f32 v47,v47
mm v[208:211],v[88:91],a[32:35],v[208:211]
dt v[72:73],v11 offset:49152
mm v[208:211],v[92:95],a[48:51],v[208:211]
v_rcp_f32 v45,v45
mm v[212:215],v[88:91],a[36:39],v[212:215]
dt v[74:75],v11 offset:49408
v_add_f32 v46,1.0,v46
mm v[212:215],v[92:95],a[52:55],v[212:215]
v_mul_f32 v54,v114,v146
v_mul_f32 v51,v51,v43
mm v[216:219],v[88:91],a[40:43],v[216:219]
dt v[76:77],v11 offset:51200
cv v57,v50,v51
mm v[216:219],v[92:95],a[56:59],v[216:219]
s_add_u32 m0,s36,36864
v_rcp_f32 v46,v46
mm v[220:223],v[88:91],a[44:47],v[220:223]
dt v[78:79],v11 offset:51456
v_add_f32 v47,1.0,v47
mm v[220:223],v[92:95],a[60:63],v[220:223]
s_waitcnt lgkmcnt(4)
bl v4,s[16:19],s56 offen lds
mm v[160:163],v[64:67],a[64:67],v[160:163]
dt v[80:81],v10 offset:53248
v_mul_f32 v55,v115,v147
mm v[160:163],v[68:71],a[80:83],v[160:163]
v_mul_f32 v52,v52,v44
mm v[164:167],v[64:67],a[68:71],v[164:167]
dt v[82:83],v10 offset:53504
mm v[164:167],v[68:71],a[84:87],v[164:167]
v_rcp_f32 v47,v47
mm v[168:171],v[64:67],a[72:75],v[168:171]
dt v[84:85],v10 offset:55296
v_mul_f32 v53,v53,v45
mm v[168:171],v[68:71],a[88:91],v[168:171]
cv v58,v52,v53
v_mul_f32 v54,v54,v46
mm v[172:175],v[64:67],a[76:79],v[172:175]
dt v[86:87],v10 offset:55552
mm v[172:175],v[68:71],a[92:95],v[172:175]
s_waitcnt lgkmcnt(4)
v_mul_f32 v55,v55,v47
cv v59,v54,v55
mm v[176:179],v[72:75],a[64:67],v[176:179]
dt v[88:89],v11 offset:53248
mm v[176:179],v[76:79],a[80:83],v[176:179]
buffer_store_dwordx4 v[56:59],v2,s[8:11],s42 offen offset:2048 sc1
mm v[180:183],v[72:75],a[68:71],v[180:183]
dt v[90:91],v11 offset:53504
v_mul_f32 v40,s61,v100
mm v[180:183],v[76:79],a[84:87],v[180:183]
v_mul_f32 v41,s61,v101
mm v[184:187],v[72:75],a[72:75],v[184:187]
dt v[92:93],v11 offset:55296
mm v[184:187],v[76:79],a[88:91],v[184:187]
v_exp_f32 v40,v40
mm v[188:191],v[72:75],a[76:79],v[188:191]
dt v[94:95],v11 offset:55552
v_mul_f32 v42,s61,v102
mm v[188:191],v[76:79],a[92:95],v[188:191]
s_waitcnt lgkmcnt(4)
s_waitcnt vmcnt(17)
mm v[192:195],v[80:83],a[64:67],v[192:195]
s_barrier
dt v[64:65],v8 offset:57344
mm v[192:195],v[84:87],a[80:83],v[192:195]
s_add_u32 m0,s36,98304
s_add_u32 s57,s53,2949120
mm v[196:199],v[80:83],a[68:71],v[196:199]
dt v[66:67],v8 offset:57600
mm v[196:199],v[84:87],a[84:87],v[196:199]
bl v4,s[12:15],s57 offen lds
mm v[200:203],v[80:83],a[72:75],v[200:203]
dt v[68:69],v8 offset:59392
mm v[200:203],v[84:87],a[88:91],v[200:203]
v_exp_f32 v41,v41
mm v[204:207],v[80:83],a[76:79],v[204:207]
dt v[70:71],v8 offset:59648
v_add_f32 v40,1.0,v40
mm v[204:207],v[84:87],a[92:95],v[204:207]
s_waitcnt lgkmcnt(4)
v_mul_f32 v48,v100,v132
v_mul_f32 v43,s61,v103
mm v[208:211],v[88:91],a[64:67],v[208:211]
dt v[72:73],v9 offset:57344
mm v[208:211],v[92:95],a[80:83],v[208:211]
v_exp_f32 v42,v42
mm v[212:215],v[88:91],a[68:71],v[212:215]
dt v[74:75],v9 offset:57600
mm v[212:215],v[92:95],a[84:87],v[212:215]
v_rcp_f32 v40,v40
mm v[216:219],v[88:91],a[72:75],v[216:219]
dt v[76:77],v9 offset:59392
v_add_f32 v41,1.0,v41
mm v[216:219],v[92:95],a[88:91],v[216:219]
v_mul_f32 v49,v101,v133
v_mul_f32 v44,s61,v116
mm v[220:223],v[88:91],a[76:79],v[220:223]
s_add_u32 m0,s36,102400
dt v[78:79],v9 offset:59648
mm v[220:223],v[92:95],a[92:95],v[220:223]
s_waitcnt lgkmcnt(4)
v_exp_f32 v43,v43
mm v[160:163],v[64:67],a[96:99],v[160:163]
dt v[80:81],v8 offset:61440
mm v[160:163],v[68:71],a[112:115],v[160:163]
bl v4,s[16:19],s57 offen lds
mm v[164:167],v[64:67],a[100:103],v[164:167]
dt v[82:83],v8 offset:61696
mm v[164:167],v[68:71],a[116:119],v[164:167]
v_rcp_f32 v41,v41
mm v[168:171],v[64:67],a[104:107],v[168:171]
dt v[84:85],v8 offset:63488
v_add_f32 v42,1.0,v42
mm v[168:171],v[68:71],a[120:123],v[168:171]
v_mul_f32 v50,v102,v134
v_mul_f32 v45,s61,v117
mm v[172:175],v[64:67],a[108:111],v[172:175]
dt v[86:87],v8 offset:63744
mm v[172:175],v[68:71],a[124:127],v[172:175]
s_waitcnt lgkmcnt(4)
v_exp_f32 v44,v44
mm v[176:179],v[72:75],a[96:99],v[176:179]
dt v[88:89],v9 offset:61440
mm v[176:179],v[76:79],a[112:115],v[176:179]
v_rcp_f32 v42,v42
mm v[180:183],v[72:75],a[100:103],v[180:183]
dt v[90:91],v9 offset:61696
v_add_f32 v43,1.0,v43
mm v[180:183],v[76:79],a[116:119],v[180:183]
v_mul_f32 v51,v103,v135
v_mul_f32 v48,v48,v40
mm v[184:187],v[72:75],a[104:107],v[184:187]
dt v[92:93],v9 offset:63488
v_mul_f32 v46,s61,v118
mm v[184:187],v[76:79],a[120:123],v[184:187]
v_exp_f32 v45,v45
mm v[188:191],v[72:75],a[108:111],v[188:191]
s_add_u32 m0,s36,40960
s_add_u32 s58,s53,3538944
dt v[94:95],v9 offset:63744
mm v[188:191],v[76:79],a[124:127],v[188:191]
s_waitcnt lgkmcnt(4)
v_rcp_f32 v43,v43
mm v[192:195],v[80:83],a[96:99],v[192:195]
dt v[64:65],v10 offset:57344
v_add_f32 v44,1.0,v44
mm v[192:195],v[84:87],a[112:115],v[192:195]
bl v4,s[12:15],s58 offen lds
mm v[196:199],v[80:83],a[100:103],v[196:199]
dt v[66:67],v10 offset:57600
v_mul_f32 v52,v116,v148
mm v[196:199],v[84:87],a[116:119],v[196:199]
v_mul_f32 v49,v49,v41
cv v60,v48,v49
mm v[200:203],v[80:83],a[104:107],v[200:203]
dt v[68:69],v10 offset:59392
v_mul_f32 v47,s61,v119
mm v[200:203],v[84:87],a[120:123],v[200:203]
v_exp_f32 v46,v46
mm v[204:207],v[80:83],a[108:111],v[204:207]
dt v[70:71],v10 offset:59648
mm v[204:207],v[84:87],a[124:127],v[204:207]
s_waitcnt lgkmcnt(4)
v_rcp_f32 v44,v44
mm v[208:211],v[88:91],a[96:99],v[208:211]
dt v[72:73],v11 offset:57344
v_add_f32 v45,1.0,v45
mm v[208:211],v[92:95],a[112:115],v[208:211]
v_mul_f32 v53,v117,v149
v_mul_f32 v50,v50,v42
mm v[212:215],v[88:91],a[100:103],v[212:215]
dt v[74:75],v11 offset:57600
mm v[212:215],v[92:95],a[116:119],v[212:215]
v_exp_f32 v47,v47
mm v[216:219],v[88:91],a[104:107],v[216:219]
dt v[76:77],v11 offset:59392
mm v[216:219],v[92:95],a[120:123],v[216:219]
s_add_u32 m0,s36,45056
v_rcp_f32 v45,v45
mm v[220:223],v[88:91],a[108:111],v[220:223]
dt v[78:79],v11 offset:59648
v_add_f32 v46,1.0,v46
mm v[220:223],v[92:95],a[124:127],v[220:223]
s_waitcnt lgkmcnt(4)
bl v4,s[16:19],s58 offen lds
mm v[160:163],v[64:67],a[128:131],v[160:163]
dt v[80:81],v10 offset:61440
v_mul_f32 v54,v118,v150
mm v[160:163],v[68:71],a[144:147],v[160:163]
v_mul_f32 v51,v51,v43
mm v[164:167],v[64:67],a[132:135],v[164:167]
dt v[82:83],v10 offset:61696
cv v61,v50,v51
mm v[164:167],v[68:71],a[148:151],v[164:167]
v_rcp_f32 v46,v46
mm v[168:171],v[64:67],a[136:139],v[168:171]
dt v[84:85],v10 offset:63488
mm v[168:171],v[68:71],a[152:155],v[168:171]
v_add_f32 v47,1.0,v47
v_mul_f32 v55,v119,v151
mm v[172:175],v[64:67],a[140:143],v[172:175]
dt v[86:87],v10 offset:63744
v_mul_f32 v52,v52,v44
mm v[172:175],v[68:71],a[156:159],v[172:175]
s_waitcnt lgkmcnt(4)
v_rcp_f32 v47,v47
mm v[176:179],v[72:75],a[128:131],v[176:179]
dt v[88:89],v11 offset:61440
mm v[176:179],v[76:79],a[144:147],v[176:179]
v_mul_f32 v53,v53,v45
mm v[180:183],v[72:75],a[132:135],v[180:183]
dt v[90:91],v11 offset:61696
cv v62,v52,v53
mm v[180:183],v[76:79],a[148:151],v[180:183]
v_mul_f32 v54,v54,v46
v_mul_f32 v55,v55,v47
mm v[184:187],v[72:75],a[136:139],v[184:187]
dt v[92:93],v11 offset:63488
mm v[184:187],v[76:79],a[152:155],v[184:187]
s_add_u32 m0,s36,106496
s_add_u32 s59,s53,4128768
cv v63,v54,v55
mm v[188:191],v[72:75],a[140:143],v[188:191]
dt v[94:95],v11 offset:63744
mm v[188:191],v[76:79],a[156:159],v[188:191]
s_waitcnt lgkmcnt(4)
bl v4,s[12:15],s59 offen lds
mm v[192:195],v[80:83],a[128:131],v[192:195]
dt v[64:65],v8 offset:0
mm v[192:195],v[84:87],a[144:147],v[192:195]
buffer_store_dwordx4 v[60:63],v2,s[8:11],s43 offen offset:2048 sc1
mm v[196:199],v[80:83],a[132:135],v[196:199]
dt v[66:67],v8 offset:256
v_mul_f32 v40,s61,v104
mm v[196:199],v[84:87],a[148:151],v[196:199]
v_mul_f32 v41,s61,v105
mm v[200:203],v[80:83],a[136:139],v[200:203]
dt v[68:69],v8 offset:2048
mm v[200:203],v[84:87],a[152:155],v[200:203]
v_exp_f32 v40,v40
mm v[204:207],v[80:83],a[140:143],v[204:207]
dt v[70:71],v8 offset:2304
v_mul_f32 v42,s61,v106
mm v[204:207],v[84:87],a[156:159],v[204:207]
s_waitcnt lgkmcnt(4)
v_exp_f32 v41,v41
mm v[208:211],v[88:91],a[128:131],v[208:211]
dt v[72:73],v9 offset:0
v_add_f32 v40,1.0,v40
mm v[208:211],v[92:95],a[144:147],v[208:211]
v_mul_f32 v48,v104,v136
v_mul_f32 v43,s61,v107
mm v[212:215],v[88:91],a[132:135],v[212:215]
dt v[74:75],v9 offset:256
mm v[212:215],v[92:95],a[148:151],v[212:215]
v_exp_f32 v42,v42
mm v[216:219],v[88:91],a[136:139],v[216:219]
dt v[76:77],v9 offset:2048
mm v[216:219],v[92:95],a[152:155],v[216:219]
s_add_u32 m0,s36,110592
v_rcp_f32 v40,v40
mm v[220:223],v[88:91],a[140:143],v[220:223]
dt v[78:79],v9 offset:2304
v_add_f32 v41,1.0,v41
mm v[220:223],v[92:95],a[156:159],v[220:223]
s_waitcnt lgkmcnt(4)
bl v4,s[16:19],s59 offen lds
mm v[160:163],v[64:67],a[160:163],v[160:163]
dt v[80:81],v8 offset:4096
v_mul_f32 v49,v105,v137
mm v[160:163],v[68:71],a[176:179],v[160:163]
v_mul_f32 v44,s61,v120
mm v[164:167],v[64:67],a[164:167],v[164:167]
dt v[82:83],v8 offset:4352
mm v[164:167],v[68:71],a[180:183],v[164:167]
v_exp_f32 v43,v43
mm v[168:171],v[64:67],a[168:171],v[168:171]
dt v[84:85],v8 offset:6144
mm v[168:171],v[68:71],a[184:187],v[168:171]
v_rcp_f32 v41,v41
mm v[172:175],v[64:67],a[172:175],v[172:175]
dt v[86:87],v8 offset:6400
v_add_f32 v42,1.0,v42
mm v[172:175],v[68:71],a[188:191],v[172:175]
s_waitcnt lgkmcnt(4)
v_mul_f32 v50,v106,v138
v_mul_f32 v45,s61,v121
mm v[176:179],v[72:75],a[160:163],v[176:179]
dt v[88:89],v9 offset:4096
mm v[176:179],v[76:79],a[176:179],v[176:179]
v_exp_f32 v44,v44
mm v[180:183],v[72:75],a[164:167],v[180:183]
dt v[90:91],v9 offset:4352
mm v[180:183],v[76:79],a[180:183],v[180:183]
v_rcp_f32 v42,v42
mm v[184:187],v[72:75],a[168:171],v[184:187]
dt v[92:93],v9 offset:6144
v_add_f32 v43,1.0,v43
mm v[184:187],v[76:79],a[184:187],v[184:187]
s_add_u32 m0,s36,49152
s_add_u32 s56,s53,4718592
v_mul_f32 v51,v107,v139
mm v[188:191],v[72:75],a[172:175],v[188:191]
dt v[94:95],v9 offset:6400
v_mul_f32 v48,v48,v40
mm v[188:191],v[76:79],a[188:191],v[188:191]
s_waitcnt lgkmcnt(4)
bl v4,s[12:15],s56 offen lds
mm v[192:195],v[80:83],a[160:163],v[192:195]
dt v[64:65],v10 offset:0
v_mul_f32 v46,s61,v122
mm v[192:195],v[84:87],a[176:179],v[192:195]
v_exp_f32 v45,v45
mm v[196:199],v[80:83],a[164:167],v[196:199]
dt v[66:67],v10 offset:256
mm v[196:199],v[84:87],a[180:183],v[196:199]
v_rcp_f32 v43,v43
mm v[200:203],v[80:83],a[168:171],v[200:203]
dt v[68:69],v10 offset:2048
v_add_f32 v44,1.0,v44
mm v[200:203],v[84:87],a[184:187],v[200:203]
v_mul_f32 v52,v120,v152
mm v[204:207],v[80:83],a[172:175],v[204:207]
dt v[70:71],v10 offset:2304
v_mul_f32 v49,v49,v41
mm v[204:207],v[84:87],a[188:191],v[204:207]
s_waitcnt lgkmcnt(4)
cv v56,v48,v49
v_mul_f32 v47,s61,v123
mm v[208:211],v[88:91],a[160:163],v[208:211]
dt v[72:73],v11 offset:0
mm v[208:211],v[92:95],a[176:179],v[208:211]
v_exp_f32 v46,v46
mm v[212:215],v[88:91],a[164:167],v[212:215]
dt v[74:75],v11 offset:256
mm v[212:215],v[92:95],a[180:183],v[212:215]
v_rcp_f32 v44,v44
mm v[216:219],v[88:91],a[168:171],v[216:219]
dt v[76:77],v11 offset:2048
v_add_f32 v45,1.0,v45
mm v[216:219],v[92:95],a[184:187],v[216:219]
s_add_u32 m0,s36,53248
v_mul_f32 v53,v121,v153
mm v[220:223],v[88:91],a[172:175],v[220:223]
dt v[78:79],v11 offset:2304
v_mul_f32 v50,v50,v42
mm v[220:223],v[92:95],a[188:191],v[220:223]
s_waitcnt lgkmcnt(4)
bl v4,s[16:19],s56 offen lds
mm v[160:163],v[64:67],a[192:195],v[160:163]
dt v[80:81],v10 offset:4096
mm v[160:163],v[68:71],a[208:211],v[160:163]
v_exp_f32 v47,v47
mm v[164:167],v[64:67],a[196:199],v[164:167]
dt v[82:83],v10 offset:4352
mm v[164:167],v[68:71],a[212:215],v[164:167]
v_rcp_f32 v45,v45
mm v[168:171],v[64:67],a[200:203],v[168:171]
dt v[84:85],v10 offset:6144
v_add_f32 v46,1.0,v46
mm v[168:171],v[68:71],a[216:219],v[168:171]
v_mul_f32 v54,v122,v154
v_mul_f32 v51,v51,v43
mm v[172:175],v[64:67],a[204:207],v[172:175]
dt v[86:87],v10 offset:6400
cv v57,v50,v51
mm v[172:175],v[68:71],a[220:223],v[172:175]
s_waitcnt lgkmcnt(4)
v_rcp_f32 v46,v46
mm v[176:179],v[72:75],a[192:195],v[176:179]
dt v[88:89],v11 offset:4096
mm v[176:179],v[76:79],a[208:211],v[176:179]
v_add_f32 v47,1.0,v47
v_mul_f32 v55,v123,v155
mm v[180:183],v[72:75],a[196:199],v[180:183]
dt v[90:91],v11 offset:4352
mm v[180:183],v[76:79],a[212:215],v[180:183]
v_mul_f32 v52,v52,v44
mm v[184:187],v[72:75],a[200:203],v[184:187]
dt v[92:93],v11 offset:6144
mm v[184:187],v[76:79],a[216:219],v[184:187]
v_rcp_f32 v47,v47
mm v[188:191],v[72:75],a[204:207],v[188:191]
dt v[94:95],v11 offset:6400
v_mul_f32 v53,v53,v45
mm v[188:191],v[76:79],a[220:223],v[188:191]
s_waitcnt lgkmcnt(4)
s_waitcnt vmcnt(17)
cv v58,v52,v53
mm v[192:195],v[80:83],a[192:195],v[192:195]
s_barrier
dt v[64:65],v8 offset:8192
v_mul_f32 v54,v54,v46
mm v[192:195],v[84:87],a[208:211],v[192:195]
s_add_u32 m0,s37,114688
s_add_u32 s57,s54,128
v_mul_f32 v55,v55,v47
mm v[196:199],v[80:83],a[196:199],v[196:199]
dt v[66:67],v8 offset:8448
cv v59,v54,v55
mm v[196:199],v[84:87],a[212:215],v[196:199]
bl v5,s[20:23],s57 offen lds
mm v[200:203],v[80:83],a[200:203],v[200:203]
dt v[68:69],v8 offset:10240
mm v[200:203],v[84:87],a[216:219],v[200:203]
buffer_store_dwordx4 v[56:59],v2,s[8:11],s44 offen offset:2048 sc1
mm v[204:207],v[80:83],a[204:207],v[204:207]
dt v[70:71],v8 offset:10496
v_mul_f32 v40,s61,v108
mm v[204:207],v[84:87],a[220:223],v[204:207]
s_waitcnt lgkmcnt(4)
v_mul_f32 v41,s61,v109
mm v[208:211],v[88:91],a[192:195],v[208:211]
dt v[72:73],v9 offset:8192
mm v[208:211],v[92:95],a[208:211],v[208:211]
v_exp_f32 v40,v40
mm v[212:215],v[88:91],a[196:199],v[212:215]
dt v[74:75],v9 offset:8448
v_mul_f32 v42,s61,v110
mm v[212:215],v[92:95],a[212:215],v[212:215]
v_exp_f32 v41,v41
mm v[216:219],v[88:91],a[200:203],v[216:219]
s_add_u32 m0,s37,115712
dt v[76:77],v9 offset:10240
v_add_f32 v40,1.0,v40
mm v[216:219],v[92:95],a[216:219],v[216:219]
v_mul_f32 v48,v108,v140
mm v[220:223],v[88:91],a[204:207],v[220:223]
dt v[78:79],v9 offset:10496
v_mul_f32 v43,s61,v111
mm v[220:223],v[92:95],a[220:223],v[220:223]
s_waitcnt lgkmcnt(4)
bl v6,s[20:23],s57 offen lds
mm v[160:163],v[64:67],a[224:227],v[160:163]
dt v[80:81],v8 offset:12288
mm v[160:163],v[68:71],a[240:243],v[160:163]
v_exp_f32 v42,v42
mm v[164:167],v[64:67],a[228:231],v[164:167]
dt v[82:83],v8 offset:12544
mm v[164:167],v[68:71],a[244:247],v[164:167]
v_rcp_f32 v40,v40
mm v[168:171],v[64:67],a[232:235],v[168:171]
dt v[84:85],v8 offset:14336
v_add_f32 v41,1.0,v41
mm v[168:171],v[68:71],a[248:251],v[168:171]
v_mul_f32 v49,v109,v141
v_mul_f32 v44,s61,v124
mm v[172:175],v[64:67],a[236:239],v[172:175]
dt v[86:87],v8 offset:14592
mm v[172:175],v[68:71],a[252:255],v[172:175]
s_waitcnt lgkmcnt(4)
v_exp_f32 v43,v43
mm v[176:179],v[72:75],a[224:227],v[176:179]
dt v[88:89],v9 offset:12288
mm v[176:179],v[76:79],a[240:243],v[176:179]
v_rcp_f32 v41,v41
mm v[180:183],v[72:75],a[228:231],v[180:183]
s_add_u32 m0,s37,57344
s_add_u32 s58,s54,524416
dt v[90:91],v9 offset:12544
mm v[180:183],v[76:79],a[244:247],v[180:183]
v_add_f32 v42,1.0,v42
v_mul_f32 v50,v110,v142
mm v[184:187],v[72:75],a[232:235],v[184:187]
dt v[92:93],v9 offset:14336
v_mul_f32 v45,s61,v125
mm v[184:187],v[76:79],a[248:251],v[184:187]
bl v5,s[20:23],s58 offen lds
mm v[188:191],v[72:75],a[236:239],v[188:191]
dt v[94:95],v9 offset:14592
mm v[188:191],v[76:79],a[252:255],v[188:191]
s_waitcnt lgkmcnt(4)
v_exp_f32 v44,v44
mm v[192:195],v[80:83],a[224:227],v[192:195]
dt v[64:65],v10 offset:8192
mm v[192:195],v[84:87],a[240:243],v[192:195]
v_rcp_f32 v42,v42
mm v[196:199],v[80:83],a[228:231],v[196:199]
dt v[66:67],v10 offset:8448
v_add_f32 v43,1.0,v43
mm v[196:199],v[84:87],a[244:247],v[196:199]
v_mul_f32 v51,v111,v143
mm v[200:203],v[80:83],a[232:235],v[200:203]
dt v[68:69],v10 offset:10240
v_mul_f32 v48,v48,v40
mm v[200:203],v[84:87],a[248:251],v[200:203]
v_mul_f32 v46,s61,v126
mm v[204:207],v[80:83],a[236:239],v[204:207]
dt v[70:71],v10 offset:10496
mm v[204:207],v[84:87],a[252:255],v[204:207]
s_waitcnt lgkmcnt(4)
v_exp_f32 v45,v45
mm v[208:211],v[88:91],a[224:227],v[208:211]
s_add_u32 m0,s37,58368
dt v[72:73],v11 offset:8192
mm v[208:211],v[92:95],a[240:243],v[208:211]
v_rcp_f32 v43,v43
mm v[212:215],v[88:91],a[228:231],v[212:215]
dt v[74:75],v11 offset:8448
v_add_f32 v44,1.0,v44
mm v[212:215],v[92:95],a[244:247],v[212:215]
bl v6,s[20:23],s58 offen lds
mm v[216:219],v[88:91],a[232:235],v[216:219]
dt v[76:77],v11 offset:10240
v_mul_f32 v52,v124,v156
mm v[216:219],v[92:95],a[248:251],v[216:219]
v_mul_f32 v49,v49,v41
cv v60,v48,v49
mm v[220:223],v[88:91],a[236:239],v[220:223]
dt v[78:79],v11 offset:10496
v_mul_f32 v47,s61,v127
mm v[220:223],v[92:95],a[252:255],v[220:223]
s_waitcnt lgkmcnt(4)
v_exp_f32 v46,v46
mm v[160:163],v[64:67],v[224:227],v[160:163]
dt v[80:81],v10 offset:12288
mm v[160:163],v[68:71],v[240:243],v[160:163]
v_rcp_f32 v44,v44
mm v[164:167],v[64:67],v[228:231],v[164:167]
dt v[82:83],v10 offset:12544
v_add_f32 v45,1.0,v45
mm v[164:167],v[68:71],v[244:247],v[164:167]
v_mul_f32 v53,v125,v157
mm v[168:171],v[64:67],v[232:235],v[168:171]
dt v[84:85],v10 offset:14336
v_mul_f32 v50,v50,v42
mm v[168:171],v[68:71],v[248:251],v[168:171]
v_exp_f32 v47,v47
mm v[172:175],v[64:67],v[236:239],v[172:175]
s_add_u32 m0,s37,122880
s_add_u32 s59,s54,1048704
dt v[86:87],v10 offset:14592
mm v[172:175],v[68:71],v[252:255],v[172:175]
s_waitcnt lgkmcnt(4)
v_rcp_f32 v45,v45
mm v[176:179],v[72:75],v[224:227],v[176:179]
dt v[88:89],v11 offset:12288
mm v[176:179],v[76:79],v[240:243],v[176:179]
bl v5,s[20:23],s59 offen lds
mm v[180:183],v[72:75],v[228:231],v[180:183]
dt v[90:91],v11 offset:12544
mm v[180:183],v[76:79],v[244:247],v[180:183]
v_add_f32 v46,1.0,v46
v_mul_f32 v54,v126,v158
mm v[184:187],v[72:75],v[232:235],v[184:187]
dt v[92:93],v11 offset:14336
v_mul_f32 v51,v51,v43
mm v[184:187],v[76:79],v[248:251],v[184:187]
cv v61,v50,v51
mm v[188:191],v[72:75],v[236:239],v[188:191]
dt v[94:95],v11 offset:14592
mm v[188:191],v[76:79],v[252:255],v[188:191]
s_waitcnt lgkmcnt(4)
v_rcp_f32 v46,v46
mm v[192:195],v[80:83],v[224:227],v[192:195]
dt v[64:65],v8 offset:16384
v_add_f32 v47,1.0,v47
mm v[192:195],v[84:87],v[240:243],v[192:195]
v_mul_f32 v55,v127,v159
v_mul_f32 v52,v52,v44
mm v[196:199],v[80:83],v[228:231],v[196:199]
dt v[66:67],v8 offset:16640
mm v[196:199],v[84:87],v[244:247],v[196:199]
v_rcp_f32 v47,v47
mm v[200:203],v[80:83],v[232:235],v[200:203]
s_add_u32 m0,s37,123904
dt v[68:69],v8 offset:18432
v_mul_f32 v53,v53,v45
mm v[200:203],v[84:87],v[248:251],v[200:203]
cv v62,v52,v53
mm v[204:207],v[80:83],v[236:239],v[204:207]
dt v[70:71],v8 offset:18688
v_mul_f32 v54,v54,v46
mm v[204:207],v[84:87],v[252:255],v[204:207]
s_waitcnt lgkmcnt(4)
bl v6,s[20:23],s59 offen lds
mm v[208:211],v[88:91],v[224:227],v[208:211]
dt v[72:73],v9 offset:16384
v_mul_f32 v55,v55,v47
mm v[208:211],v[92:95],v[240:243],v[208:211]
cv v63,v54,v55
mm v[212:215],v[88:91],v[228:231],v[212:215]
dt v[74:75],v9 offset:16640
mm v[212:215],v[92:95],v[244:247],v[212:215]
buffer_store_dwordx4 v[60:63],v2,s[8:11],s45 offen offset:2048 sc1
mm v[216:219],v[88:91],v[232:235],v[216:219]
dt v[76:77],v9 offset:18432
mm v[216:219],v[92:95],v[248:251],v[216:219]
mm v[220:223],v[88:91],v[236:239],v[220:223]
dt v[78:79],v9 offset:18688
mm v[220:223],v[92:95],v[252:255],v[220:223]
s_waitcnt lgkmcnt(4)
mm v[96:99],v[64:67],a[0:3],0
dt v[80:81],v8 offset:20480
mm v[96:99],v[68:71],a[16:19],v[96:99]
mm v[100:103],v[64:67],a[4:7],0
s_add_u32 m0,s37,0
s_add_u32 s56,s54,1572992
dt v[82:83],v8 offset:20736
mm v[100:103],v[68:71],a[20:23],v[100:103]
mm v[104:107],v[64:67],a[8:11],0
dt v[84:85],v8 offset:22528
mm v[104:107],v[68:71],a[24:27],v[104:107]
bl v5,s[20:23],s56 offen lds
mm v[108:111],v[64:67],a[12:15],0
dt v[86:87],v8 offset:22784
v_mul_f32 v40,s61,v160
mm v[108:111],v[68:71],a[28:31],v[108:111]
s_waitcnt lgkmcnt(4)
v_mul_f32 v41,s61,v161
mm v[112:115],v[72:75],a[0:3],0
dt v[88:89],v9 offset:20480
mm v[112:115],v[76:79],a[16:19],v[112:115]
v_exp_f32 v40,v40
mm v[116:119],v[72:75],a[4:7],0
dt v[90:91],v9 offset:20736
v_mul_f32 v42,s61,v162
mm v[116:119],v[76:79],a[20:23],v[116:119]
v_exp_f32 v41,v41
mm v[120:123],v[72:75],a[8:11],0
dt v[92:93],v9 offset:22528
v_add_f32 v40,1.0,v40
mm v[120:123],v[76:79],a[24:27],v[120:123]
v_mul_f32 v48,v160,v192
v_mul_f32 v43,s61,v163
mm v[124:127],v[72:75],a[12:15],0
dt v[94:95],v9 offset:22784
mm v[124:127],v[76:79],a[28:31],v[124:127]
s_waitcnt lgkmcnt(4)
v_exp_f32 v42,v42
mm v[128:131],v[80:83],a[0:3],0
s_add_u32 m0,s37,1024
dt v[64:65],v10 offset:16384
mm v[128:131],v[84:87],a[16:19],v[128:131]
v_rcp_f32 v40,v40
mm v[132:135],v[80:83],a[4:7],0
dt v[66:67],v10 offset:16640
v_add_f32 v41,1.0,v41
mm v[132:135],v[84:87],a[20:23],v[132:135]
bl v6,s[20:23],s56 offen lds
mm v[136:139],v[80:83],a[8:11],0
dt v[68:69],v10 offset:18432
v_mul_f32 v49,v161,v193
mm v[136:139],v[84:87],a[24:27],v[136:139]
v_mul_f32 v44,s61,v176
mm v[140:143],v[80:83],a[12:15],0
dt v[70:71],v10 offset:18688
mm v[140:143],v[84:87],a[28:31],v[140:143]
s_waitcnt lgkmcnt(4)
v_exp_f32 v43,v43
mm v[144:147],v[88:91],a[0:3],0
dt v[72:73],v11 offset:16384
mm v[144:147],v[92:95],a[16:19],v[144:147]
v_rcp_f32 v41,v41
mm v[148:151],v[88:91],a[4:7],0
dt v[74:75],v11 offset:16640
v_add_f32 v42,1.0,v42
mm v[148:151],v[92:95],a[20:23],v[148:151]
v_mul_f32 v50,v162,v194
v_mul_f32 v45,s61,v177
mm v[152:155],v[88:91],a[8:11],0
dt v[76:77],v11 offset:18432
mm v[152:155],v[92:95],a[24:27],v[152:155]
v_exp_f32 v44,v44
mm v[156:159],v[88:91],a[12:15],0
s_getpc_b64 s[0:1]
L_cpf2:
s_add_u32 s100,s47,4096
s_min_u32 s100,s100,L_mid-1024-L_cpf2
s_add_u32 s0,s0,s100
s_addc_u32 s1,s1,0
dt v[78:79],v11 offset:18688
mm v[156:159],v[92:95],a[28:31],v[156:159]
s_waitcnt lgkmcnt(4)
v_rcp_f32 v42,v42
mm v[96:99],v[64:67],a[32:35],v[96:99]
dt v[80:81],v10 offset:20480
v_add_f32 v43,1.0,v43
mm v[96:99],v[68:71],a[48:51],v[96:99]
global_load_dword v0,v3,s[0:1]
mm v[100:103],v[64:67],a[36:39],v[100:103]
dt v[82:83],v10 offset:20736
v_mul_f32 v51,v163,v195
mm v[100:103],v[68:71],a[52:55],v[100:103]
v_mul_f32 v48,v48,v40
mm v[104:107],v[64:67],a[40:43],v[104:107]
dt v[84:85],v10 offset:22528
v_mul_f32 v46,s61,v178
mm v[104:107],v[68:71],a[56:59],v[104:107]
v_exp_f32 v45,v45
mm v[108:111],v[64:67],a[44:47],v[108:111]
dt v[86:87],v10 offset:22784
mm v[108:111],v[68:71],a[60:63],v[108:111]
s_waitcnt lgkmcnt(4)
v_rcp_f32 v43,v43
mm v[112:115],v[72:75],a[32:35],v[112:115]
dt v[88:89],v11 offset:20480
v_add_f32 v44,1.0,v44
mm v[112:115],v[76:79],a[48:51],v[112:115]
v_mul_f32 v52,v176,v208
mm v[116:119],v[72:75],a[36:39],v[116:119]
dt v[90:91],v11 offset:20736
v_mul_f32 v49,v49,v41
mm v[116:119],v[76:79],a[52:55],v[116:119]
cv v56,v48,v49
mm v[120:123],v[72:75],a[40:43],v[120:123]
dt v[92:93],v11 offset:22528
v_mul_f32 v47,s61,v179
mm v[120:123],v[76:79],a[56:59],v[120:123]
v_exp_f32 v46,v46
mm v[124:127],v[72:75],a[44:47],v[124:127]
dt v[94:95],v11 offset:22784
mm v[124:127],v[76:79],a[60:63],v[124:127]
s_waitcnt lgkmcnt(4)
s_waitcnt vmcnt(18)
mm v[128:131],v[80:83],a[32:35],v[128:131]
s_barrier
dt v[64:65],v8 offset:24576
mm v[128:131],v[84:87],a[48:51],v[128:131]
s_add_u32 m0,s37,65536
s_add_u32 s57,s54,2097280
mm v[132:135],v[80:83],a[36:39],v[132:135]
dt v[66:67],v8 offset:24832
mm v[132:135],v[84:87],a[52:55],v[132:135]
bl v5,s[20:23],s57 offen lds
mm v[136:139],v[80:83],a[40:43],v[136:139]
dt v[68:69],v8 offset:26624
mm v[136:139],v[84:87],a[56:59],v[136:139]
v_rcp_f32 v44,v44
mm v[140:143],v[80:83],a[44:47],v[140:143]
dt v[70:71],v8 offset:26880
v_add_f32 v45,1.0,v45
mm v[140:143],v[84:87],a[60:63],v[140:143]
s_waitcnt lgkmcnt(4)
v_mul_f32 v53,v177,v209
v_mul_f32 v50,v50,v42
mm v[144:147],v[88:91],a[32:35],v[144:147]
dt v[72:73],v9 offset:24576
mm v[144:147],v[92:95],a[48:51],v[144:147]
v_exp_f32 v47,v47
mm v[148:151],v[88:91],a[36:39],v[148:151]
dt v[74:75],v9 offset:24832
mm v[148:151],v[92:95],a[52:55],v[148:151]
v_rcp_f32 v45,v45
mm v[152:155],v[88:91],a[40:43],v[152:155]
dt v[76:77],v9 offset:26624
v_add_f32 v46,1.0,v46
mm v[152:155],v[92:95],a[56:59],v[152:155]
v_mul_f32 v54,v178,v210
v_mul_f32 v51,v51,v43
mm v[156:159],v[88:91],a[44:47],v[156:159]
s_add_u32 m0,s37,66560
dt v[78:79],v9 offset:26880
cv v57,v50,v51
mm v[156:159],v[92:95],a[60:63],v[156:159]
s_waitcnt lgkmcnt(4)
v_rcp_f32 v46,v46
mm v[96:99],v[64:67],a[64:67],v[96:99]
dt v[80:81],v8 offset:28672
v_add_f32 v47,1.0,v47
mm v[96:99],v[68:71],a[80:83],v[96:99]
bl v6,s[20:23],s57 offen lds
mm v[100:103],v[64:67],a[68:71],v[100:103]
dt v[82:83],v8 offset:28928
v_mul_f32 v55,v179,v211
mm v[100:103],v[68:71],a[84:87],v[100:103]
v_mul_f32 v52,v52,v44
mm v[104:107],v[64:67],a[72:75],v[104:107]
dt v[84:85],v8 offset:30720
mm v[104:107],v[68:71],a[88:91],v[104:107]
v_rcp_f32 v47,v47
mm v[108:111],v[64:67],a[76:79],v[108:111]
dt v[86:87],v8 offset:30976
v_mul_f32 v53,v53,v45
mm v[108:111],v[68:71],a[92:95],v[108:111]
s_waitcnt lgkmcnt(4)
cv v58,v52,v53
v_mul_f32 v54,v54,v46
mm v[112:115],v[72:75],a[64:67],v[112:115]
dt v[88:89],v9 offset:28672
v_mul_f32 v55,v55,v47
mm v[112:115],v[76:79],a[80:83],v[112:115]
cv v59,v54,v55
mm v[116:119],v[72:75],a[68:71],v[116:119]
dt v[90:91],v9 offset:28928
mm v[116:119],v[76:79],a[84:87],v[116:119]
buffer_store_dwordx4 v[56:59],v2,s[8:11],s42 offen offset:3072 sc1
mm v[120:123],v[72:75],a[72:75],v[120:123]
dt v[92:93],v9 offset:30720
v_mul_f32 v40,s61,v164
mm v[120:123],v[76:79],a[88:91],v[120:123]
v_mul_f32 v41,s61,v165
mm v[124:127],v[72:75],a[76:79],v[124:127]
s_add_u32 m0,s37,8192
s_add_u32 s58,s54,2621568
dt v[94:95],v9 offset:30976
mm v[124:127],v[76:79],a[92:95],v[124:127]
s_waitcnt lgkmcnt(4)
v_exp_f32 v40,v40
mm v[128:131],v[80:83],a[64:67],v[128:131]
dt v[64:65],v10 offset:24576
v_mul_f32 v42,s61,v166
mm v[128:131],v[84:87],a[80:83],v[128:131]
bl v5,s[20:23],s58 offen lds
mm v[132:135],v[80:83],a[68:71],v[132:135]
dt v[66:67],v10 offset:24832
mm v[132:135],v[84:87],a[84:87],v[132:135]
v_exp_f32 v41,v41
mm v[136:139],v[80:83],a[72:75],v[136:139]
dt v[68:69],v10 offset:26624
v_add_f32 v40,1.0,v40
mm v[136:139],v[84:87],a[88:91],v[136:139]
v_mul_f32 v48,v164,v196
v_mul_f32 v43,s61,v167
mm v[140:143],v[80:83],a[76:79],v[140:143]
dt v[70:71],v10 offset:26880
mm v[140:143],v[84:87],a[92:95],v[140:143]
s_waitcnt lgkmcnt(4)
v_exp_f32 v42,v42
mm v[144:147],v[88:91],a[64:67],v[144:147]
dt v[72:73],v11 offset:24576
mm v[144:147],v[92:95],a[80:83],v[144:147]
v_rcp_f32 v40,v40
mm v[148:151],v[88:91],a[68:71],v[148:151]
dt v[74:75],v11 offset:24832
v_add_f32 v41,1.0,v41
mm v[148:151],v[92:95],a[84:87],v[148:151]
v_mul_f32 v49,v165,v197
v_mul_f32 v44,s61,v180
mm v[152:155],v[88:91],a[72:75],v[152:155]
dt v[76:77],v11 offset:26624
mm v[152:155],v[92:95],a[88:91],v[152:155]
s_add_u32 m0,s37,9216
v_exp_f32 v43,v43
mm v[156:159],v[88:91],a[76:79],v[156:159]
dt v[78:79],v11 offset:26880
mm v[156:159],v[92:95],a[92:95],v[156:159]
s_waitcnt lgkmcnt(4)
bl v6,s[20:23],s58 offen lds
mm v[96:99],v[64:67],a[96:99],v[96:99]
dt v[80:81],v10 offset:28672
mm v[96:99],v[68:71],a[112:115],v[96:99]
v_rcp_f32 v41,v41
mm v[100:103],v[64:67],a[100:103],v[100:103]
dt v[82:83],v10 offset:28928
v_add_f32 v42,1.0,v42
mm v[100:103],v[68:71],a[116:119],v[100:103]
v_mul_f32 v50,v166,v198
v_mul_f32 v45,s61,v181
mm v[104:107],v[64:67],a[104:107],v[104:107]
dt v[84:85],v10 offset:30720
mm v[104:107],v[68:71],a[120:123],v[104:107]
v_exp_f32 v44,v44
mm v[108:111],v[64:67],a[108:111],v[108:111]
dt v[86:87],v10 offset:30976
mm v[108:111],v[68:71],a[124:127],v[108:111]
s_waitcnt lgkmcnt(4)
v_rcp_f32 v42,v42
mm v[112:115],v[72:75],a[96:99],v[112:115]
dt v[88:89],v11 offset:28672
v_add_f32 v43,1.0,v43
mm v[112:115],v[76:79],a[112:115],v[112:115]
v_mul_f32 v51,v167,v199
v_mul_f32 v48,v48,v40
mm v[116:119],v[72:75],a[100:103],v[116:119]
dt v[90:91],v11 offset:28928
v_mul_f32 v46,s61,v182
mm v[116:119],v[76:79],a[116:119],v[116:119]
v_exp_f32 v45,v45
mm v[120:123],v[72:75],a[104:107],v[120:123]
dt v[92:93],v11 offset:30720
mm v[120:123],v[76:79],a[120:123],v[120:123]
s_add_u32 m0,s37,73728
s_add_u32 s59,s54,3145856
mm v[124:127],v[72:75],a[108:111],v[124:127]
dt v[94:95],v11 offset:30976
mm v[124:127],v[76:79],a[124:127],v[124:127]
s_waitcnt lgkmcnt(4)
bl v5,s[20:23],s59 offen lds
mm v[128:131],v[80:83],a[96:99],v[128:131]
dt v[64:65],v8 offset:32768
mm v[128:131],v[84:87],a[112:115],v[128:131]
v_rcp_f32 v43,v43
mm v[132:135],v[80:83],a[100:103],v[132:135]
dt v[66:67],v8 offset:33024
v_add_f32 v44,1.0,v44
mm v[132:135],v[84:87],a[116:119],v[132:135]
v_mul_f32 v52,v180,v212
v_mul_f32 v49,v49,v41
mm v[136:139],v[80:83],a[104:107],v[136:139]
dt v[68:69],v8 offset:34816
cv v60,v48,v49
mm v[136:139],v[84:87],a[120:123],v[136:139]
v_mul_f32 v47,s61,v183
mm v[140:143],v[80:83],a[108:111],v[140:143]
dt v[70:71],v8 offset:35072
mm v[140:143],v[84:87],a[124:127],v[140:143]
s_waitcnt lgkmcnt(4)
v_exp_f32 v46,v46
mm v[144:147],v[88:91],a[96:99],v[144:147]
dt v[72:73],v9 offset:32768
mm v[144:147],v[92:95],a[112:115],v[144:147]
v_rcp_f32 v44,v44
mm v[148:151],v[88:91],a[100:103],v[148:151]
dt v[74:75],v9 offset:33024
v_add_f32 v45,1.0,v45
mm v[148:151],v[92:95],a[116:119],v[148:151]
v_mul_f32 v53,v181,v213
v_mul_f32 v50,v50,v42
mm v[152:155],v[88:91],a[104:107],v[152:155]
dt v[76:77],v9 offset:34816
mm v[152:155],v[92:95],a[120:123],v[152:155]
s_add_u32 m0,s37,74752
v_exp_f32 v47,v47
mm v[156:159],v[88:91],a[108:111],v[156:159]
dt v[78:79],v9 offset:35072
mm v[156:159],v[92:95],a[124:127],v[156:159]
s_waitcnt lgkmcnt(4)
bl v6,s[20:23],s59 offen lds
mm v[96:99],v[64:67],a[128:131],v[96:99]
dt v[80:81],v8 offset:36864
mm v[96:99],v[68:71],a[144:147],v[96:99]
v_rcp_f32 v45,v45
mm v[100:103],v[64:67],a[132:135],v[100:103]
dt v[82:83],v8 offset:37120
v_add_f32 v46,1.0,v46
mm v[100:103],v[68:71],a[148:151],v[100:103]
v_mul_f32 v54,v182,v214
v_mul_f32 v51,v51,v43
mm v[104:107],v[64:67],a[136:139],v[104:107]
dt v[84:85],v8 offset:38912
cv v61,v50,v51
mm v[104:107],v[68:71],a[152:155],v[104:107]
v_rcp_f32 v46,v46
mm v[108:111],v[64:67],a[140:143],v[108:111]
dt v[86:87],v8 offset:39168
v_add_f32 v47,1.0,v47
mm v[108:111],v[68:71],a[156:159],v[108:111]
s_waitcnt lgkmcnt(4)
v_mul_f32 v55,v183,v215
v_mul_f32 v52,v52,v44
mm v[112:115],v[72:75],a[128:131],v[112:115]
dt v[88:89],v9 offset:36864
mm v[112:115],v[76:79],a[144:147],v[112:115]
v_rcp_f32 v47,v47
mm v[116:119],v[72:75],a[132:135],v[116:119]
dt v[90:91],v9 offset:37120
v_mul_f32 v53,v53,v45
mm v[116:119],v[76:79],a[148:151],v[116:119]
cv v62,v52,v53
v_mul_f32 v54,v54,v46
mm v[120:123],v[72:75],a[136:139],v[120:123]
dt v[92:93],v9 offset:38912
v_mul_f32 v55,v55,v47
mm v[120:123],v[76:79],a[152:155],v[120:123]
s_add_u32 m0,s37,16384
s_add_u32 s56,s54,3670144
cv v63,v54,v55
mm v[124:127],v[72:75],a[140:143],v[124:127]
dt v[94:95],v9 offset:39168
mm v[124:127],v[76:79],a[156:159],v[124:127]
s_waitcnt lgkmcnt(4)
bl v5,s[20:23],s56 offen lds
mm v[128:131],v[80:83],a[128:131],v[128:131]
dt v[64:65],v10 offset:32768
mm v[128:131],v[84:87],a[144:147],v[128:131]
buffer_store_dwordx4 v[60:63],v2,s[8:11],s43 offen offset:3072 sc1
mm v[132:135],v[80:83],a[132:135],v[132:135]
dt v[66:67],v10 offset:33024
v_mul_f32 v40,s61,v168
mm v[132:135],v[84:87],a[148:151],v[132:135]
v_mul_f32 v41,s61,v169
mm v[136:139],v[80:83],a[136:139],v[136:139]
dt v[68:69],v10 offset:34816
mm v[136:139],v[84:87],a[152:155],v[136:139]
v_exp_f32 v40,v40
mm v[140:143],v[80:83],a[140:143],v[140:143]
dt v[70:71],v10 offset:35072
v_mul_f32 v42,s61,v170
mm v[140:143],v[84:87],a[156:159],v[140:143]
s_waitcnt lgkmcnt(4)
v_exp_f32 v41,v41
mm v[144:147],v[88:91],a[128:131],v[144:147]
dt v[72:73],v11 offset:32768
v_add_f32 v40,1.0,v40
mm v[144:147],v[92:95],a[144:147],v[144:147]
v_mul_f32 v48,v168,v200
v_mul_f32 v43,s61,v171
mm v[148:151],v[88:91],a[132:135],v[148:151]
dt v[74:75],v11 offset:33024
mm v[148:151],v[92:95],a[148:151],v[148:151]
v_exp_f32 v42,v42
mm v[152:155],v[88:91],a[136:139],v[152:155]
dt v[76:77],v11 offset:34816
mm v[152:155],v[92:95],a[152:155],v[152:155]
s_add_u32 m0,s37,17408
v_rcp_f32 v40,v40
mm v[156:159],v[88:91],a[140:143],v[156:159]
dt v[78:79],v11 offset:35072
v_add_f32 v41,1.0,v41
mm v[156:159],v[92:95],a[156:159],v[156:159]
s_waitcnt lgkmcnt(4)
bl v6,s[20:23],s56 offen lds
mm v[96:99],v[64:67],a[160:163],v[96:99]
dt v[80:81],v10 offset:36864
v_mul_f32 v49,v169,v201
mm v[96:99],v[68:71],a[176:179],v[96:99]
v_mul_f32 v44,s61,v184
mm v[100:103],v[64:67],a[164:167],v[100:103]
dt v[82:83],v10 offset:37120
mm v[100:103],v[68:71],a[180:183],v[100:103]
v_exp_f32 v43,v43
mm v[104:107],v[64:67],a[168:171],v[104:107]
dt v[84:85],v10 offset:38912
mm v[104:107],v[68:71],a[184:187],v[104:107]
v_rcp_f32 v41,v41
mm v[108:111],v[64:67],a[172:175],v[108:111]
dt v[86:87],v10 offset:39168
v_add_f32 v42,1.0,v42
mm v[108:111],v[68:71],a[188:191],v[108:111]
s_waitcnt lgkmcnt(4)
v_mul_f32 v50,v170,v202
v_mul_f32 v45,s61,v185
mm v[112:115],v[72:75],a[160:163],v[112:115]
dt v[88:89],v11 offset:36864
mm v[112:115],v[76:79],a[176:179],v[112:115]
v_exp_f32 v44,v44
mm v[116:119],v[72:75],a[164:167],v[116:119]
dt v[90:91],v11 offset:37120
mm v[116:119],v[76:79],a[180:183],v[116:119]
v_rcp_f32 v42,v42
mm v[120:123],v[72:75],a[168:171],v[120:123]
dt v[92:93],v11 offset:38912
v_add_f32 v43,1.0,v43
mm v[120:123],v[76:79],a[184:187],v[120:123]
v_mul_f32 v51,v171,v203
v_mul_f32 v48,v48,v40
mm v[124:127],v[72:75],a[172:175],v[124:127]
dt v[94:95],v11 offset:39168
v_mul_f32 v46,s61,v186
mm v[124:127],v[76:79],a[188:191],v[124:127]
s_waitcnt lgkmcnt(4)
s_waitcnt vmcnt(18)
mm v[128:131],v[80:83],a[160:163],v[128:131]
s_barrier
dt v[64:65],v8 offset:40960
mm v[128:131],v[84:87],a[176:179],v[128:131]
s_add_u32 m0,s37,81920
s_add_u32 s57,s54,4194432
mm v[132:135],v[80:83],a[164:167],v[132:135]
dt v[66:67],v8 offset:41216
mm v[132:135],v[84:87],a[180:183],v[132:135]
bl v5,s[20:23],s57 offen lds
mm v[136:139],v[80:83],a[168:171],v[136:139]
dt v[68:69],v8 offset:43008
mm v[136:139],v[84:87],a[184:187],v[136:139]
v_exp_f32 v45,v45
mm v[140:143],v[80:83],a[172:175],v[140:143]
dt v[70:71],v8 offset:43264
mm v[140:143],v[84:87],a[188:191],v[140:143]
s_waitcnt lgkmcnt(4)
v_rcp_f32 v43,v43
mm v[144:147],v[88:91],a[160:163],v[144:147]
dt v[72:73],v9 offset:40960
v_add_f32 v44,1.0,v44
mm v[144:147],v[92:95],a[176:179],v[144:147]
v_mul_f32 v52,v184,v216
v_mul_f32 v49,v49,v41
mm v[148:151],v[88:91],a[164:167],v[148:151]
dt v[74:75],v9 offset:41216
cv v56,v48,v49
mm v[148:151],v[92:95],a[180:183],v[148:151]
v_mul_f32 v47,s61,v187
mm v[152:155],v[88:91],a[168:171],v[152:155]
dt v[76:77],v9 offset:43008
mm v[152:155],v[92:95],a[184:187],v[152:155]
v_exp_f32 v46,v46
mm v[156:159],v[88:91],a[172:175],v[156:159]
s_add_u32 m0,s37,82944
dt v[78:79],v9 offset:43264
mm v[156:159],v[92:95],a[188:191],v[156:159]
s_waitcnt lgkmcnt(4)
v_rcp_f32 v44,v44
mm v[96:99],v[64:67],a[192:195],v[96:99]
dt v[80:81],v8 offset:45056
v_add_f32 v45,1.0,v45
mm v[96:99],v[68:71],a[208:211],v[96:99]
bl v6,s[20:23],s57 offen lds
mm v[100:103],v[64:67],a[196:199],v[100:103]
dt v[82:83],v8 offset:45312
v_mul_f32 v53,v185,v217
mm v[100:103],v[68:71],a[212:215],v[100:103]
v_mul_f32 v50,v50,v42
mm v[104:107],v[64:67],a[200:203],v[104:107]
dt v[84:85],v8 offset:47104
mm v[104:107],v[68:71],a[216:219],v[104:107]
v_exp_f32 v47,v47
mm v[108:111],v[64:67],a[204:207],v[108:111]
dt v[86:87],v8 offset:47360
mm v[108:111],v[68:71],a[220:223],v[108:111]
s_waitcnt lgkmcnt(4)
v_rcp_f32 v45,v45
mm v[112:115],v[72:75],a[192:195],v[112:115]
dt v[88:89],v9 offset:45056
v_add_f32 v46,1.0,v46
mm v[112:115],v[76:79],a[208:211],v[112:115]
v_mul_f32 v54,v186,v218
v_mul_f32 v51,v51,v43
mm v[116:119],v[72:75],a[196:199],v[116:119]
dt v[90:91],v9 offset:45312
cv v57,v50,v51
mm v[116:119],v[76:79],a[212:215],v[116:119]
v_rcp_f32 v46,v46
mm v[120:123],v[72:75],a[200:203],v[120:123]
dt v[92:93],v9 offset:47104
v_add_f32 v47,1.0,v47
mm v[120:123],v[76:79],a[216:219],v[120:123]
v_mul_f32 v55,v187,v219
v_mul_f32 v52,v52,v44
mm v[124:127],v[72:75],a[204:207],v[124:127]
s_add_u32 m0,s37,24576
s_add_u32 s58,s54,0
dt v[94:95],v9 offset:47360
mm v[124:127],v[76:79],a[220:223],v[124:127]
s_waitcnt lgkmcnt(4)
v_rcp_f32 v47,v47
mm v[128:131],v[80:83],a[192:195],v[128:131]
dt v[64:65],v10 offset:40960
v_mul_f32 v53,v53,v45
mm v[128:131],v[84:87],a[208:211],v[128:131]
bl v5,s[20:23],s58 offen lds
mm v[132:135],v[80:83],a[196:199],v[132:135]
dt v[66:67],v10 offset:41216
cv v58,v52,v53
mm v[132:135],v[84:87],a[212:215],v[132:135]
v_mul_f32 v54,v54,v46
v_mul_f32 v55,v55,v47
mm v[136:139],v[80:83],a[200:203],v[136:139]
dt v[68:69],v10 offset:43008
cv v59,v54,v55
mm v[136:139],v[84:87],a[216:219],v[136:139]
buffer_store_dwordx4 v[56:59],v2,s[8:11],s44 offen offset:3072 sc1
mm v[140:143],v[80:83],a[204:207],v[140:143]
dt v[70:71],v10 offset:43264
mm v[140:143],v[84:87],a[220:223],v[140:143]
s_waitcnt lgkmcnt(4)
v_mul_f32 v40,s61,v172
mm v[144:147],v[88:91],a[192:195],v[144:147]
dt v[72:73],v11 offset:40960
v_mul_f32 v41,s61,v173
mm v[144:147],v[92:95],a[208:211],v[144:147]
v_exp_f32 v40,v40
mm v[148:151],v[88:91],a[196:199],v[148:151]
dt v[74:75],v11 offset:41216
mm v[148:151],v[92:95],a[212:215],v[148:151]
v_mul_f32 v42,s61,v174
mm v[152:155],v[88:91],a[200:203],v[152:155]
dt v[76:77],v11 offset:43008
mm v[152:155],v[92:95],a[216:219],v[152:155]
s_add_u32 m0,s37,25600
v_exp_f32 v41,v41
mm v[156:159],v[88:91],a[204:207],v[156:159]
dt v[78:79],v11 offset:43264
v_add_f32 v40,1.0,v40
mm v[156:159],v[92:95],a[220:223],v[156:159]
s_waitcnt lgkmcnt(4)
bl v6,s[20:23],s58 offen lds
mm v[96:99],v[64:67],a[224:227],v[96:99]
dt v[80:81],v10 offset:45056
v_mul_f32 v48,v172,v204
mm v[96:99],v[68:71],a[240:243],v[96:99]
v_mul_f32 v43,s61,v175
mm v[100:103],v[64:67],a[228:231],v[100:103]
dt v[82:83],v10 offset:45312
mm v[100:103],v[68:71],a[244:247],v[100:103]
v_exp_f32 v42,v42
mm v[104:107],v[64:67],a[232:235],v[104:107]
dt v[84:85],v10 offset:47104
mm v[104:107],v[68:71],a[248:251],v[104:107]
v_rcp_f32 v40,v40
mm v[108:111],v[64:67],a[236:239],v[108:111]
dt v[86:87],v10 offset:47360
v_add_f32 v41,1.0,v41
mm v[108:111],v[68:71],a[252:255],v[108:111]
s_waitcnt lgkmcnt(4)
v_mul_f32 v49,v173,v205
v_mul_f32 v44,s61,v188
mm v[112:115],v[72:75],a[224:227],v[112:115]
dt v[88:89],v11 offset:45056
mm v[112:115],v[76:79],a[240:243],v[112:115]
v_exp_f32 v43,v43
mm v[116:119],v[72:75],a[228:231],v[116:119]
dt v[90:91],v11 offset:45312
mm v[116:119],v[76:79],a[244:247],v[116:119]
v_rcp_f32 v41,v41
mm v[120:123],v[72:75],a[232:235],v[120:123]
dt v[92:93],v11 offset:47104
v_add_f32 v42,1.0,v42
mm v[120:123],v[76:79],a[248:251],v[120:123]
s_add_u32 m0,s37,90112
s_add_u32 s59,s54,524288
v_mul_f32 v50,v174,v206
mm v[124:127],v[72:75],a[236:239],v[124:127]
dt v[94:95],v11 offset:47360
v_mul_f32 v45,s61,v189
mm v[124:127],v[76:79],a[252:255],v[124:127]
s_waitcnt lgkmcnt(4)
bl v5,s[20:23],s59 offen lds
mm v[128:131],v[80:83],a[224:227],v[128:131]
dt v[64:65],v8 offset:49152
mm v[128:131],v[84:87],a[240:243],v[128:131]
v_exp_f32 v44,v44
mm v[132:135],v[80:83],a[228:231],v[132:135]
dt v[66:67],v8 offset:49408
mm v[132:135],v[84:87],a[244:247],v[132:135]
v_rcp_f32 v42,v42
mm v[136:139],v[80:83],a[232:235],v[136:139]
dt v[68:69],v8 offset:51200
v_add_f32 v43,1.0,v43
mm v[136:139],v[84:87],a[248:251],v[136:139]
v_mul_f32 v51,v175,v207
v_mul_f32 v48,v48,v40
mm v[140:143],v[80:83],a[236:239],v[140:143]
dt v[70:71],v8 offset:51456
v_mul_f32 v46,s61,v190
mm v[140:143],v[84:87],a[252:255],v[140:143]
s_waitcnt lgkmcnt(4)
v_exp_f32 v45,v45
mm v[144:147],v[88:91],a[224:227],v[144:147]
dt v[72:73],v9 offset:49152
mm v[144:147],v[92:95],a[240:243],v[144:147]
v_rcp_f32 v43,v43
mm v[148:151],v[88:91],a[228:231],v[148:151]
dt v[74:75],v9 offset:49408
v_add_f32 v44,1.0,v44
mm v[148:151],v[92:95],a[244:247],v[148:151]
v_mul_f32 v52,v188,v220
mm v[152:155],v[88:91],a[232:235],v[152:155]
dt v[76:77],v9 offset:51200
v_mul_f32 v49,v49,v41
mm v[152:155],v[92:95],a[248:251],v[152:155]
s_add_u32 m0,s37,91136
cv v60,v48,v49
mm v[156:159],v[88:91],a[236:239],v[156:159]
dt v[78:79],v9 offset:51456
v_mul_f32 v47,s61,v191
mm v[156:159],v[92:95],a[252:255],v[156:159]
s_waitcnt lgkmcnt(4)
bl v6,s[20:23],s59 offen lds
mm v[96:99],v[64:67],v[224:227],v[96:99]
dt v[80:81],v8 offset:53248
mm v[96:99],v[68:71],v[240:243],v[96:99]
v_exp_f32 v46,v46
mm v[100:103],v[64:67],v[228:231],v[100:103]
dt v[82:83],v8 offset:53504
mm v[100:103],v[68:71],v[244:247],v[100:103]
v_rcp_f32 v44,v44
mm v[104:107],v[64:67],v[232:235],v[104:107]
dt v[84:85],v8 offset:55296
v_add_f32 v45,1.0,v45
mm v[104:107],v[68:71],v[248:251],v[104:107]
v_mul_f32 v53,v189,v221
v_mul_f32 v50,v50,v42
mm v[108:111],v[64:67],v[236:239],v[108:111]
dt v[86:87],v8 offset:55552
mm v[108:111],v[68:71],v[252:255],v[108:111]
s_waitcnt lgkmcnt(4)
v_exp_f32 v47,v47
mm v[112:115],v[72:75],v[224:227],v[112:115]
dt v[88:89],v9 offset:53248
mm v[112:115],v[76:79],v[240:243],v[112:115]
v_rcp_f32 v45,v45
mm v[116:119],v[72:75],v[228:231],v[116:119]
dt v[90:91],v9 offset:53504
v_add_f32 v46,1.0,v46
mm v[116:119],v[76:79],v[244:247],v[116:119]
v_mul_f32 v54,v190,v222
v_mul_f32 v51,v51,v43
mm v[120:123],v[72:75],v[232:235],v[120:123]
dt v[92:93],v9 offset:55296
mm v[120:123],v[76:79],v[248:251],v[120:123]
s_add_u32 m0,s37,32768
s_add_u32 s56,s54,1048576
cv v61,v50,v51
mm v[124:127],v[72:75],v[236:239],v[124:127]
dt v[94:95],v9 offset:55552
mm v[124:127],v[76:79],v[252:255],v[124:127]
s_waitcnt lgkmcnt(4)
bl v5,s[20:23],s56 offen lds
mm v[128:131],v[80:83],v[224:227],v[128:131]
dt v[64:65],v14 offset:49152
mm v[128:131],v[84:87],v[240:243],v[128:131]
v_rcp_f32 v46,v46
mm v[132:135],v[80:83],v[228:231],v[132:135]
dt v[66:67],v14 offset:49664
v_add_f32 v47,1.0,v47
mm v[132:135],v[84:87],v[244:247],v[132:135]
v_mul_f32 v55,v191,v223
v_mul_f32 v52,v52,v44
mm v[136:139],v[80:83],v[232:235],v[136:139]
dt v[68:69],v14 offset:53248
mm v[136:139],v[84:87],v[248:251],v[136:139]
v_rcp_f32 v47,v47
mm v[140:143],v[80:83],v[236:239],v[140:143]
dt v[70:71],v14 offset:53760
v_mul_f32 v53,v53,v45
mm v[140:143],v[84:87],v[252:255],v[140:143]
s_waitcnt lgkmcnt(4)
cv v62,v52,v53
v_mul_f32 v54,v54,v46
mm v[144:147],v[88:91],v[224:227],v[144:147]
dt v[72:73],v14 offset:49160
v_mul_f32 v55,v55,v47
mm v[144:147],v[92:95],v[240:243],v[144:147]
cv v63,v54,v55
mm v[148:151],v[88:91],v[228:231],v[148:151]
dt v[74:75],v14 offset:49672
mm v[148:151],v[92:95],v[244:247],v[148:151]
buffer_store_dwordx4 v[60:63],v2,s[8:11],s45 offen offset:3072 sc1
mm v[152:155],v[88:91],v[232:235],v[152:155]
dt v[76:77],v14 offset:53256
mm v[152:155],v[92:95],v[248:251],v[152:155]
s_add_u32 m0,s37,33792
mm v[156:159],v[88:91],v[236:239],v[156:159]
dt v[78:79],v14 offset:53768
mm v[156:159],v[92:95],v[252:255],v[156:159]
s_waitcnt lgkmcnt(4)
bl v6,s[20:23],s56 offen lds
mm v[160:163],v[64:67],a[0:3],0
dt v[80:81],v15 offset:49152
mm v[160:163],v[68:71],a[16:19],v[160:163]
mm v[164:167],v[64:67],a[4:7],0
dt v[82:83],v15 offset:49664
mm v[164:167],v[68:71],a[20:23],v[164:167]
mm v[168:171],v[64:67],a[8:11],0
dt v[84:85],v15 offset:53248
mm v[168:171],v[68:71],a[24:27],v[168:171]
mm v[172:175],v[64:67],a[12:15],0
dt v[86:87],v15 offset:53760
v_mul_f32 v40,s61,v96
mm v[172:175],v[68:71],a[28:31],v[172:175]
s_waitcnt lgkmcnt(4)
v_mul_f32 v41,s61,v97
mm v[176:179],v[72:75],a[0:3],0
dt v[88:89],v15 offset:49160
mm v[176:179],v[76:79],a[16:19],v[176:179]
v_exp_f32 v40,v40
mm v[180:183],v[72:75],a[4:7],0
dt v[90:91],v15 offset:49672
v_mul_f32 v42,s61,v98
mm v[180:183],v[76:79],a[20:23],v[180:183]
v_exp_f32 v41,v41
mm v[184:187],v[72:75],a[8:11],0
dt v[92:93],v15 offset:53256
v_add_f32 v40,1.0,v40
mm v[184:187],v[76:79],a[24:27],v[184:187]
v_mul_f32 v48,v96,v128
v_mul_f32 v43,s61,v99
mm v[188:191],v[72:75],a[12:15],0
dt v[94:95],v15 offset:53768
mm v[188:191],v[76:79],a[28:31],v[188:191]
s_waitcnt lgkmcnt(4)
s_waitcnt vmcnt(18)
mm v[192:195],v[80:83],a[0:3],0
s_barrier
dt v[64:65],v12 offset:57344
mm v[192:195],v[84:87],a[16:19],v[192:195]
s_add_u32 m0,s37,98304
s_add_u32 s57,s54,1572864
mm v[196:199],v[80:83],a[4:7],0
dt v[66:67],v12 offset:57856
mm v[196:199],v[84:87],a[20:23],v[196:199]
bl v5,s[20:23],s57 offen lds
mm v[200:203],v[80:83],a[8:11],0
dt v[68:69],v12 offset:61440
mm v[200:203],v[84:87],a[24:27],v[200:203]
v_exp_f32 v42,v42
mm v[204:207],v[80:83],a[12:15],0
dt v[70:71],v12 offset:61952
mm v[204:207],v[84:87],a[28:31],v[204:207]
s_waitcnt lgkmcnt(4)
v_rcp_f32 v40,v40
mm v[208:211],v[88:91],a[0:3],0
dt v[72:73],v12 offset:57352
v_add_f32 v41,1.0,v41
mm v[208:211],v[92:95],a[16:19],v[208:211]
v_mul_f32 v49,v97,v129
v_mul_f32 v44,s61,v112
mm v[212:215],v[88:91],a[4:7],0
dt v[74:75],v12 offset:57864
mm v[212:215],v[92:95],a[20:23],v[212:215]
v_exp_f32 v43,v43
mm v[216:219],v[88:91],a[8:11],0
dt v[76:77],v12 offset:61448
mm v[216:219],v[92:95],a[24:27],v[216:219]
v_rcp_f32 v41,v41
mm v[220:223],v[88:91],a[12:15],0
s_add_u32 m0,s37,99328
dt v[78:79],v12 offset:61960
v_add_f32 v42,1.0,v42
mm v[220:223],v[92:95],a[28:31],v[220:223]
s_waitcnt lgkmcnt(4)
v_mul_f32 v50,v98,v130
v_mul_f32 v45,s61,v113
mm v[160:163],v[64:67],a[32:35],v[160:163]
dt v[80:81],v13 offset:57344
mm v[160:163],v[68:71],a[48:51],v[160:163]
bl v6,s[20:23],s57 offen lds
mm v[164:167],v[64:67],a[36:39],v[164:167]
dt v[82:83],v13 offset:57856
mm v[164:167],v[68:71],a[52:55],v[164:167]
v_exp_f32 v44,v44
mm v[168:171],v[64:67],a[40:43],v[168:171]
dt v[84:85],v13 offset:61440
mm v[168:171],v[68:71],a[56:59],v[168:171]
v_rcp_f32 v42,v42
mm v[172:175],v[64:67],a[44:47],v[172:175]
dt v[86:87],v13 offset:61952
v_add_f32 v43,1.0,v43
mm v[172:175],v[68:71],a[60:63],v[172:175]
s_waitcnt lgkmcnt(4)
v_mul_f32 v51,v99,v131
v_mul_f32 v48,v48,v40
mm v[176:179],v[72:75],a[32:35],v[176:179]
dt v[88:89],v13 offset:57352
v_mul_f32 v46,s61,v114
mm v[176:179],v[76:79],a[48:51],v[176:179]
v_exp_f32 v45,v45
mm v[180:183],v[72:75],a[36:39],v[180:183]
dt v[90:91],v13 offset:57864
mm v[180:183],v[76:79],a[52:55],v[180:183]
v_rcp_f32 v43,v43
mm v[184:187],v[72:75],a[40:43],v[184:187]
dt v[92:93],v13 offset:61448
v_add_f32 v44,1.0,v44
mm v[184:187],v[76:79],a[56:59],v[184:187]
v_mul_f32 v52,v112,v144
v_mul_f32 v49,v49,v41
mm v[188:191],v[72:75],a[44:47],v[188:191]
s_add_u32 m0,s37,40960
s_add_u32 s58,s54,2097152
dt v[94:95],v13 offset:61960
mm v[188:191],v[76:79],a[60:63],v[188:191]
s_waitcnt lgkmcnt(4)
cv v56,v48,v49
v_mul_f32 v47,s61,v115
mm v[192:195],v[80:83],a[32:35],v[192:195]
dt v[64:65],v14 offset:57344
mm v[192:195],v[84:87],a[48:51],v[192:195]
bl v5,s[20:23],s58 offen lds
mm v[196:199],v[80:83],a[36:39],v[196:199]
dt v[66:67],v14 offset:57856
mm v[196:199],v[84:87],a[52:55],v[196:199]
v_exp_f32 v46,v46
mm v[200:203],v[80:83],a[40:43],v[200:203]
dt v[68:69],v14 offset:61440
mm v[200:203],v[84:87],a[56:59],v[200:203]
v_rcp_f32 v44,v44
mm v[204:207],v[80:83],a[44:47],v[204:207]
dt v[70:71],v14 offset:61952
v_add_f32 v45,1.0,v45
mm v[204:207],v[84:87],a[60:63],v[204:207]
s_waitcnt lgkmcnt(4)
v_mul_f32 v53,v113,v145
v_mul_f32 v50,v50,v42
mm v[208:211],v[88:91],a[32:35],v[208:211]
dt v[72:73],v14 offset:57352
mm v[208:211],v[92:95],a[48:51],v[208:211]
v_exp_f32 v47,v47
mm v[212:215],v[88:91],a[36:39],v[212:215]
dt v[74:75],v14 offset:57864
mm v[212:215],v[92:95],a[52:55],v[212:215]
v_rcp_f32 v45,v45
mm v[216:219],v[88:91],a[40:43],v[216:219]
dt v[76:77],v14 offset:61448
v_add_f32 v46,1.0,v46
mm v[216:219],v[92:95],a[56:59],v[216:219]
s_add_u32 m0,s37,41984
v_mul_f32 v54,v114,v146
v_mul_f32 v51,v51,v43
mm v[220:223],v[88:91],a[44:47],v[220:223]
dt v[78:79],v14 offset:61960
cv v57,v50,v51
mm v[220:223],v[92:95],a[60:63],v[220:223]
s_waitcnt lgkmcnt(4)
bl v6,s[20:23],s58 offen lds
mm v[160:163],v[64:67],a[64:67],v[160:163]
dt v[80:81],v15 offset:57344
mm v[160:163],v[68:71],a[80:83],v[160:163]
v_rcp_f32 v46,v46
mm v[164:167],v[64:67],a[68:71],v[164:167]
dt v[82:83],v15 offset:57856
v_add_f32 v47,1.0,v47
mm v[164:167],v[68:71],a[84:87],v[164:167]
v_mul_f32 v55,v115,v147
v_mul_f32 v52,v52,v44
mm v[168:171],v[64:67],a[72:75],v[168:171]
dt v[84:85],v15 offset:61440
mm v[168:171],v[68:71],a[88:91],v[168:171]
v_rcp_f32 v47,v47
mm v[172:175],v[64:67],a[76:79],v[172:175]
dt v[86:87],v15 offset:61952
v_mul_f32 v53,v53,v45
mm v[172:175],v[68:71],a[92:95],v[172:175]
s_waitcnt lgkmcnt(4)
cv v58,v52,v53
v_mul_f32 v54,v54,v46
mm v[176:179],v[72:75],a[64:67],v[176:179]
dt v[88:89],v15 offset:57352
v_mul_f32 v55,v55,v47
mm v[176:179],v[76:79],a[80:83],v[176:179]
cv v59,v54,v55
mm v[180:183],v[72:75],a[68:71],v[180:183]
s_add_u32 s101,s42,s46
dt v[90:91],v15 offset:57864
mm v[180:183],v[76:79],a[84:87],v[180:183]
buffer_store_dwordx4 v[56:59],v2,s[8:11],s101 offen offset:0 sc1
mm v[184:187],v[72:75],a[72:75],v[184:187]
dt v[92:93],v15 offset:61448
v_mul_f32 v40,s61,v100
mm v[184:187],v[76:79],a[88:91],v[184:187]
s_add_u32 m0,s37,106496
s_add_u32 s59,s54,2621440
v_mul_f32 v41,s61,v101
mm v[188:191],v[72:75],a[76:79],v[188:191]
dt v[94:95],v15 offset:61960
mm v[188:191],v[76:79],a[92:95],v[188:191]
s_waitcnt lgkmcnt(4)
bl v5,s[20:23],s59 offen lds
mm v[192:195],v[80:83],a[64:67],v[192:195]
dt v[64:65],v12 offset:0
mm v[192:195],v[84:87],a[80:83],v[192:195]
v_exp_f32 v40,v40
mm v[196:199],v[80:83],a[68:71],v[196:199]
dt v[66:67],v12 offset:512
v_mul_f32 v42,s61,v102
mm v[196:199],v[84:87],a[84:87],v[196:199]
v_exp_f32 v41,v41
mm v[200:203],v[80:83],a[72:75],v[200:203]
dt v[68:69],v12 offset:4096
v_add_f32 v40,1.0,v40
mm v[200:203],v[84:87],a[88:91],v[200:203]
v_mul_f32 v48,v100,v132
v_mul_f32 v43,s61,v103
mm v[204:207],v[80:83],a[76:79],v[204:207]
dt v[70:71],v12 offset:4608
mm v[204:207],v[84:87],a[92:95],v[204:207]
s_waitcnt lgkmcnt(4)
v_exp_f32 v42,v42
mm v[208:211],v[88:91],a[64:67],v[208:211]
dt v[72:73],v12 offset:8
mm v[208:211],v[92:95],a[80:83],v[208:211]
v_rcp_f32 v40,v40
mm v[212:215],v[88:91],a[68:71],v[212:215]
dt v[74:75],v12 offset:520
v_add_f32 v41,1.0,v41
mm v[212:215],v[92:95],a[84:87],v[212:215]
v_mul_f32 v49,v101,v133
v_mul_f32 v44,s61,v116
mm v[216:219],v[88:91],a[72:75],v[216:219]
dt v[76:77],v12 offset:4104
mm v[216:219],v[92:95],a[88:91],v[216:219]
s_add_u32 m0,s37,107520
v_exp_f32 v43,v43
mm v[220:223],v[88:91],a[76:79],v[220:223]
dt v[78:79],v12 offset:4616
mm v[220:223],v[92:95],a[92:95],v[220:223]
s_waitcnt lgkmcnt(4)
bl v6,s[20:23],s59 offen lds
mm v[160:163],v[64:67],a[96:99],v[160:163]
dt v[80:81],v13 offset:0
mm v[160:163],v[68:71],a[112:115],v[160:163]
v_rcp_f32 v41,v41
mm v[164:167],v[64:67],a[100:103],v[164:167]
dt v[82:83],v13 offset:512
v_add_f32 v42,1.0,v42
mm v[164:167],v[68:71],a[116:119],v[164:167]
v_mul_f32 v50,v102,v134
v_mul_f32 v45,s61,v117
mm v[168:171],v[64:67],a[104:107],v[168:171]
dt v[84:85],v13 offset:4096
mm v[168:171],v[68:71],a[120:123],v[168:171]
v_exp_f32 v44,v44
mm v[172:175],v[64:67],a[108:111],v[172:175]
dt v[86:87],v13 offset:4608
mm v[172:175],v[68:71],a[124:127],v[172:175]
s_waitcnt lgkmcnt(4)
v_rcp_f32 v42,v42
mm v[176:179],v[72:75],a[96:99],v[176:179]
dt v[88:89],v13 offset:8
v_add_f32 v43,1.0,v43
mm v[176:179],v[76:79],a[112:115],v[176:179]
v_mul_f32 v51,v103,v135
v_mul_f32 v48,v48,v40
mm v[180:183],v[72:75],a[100:103],v[180:183]
dt v[90:91],v13 offset:520
v_mul_f32 v46,s61,v118
mm v[180:183],v[76:79],a[116:119],v[180:183]
v_exp_f32 v45,v45
mm v[184:187],v[72:75],a[104:107],v[184:187]
dt v[92:93],v13 offset:4104
mm v[184:187],v[76:79],a[120:123],v[184:187]
s_add_u32 m0,s37,49152
s_add_u32 s56,s54,3145728
mm v[188:191],v[72:75],a[108:111],v[188:191]
dt v[94:95],v13 offset:4616
mm v[188:191],v[76:79],a[124:127],v[188:191]
s_waitcnt lgkmcnt(4)
bl v5,s[20:23],s56 offen lds
mm v[192:195],v[80:83],a[96:99],v[192:195]
dt v[64:65],v14 offset:0
mm v[192:195],v[84:87],a[112:115],v[192:195]
v_rcp_f32 v43,v43
mm v[196:199],v[80:83],a[100:103],v[196:199]
dt v[66:67],v14 offset:512
v_add_f32 v44,1.0,v44
mm v[196:199],v[84:87],a[116:119],v[196:199]
v_mul_f32 v52,v116,v148
v_mul_f32 v49,v49,v41
mm v[200:203],v[80:83],a[104:107],v[200:203]
dt v[68:69],v14 offset:4096
cv v60,v48,v49
mm v[200:203],v[84:87],a[120:123],v[200:203]
v_mul_f32 v47,s61,v119
mm v[204:207],v[80:83],a[108:111],v[204:207]
dt v[70:71],v14 offset:4608
mm v[204:207],v[84:87],a[124:127],v[204:207]
s_waitcnt lgkmcnt(4)
v_exp_f32 v46,v46
mm v[208:211],v[88:91],a[96:99],v[208:211]
dt v[72:73],v14 offset:8
mm v[208:211],v[92:95],a[112:115],v[208:211]
v_rcp_f32 v44,v44
mm v[212:215],v[88:91],a[100:103],v[212:215]
dt v[74:75],v14 offset:520
v_add_f32 v45,1.0,v45
mm v[212:215],v[92:95],a[116:119],v[212:215]
v_mul_f32 v53,v117,v149
v_mul_f32 v50,v50,v42
mm v[216:219],v[88:91],a[104:107],v[216:219]
dt v[76:77],v14 offset:4104
mm v[216:219],v[92:95],a[120:123],v[216:219]
s_add_u32 m0,s37,50176
v_exp_f32 v47,v47
mm v[220:223],v[88:91],a[108:111],v[220:223]
dt v[78:79],v14 offset:4616
mm v[220:223],v[92:95],a[124:127],v[220:223]
s_waitcnt lgkmcnt(4)
bl v6,s[20:23],s56 offen lds
mm v[160:163],v[64:67],a[128:131],v[160:163]
dt v[80:81],v15 offset:0
mm v[160:163],v[68:71],a[144:147],v[160:163]
v_rcp_f32 v45,v45
mm v[164:167],v[64:67],a[132:135],v[164:167]
dt v[82:83],v15 offset:512
v_add_f32 v46,1.0,v46
mm v[164:167],v[68:71],a[148:151],v[164:167]
v_mul_f32 v54,v118,v150
v_mul_f32 v51,v51,v43
mm v[168:171],v[64:67],a[136:139],v[168:171]
dt v[84:85],v15 offset:4096
cv v61,v50,v51
mm v[168:171],v[68:71],a[152:155],v[168:171]
v_rcp_f32 v46,v46
mm v[172:175],v[64:67],a[140:143],v[172:175]
dt v[86:87],v15 offset:4608
v_add_f32 v47,1.0,v47
mm v[172:175],v[68:71],a[156:159],v[172:175]
s_waitcnt lgkmcnt(4)
v_mul_f32 v55,v119,v151
v_mul_f32 v52,v52,v44
mm v[176:179],v[72:75],a[128:131],v[176:179]
dt v[88:89],v15 offset:8
mm v[176:179],v[76:79],a[144:147],v[176:179]
v_rcp_f32 v47,v47
mm v[180:183],v[72:75],a[132:135],v[180:183]
dt v[90:91],v15 offset:520
v_mul_f32 v53,v53,v45
mm v[180:183],v[76:79],a[148:151],v[180:183]
cv v62,v52,v53
v_mul_f32 v54,v54,v46
mm v[184:187],v[72:75],a[136:139],v[184:187]
dt v[92:93],v15 offset:4104
v_mul_f32 v55,v55,v47
mm v[184:187],v[76:79],a[152:155],v[184:187]
cv v63,v54,v55
mm v[188:191],v[72:75],a[140:143],v[188:191]
s_add_u32 s101,s43,s46
dt v[94:95],v15 offset:4616
buffer_store_dwordx4 v[60:63],v2,s[8:11],s101 offen offset:0 sc1
mm v[188:191],v[76:79],a[156:159],v[188:191]
s_waitcnt lgkmcnt(4)
s_waitcnt vmcnt(18)
mm v[192:195],v[80:83],a[128:131],v[192:195]
s_barrier
dt v[64:65],v12 offset:8192
v_mul_f32 v40,s61,v104
mm v[192:195],v[84:87],a[144:147],v[192:195]
s_add_u32 m0,s37,114688
s_add_u32 s57,s54,3670016
v_mul_f32 v41,s61,v105
mm v[196:199],v[80:83],a[132:135],v[196:199]
dt v[66:67],v12 offset:8704
mm v[196:199],v[84:87],a[148:151],v[196:199]
bl v5,s[20:23],s57 offen lds
mm v[200:203],v[80:83],a[136:139],v[200:203]
dt v[68:69],v12 offset:12288
mm v[200:203],v[84:87],a[152:155],v[200:203]
v_exp_f32 v40,v40
mm v[204:207],v[80:83],a[140:143],v[204:207]
dt v[70:71],v12 offset:12800
v_mul_f32 v42,s61,v106
mm v[204:207],v[84:87],a[156:159],v[204:207]
s_waitcnt lgkmcnt(4)
v_exp_f32 v41,v41
mm v[208:211],v[88:91],a[128:131],v[208:211]
dt v[72:73],v12 offset:8200
v_add_f32 v40,1.0,v40
mm v[208:211],v[92:95],a[144:147],v[208:211]
v_mul_f32 v48,v104,v136
mm v[212:215],v[88:91],a[132:135],v[212:215]
dt v[74:75],v12 offset:8712
v_mul_f32 v43,s61,v107
mm v[212:215],v[92:95],a[148:151],v[212:215]
v_exp_f32 v42,v42
mm v[216:219],v[88:91],a[136:139],v[216:219]
dt v[76:77],v12 offset:12296
mm v[216:219],v[92:95],a[152:155],v[216:219]
v_rcp_f32 v40,v40
mm v[220:223],v[88:91],a[140:143],v[220:223]
s_add_u32 m0,s37,115712
dt v[78:79],v12 offset:12808
mm v[220:223],v[92:95],a[156:159],v[220:223]
s_waitcnt lgkmcnt(4)
v_add_f32 v41,1.0,v41
v_mul_f32 v49,v105,v137
mm v[160:163],v[64:67],a[160:163],v[160:163]
dt v[80:81],v13 offset:8192
v_mul_f32 v44,s61,v120
mm v[160:163],v[68:71],a[176:179],v[160:163]
bl v6,s[20:23],s57 offen lds
mm v[164:167],v[64:67],a[164:167],v[164:167]
dt v[82:83],v13 offset:8704
mm v[164:167],v[68:71],a[180:183],v[164:167]
v_exp_f32 v43,v43
mm v[168:171],v[64:67],a[168:171],v[168:171]
dt v[84:85],v13 offset:12288
mm v[168:171],v[68:71],a[184:187],v[168:171]
v_rcp_f32 v41,v41
mm v[172:175],v[64:67],a[172:175],v[172:175]
dt v[86:87],v13 offset:12800
v_add_f32 v42,1.0,v42
mm v[172:175],v[68:71],a[188:191],v[172:175]
s_waitcnt lgkmcnt(4)
v_mul_f32 v50,v106,v138
v_mul_f32 v45,s61,v121
mm v[176:179],v[72:75],a[160:163],v[176:179]
dt v[88:89],v13 offset:8200
mm v[176:179],v[76:79],a[176:179],v[176:179]
v_exp_f32 v44,v44
mm v[180:183],v[72:75],a[164:167],v[180:183]
dt v[90:91],v13 offset:8712
mm v[180:183],v[76:79],a[180:183],v[180:183]
v_rcp_f32 v42,v42
mm v[184:187],v[72:75],a[168:171],v[184:187]
dt v[92:93],v13 offset:12296
v_add_f32 v43,1.0,v43
mm v[184:187],v[76:79],a[184:187],v[184:187]
v_mul_f32 v51,v107,v139
mm v[188:191],v[72:75],a[172:175],v[188:191]
s_add_u32 m0,s37,57344
s_add_u32 s58,s54,4194304
dt v[94:95],v13 offset:12808
mm v[188:191],v[76:79],a[188:191],v[188:191]
s_waitcnt lgkmcnt(4)
v_mul_f32 v48,v48,v40
v_mul_f32 v46,s61,v122
mm v[192:195],v[80:83],a[160:163],v[192:195]
dt v[64:65],v14 offset:8192
mm v[192:195],v[84:87],a[176:179],v[192:195]
bl v5,s[20:23],s58 offen lds
mm v[196:199],v[80:83],a[164:167],v[196:199]
dt v[66:67],v14 offset:8704
mm v[196:199],v[84:87],a[180:183],v[196:199]
v_exp_f32 v45,v45
mm v[200:203],v[80:83],a[168:171],v[200:203]
dt v[68:69],v14 offset:12288
mm v[200:203],v[84:87],a[184:187],v[200:203]
v_rcp_f32 v43,v43
mm v[204:207],v[80:83],a[172:175],v[204:207]
dt v[70:71],v14 offset:12800
v_add_f32 v44,1.0,v44
mm v[204:207],v[84:87],a[188:191],v[204:207]
s_waitcnt lgkmcnt(4)
v_mul_f32 v52,v120,v152
v_mul_f32 v49,v49,v41
mm v[208:211],v[88:91],a[160:163],v[208:211]
dt v[72:73],v14 offset:8200
cv v56,v48,v49
mm v[208:211],v[92:95],a[176:179],v[208:211]
v_mul_f32 v47,s61,v123
mm v[212:215],v[88:91],a[164:167],v[212:215]
dt v[74:75],v14 offset:8712
mm v[212:215],v[92:95],a[180:183],v[212:215]
v_exp_f32 v46,v46
mm v[216:219],v[88:91],a[168:171],v[216:219]
dt v[76:77],v14 offset:12296
mm v[216:219],v[92:95],a[184:187],v[216:219]
s_add_u32 m0,s37,58368
v_rcp_f32 v44,v44
mm v[220:223],v[88:91],a[172:175],v[220:223]
dt v[78:79],v14 offset:12808
v_add_f32 v45,1.0,v45
mm v[220:223],v[92:95],a[188:191],v[220:223]
s_waitcnt lgkmcnt(4)
bl v6,s[20:23],s58 offen lds
mm v[160:163],v[64:67],a[192:195],v[160:163]
dt v[80:81],v15 offset:8192
v_mul_f32 v53,v121,v153
mm v[160:163],v[68:71],a[208:211],v[160:163]
v_mul_f32 v50,v50,v42
mm v[164:167],v[64:67],a[196:199],v[164:167]
dt v[82:83],v15 offset:8704
mm v[164:167],v[68:71],a[212:215],v[164:167]
v_exp_f32 v47,v47
mm v[168:171],v[64:67],a[200:203],v[168:171]
dt v[84:85],v15 offset:12288
mm v[168:171],v[68:71],a[216:219],v[168:171]
v_rcp_f32 v45,v45
mm v[172:175],v[64:67],a[204:207],v[172:175]
dt v[86:87],v15 offset:12800
v_add_f32 v46,1.0,v46
mm v[172:175],v[68:71],a[220:223],v[172:175]
s_waitcnt lgkmcnt(4)
v_mul_f32 v54,v122,v154
v_mul_f32 v51,v51,v43
mm v[176:179],v[72:75],a[192:195],v[176:179]
dt v[88:89],v15 offset:8200
cv v57,v50,v51
mm v[176:179],v[76:79],a[208:211],v[176:179]
v_rcp_f32 v46,v46
mm v[180:183],v[72:75],a[196:199],v[180:183]
dt v[90:91],v15 offset:8712
v_add_f32 v47,1.0,v47
mm v[180:183],v[76:79],a[212:215],v[180:183]
v_mul_f32 v55,v123,v155
v_mul_f32 v52,v52,v44
mm v[184:187],v[72:75],a[200:203],v[184:187]
dt v[92:93],v15 offset:12296
mm v[184:187],v[76:79],a[216:219],v[184:187]
s_add_u32 m0,s37,122880
s_add_u32 s59,s55,0
mm v[188:191],v[72:75],a[204:207],v[188:191]
dt v[94:95],v15 offset:12808
mm v[188:191],v[76:79],a[220:223],v[188:191]
s_waitcnt lgkmcnt(4)
bl v16,s[24:27],s59 offen lds
mm v[192:195],v[80:83],a[192:195],v[192:195]
dt v[64:65],v12 offset:16384
mm v[192:195],v[84:87],a[208:211],v[192:195]
v_rcp_f32 v47,v47
mm v[196:199],v[80:83],a[196:199],v[196:199]
dt v[66:67],v12 offset:16896
v_mul_f32 v53,v53,v45
mm v[196:199],v[84:87],a[212:215],v[196:199]
cv v58,v52,v53
v_mul_f32 v54,v54,v46
mm v[200:203],v[80:83],a[200:203],v[200:203]
dt v[68:69],v12 offset:20480
v_mul_f32 v55,v55,v47
mm v[200:203],v[84:87],a[216:219],v[200:203]
cv v59,v54,v55
mm v[204:207],v[80:83],a[204:207],v[204:207]
s_add_u32 s101,s44,s46
dt v[70:71],v12 offset:20992
mm v[204:207],v[84:87],a[220:223],v[204:207]
s_waitcnt lgkmcnt(4)
buffer_store_dwordx4 v[56:59],v2,s[8:11],s101 offen offset:0 sc1
mm v[208:211],v[88:91],a[192:195],v[208:211]
dt v[72:73],v12 offset:16392
v_mul_f32 v40,s61,v108
mm v[208:211],v[92:95],a[208:211],v[208:211]
v_mul_f32 v41,s61,v109
mm v[212:215],v[88:91],a[196:199],v[212:215]
dt v[74:75],v12 offset:16904
mm v[212:215],v[92:95],a[212:215],v[212:215]
v_exp_f32 v40,v40
mm v[216:219],v[88:91],a[200:203],v[216:219]
dt v[76:77],v12 offset:20488
v_mul_f32 v42,s61,v110
mm v[216:219],v[92:95],a[216:219],v[216:219]
s_add_u32 m0,s37,123904
v_exp_f32 v41,v41
mm v[220:223],v[88:91],a[204:207],v[220:223]
dt v[78:79],v12 offset:21000
v_add_f32 v40,1.0,v40
mm v[220:223],v[92:95],a[220:223],v[220:223]
s_waitcnt lgkmcnt(4)
bl v17,s[24:27],s59 offen lds
mm v[160:163],v[64:67],a[224:227],v[160:163]
dt v[80:81],v13 offset:16384
v_mul_f32 v48,v108,v140
mm v[160:163],v[68:71],a[240:243],v[160:163]
v_mul_f32 v43,s61,v111
mm v[164:167],v[64:67],a[228:231],v[164:167]
dt v[82:83],v13 offset:16896
mm v[164:167],v[68:71],a[244:247],v[164:167]
v_exp_f32 v42,v42
mm v[168:171],v[64:67],a[232:235],v[168:171]
dt v[84:85],v13 offset:20480
mm v[168:171],v[68:71],a[248:251],v[168:171]
v_rcp_f32 v40,v40
mm v[172:175],v[64:67],a[236:239],v[172:175]
dt v[86:87],v13 offset:20992
v_add_f32 v41,1.0,v41
mm v[172:175],v[68:71],a[252:255],v[172:175]
s_waitcnt lgkmcnt(4)
v_mul_f32 v49,v109,v141
v_mul_f32 v44,s61,v124
mm v[176:179],v[72:75],a[224:227],v[176:179]
dt v[88:89],v13 offset:16392
mm v[176:179],v[76:79],a[240:243],v[176:179]
v_exp_f32 v43,v43
mm v[180:183],v[72:75],a[228:231],v[180:183]
dt v[90:91],v13 offset:16904
mm v[180:183],v[76:79],a[244:247],v[180:183]
v_rcp_f32 v41,v41
mm v[184:187],v[72:75],a[232:235],v[184:187]
dt v[92:93],v13 offset:20488
v_add_f32 v42,1.0,v42
mm v[184:187],v[76:79],a[248:251],v[184:187]
s_add_u32 m0,s37,0
s_add_u32 s56,s55,0
v_mul_f32 v50,v110,v142
mm v[188:191],v[72:75],a[236:239],v[188:191]
dt v[94:95],v13 offset:21000
v_mul_f32 v45,s61,v125
mm v[188:191],v[76:79],a[252:255],v[188:191]
s_waitcnt lgkmcnt(4)
bl v18,s[28:31],s56 offen lds
mm v[192:195],v[80:83],a[224:227],v[192:195]
dt v[64:65],v14 offset:16384
mm v[192:195],v[84:87],a[240:243],v[192:195]
v_exp_f32 v44,v44
mm v[196:199],v[80:83],a[228:231],v[196:199]
dt v[66:67],v14 offset:16896
mm v[196:199],v[84:87],a[244:247],v[196:199]
v_rcp_f32 v42,v42
mm v[200:203],v[80:83],a[232:235],v[200:203]
dt v[68:69],v14 offset:20480
v_add_f32 v43,1.0,v43
mm v[200:203],v[84:87],a[248:251],v[200:203]
v_mul_f32 v51,v111,v143
v_mul_f32 v48,v48,v40
mm v[204:207],v[80:83],a[236:239],v[204:207]
dt v[70:71],v14 offset:20992
v_mul_f32 v46,s61,v126
mm v[204:207],v[84:87],a[252:255],v[204:207]
s_waitcnt lgkmcnt(4)
v_exp_f32 v45,v45
mm v[208:211],v[88:91],a[224:227],v[208:211]
dt v[72:73],v14 offset:16392
mm v[208:211],v[92:95],a[240:243],v[208:211]
v_rcp_f32 v43,v43
mm v[212:215],v[88:91],a[228:231],v[212:215]
dt v[74:75],v14 offset:16904
v_add_f32 v44,1.0,v44
mm v[212:215],v[92:95],a[244:247],v[212:215]
v_mul_f32 v52,v124,v156
v_mul_f32 v49,v49,v41
mm v[216:219],v[88:91],a[232:235],v[216:219]
dt v[76:77],v14 offset:20488
cv v60,v48,v49
mm v[216:219],v[92:95],a[248:251],v[216:219]
s_add_u32 m0,s37,1024
v_mul_f32 v47,s61,v127
mm v[220:223],v[88:91],a[236:239],v[220:223]
dt v[78:79],v14 offset:21000
mm v[220:223],v[92:95],a[252:255],v[220:223]
s_waitcnt lgkmcnt(4)
bl v19,s[28:31],s56 offen lds
mm v[160:163],v[64:67],v[224:227],v[160:163]
dt v[80:81],v15 offset:16384
mm v[160:163],v[68:71],v[240:243],v[160:163]
v_exp_f32 v46,v46
mm v[164:167],v[64:67],v[228:231],v[164:167]
dt v[82:83],v15 offset:16896
mm v[164:167],v[68:71],v[244:247],v[164:167]
v_rcp_f32 v44,v44
mm v[168:171],v[64:67],v[232:235],v[168:171]
dt v[84:85],v15 offset:20480
v_add_f32 v45,1.0,v45
mm v[168:171],v[68:71],v[248:251],v[168:171]
v_mul_f32 v53,v125,v157
v_mul_f32 v50,v50,v42
mm v[172:175],v[64:67],v[236:239],v[172:175]
dt v[86:87],v15 offset:20992
mm v[172:175],v[68:71],v[252:255],v[172:175]
s_waitcnt lgkmcnt(4)
v_exp_f32 v47,v47
mm v[176:179],v[72:75],v[224:227],v[176:179]
dt v[88:89],v15 offset:16392
mm v[176:179],v[76:79],v[240:243],v[176:179]
v_rcp_f32 v45,v45
mm v[180:183],v[72:75],v[228:231],v[180:183]
dt v[90:91],v15 offset:16904
v_add_f32 v46,1.0,v46
mm v[180:183],v[76:79],v[244:247],v[180:183]
v_mul_f32 v54,v126,v158
v_mul_f32 v51,v51,v43
mm v[184:187],v[72:75],v[232:235],v[184:187]
dt v[92:93],v15 offset:20488
cv v61,v50,v51
mm v[184:187],v[76:79],v[248:251],v[184:187]
v_rcp_f32 v46,v46
mm v[188:191],v[72:75],v[236:239],v[188:191]
dt v[94:95],v15 offset:21000
mm v[188:191],v[76:79],v[252:255],v[188:191]
s_waitcnt lgkmcnt(4)
s_waitcnt vmcnt(17)
v_add_f32 v47,1.0,v47
mm v[192:195],v[80:83],v[224:227],v[192:195]
s_barrier
dt v[64:65],v12 offset:24576
v_mul_f32 v55,v127,v159
mm v[192:195],v[84:87],v[240:243],v[192:195]
s_add_u32 m0,s37,65536
s_add_u32 s57,s55,8192
v_mul_f32 v52,v52,v44
mm v[196:199],v[80:83],v[228:231],v[196:199]
dt v[66:67],v12 offset:25088
mm v[196:199],v[84:87],v[244:247],v[196:199]
bl v16,s[24:27],s57 offen lds
mm v[200:203],v[80:83],v[232:235],v[200:203]
dt v[68:69],v12 offset:28672
mm v[200:203],v[84:87],v[248:251],v[200:203]
v_rcp_f32 v47,v47
mm v[204:207],v[80:83],v[236:239],v[204:207]
dt v[70:71],v12 offset:29184
v_mul_f32 v53,v53,v45
mm v[204:207],v[84:87],v[252:255],v[204:207]
s_waitcnt lgkmcnt(4)
cv v62,v52,v53
v_mul_f32 v54,v54,v46
mm v[208:211],v[88:91],v[224:227],v[208:211]
dt v[72:73],v12 offset:24584
v_mul_f32 v55,v55,v47
mm v[208:211],v[92:95],v[240:243],v[208:211]
cv v63,v54,v55
mm v[212:215],v[88:91],v[228:231],v[212:215]
s_add_u32 s101,s45,s46
dt v[74:75],v12 offset:25096
mm v[212:215],v[92:95],v[244:247],v[212:215]
buffer_store_dwordx4 v[60:63],v2,s[8:11],s101 offen offset:0 sc1
mm v[216:219],v[88:91],v[232:235],v[216:219]
s_add_u32 m0,s37,66560
dt v[76:77],v12 offset:28680
mm v[216:219],v[92:95],v[248:251],v[216:219]
mm v[220:223],v[88:91],v[236:239],v[220:223]
dt v[78:79],v12 offset:29192
mm v[220:223],v[92:95],v[252:255],v[220:223]
s_waitcnt lgkmcnt(4)
bl v17,s[24:27],s57 offen lds
mm v[96:99],v[64:67],a[0:3],0
dt v[80:81],v13 offset:24576
mm v[96:99],v[68:71],a[16:19],v[96:99]
mm v[100:103],v[64:67],a[4:7],0
dt v[82:83],v13 offset:25088
mm v[100:103],v[68:71],a[20:23],v[100:103]
mm v[104:107],v[64:67],a[8:11],0
dt v[84:85],v13 offset:28672
mm v[104:107],v[68:71],a[24:27],v[104:107]
mm v[108:111],v[64:67],a[12:15],0
dt v[86:87],v13 offset:29184
v_mul_f32 v160,s62,v160
mm v[108:111],v[68:71],a[28:31],v[108:111]
s_waitcnt lgkmcnt(4)
mm v[112:115],v[72:75],a[0:3],0
dt v[88:89],v13 offset:24584
v_mul_f32 v161,s62,v161
mm v[112:115],v[76:79],a[16:19],v[112:115]
mm v[116:119],v[72:75],a[4:7],0
s_add_u32 m0,s37,8192
s_add_u32 s58,s55,8192
dt v[90:91],v13 offset:25096
mm v[116:119],v[76:79],a[20:23],v[116:119]
v_mul_f32 v162,s62,v162
mm v[120:123],v[72:75],a[8:11],0
dt v[92:93],v13 offset:28680
mm v[120:123],v[76:79],a[24:27],v[120:123]
bl v18,s[28:31],s58 offen lds
mm v[124:127],v[72:75],a[12:15],0
dt v[94:95],v13 offset:29192
mm v[124:127],v[76:79],a[28:31],v[124:127]
s_waitcnt lgkmcnt(4)
v_mul_f32 v163,s62,v163
mm v[128:131],v[80:83],a[0:3],0
dt v[64:65],v14 offset:24576
mm v[128:131],v[84:87],a[16:19],v[128:131]
v_mul_f32 v176,s62,v176
mm v[132:135],v[80:83],a[4:7],0
dt v[66:67],v14 offset:25088
mm v[132:135],v[84:87],a[20:23],v[132:135]
mm v[136:139],v[80:83],a[8:11],0
dt v[68:69],v14 offset:28672
v_mul_f32 v177,s62,v177
mm v[136:139],v[84:87],a[24:27],v[136:139]
mm v[140:143],v[80:83],a[12:15],0
dt v[70:71],v14 offset:29184
mm v[140:143],v[84:87],a[28:31],v[140:143]
s_waitcnt lgkmcnt(4)
v_mul_f32 v178,s62,v178
mm v[144:147],v[88:91],a[0:3],0
s_add_u32 m0,s37,9216
dt v[72:73],v14 offset:24584
mm v[144:147],v[92:95],a[16:19],v[144:147]
v_mul_f32 v179,s62,v179
mm v[148:151],v[88:91],a[4:7],0
dt v[74:75],v14 offset:25096
mm v[148:151],v[92:95],a[20:23],v[148:151]
bl v19,s[28:31],s58 offen lds
mm v[152:155],v[88:91],a[8:11],0
dt v[76:77],v14 offset:28680
mm v[152:155],v[92:95],a[24:27],v[152:155]
cv v160,v160,v161
mm v[156:159],v[88:91],a[12:15],0
dt v[78:79],v14 offset:29192
mm v[156:159],v[92:95],a[28:31],v[156:159]
s_waitcnt lgkmcnt(4)
cv v161,v162,v163
mm v[96:99],v[64:67],a[32:35],v[96:99]
dt v[80:81],v15 offset:24576
mm v[96:99],v[68:71],a[48:51],v[96:99]
mm v[100:103],v[64:67],a[36:39],v[100:103]
dt v[82:83],v15 offset:25088
cv v162,v176,v177
mm v[100:103],v[68:71],a[52:55],v[100:103]
mm v[104:107],v[64:67],a[40:43],v[104:107]
dt v[84:85],v15 offset:28672
mm v[104:107],v[68:71],a[56:59],v[104:107]
cv v163,v178,v179
mm v[108:111],v[64:67],a[44:47],v[108:111]
s_add_u32 m0,s37,73728
s_add_u32 s59,s55,16384
dt v[86:87],v15 offset:29184
mm v[108:111],v[68:71],a[60:63],v[108:111]
s_waitcnt lgkmcnt(4)
v_mul_f32 v192,s62,v192
mm v[112:115],v[72:75],a[32:35],v[112:115]
dt v[88:89],v15 offset:24584
mm v[112:115],v[76:79],a[48:51],v[112:115]
bl v16,s[24:27],s59 offen lds
mm v[116:119],v[72:75],a[36:39],v[116:119]
dt v[90:91],v15 offset:25096
mm v[116:119],v[76:79],a[52:55],v[116:119]
v_mul_f32 v193,s62,v193
mm v[120:123],v[72:75],a[40:43],v[120:123]
dt v[92:93],v15 offset:28680
mm v[120:123],v[76:79],a[56:59],v[120:123]
mm v[124:127],v[72:75],a[44:47],v[124:127]
dt v[94:95],v15 offset:29192
v_mul_f32 v194,s62,v194
mm v[124:127],v[76:79],a[60:63],v[124:127]
s_waitcnt lgkmcnt(4)
mm v[128:131],v[80:83],a[32:35],v[128:131]
dt v[64:65],v12 offset:32768
mm v[128:131],v[84:87],a[48:51],v[128:131]
v_mul_f32 v195,s62,v195
mm v[132:135],v[80:83],a[36:39],v[132:135]
dt v[66:67],v12 offset:33280
mm v[132:135],v[84:87],a[52:55],v[132:135]
v_mul_f32 v208,s62,v208
mm v[136:139],v[80:83],a[40:43],v[136:139]
s_add_u32 m0,s37,74752
dt v[68:69],v12 offset:36864
mm v[136:139],v[84:87],a[56:59],v[136:139]
v_mul_f32 v209,s62,v209
mm v[140:143],v[80:83],a[44:47],v[140:143]
dt v[70:71],v12 offset:37376
mm v[140:143],v[84:87],a[60:63],v[140:143]
s_waitcnt lgkmcnt(4)
bl v17,s[24:27],s59 offen lds
mm v[144:147],v[88:91],a[32:35],v[144:147]
dt v[72:73],v12 offset:32776
mm v[144:147],v[92:95],a[48:51],v[144:147]
v_mul_f32 v210,s62,v210
mm v[148:151],v[88:91],a[36:39],v[148:151]
dt v[74:75],v12 offset:33288
mm v[148:151],v[92:95],a[52:55],v[148:151]
mm v[152:155],v[88:91],a[40:43],v[152:155]
dt v[76:77],v12 offset:36872
v_mul_f32 v211,s62,v211
mm v[152:155],v[92:95],a[56:59],v[152:155]
mm v[156:159],v[88:91],a[44:47],v[156:159]
dt v[78:79],v12 offset:37384
cv v192,v192,v193
mm v[156:159],v[92:95],a[60:63],v[156:159]
s_waitcnt lgkmcnt(4)
mm v[96:99],v[64:67],a[64:67],v[96:99]
dt v[80:81],v13 offset:32768
mm v[96:99],v[68:71],a[80:83],v[96:99]
cv v193,v194,v195
mm v[100:103],v[64:67],a[68:71],v[100:103]
s_add_u32 m0,s37,16384
s_add_u32 s56,s55,16384
dt v[82:83],v13 offset:33280
mm v[100:103],v[68:71],a[84:87],v[100:103]
mm v[104:107],v[64:67],a[72:75],v[104:107]
dt v[84:85],v13 offset:36864
cv v194,v208,v209
mm v[104:107],v[68:71],a[88:91],v[104:107]
bl v18,s[28:31],s56 offen lds
mm v[108:111],v[64:67],a[76:79],v[108:111]
dt v[86:87],v13 offset:37376
mm v[108:111],v[68:71],a[92:95],v[108:111]
s_waitcnt lgkmcnt(4)
mm v[112:115],v[72:75],a[64:67],v[112:115]
dt v[88:89],v13 offset:32776
cv v195,v210,v211
mm v[112:115],v[76:79],a[80:83],v[112:115]
mm v[116:119],v[72:75],a[68:71],v[116:119]
dt v[90:91],v13 offset:33288
v_mul_f32 v164,s62,v164
mm v[116:119],v[76:79],a[84:87],v[116:119]
mm v[120:123],v[72:75],a[72:75],v[120:123]
dt v[92:93],v13 offset:36872
mm v[120:123],v[76:79],a[88:91],v[120:123]
v_mul_f32 v165,s62,v165
mm v[124:127],v[72:75],a[76:79],v[124:127]
dt v[94:95],v13 offset:37384
mm v[124:127],v[76:79],a[92:95],v[124:127]
s_waitcnt lgkmcnt(4)
v_mul_f32 v166,s62,v166
mm v[128:131],v[80:83],a[64:67],v[128:131]
s_add_u32 m0,s37,17408
dt v[64:65],v14 offset:32768
mm v[128:131],v[84:87],a[80:83],v[128:131]
v_mul_f32 v167,s62,v167
mm v[132:135],v[80:83],a[68:71],v[132:135]
dt v[66:67],v14 offset:33280
mm v[132:135],v[84:87],a[84:87],v[132:135]
bl v19,s[28:31],s56 offen lds
mm v[136:139],v[80:83],a[72:75],v[136:139]
dt v[68:69],v14 offset:36864
mm v[136:139],v[84:87],a[88:91],v[136:139]
v_mul_f32 v180,s62,v180
mm v[140:143],v[80:83],a[76:79],v[140:143]
dt v[70:71],v14 offset:37376
mm v[140:143],v[84:87],a[92:95],v[140:143]
s_waitcnt lgkmcnt(4)
mm v[144:147],v[88:91],a[64:67],v[144:147]
dt v[72:73],v14 offset:32776
v_mul_f32 v181,s62,v181
mm v[144:147],v[92:95],a[80:83],v[144:147]
mm v[148:151],v[88:91],a[68:71],v[148:151]
dt v[74:75],v14 offset:33288
mm v[148:151],v[92:95],a[84:87],v[148:151]
v_mul_f32 v182,s62,v182
mm v[152:155],v[88:91],a[72:75],v[152:155]
dt v[76:77],v14 offset:36872
mm v[152:155],v[92:95],a[88:91],v[152:155]
v_mul_f32 v183,s62,v183
mm v[156:159],v[88:91],a[76:79],v[156:159]
s_getpc_b64 s[0:1]
L_cpf3:
s_add_u32 s100,s47,4096
s_min_u32 s100,s100,L_mid-1024-L_cpf3
s_add_u32 s0,s0,s100
s_addc_u32 s1,s1,0
dt v[78:79],v14 offset:37384
mm v[156:159],v[92:95],a[92:95],v[156:159]
s_waitcnt lgkmcnt(4)
cv v164,v164,v165
mm v[96:99],v[64:67],a[96:99],v[96:99]
dt v[80:81],v15 offset:32768
mm v[96:99],v[68:71],a[112:115],v[96:99]
global_load_dword v0,v3,s[0:1]
mm v[100:103],v[64:67],a[100:103],v[100:103]
dt v[82:83],v15 offset:33280
mm v[100:103],v[68:71],a[116:119],v[100:103]
cv v165,v166,v167
mm v[104:107],v[64:67],a[104:107],v[104:107]
dt v[84:85],v15 offset:36864
mm v[104:107],v[68:71],a[120:123],v[104:107]
mm v[108:111],v[64:67],a[108:111],v[108:111]
dt v[86:87],v15 offset:37376
cv v166,v180,v181
mm v[108:111],v[68:71],a[124:127],v[108:111]
s_waitcnt lgkmcnt(4)
mm v[112:115],v[72:75],a[96:99],v[112:115]
dt v[88:89],v15 offset:32776
cv v167,v182,v183
mm v[112:115],v[76:79],a[112:115],v[112:115]
mm v[116:119],v[72:75],a[100:103],v[116:119]
dt v[90:91],v15 offset:33288
mm v[116:119],v[76:79],a[116:119],v[116:119]
v_mul_f32 v196,s62,v196
mm v[120:123],v[72:75],a[104:107],v[120:123]
dt v[92:93],v15 offset:36872
mm v[120:123],v[76:79],a[120:123],v[120:123]
v_mul_f32 v197,s62,v197
mm v[124:127],v[72:75],a[108:111],v[124:127]
dt v[94:95],v15 offset:37384
mm v[124:127],v[76:79],a[124:127],v[124:127]
s_waitcnt lgkmcnt(4)
s_waitcnt vmcnt(8)
mm v[128:131],v[80:83],a[96:99],v[128:131]
s_barrier
dt v[64:65],v12 offset:40960
mm v[128:131],v[84:87],a[112:115],v[128:131]
s_add_u32 m0,s37,81920
s_add_u32 s57,s55,24576
buffer_store_dword v1,off,s[8:11],s74 offset:16 sc1
v_mul_f32 v198,s62,v198
mm v[132:135],v[80:83],a[100:103],v[132:135]
dt v[66:67],v12 offset:41472
mm v[132:135],v[84:87],a[116:119],v[132:135]
bl v16,s[24:27],s57 offen lds
mm v[136:139],v[80:83],a[104:107],v[136:139]
dt v[68:69],v12 offset:45056
mm v[136:139],v[84:87],a[120:123],v[136:139]
v_mul_f32 v199,s62,v199
mm v[140:143],v[80:83],a[108:111],v[140:143]
dt v[70:71],v12 offset:45568
mm v[140:143],v[84:87],a[124:127],v[140:143]
s_waitcnt lgkmcnt(4)
v_mul_f32 v212,s62,v212
mm v[144:147],v[88:91],a[96:99],v[144:147]
dt v[72:73],v12 offset:40968
mm v[144:147],v[92:95],a[112:115],v[144:147]
mm v[148:151],v[88:91],a[100:103],v[148:151]
dt v[74:75],v12 offset:41480
v_mul_f32 v213,s62,v213
mm v[148:151],v[92:95],a[116:119],v[148:151]
mm v[152:155],v[88:91],a[104:107],v[152:155]
dt v[76:77],v12 offset:45064
mm v[152:155],v[92:95],a[120:123],v[152:155]
v_mul_f32 v214,s62,v214
mm v[156:159],v[88:91],a[108:111],v[156:159]
s_add_u32 m0,s37,82944
dt v[78:79],v12 offset:45576
mm v[156:159],v[92:95],a[124:127],v[156:159]
s_waitcnt lgkmcnt(4)
v_mul_f32 v215,s62,v215
mm v[96:99],v[64:67],a[128:131],v[96:99]
dt v[80:81],v13 offset:40960
mm v[96:99],v[68:71],a[144:147],v[96:99]
bl v17,s[24:27],s57 offen lds
mm v[100:103],v[64:67],a[132:135],v[100:103]
dt v[82:83],v13 offset:41472
mm v[100:103],v[68:71],a[148:151],v[100:103]
cv v196,v196,v197
mm v[104:107],v[64:67],a[136:139],v[104:107]
dt v[84:85],v13 offset:45056
mm v[104:107],v[68:71],a[152:155],v[104:107]
cv v197,v198,v199
mm v[108:111],v[64:67],a[140:143],v[108:111]
dt v[86:87],v13 offset:45568
mm v[108:111],v[68:71],a[156:159],v[108:111]
s_waitcnt lgkmcnt(4)
mm v[112:115],v[72:75],a[128:131],v[112:115]
dt v[88:89],v13 offset:40968
cv v198,v212,v213
mm v[112:115],v[76:79],a[144:147],v[112:115]
mm v[116:119],v[72:75],a[132:135],v[116:119]
dt v[90:91],v13 offset:41480
cv v199,v214,v215
mm v[116:119],v[76:79],a[148:151],v[116:119]
mm v[120:123],v[72:75],a[136:139],v[120:123]
dt v[92:93],v13 offset:45064
mm v[120:123],v[76:79],a[152:155],v[120:123]
v_mul_f32 v168,s62,v168
mm v[124:127],v[72:75],a[140:143],v[124:127]
s_add_u32 m0,s37,24576
s_add_u32 s58,s55,24576
dt v[94:95],v13 offset:45576
mm v[124:127],v[76:79],a[156:159],v[124:127]
s_waitcnt lgkmcnt(4)
mm v[128:131],v[80:83],a[128:131],v[128:131]
dt v[64:65],v14 offset:40960
v_mul_f32 v169,s62,v169
mm v[128:131],v[84:87],a[144:147],v[128:131]
bl v18,s[28:31],s58 offen lds
mm v[132:135],v[80:83],a[132:135],v[132:135]
dt v[66:67],v14 offset:41472
mm v[132:135],v[84:87],a[148:151],v[132:135]
v_mul_f32 v170,s62,v170
mm v[136:139],v[80:83],a[136:139],v[136:139]
dt v[68:69],v14 offset:45056
mm v[136:139],v[84:87],a[152:155],v[136:139]
mm v[140:143],v[80:83],a[140:143],v[140:143]
dt v[70:71],v14 offset:45568
v_mul_f32 v171,s62,v171
mm v[140:143],v[84:87],a[156:159],v[140:143]
s_waitcnt lgkmcnt(4)
mm v[144:147],v[88:91],a[128:131],v[144:147]
dt v[72:73],v14 offset:40968
mm v[144:147],v[92:95],a[144:147],v[144:147]
v_mul_f32 v184,s62,v184
mm v[148:151],v[88:91],a[132:135],v[148:151]
dt v[74:75],v14 offset:41480
mm v[148:151],v[92:95],a[148:151],v[148:151]
v_mul_f32 v185,s62,v185
mm v[152:155],v[88:91],a[136:139],v[152:155]
dt v[76:77],v14 offset:45064
mm v[152:155],v[92:95],a[152:155],v[152:155]
s_add_u32 m0,s37,25600
v_mul_f32 v186,s62,v186
mm v[156:159],v[88:91],a[140:143],v[156:159]
dt v[78:79],v14 offset:45576
mm v[156:159],v[92:95],a[156:159],v[156:159]
s_waitcnt lgkmcnt(4)
bl v19,s[28:31],s58 offen lds
mm v[96:99],v[64:67],a[160:163],v[96:99]
dt v[80:81],v15 offset:40960
mm v[96:99],v[68:71],a[176:179],v[96:99]
v_mul_f32 v187,s62,v187
mm v[100:103],v[64:67],a[164:167],v[100:103]
dt v[82:83],v15 offset:41472
mm v[100:103],v[68:71],a[180:183],v[100:103]
mm v[104:107],v[64:67],a[168:171],v[104:107]
dt v[84:85],v15 offset:45056
cv v168,v168,v169
mm v[104:107],v[68:71],a[184:187],v[104:107]
mm v[108:111],v[64:67],a[172:175],v[108:111]
dt v[86:87],v15 offset:45568
mm v[108:111],v[68:71],a[188:191],v[108:111]
s_waitcnt lgkmcnt(4)
cv v169,v170,v171
mm v[112:115],v[72:75],a[160:163],v[112:115]
dt v[88:89],v15 offset:40968
mm v[112:115],v[76:79],a[176:179],v[112:115]
cv v170,v184,v185
mm v[116:119],v[72:75],a[164:167],v[116:119]
dt v[90:91],v15 offset:41480
mm v[116:119],v[76:79],a[180:183],v[116:119]
cv v171,v186,v187
mm v[120:123],v[72:75],a[168:171],v[120:123]
dt v[92:93],v15 offset:45064
mm v[120:123],v[76:79],a[184:187],v[120:123]
s_add_u32 m0,s37,90112
s_add_u32 s59,s55,32768
mm v[124:127],v[72:75],a[172:175],v[124:127]
dt v[94:95],v15 offset:45576
mm v[124:127],v[76:79],a[188:191],v[124:127]
s_waitcnt lgkmcnt(4)
bl v16,s[24:27],s59 offen lds
mm v[128:131],v[80:83],a[160:163],v[128:131]
dt v[64:65],v12 offset:49152
v_mul_f32 v200,s62,v200
mm v[128:131],v[84:87],a[176:179],v[128:131]
mm v[132:135],v[80:83],a[164:167],v[132:135]
dt v[66:67],v12 offset:49664
mm v[132:135],v[84:87],a[180:183],v[132:135]
v_mul_f32 v201,s62,v201
mm v[136:139],v[80:83],a[168:171],v[136:139]
dt v[68:69],v12 offset:53248
mm v[136:139],v[84:87],a[184:187],v[136:139]
v_mul_f32 v202,s62,v202
mm v[140:143],v[80:83],a[172:175],v[140:143]
dt v[70:71],v12 offset:53760
mm v[140:143],v[84:87],a[188:191],v[140:143]
s_waitcnt lgkmcnt(4)
v_mul_f32 v203,s62,v203
mm v[144:147],v[88:91],a[160:163],v[144:147]
dt v[72:73],v12 offset:49160
mm v[144:147],v[92:95],a[176:179],v[144:147]
mm v[148:151],v[88:91],a[164:167],v[148:151]
dt v[74:75],v12 offset:49672
v_mul_f32 v216,s62,v216
mm v[148:151],v[92:95],a[180:183],v[148:151]
mm v[152:155],v[88:91],a[168:171],v[152:155]
dt v[76:77],v12 offset:53256
mm v[152:155],v[92:95],a[184:187],v[152:155]
s_add_u32 m0,s37,91136
v_mul_f32 v217,s62,v217
mm v[156:159],v[88:91],a[172:175],v[156:159]
dt v[78:79],v12 offset:53768
mm v[156:159],v[92:95],a[188:191],v[156:159]
s_waitcnt lgkmcnt(4)
bl v17,s[24:27],s59 offen lds
mm v[96:99],v[64:67],a[192:195],v[96:99]
dt v[80:81],v13 offset:49152
v_mul_f32 v218,s62,v218
mm v[96:99],v[68:71],a[208:211],v[96:99]
mm v[100:103],v[64:67],a[196:199],v[100:103]
dt v[82:83],v13 offset:49664
mm v[100:103],v[68:71],a[212:215],v[100:103]
v_mul_f32 v219,s62,v219
mm v[104:107],v[64:67],a[200:203],v[104:107]
dt v[84:85],v13 offset:53248
mm v[104:107],v[68:71],a[216:219],v[104:107]
cv v200,v200,v201
mm v[108:111],v[64:67],a[204:207],v[108:111]
dt v[86:87],v13 offset:53760
mm v[108:111],v[68:71],a[220:223],v[108:111]
s_waitcnt lgkmcnt(4)
mm v[112:115],v[72:75],a[192:195],v[112:115]
dt v[88:89],v13 offset:49160
cv v201,v202,v203
mm v[112:115],v[76:79],a[208:211],v[112:115]
mm v[116:119],v[72:75],a[196:199],v[116:119]
dt v[90:91],v13 offset:49672
cv v202,v216,v217
mm v[116:119],v[76:79],a[212:215],v[116:119]
mm v[120:123],v[72:75],a[200:203],v[120:123]
dt v[92:93],v13 offset:53256
mm v[120:123],v[76:79],a[216:219],v[120:123]
s_add_u32 m0,s37,32768
s_add_u32 s56,s55,32768
cv v203,v218,v219
mm v[124:127],v[72:75],a[204:207],v[124:127]
dt v[94:95],v13 offset:53768
mm v[124:127],v[76:79],a[220:223],v[124:127]
s_waitcnt lgkmcnt(4)
bl v18,s[28:31],s56 offen lds
mm v[128:131],v[80:83],a[192:195],v[128:131]
dt v[64:65],v14 offset:49152
mm v[128:131],v[84:87],a[208:211],v[128:131]
v_mul_f32 v172,s62,v172
mm v[132:135],v[80:83],a[196:199],v[132:135]
dt v[66:67],v14 offset:49664
mm v[132:135],v[84:87],a[212:215],v[132:135]
v_mul_f32 v173,s62,v173
mm v[136:139],v[80:83],a[200:203],v[136:139]
dt v[68:69],v14 offset:53248
mm v[136:139],v[84:87],a[216:219],v[136:139]
mm v[140:143],v[80:83],a[204:207],v[140:143]
dt v[70:71],v14 offset:53760
v_mul_f32 v174,s62,v174
mm v[140:143],v[84:87],a[220:223],v[140:143]
s_waitcnt lgkmcnt(4)
mm v[144:147],v[88:91],a[192:195],v[144:147]
dt v[72:73],v14 offset:49160
mm v[144:147],v[92:95],a[208:211],v[144:147]
v_mul_f32 v175,s62,v175
mm v[148:151],v[88:91],a[196:199],v[148:151]
dt v[74:75],v14 offset:49672
mm v[148:151],v[92:95],a[212:215],v[148:151]
v_mul_f32 v188,s62,v188
mm v[152:155],v[88:91],a[200:203],v[152:155]
dt v[76:77],v14 offset:53256
mm v[152:155],v[92:95],a[216:219],v[152:155]
s_add_u32 m0,s37,33792
v_mul_f32 v189,s62,v189
mm v[156:159],v[88:91],a[204:207],v[156:159]
dt v[78:79],v14 offset:53768
mm v[156:159],v[92:95],a[220:223],v[156:159]
s_waitcnt lgkmcnt(4)
bl v19,s[28:31],s56 offen lds
mm v[96:99],v[64:67],a[224:227],v[96:99]
dt v[80:81],v15 offset:49152
mm v[96:99],v[68:71],a[240:243],v[96:99]
v_mul_f32 v190,s62,v190
mm v[100:103],v[64:67],a[228:231],v[100:103]
dt v[82:83],v15 offset:49664
mm v[100:103],v[68:71],a[244:247],v[100:103]
mm v[104:107],v[64:67],a[232:235],v[104:107]
dt v[84:85],v15 offset:53248
v_mul_f32 v191,s62,v191
mm v[104:107],v[68:71],a[248:251],v[104:107]
v_mov_b32 v49,0x44800000
mm v[108:111],v[64:67],a[236:239],v[108:111]
dt v[86:87],v15 offset:53760
mm v[108:111],v[68:71],a[252:255],v[108:111]
s_waitcnt lgkmcnt(4)
cv v172,v172,v173
v_mov_b32 v32,0
mm v[112:115],v[72:75],a[224:227],v[112:115]
dt v[88:89],v15 offset:49160
mm v[112:115],v[76:79],a[240:243],v[112:115]
cv v173,v174,v175
mm v[116:119],v[72:75],a[228:231],v[116:119]
dt v[90:91],v15 offset:49672
mm v[116:119],v[76:79],a[244:247],v[116:119]
cv v174,v188,v189
v_mov_b32 v33,0
mm v[120:123],v[72:75],a[232:235],v[120:123]
dt v[92:93],v15 offset:53256
mm v[120:123],v[76:79],a[248:251],v[120:123]
mm v[124:127],v[72:75],a[236:239],v[124:127]
dt v[94:95],v15 offset:53768
cv v175,v190,v191
mm v[124:127],v[76:79],a[252:255],v[124:127]
s_waitcnt lgkmcnt(4)
s_waitcnt vmcnt(16)
v_mov_b32 v34,0
mm v[128:131],v[80:83],a[224:227],v[128:131]
s_barrier
dt v[64:65],v12 offset:57344
mm v[128:131],v[84:87],a[240:243],v[128:131]
s_add_u32 m0,s37,98304
s_add_u32 s57,s55,40960
mm v[132:135],v[80:83],a[228:231],v[132:135]
dt v[66:67],v12 offset:57856
v_mul_f32 v204,s62,v204
mm v[132:135],v[84:87],a[244:247],v[132:135]
bl v16,s[24:27],s57 offen lds
mm v[136:139],v[80:83],a[232:235],v[136:139]
dt v[68:69],v12 offset:61440
mm v[136:139],v[84:87],a[248:251],v[136:139]
v_mul_f32 v205,s62,v205
v_mov_b32 v35,0
mm v[140:143],v[80:83],a[236:239],v[140:143]
dt v[70:71],v12 offset:61952
mm v[140:143],v[84:87],a[252:255],v[140:143]
s_waitcnt lgkmcnt(4)
mm v[144:147],v[88:91],a[224:227],v[144:147]
dt v[72:73],v12 offset:57352
v_bfe_u32 v55,v7,12,2
mm v[144:147],v[92:95],a[240:243],v[144:147]
s_add_u32 m0,s37,99328
v_mul_f32 v206,s62,v206
mm v[148:151],v[88:91],a[228:231],v[148:151]
dt v[74:75],v12 offset:57864
mm v[148:151],v[92:95],a[244:247],v[148:151]
bl v17,s[24:27],s57 offen lds
mm v[152:155],v[88:91],a[232:235],v[152:155]
dt v[76:77],v12 offset:61448
mm v[152:155],v[92:95],a[248:251],v[152:155]
v_min_u32 v54,0xf0,v2
v_mul_f32 v207,s62,v207
mm v[156:159],v[88:91],a[236:239],v[156:159]
dt v[78:79],v12 offset:61960
mm v[156:159],v[92:95],a[252:255],v[156:159]
s_waitcnt lgkmcnt(4)
mm v[96:99],v[64:67],v[224:227],v[96:99]
dt v[80:81],v13 offset:57344
v_mul_f32 v220,s62,v220
mm v[96:99],v[68:71],v[240:243],v[96:99]
v_lshlrev_b32 v55,11,v55
mm v[100:103],v[64:67],v[228:231],v[100:103]
dt v[82:83],v13 offset:57856
mm v[100:103],v[68:71],v[244:247],v[100:103]
s_add_u32 m0,s37,40960
s_add_u32 s58,s55,40960
v_mul_f32 v221,s62,v221
mm v[104:107],v[64:67],v[232:235],v[104:107]
dt v[84:85],v13 offset:61440
mm v[104:107],v[68:71],v[248:251],v[104:107]
bl v18,s[28:31],s58 offen lds
mm v[108:111],v[64:67],v[236:239],v[108:111]
dt v[86:87],v13 offset:61952
mm v[108:111],v[68:71],v[252:255],v[108:111]
s_waitcnt lgkmcnt(4)
v_lshl_add_u32 v54,v54,3,v55
mm v[112:115],v[72:75],v[224:227],v[112:115]
dt v[88:89],v13 offset:57352
v_mul_f32 v222,s62,v222
mm v[112:115],v[76:79],v[240:243],v[112:115]
mm v[116:119],v[72:75],v[228:231],v[116:119]
dt v[90:91],v13 offset:57864
mm v[116:119],v[76:79],v[244:247],v[116:119]
v_mul_f32 v223,s62,v223
mm v[120:123],v[72:75],v[232:235],v[120:123]
dt v[92:93],v13 offset:61448
mm v[120:123],v[76:79],v[248:251],v[120:123]
s_add_u32 m0,s37,41984
cv v204,v204,v205
mm v[124:127],v[72:75],v[236:239],v[124:127]
dt v[94:95],v13 offset:61960
mm v[124:127],v[76:79],v[252:255],v[124:127]
s_waitcnt lgkmcnt(4)
bl v19,s[28:31],s58 offen lds
mm v[128:131],v[80:83],v[224:227],v[128:131]
ds_read_b128 a[128:131],v20 offset:57344
mm v[128:131],v[84:87],v[240:243],v[128:131]
ds_read_b128 a[132:135],v21 offset:57344
cv v205,v206,v207
mm v[132:135],v[80:83],v[228:231],v[132:135]
ds_read_b128 a[136:139],v22 offset:57344
mm v[132:135],v[84:87],v[244:247],v[132:135]
ds_read_b128 a[140:143],v23 offset:57344
mm v[136:139],v[80:83],v[232:235],v[136:139]
ds_read_b128 a[144:147],v20 offset:61440
mm v[136:139],v[84:87],v[248:251],v[136:139]
ds_read_b128 a[148:151],v21 offset:61440
cv v206,v220,v221
mm v[140:143],v[80:83],v[236:239],v[140:143]
ds_read_b128 a[152:155],v22 offset:61440
mm v[140:143],v[84:87],v[252:255],v[140:143]
s_waitcnt lgkmcnt(7)
ds_read_b128 a[156:159],v23 offset:61440
mm v[144:147],v[88:91],v[224:227],v[144:147]
cv v207,v222,v223
mm v[144:147],v[92:95],v[240:243],v[144:147]
s_add_u32 m0,s37,106496
s_add_u32 s59,s55,49152
mm v[148:151],v[88:91],v[228:231],v[148:151]
mm v[148:151],v[92:95],v[244:247],v[148:151]
bl v16,s[24:27],s59 offen lds
mm v[152:155],v[88:91],v[232:235],v[152:155]
mm v[152:155],v[92:95],v[248:251],v[152:155]
mm v[156:159],v[88:91],v[236:239],v[156:159]
mm v[156:159],v[92:95],v[252:255],v[156:159]
s_waitcnt lgkmcnt(0)
s_nop 7
v_mul_f32 v96,s62,v96
v_mul_f32 v97,s62,v97
v_mul_f32 v98,s62,v98
v_mul_f32 v99,s62,v99
v_mul_f32 v112,s62,v112
v_mul_f32 v113,s62,v113
v_mul_f32 v114,s62,v114
v_mul_f32 v115,s62,v115
cv v96,v96,v97
cv v97,v98,v99
cv v98,v112,v113
cv v99,v114,v115
v_mul_f32 v128,s62,v128
v_mul_f32 v129,s62,v129
v_mul_f32 v130,s62,v130
v_mul_f32 v131,s62,v131
v_mul_f32 v144,s62,v144
v_mul_f32 v145,s62,v145
mm v[224:227],a[136:139],v[160:163],0
v_mul_f32 v146,s62,v146
v_mul_f32 v147,s62,v147
cv v128,v128,v129
mm v[224:227],a[140:143],v[192:195],v[224:227]
ds_read_b128 a[160:163],v20 offset:0
cv v129,v130,v131
mm v[240:243],a[152:155],v[160:163],0
s_add_u32 m0,s37,107520
cv v130,v144,v145
cv v131,v146,v147
mm v[240:243],a[156:159],v[192:195],v[240:243]
v_mul_f32 v100,s62,v100
v_mul_f32 v101,s62,v101
v_mul_f32 v102,s62,v102
v_mul_f32 v103,s62,v103
mm v[224:227],a[128:131],v[96:99],v[224:227]
bl v17,s[24:27],s59 offen lds
v_mul_f32 v116,s62,v116
v_mul_f32 v117,s62,v117
mm v[224:227],a[132:135],v[128:131],v[224:227]
ds_read_b128 a[164:167],v21 offset:0
v_mul_f32 v118,s62,v118
v_mul_f32 v119,s62,v119
mm v[240:243],a[144:147],v[96:99],v[240:243]
cv v100,v100,v101
cv v101,v102,v103
cv v102,v116,v117
cv v103,v118,v119
mm v[240:243],a[148:151],v[128:131],v[240:243]
v_mul_f32 v132,s62,v132
v_mul_f32 v133,s62,v133
v_mul_f32 v134,s62,v134
v_mul_f32 v135,s62,v135
mm v[228:231],a[136:139],v[164:167],0
v_mul_f32 v148,s62,v148
v_mul_f32 v149,s62,v149
v_mul_f32 v150,s62,v150
mm v[228:231],a[140:143],v[196:199],v[228:231]
ds_read_b128 a[168:171],v22 offset:0
v_mul_f32 v151,s62,v151
cv v132,v132,v133
cv v133,v134,v135
mm v[244:247],a[152:155],v[164:167],0
s_add_u32 m0,s37,49152
s_add_u32 s56,s55,49152
cv v134,v148,v149
cv v135,v150,v151
mm v[244:247],a[156:159],v[196:199],v[244:247]
v_mul_f32 v104,s62,v104
v_mul_f32 v105,s62,v105
v_mul_f32 v106,s62,v106
v_mul_f32 v107,s62,v107
mm v[228:231],a[128:131],v[100:103],v[228:231]
bl v18,s[28:31],s56 offen lds
v_mul_f32 v120,s62,v120
mm v[228:231],a[132:135],v[132:135],v[228:231]
ds_read_b128 a[172:175],v23 offset:0
v_mul_f32 v121,s62,v121
v_mul_f32 v122,s62,v122
v_mul_f32 v123,s62,v123
mm v[244:247],a[144:147],v[100:103],v[244:247]
cv v104,v104,v105
cv v105,v106,v107
cv v106,v120,v121
mm v[244:247],a[148:151],v[132:135],v[244:247]
cv v107,v122,v123
v_mul_f32 v136,s62,v136
v_mul_f32 v137,s62,v137
v_mul_f32 v138,s62,v138
mm v[232:235],a[136:139],v[168:171],0
v_mul_f32 v139,s62,v139
v_mul_f32 v152,s62,v152
v_mul_f32 v153,s62,v153
mm v[232:235],a[140:143],v[200:203],v[232:235]
ds_read_b128 a[176:179],v20 offset:4096
v_mul_f32 v154,s62,v154
v_mul_f32 v155,s62,v155
cv v136,v136,v137
mm v[248:251],a[152:155],v[168:171],0
cv v137,v138,v139
cv v138,v152,v153
cv v139,v154,v155
mm v[248:251],a[156:159],v[200:203],v[248:251]
v_mul_f32 v108,s62,v108
v_mul_f32 v109,s62,v109
v_mul_f32 v110,s62,v110
v_mul_f32 v111,s62,v111
mm v[232:235],a[128:131],v[104:107],v[232:235]
s_add_u32 m0,s37,50176
v_mul_f32 v124,s62,v124
v_mul_f32 v125,s62,v125
v_mul_f32 v126,s62,v126
mm v[232:235],a[132:135],v[136:139],v[232:235]
ds_read_b128 a[180:183],v21 offset:4096
v_mul_f32 v127,s62,v127
cv v108,v108,v109
cv v109,v110,v111
mm v[248:251],a[144:147],v[104:107],v[248:251]
bl v19,s[28:31],s56 offen lds
cv v110,v124,v125
mm v[248:251],a[148:151],v[136:139],v[248:251]
cv v111,v126,v127
v_mul_f32 v140,s62,v140
v_mul_f32 v141,s62,v141
v_mul_f32 v142,s62,v142
mm v[236:239],a[136:139],v[172:175],0
v_mul_f32 v143,s62,v143
v_mul_f32 v156,s62,v156
v_mul_f32 v157,s62,v157
mm v[236:239],a[140:143],v[204:207],v[236:239]
ds_read_b128 a[184:187],v22 offset:4096
v_mul_f32 v158,s62,v158
v_mul_f32 v159,s62,v159
cv v140,v140,v141
mm v[252:255],a[152:155],v[172:175],0
cv v141,v142,v143
cv v142,v156,v157
cv v143,v158,v159
mm v[252:255],a[156:159],v[204:207],v[252:255]
v_max3_f32 v36,v224,v225,v226
v_max3_f32 v36,v36,v227,v240
v_max3_f32 v36,v36,v241,v242
mm v[236:239],a[128:131],v[108:111],v[236:239]
v_max_f32 v36,v36,v243
v_max3_f32 v37,v228,v229,v230
v_max3_f32 v37,v37,v231,v244
mm v[236:239],a[132:135],v[140:143],v[236:239]
ds_read_b128 a[188:191],v23 offset:4096
v_max3_f32 v37,v37,v245,v246
v_max_f32 v37,v37,v247
mm v[252:255],a[144:147],v[108:111],v[252:255]
v_max3_f32 v38,v232,v233,v234
v_max3_f32 v38,v38,v235,v248
v_max3_f32 v38,v38,v249,v250
mm v[252:255],a[148:151],v[140:143],v[252:255]
s_waitcnt lgkmcnt(4)
s_waitcnt vmcnt(14)
v_max_f32 v38,v38,v251
s_nop 6
v_max3_f32 v39,v236,v237,v238
v_max3_f32 v39,v39,v239,v252
v_max3_f32 v39,v39,v253,v254
v_max_f32 v39,v39,v255
v_mov_b32 v50,v36
v_mov_b32 v51,v37
v_mov_b32 v52,v38
v_mov_b32 v53,v39
v_permlane16_swap_b32 v36,v50
v_permlane16_swap_b32 v37,v51
v_permlane16_swap_b32 v38,v52
v_permlane16_swap_b32 v39,v53
v_max_f32 v36,v36,v50
v_max_f32 v37,v37,v51
v_max_f32 v38,v38,v52
v_max_f32 v39,v39,v53
v_mov_b32 v50,v36
v_mov_b32 v51,v37
v_mov_b32 v52,v38
v_mov_b32 v53,v39
v_permlane32_swap_b32 v36,v50
v_permlane32_swap_b32 v37,v51
v_permlane32_swap_b32 v38,v52
v_permlane32_swap_b32 v39,v53
v_max_f32 v36,v36,v50
v_max_f32 v37,v37,v51
v_max_f32 v38,v38,v52
v_max_f32 v39,v39,v53
v_sub_f32 v80,0,v36
v_sub_f32 v81,0,v36
v_sub_f32 v82,0,v36
v_sub_f32 v83,0,v36
v_sub_f32 v224,v224,v36
v_sub_f32 v225,v225,v36
mm v[112:115],a[160:163],v[96:99],v[80:83]
s_barrier
v_sub_f32 v84,0,v37
v_sub_f32 v85,0,v37
v_sub_f32 v86,0,v37
v_sub_f32 v87,0,v37
mm v[112:115],a[164:167],v[128:131],v[112:115]
s_add_u32 m0,s37,114688
s_add_u32 s57,s55,57344
ds_read_b128 a[128:131],v20 offset:8192
v_sub_f32 v226,v226,v36
mm v[112:115],a[168:171],v[160:163],v[112:115]
bl v16,s[24:27],s57 offen lds
v_sub_f32 v227,v227,v36
mm v[112:115],a[172:175],v[192:195],v[112:115]
v_sub_f32 v88,0,v38
v_sub_f32 v89,0,v38
v_sub_f32 v90,0,v38
mm v[116:119],a[160:163],v[100:103],v[84:87]
v_sub_f32 v91,0,v38
v_sub_f32 v240,v240,v36
mm v[116:119],a[164:167],v[132:135],v[116:119]
ds_read_b128 a[132:135],v21 offset:8192
v_sub_f32 v241,v241,v36
mm v[116:119],a[168:171],v[164:167],v[116:119]
v_sub_f32 v242,v242,v36
v_sub_f32 v243,v243,v36
mm v[116:119],a[172:175],v[196:199],v[116:119]
v_sub_f32 v92,0,v39
v_sub_f32 v93,0,v39
v_sub_f32 v94,0,v39
mm v[120:123],a[160:163],v[104:107],v[88:91]
v_sub_f32 v95,0,v39
v_sub_f32 v228,v228,v37
mm v[120:123],a[164:167],v[136:139],v[120:123]
ds_read_b128 a[136:139],v22 offset:8192
v_sub_f32 v229,v229,v37
mm v[120:123],a[168:171],v[168:171],v[120:123]
v_sub_f32 v230,v230,v37
v_sub_f32 v231,v231,v37
mm v[120:123],a[172:175],v[200:203],v[120:123]
v_sub_f32 v244,v244,v37
v_sub_f32 v245,v245,v37
v_sub_f32 v246,v246,v37
mm v[124:127],a[160:163],v[108:111],v[92:95]
s_add_u32 m0,s37,115712
v_sub_f32 v247,v247,v37
v_exp_f32 v40,v224
mm v[124:127],a[164:167],v[140:143],v[124:127]
ds_read_b128 a[140:143],v23 offset:8192
mm v[124:127],a[168:171],v[172:175],v[124:127]
bl v17,s[24:27],s57 offen lds
mm v[124:127],a[172:175],v[204:207],v[124:127]
s_waitcnt lgkmcnt(4)
v_exp_f32 v41,v225
mm v[144:147],a[176:179],v[96:99],v[80:83]
v_exp_f32 v42,v226
mm v[144:147],a[180:183],v[128:131],v[144:147]
dt a[160:161],v24 offset:0
mm v[144:147],a[184:187],v[160:163],v[144:147]
v_exp_f32 v43,v227
v_add_f32 v36,v40,v41
mm v[144:147],a[188:191],v[192:195],v[144:147]
dt a[162:163],v24 offset:4096
cv v176,v40,v41
mm v[148:151],a[176:179],v[100:103],v[84:87]
v_exp_f32 v44,v240
v_add_f32 v36,v36,v42
mm v[148:151],a[180:183],v[132:135],v[148:151]
dt a[164:165],v25 offset:0
mm v[148:151],a[184:187],v[164:167],v[148:151]
v_exp_f32 v45,v241
v_add_f32 v36,v36,v43
mm v[148:151],a[188:191],v[196:199],v[148:151]
dt a[166:167],v25 offset:4096
cv v177,v42,v43
mm v[152:155],a[176:179],v[104:107],v[88:91]
v_exp_f32 v46,v242
v_add_f32 v36,v36,v44
mm v[152:155],a[180:183],v[136:139],v[152:155]
dt a[168:169],v26 offset:0
mm v[152:155],a[184:187],v[168:171],v[152:155]
s_add_u32 m0,s37,57344
s_add_u32 s58,s55,57344
v_exp_f32 v47,v243
mm v[152:155],a[188:191],v[200:203],v[152:155]
dt a[170:171],v26 offset:4096
v_add_f32 v36,v36,v45
mm v[156:159],a[176:179],v[108:111],v[92:95]
bl v18,s[28:31],s58 offen lds
cv v178,v44,v45
mm v[156:159],a[180:183],v[140:143],v[156:159]
dt a[172:173],v27 offset:0
v_sub_f32 v232,v232,v38
mm v[156:159],a[184:187],v[172:175],v[156:159]
v_sub_f32 v233,v233,v38
v_sub_f32 v234,v234,v38
v_sub_f32 v235,v235,v38
mm v[156:159],a[188:191],v[204:207],v[156:159]
s_waitcnt lgkmcnt(7)
dt a[174:175],v27 offset:4096
v_sub_f32 v248,v248,v38
v_sub_f32 v249,v249,v38
v_sub_f32 v250,v250,v38
v_sub_f32 v251,v251,v38
v_exp_f32 v56,v228
v_add_f32 v36,v36,v46
v_exp_f32 v57,v229
v_add_f32 v36,v36,v47
cv v179,v46,v47
v_exp_f32 v58,v230
v_exp_f32 v59,v231
v_add_f32 v37,v56,v57
cv v180,v56,v57
v_exp_f32 v40,v244
v_add_f32 v37,v37,v58
v_exp_f32 v41,v245
v_add_f32 v37,v37,v59
cv v181,v58,v59
v_exp_f32 v42,v246
v_add_f32 v37,v37,v40
v_exp_f32 v43,v247
v_add_f32 v37,v37,v41
cv v182,v40,v41
v_sub_f32 v236,v236,v39
v_sub_f32 v237,v237,v39
v_sub_f32 v238,v238,v39
v_sub_f32 v239,v239,v39
v_sub_f32 v252,v252,v39
v_sub_f32 v253,v253,v39
v_sub_f32 v254,v254,v39
v_sub_f32 v255,v255,v39
v_exp_f32 v44,v232
v_add_f32 v37,v37,v42
v_exp_f32 v45,v233
v_add_f32 v37,v37,v43
cv v183,v42,v43
v_exp_f32 v46,v234
v_exp_f32 v47,v235
v_add_f32 v38,v44,v45
cv v184,v44,v45
v_exp_f32 v56,v248
v_add_f32 v38,v38,v46
v_exp_f32 v57,v249
v_add_f32 v38,v38,v47
cv v185,v46,v47
v_exp_f32 v58,v250
v_add_f32 v38,v38,v56
v_exp_f32 v59,v251
v_add_f32 v38,v38,v57
cv v186,v56,v57
v_exp_f32 v40,v236
v_add_f32 v38,v38,v58
v_exp_f32 v41,v237
v_add_f32 v38,v38,v59
cv v187,v58,v59
v_exp_f32 v42,v238
v_exp_f32 v43,v239
v_add_f32 v39,v40,v41
cv v188,v40,v41
v_exp_f32 v44,v252
v_add_f32 v39,v39,v42
v_exp_f32 v45,v253
v_add_f32 v39,v39,v43
cv v189,v42,v43
v_exp_f32 v46,v254
v_add_f32 v39,v39,v44
v_exp_f32 v47,v255
v_add_f32 v39,v39,v45
cv v190,v44,v45
v_add_f32 v39,v39,v46
v_add_f32 v39,v39,v47
cv v191,v46,v47
s_nop 1
mm v[224:227],a[128:131],v[96:99],v[80:83]
v_exp_f32 v40,v112
mm v[224:227],a[132:135],v[128:131],v[224:227]
ds_read_b128 a[144:147],v20 offset:12288
ds_read_b128 v[60:63],v7 offset:48
v_add_f32 v32,v32,v36
mm v[224:227],a[136:139],v[160:163],v[224:227]
v_exp_f32 v41,v113
mm v[224:227],a[140:143],v[192:195],v[224:227]
v_exp_f32 v42,v114
mm v[228:231],a[128:131],v[100:103],v[84:87]
v_exp_f32 v43,v115
mm v[228:231],a[132:135],v[132:135],v[228:231]
ds_read_b128 a[148:151],v21 offset:12288
v_exp_f32 v44,v144
mm v[228:231],a[136:139],v[164:167],v[228:231]
ds_read_b128 v[8:11],v7 offset:16
v_add_f32 v36,v40,v41
mm v[228:231],a[140:143],v[196:199],v[228:231]
v_exp_f32 v45,v145
mm v[232:235],a[128:131],v[104:107],v[88:91]
s_add_u32 m0,s37,58368
v_exp_f32 v46,v146
cv v208,v40,v41
mm v[232:235],a[132:135],v[136:139],v[232:235]
ds_read_b128 a[152:155],v22 offset:12288
v_add_f32 v36,v36,v42
mm v[232:235],a[136:139],v[168:171],v[232:235]
bl v19,s[28:31],s58 offen lds
v_add_f32 v36,v36,v43
mm v[232:235],a[140:143],v[200:203],v[232:235]
v_exp_f32 v47,v147
mm v[236:239],a[128:131],v[108:111],v[92:95]
ds_read_b128 v[12:15],v7 offset:32
cv v209,v42,v43
mm v[236:239],a[132:135],v[140:143],v[236:239]
ds_read_b128 a[156:159],v23 offset:12288
v_exp_f32 v56,v116
mm v[236:239],a[136:139],v[172:175],v[236:239]
v_exp_f32 v57,v117
mm v[236:239],a[140:143],v[204:207],v[236:239]
s_waitcnt lgkmcnt(7)
v_exp_f32 v58,v118
v_add_f32 v36,v36,v44
mm a[0:3],a[160:163],v[176:179],0
v_exp_f32 v59,v119
mm a[4:7],a[160:163],v[180:183],0
dt a[176:177],v28 offset:0
ds_read_b128 v[4:7],v7 offset:0
v_add_f32 v36,v36,v45
mm a[8:11],a[160:163],v[184:187],0
v_exp_f32 v40,v148
mm a[12:15],a[160:163],v[188:191],0
dt a[178:179],v28 offset:4096
cv v210,v44,v45
mm a[16:19],a[164:167],v[176:179],0
v_exp_f32 v41,v149
v_add_f32 v36,v36,v46
mm a[20:23],a[164:167],v[180:183],0
dt a[180:181],v29 offset:0
v_add_f32 v36,v36,v47
mm a[24:27],a[164:167],v[184:187],0
s_add_u32 m0,s37,122880
s_add_u32 s59,s55,65536
v_exp_f32 v42,v150
mm a[28:31],a[164:167],v[188:191],0
dt a[182:183],v29 offset:4096
cv v211,v46,v47
mm a[32:35],a[168:171],v[176:179],0
bl v16,s[24:27],s59 offen lds
mm a[36:39],a[168:171],v[180:183],0
dt a[184:185],v30 offset:0
v_exp_f32 v43,v151
mm a[40:43],a[168:171],v[184:187],0
v_exp_f32 v44,v120
mm a[44:47],a[168:171],v[188:191],0
dt a[186:187],v30 offset:4096
v_exp_f32 v45,v121
mm a[48:51],a[172:175],v[176:179],0
v_exp_f32 v46,v122
mm a[52:55],a[172:175],v[180:183],0
dt a[188:189],v31 offset:0
v_add_f32 v33,v33,v37
mm a[56:59],a[172:175],v[184:187],0
v_exp_f32 v47,v123
v_add_f32 v37,v56,v57
mm a[60:63],a[172:175],v[188:191],0
s_waitcnt lgkmcnt(8)
dt a[190:191],v31 offset:4096
cv v212,v56,v57
mm v[240:243],a[144:147],v[96:99],v[80:83]
v_exp_f32 v56,v152
v_add_f32 v37,v37,v58
mm v[240:243],a[148:151],v[128:131],v[240:243]
ds_read_b128 a[128:131],v20 offset:16384
v_add_f32 v37,v37,v59
mm v[240:243],a[152:155],v[160:163],v[240:243]
v_exp_f32 v57,v153
cv v213,v58,v59
mm v[240:243],a[156:159],v[192:195],v[240:243]
v_exp_f32 v58,v154
mm v[244:247],a[144:147],v[100:103],v[84:87]
s_add_u32 m0,s37,123904
v_exp_f32 v59,v155
mm v[244:247],a[148:151],v[132:135],v[244:247]
ds_read_b128 a[132:135],v21 offset:16384
v_add_f32 v37,v37,v40
v_add_f32 v37,v37,v41
mm v[244:247],a[152:155],v[164:167],v[244:247]
bl v17,s[24:27],s59 offen lds
mm v[244:247],a[156:159],v[196:199],v[244:247]
cv v214,v40,v41
v_exp_f32 v40,v124
mm v[248:251],a[144:147],v[104:107],v[88:91]
v_exp_f32 v41,v125
mm v[248:251],a[148:151],v[136:139],v[248:251]
ds_read_b128 a[136:139],v22 offset:16384
v_add_f32 v37,v37,v42
mm v[248:251],a[152:155],v[168:171],v[248:251]
v_add_f32 v37,v37,v43
cv v215,v42,v43
v_add_f32 v34,v34,v38
mm v[248:251],a[156:159],v[200:203],v[248:251]
v_exp_f32 v42,v126
mm v[252:255],a[144:147],v[108:111],v[92:95]
v_exp_f32 v43,v127
v_add_f32 v38,v44,v45
mm v[252:255],a[148:151],v[140:143],v[252:255]
ds_read_b128 a[140:143],v23 offset:16384
cv v216,v44,v45
mm v[252:255],a[152:155],v[172:175],v[252:255]
v_exp_f32 v44,v156
mm v[252:255],a[156:159],v[204:207],v[252:255]
s_waitcnt lgkmcnt(4)
v_exp_f32 v45,v157
v_add_f32 v38,v38,v46
mm a[64:67],a[176:179],v[176:179],0
v_add_f32 v38,v38,v47
cv v217,v46,v47
mm a[68:71],a[176:179],v[180:183],0
dt a[160:161],v24 offset:8192
v_exp_f32 v46,v158
mm a[72:75],a[176:179],v[184:187],0
s_getpc_b64 s[0:1]
L_cpf4:
s_add_u32 s100,s47,4096
s_min_u32 s100,s100,L_mid-1024-L_cpf4
s_add_u32 s0,s0,s100
s_addc_u32 s1,s1,0
v_exp_f32 v47,v159
mm a[76:79],a[176:179],v[188:191],0
dt a[162:163],v24 offset:12288
v_add_f32 v38,v38,v56
v_add_f32 v38,v38,v57
mm a[80:83],a[180:183],v[176:179],0
global_load_dword v55,v3,s[0:1]
mm a[84:87],a[180:183],v[180:183],0
dt a[164:165],v25 offset:8192
cv v218,v56,v57
mm a[88:91],a[180:183],v[184:187],0
v_add_f32 v38,v38,v58
v_add_f32 v38,v38,v59
cv v219,v58,v59
mm a[92:95],a[180:183],v[188:191],0
dt a[166:167],v25 offset:12288
v_add_f32 v35,v35,v39
mm a[96:99],a[184:187],v[176:179],0
v_add_f32 v39,v40,v41
cv v220,v40,v41
v_add_f32 v39,v39,v42
mm a[100:103],a[184:187],v[180:183],0
dt a[168:169],v26 offset:8192
v_add_f32 v39,v39,v43
mm a[104:107],a[184:187],v[184:187],0
cv v221,v42,v43
v_add_f32 v39,v39,v44
mm a[108:111],a[184:187],v[188:191],0
dt a[170:171],v26 offset:12288
v_add_f32 v39,v39,v45
cv v222,v44,v45
mm a[112:115],a[188:191],v[176:179],0
v_add_f32 v39,v39,v46
v_add_f32 v39,v39,v47
mm a[116:119],a[188:191],v[180:183],0
dt a[172:173],v27 offset:8192
cv v223,v46,v47
v_max3_f32 v48,v36,v37,v38
mm a[120:123],a[188:191],v[184:187],0
v_max_f32 v48,v48,v39
v_cmp_nle_f32 vcc,v48,v49
mm a[124:127],a[188:191],v[188:191],0
s_waitcnt lgkmcnt(7)
dt a[174:175],v27 offset:12288
s_cbranch_vccnz L_rares1
L_backs1:
mm v[112:115],a[128:131],v[96:99],v[80:83]
v_exp_f32 v40,v224
mm v[112:115],a[132:135],v[128:131],v[112:115]
s_nop 0
ds_read_b128 a[144:147],v20 offset:20480
v_exp_f32 v41,v225
mm v[112:115],a[136:139],v[160:163],v[112:115]
v_exp_f32 v42,v226
mm v[112:115],a[140:143],v[192:195],v[112:115]
buffer_load_dword v55,v54,s[96:99],s82 offen
v_add_f32 v32,v32,v36
mm v[116:119],a[128:131],v[100:103],v[84:87]
v_exp_f32 v43,v227
mm v[116:119],a[132:135],v[132:135],v[116:119]
ds_read_b128 a[148:151],v21 offset:20480
v_add_f32 v36,v40,v41
mm v[116:119],a[136:139],v[164:167],v[116:119]
v_exp_f32 v44,v240
cv v176,v40,v41
mm v[116:119],a[140:143],v[196:199],v[116:119]
v_exp_f32 v45,v241
mm v[120:123],a[128:131],v[104:107],v[88:91]
v_exp_f32 v46,v242
mm v[120:123],a[132:135],v[136:139],v[120:123]
ds_read_b128 a[152:155],v22 offset:20480
v_exp_f32 v47,v243
mm v[120:123],a[136:139],v[168:171],v[120:123]
v_exp_f32 v56,v228
mm v[120:123],a[140:143],v[200:203],v[120:123]
v_exp_f32 v57,v229
mm v[124:127],a[128:131],v[108:111],v[92:95]
v_exp_f32 v58,v230
v_add_f32 v36,v36,v42
mm v[124:127],a[132:135],v[140:143],v[124:127]
ds_read_b128 a[156:159],v23 offset:20480
v_add_f32 v36,v36,v43
mm v[124:127],a[136:139],v[172:175],v[124:127]
s_add_u32 s82,s82,8192
v_exp_f32 v59,v231
mm v[124:127],a[140:143],v[204:207],v[124:127]
s_waitcnt lgkmcnt(4)
v_exp_f32 v40,v244
cv v177,v42,v43
mm a[0:3],a[160:163],v[208:211],a[0:3]
buffer_load_dword v55,v54,s[96:99],s82 offen
mm a[4:7],a[160:163],v[212:215],a[4:7]
dt a[176:177],v28 offset:8192
v_add_f32 v36,v36,v44
mm a[8:11],a[160:163],v[216:219],a[8:11]
v_exp_f32 v41,v245
v_add_f32 v36,v36,v45
mm a[12:15],a[160:163],v[220:223],a[12:15]
dt a[178:179],v28 offset:12288
cv v178,v44,v45
mm a[16:19],a[164:167],v[208:211],a[16:19]
v_exp_f32 v42,v246
mm a[20:23],a[164:167],v[212:215],a[20:23]
dt a[180:181],v29 offset:8192
v_exp_f32 v43,v247
mm a[24:27],a[164:167],v[216:219],a[24:27]
v_exp_f32 v44,v232
mm a[28:31],a[164:167],v[220:223],a[28:31]
dt a[182:183],v29 offset:12288
v_exp_f32 v45,v233
mm a[32:35],a[168:171],v[208:211],a[32:35]
v_add_f32 v36,v36,v46
v_add_f32 v36,v36,v47
mm a[36:39],a[168:171],v[212:215],a[36:39]
dt a[184:185],v30 offset:8192
cv v179,v46,v47
mm a[40:43],a[168:171],v[216:219],a[40:43]
v_exp_f32 v46,v234
v_add_f32 v33,v33,v37
mm a[44:47],a[168:171],v[220:223],a[44:47]
dt a[186:187],v30 offset:12288
v_add_f32 v37,v56,v57
mm a[48:51],a[172:175],v[208:211],a[48:51]
v_exp_f32 v47,v235
mm a[52:55],a[172:175],v[212:215],a[52:55]
dt a[188:189],v31 offset:8192
cv v180,v56,v57
v_add_f32 v37,v37,v58
mm a[56:59],a[172:175],v[216:219],a[56:59]
v_exp_f32 v56,v248
mm a[60:63],a[172:175],v[220:223],a[60:63]
s_waitcnt lgkmcnt(7)
s_waitcnt vmcnt(15)
dt a[190:191],v31 offset:12288
mm v[144:147],a[144:147],v[96:99],v[80:83]
s_barrier
v_exp_f32 v57,v249
v_add_f32 v37,v37,v59
mm v[144:147],a[148:151],v[128:131],v[144:147]
s_add_u32 m0,s37,0
s_add_u32 s56,s55,65536
ds_read_b128 a[128:131],v20 offset:24576
mm v[144:147],a[152:155],v[160:163],v[144:147]
bl v18,s[28:31],s56 offen lds
mm v[144:147],a[156:159],v[192:195],v[144:147]
cv v181,v58,v59
v_exp_f32 v58,v250
mm v[148:151],a[144:147],v[100:103],v[84:87]
v_exp_f32 v59,v251
mm v[148:151],a[148:151],v[132:135],v[148:151]
ds_read_b128 a[132:135],v21 offset:24576
v_add_f32 v37,v37,v40
mm v[148:151],a[152:155],v[164:167],v[148:151]
v_add_f32 v37,v37,v41
cv v182,v40,v41
v_add_f32 v37,v37,v42
mm v[148:151],a[156:159],v[196:199],v[148:151]
v_exp_f32 v40,v236
mm v[152:155],a[144:147],v[104:107],v[88:91]
v_exp_f32 v41,v237
mm v[152:155],a[148:151],v[136:139],v[152:155]
ds_read_b128 a[136:139],v22 offset:24576
v_add_f32 v37,v37,v43
cv v183,v42,v43
mm v[152:155],a[152:155],v[168:171],v[152:155]
v_exp_f32 v42,v238
mm v[152:155],a[156:159],v[200:203],v[152:155]
v_exp_f32 v43,v239
v_add_f32 v34,v34,v38
mm v[156:159],a[144:147],v[108:111],v[92:95]
v_add_f32 v38,v44,v45
cv v184,v44,v45
mm v[156:159],a[148:151],v[140:143],v[156:159]
ds_read_b128 a[140:143],v23 offset:24576
v_add_f32 v38,v38,v46
mm v[156:159],a[152:155],v[172:175],v[156:159]
v_exp_f32 v44,v252
v_add_f32 v38,v38,v47
mm v[156:159],a[156:159],v[204:207],v[156:159]
s_waitcnt lgkmcnt(4)
v_exp_f32 v45,v253
mm a[64:67],a[176:179],v[208:211],a[64:67]
s_add_u32 m0,s37,1024
cv v185,v46,v47
v_add_f32 v38,v38,v56
mm a[68:71],a[176:179],v[212:215],a[68:71]
dt a[160:161],v24 offset:16384
v_exp_f32 v46,v254
mm a[72:75],a[176:179],v[216:219],a[72:75]
bl v19,s[28:31],s56 offen lds
mm a[76:79],a[176:179],v[220:223],a[76:79]
dt a[162:163],v24 offset:20480
v_add_f32 v38,v38,v57
mm a[80:83],a[180:183],v[208:211],a[80:83]
v_exp_f32 v47,v255
cv v186,v56,v57
mm a[84:87],a[180:183],v[212:215],a[84:87]
dt a[164:165],v25 offset:16384
v_add_f32 v38,v38,v58
mm a[88:91],a[180:183],v[216:219],a[88:91]
v_add_f32 v38,v38,v59
cv v187,v58,v59
mm a[92:95],a[180:183],v[220:223],a[92:95]
dt a[166:167],v25 offset:20480
v_add_f32 v35,v35,v39
v_add_f32 v39,v40,v41
mm a[96:99],a[184:187],v[208:211],a[96:99]
cv v188,v40,v41
v_add_f32 v39,v39,v42
mm a[100:103],a[184:187],v[212:215],a[100:103]
dt a[168:169],v26 offset:16384
v_add_f32 v39,v39,v43
mm a[104:107],a[184:187],v[216:219],a[104:107]
cv v189,v42,v43
v_add_f32 v39,v39,v44
v_add_f32 v39,v39,v45
mm a[108:111],a[184:187],v[220:223],a[108:111]
dt a[170:171],v26 offset:20480
cv v190,v44,v45
mm a[112:115],a[188:191],v[208:211],a[112:115]
v_add_f32 v39,v39,v46
v_add_f32 v39,v39,v47
mm a[116:119],a[188:191],v[212:215],a[116:119]
dt a[172:173],v27 offset:16384
cv v191,v46,v47
v_max3_f32 v48,v36,v37,v38
mm a[120:123],a[188:191],v[216:219],a[120:123]
v_max_f32 v48,v48,v39
v_cmp_nle_f32 vcc,v48,v49
mm a[124:127],a[188:191],v[220:223],a[124:127]
s_waitcnt lgkmcnt(7)
dt a[174:175],v27 offset:20480
s_cbranch_vccnz L_rares2
L_backs2:
mm v[224:227],a[128:131],v[96:99],v[80:83]
v_exp_f32 v40,v112
mm v[224:227],a[132:135],v[128:131],v[224:227]
ds_read_b128 a[144:147],v20 offset:28672
v_exp_f32 v41,v113
mm v[224:227],a[136:139],v[160:163],v[224:227]
s_add_u32 m0,s37,65536
s_add_u32 s57,s55,73728
v_add_f32 v32,v32,v36
mm v[224:227],a[140:143],v[192:195],v[224:227]
v_exp_f32 v42,v114
mm v[228:231],a[128:131],v[100:103],v[84:87]
bl v16,s[24:27],s57 offen lds
v_add_f32 v36,v40,v41
mm v[228:231],a[132:135],v[132:135],v[228:231]
ds_read_b128 a[148:151],v21 offset:28672
cv v208,v40,v41
mm v[228:231],a[136:139],v[164:167],v[228:231]
v_exp_f32 v43,v115
mm v[228:231],a[140:143],v[196:199],v[228:231]
v_exp_f32 v44,v144
v_add_f32 v36,v36,v42
mm v[232:235],a[128:131],v[104:107],v[88:91]
v_exp_f32 v45,v145
mm v[232:235],a[132:135],v[136:139],v[232:235]
ds_read_b128 a[152:155],v22 offset:28672
v_add_f32 v36,v36,v43
mm v[232:235],a[136:139],v[168:171],v[232:235]
v_exp_f32 v46,v146
cv v209,v42,v43
mm v[232:235],a[140:143],v[200:203],v[232:235]
v_exp_f32 v47,v147
mm v[236:239],a[128:131],v[108:111],v[92:95]
v_exp_f32 v56,v116
mm v[236:239],a[132:135],v[140:143],v[236:239]
ds_read_b128 a[156:159],v23 offset:28672
v_exp_f32 v57,v117
mm v[236:239],a[136:139],v[172:175],v[236:239]
v_exp_f32 v58,v118
mm v[236:239],a[140:143],v[204:207],v[236:239]
s_waitcnt lgkmcnt(4)
v_exp_f32 v59,v119
mm a[0:3],a[160:163],v[176:179],a[0:3]
v_exp_f32 v40,v148
v_add_f32 v36,v36,v44
mm a[4:7],a[160:163],v[180:183],a[4:7]
dt a[176:177],v28 offset:16384
v_add_f32 v36,v36,v45
mm a[8:11],a[160:163],v[184:187],a[8:11]
v_exp_f32 v41,v149
mm a[12:15],a[160:163],v[188:191],a[12:15]
dt a[178:179],v28 offset:20480
v_exp_f32 v42,v150
mm a[16:19],a[164:167],v[176:179],a[16:19]
s_add_u32 m0,s37,66560
v_exp_f32 v43,v151
mm a[20:23],a[164:167],v[180:183],a[20:23]
dt a[180:181],v29 offset:16384
cv v210,v44,v45
mm a[24:27],a[164:167],v[184:187],a[24:27]
bl v17,s[24:27],s57 offen lds
v_add_f32 v36,v36,v46
mm a[28:31],a[164:167],v[188:191],a[28:31]
dt a[182:183],v29 offset:20480
v_add_f32 v36,v36,v47
mm a[32:35],a[168:171],v[176:179],a[32:35]
v_exp_f32 v44,v120
mm a[36:39],a[168:171],v[180:183],a[36:39]
dt a[184:185],v30 offset:16384
v_exp_f32 v45,v121
mm a[40:43],a[168:171],v[184:187],a[40:43]
cv v211,v46,v47
v_add_f32 v33,v33,v37
mm a[44:47],a[168:171],v[188:191],a[44:47]
dt a[186:187],v30 offset:20480
v_add_f32 v37,v56,v57
mm a[48:51],a[172:175],v[176:179],a[48:51]
v_exp_f32 v46,v122
cv v212,v56,v57
mm a[52:55],a[172:175],v[180:183],a[52:55]
dt a[188:189],v31 offset:16384
v_add_f32 v37,v37,v58
mm a[56:59],a[172:175],v[184:187],a[56:59]
v_exp_f32 v47,v123
mm a[60:63],a[172:175],v[188:191],a[60:63]
s_waitcnt lgkmcnt(7)
dt a[190:191],v31 offset:20480
v_exp_f32 v56,v152
mm v[240:243],a[144:147],v[96:99],v[80:83]
v_exp_f32 v57,v153
mm v[240:243],a[148:151],v[128:131],v[240:243]
ds_read_b128 a[128:131],v20 offset:32768
v_add_f32 v37,v37,v59
mm v[240:243],a[152:155],v[160:163],v[240:243]
cv v213,v58,v59
v_exp_f32 v58,v154
mm v[240:243],a[156:159],v[192:195],v[240:243]
v_exp_f32 v59,v155
mm v[244:247],a[144:147],v[100:103],v[84:87]
v_add_f32 v37,v37,v40
v_add_f32 v37,v37,v41
mm v[244:247],a[148:151],v[132:135],v[244:247]
ds_read_b128 a[132:135],v21 offset:32768
cv v214,v40,v41
v_add_f32 v37,v37,v42
mm v[244:247],a[152:155],v[164:167],v[244:247]
s_add_u32 s82,s82,8192
v_exp_f32 v40,v124
mm v[244:247],a[156:159],v[196:199],v[244:247]
v_exp_f32 v41,v125
mm v[248:251],a[144:147],v[104:107],v[88:91]
buffer_load_dword v55,v54,s[96:99],s82 offen
v_add_f32 v37,v37,v43
mm v[248:251],a[148:151],v[136:139],v[248:251]
ds_read_b128 a[136:139],v22 offset:32768
cv v215,v42,v43
mm v[248:251],a[152:155],v[168:171],v[248:251]
v_exp_f32 v42,v126
mm v[248:251],a[156:159],v[200:203],v[248:251]
v_exp_f32 v43,v127
v_add_f32 v34,v34,v38
mm v[252:255],a[144:147],v[108:111],v[92:95]
v_add_f32 v38,v44,v45
cv v216,v44,v45
mm v[252:255],a[148:151],v[140:143],v[252:255]
ds_read_b128 a[140:143],v23 offset:32768
v_add_f32 v38,v38,v46
mm v[252:255],a[152:155],v[172:175],v[252:255]
v_exp_f32 v44,v156
v_add_f32 v38,v38,v47
mm v[252:255],a[156:159],v[204:207],v[252:255]
s_waitcnt lgkmcnt(4)
v_exp_f32 v45,v157
mm a[64:67],a[176:179],v[176:179],a[64:67]
cv v217,v46,v47
v_add_f32 v38,v38,v56
mm a[68:71],a[176:179],v[180:183],a[68:71]
dt a[160:161],v24 offset:24576
v_exp_f32 v46,v158
mm a[72:75],a[176:179],v[184:187],a[72:75]
v_exp_f32 v47,v159
mm a[76:79],a[176:179],v[188:191],a[76:79]
dt a[162:163],v24 offset:28672
v_add_f32 v38,v38,v57
mm a[80:83],a[180:183],v[176:179],a[80:83]
cv v218,v56,v57
v_add_f32 v38,v38,v58
v_add_f32 v38,v38,v59
mm a[84:87],a[180:183],v[180:183],a[84:87]
dt a[164:165],v25 offset:24576
cv v219,v58,v59
mm a[88:91],a[180:183],v[184:187],a[88:91]
v_add_f32 v35,v35,v39
v_add_f32 v39,v40,v41
mm a[92:95],a[180:183],v[188:191],a[92:95]
dt a[166:167],v25 offset:28672
cv v220,v40,v41
v_add_f32 v39,v39,v42
mm a[96:99],a[184:187],v[176:179],a[96:99]
s_add_u32 s82,s82,8192
v_add_f32 v39,v39,v43
cv v221,v42,v43
mm a[100:103],a[184:187],v[180:183],a[100:103]
dt a[168:169],v26 offset:24576
v_add_f32 v39,v39,v44
mm a[104:107],a[184:187],v[184:187],a[104:107]
buffer_load_dword v55,v54,s[96:99],s82 offen
v_add_f32 v39,v39,v45
mm a[108:111],a[184:187],v[188:191],a[108:111]
dt a[170:171],v26 offset:28672
cv v222,v44,v45
mm a[112:115],a[188:191],v[176:179],a[112:115]
v_add_f32 v39,v39,v46
v_add_f32 v39,v39,v47
mm a[116:119],a[188:191],v[180:183],a[116:119]
dt a[172:173],v27 offset:24576
cv v223,v46,v47
v_max3_f32 v48,v36,v37,v38
mm a[120:123],a[188:191],v[184:187],a[120:123]
v_max_f32 v48,v48,v39
v_cmp_nle_f32 vcc,v48,v49
mm a[124:127],a[188:191],v[188:191],a[124:127]
s_waitcnt lgkmcnt(7)
dt a[174:175],v27 offset:28672
s_cbranch_vccnz L_rares3
L_backs3:
mm v[112:115],a[128:131],v[96:99],v[80:83]
v_exp_f32 v40,v224
mm v[112:115],a[132:135],v[128:131],v[112:115]
ds_read_b128 a[144:147],v20 offset:36864
v_exp_f32 v41,v225
mm v[112:115],a[136:139],v[160:163],v[112:115]
v_exp_f32 v42,v226
mm v[112:115],a[140:143],v[192:195],v[112:115]
v_exp_f32 v43,v227
v_add_f32 v32,v32,v36
mm v[116:119],a[128:131],v[100:103],v[84:87]
v_exp_f32 v44,v240
mm v[116:119],a[132:135],v[132:135],v[116:119]
ds_read_b128 a[148:151],v21 offset:36864
v_add_f32 v36,v40,v41
mm v[116:119],a[136:139],v[164:167],v[116:119]
v_exp_f32 v45,v241
cv v176,v40,v41
mm v[116:119],a[140:143],v[196:199],v[116:119]
v_exp_f32 v46,v242
mm v[120:123],a[128:131],v[104:107],v[88:91]
v_exp_f32 v47,v243
mm v[120:123],a[132:135],v[136:139],v[120:123]
ds_read_b128 a[152:155],v22 offset:36864
v_exp_f32 v56,v228
mm v[120:123],a[136:139],v[168:171],v[120:123]
s_add_u32 s82,s82,8192
v_exp_f32 v57,v229
mm v[120:123],a[140:143],v[200:203],v[120:123]
v_exp_f32 v58,v230
v_add_f32 v36,v36,v42
mm v[124:127],a[128:131],v[108:111],v[92:95]
buffer_load_dword v55,v54,s[96:99],s82 offen
mm v[124:127],a[132:135],v[140:143],v[124:127]
ds_read_b128 a[156:159],v23 offset:36864
v_add_f32 v36,v36,v43
mm v[124:127],a[136:139],v[172:175],v[124:127]
v_exp_f32 v59,v231
cv v177,v42,v43
mm v[124:127],a[140:143],v[204:207],v[124:127]
s_waitcnt lgkmcnt(4)
v_exp_f32 v40,v244
mm a[0:3],a[160:163],v[208:211],a[0:3]
v_exp_f32 v41,v245
mm a[4:7],a[160:163],v[212:215],a[4:7]
dt a[176:177],v28 offset:24576
v_exp_f32 v42,v246
mm a[8:11],a[160:163],v[216:219],a[8:11]
v_exp_f32 v43,v247
mm a[12:15],a[160:163],v[220:223],a[12:15]
dt a[178:179],v28 offset:28672
v_add_f32 v36,v36,v44
mm a[16:19],a[164:167],v[208:211],a[16:19]
v_add_f32 v36,v36,v45
cv v178,v44,v45
v_add_f32 v36,v36,v46
mm a[20:23],a[164:167],v[212:215],a[20:23]
dt a[180:181],v29 offset:24576
v_add_f32 v36,v36,v47
mm a[24:27],a[164:167],v[216:219],a[24:27]
v_exp_f32 v44,v232
cv v179,v46,v47
mm a[28:31],a[164:167],v[220:223],a[28:31]
dt a[182:183],v29 offset:28672
v_add_f32 v33,v33,v37
mm a[32:35],a[168:171],v[208:211],a[32:35]
v_exp_f32 v45,v233
mm a[36:39],a[168:171],v[212:215],a[36:39]
dt a[184:185],v30 offset:24576
v_exp_f32 v46,v234
mm a[40:43],a[168:171],v[216:219],a[40:43]
v_exp_f32 v47,v235
mm a[44:47],a[168:171],v[220:223],a[44:47]
dt a[186:187],v30 offset:28672
v_add_f32 v37,v56,v57
mm a[48:51],a[172:175],v[208:211],a[48:51]
cv v180,v56,v57
v_exp_f32 v56,v248
mm a[52:55],a[172:175],v[212:215],a[52:55]
dt a[188:189],v31 offset:24576
v_add_f32 v37,v37,v58
mm a[56:59],a[172:175],v[216:219],a[56:59]
v_exp_f32 v57,v249
mm a[60:63],a[172:175],v[220:223],a[60:63]
s_waitcnt lgkmcnt(7)
s_waitcnt vmcnt(14)
dt a[190:191],v31 offset:28672
v_add_f32 v37,v37,v59
mm v[144:147],a[144:147],v[96:99],v[80:83]
s_barrier
cv v181,v58,v59
v_add_f32 v37,v37,v40
mm v[144:147],a[148:151],v[128:131],v[144:147]
s_add_u32 m0,s37,8192
s_add_u32 s58,s55,73728
ds_read_b128 a[128:131],v20 offset:40960
v_add_f32 v37,v37,v41
mm v[144:147],a[152:155],v[160:163],v[144:147]
bl v18,s[28:31],s58 offen lds
mm v[144:147],a[156:159],v[192:195],v[144:147]
v_exp_f32 v58,v250
mm v[148:151],a[144:147],v[100:103],v[84:87]
v_exp_f32 v59,v251
cv v182,v40,v41
mm v[148:151],a[148:151],v[132:135],v[148:151]
ds_read_b128 a[132:135],v21 offset:40960
v_add_f32 v37,v37,v42
mm v[148:151],a[152:155],v[164:167],v[148:151]
v_exp_f32 v40,v236
mm v[148:151],a[156:159],v[196:199],v[148:151]
v_exp_f32 v41,v237
v_add_f32 v37,v37,v43
mm v[152:155],a[144:147],v[104:107],v[88:91]
cv v183,v42,v43
v_add_f32 v34,v34,v38
mm v[152:155],a[148:151],v[136:139],v[152:155]
s_add_u32 m0,s37,9216
ds_read_b128 a[136:139],v22 offset:40960
v_add_f32 v38,v44,v45
mm v[152:155],a[152:155],v[168:171],v[152:155]
v_exp_f32 v42,v238
cv v184,v44,v45
mm v[152:155],a[156:159],v[200:203],v[152:155]
bl v19,s[28:31],s58 offen lds
mm v[156:159],a[144:147],v[108:111],v[92:95]
v_exp_f32 v43,v239
v_add_f32 v38,v38,v46
mm v[156:159],a[148:151],v[140:143],v[156:159]
ds_read_b128 a[140:143],v23 offset:40960
v_add_f32 v38,v38,v47
mm v[156:159],a[152:155],v[172:175],v[156:159]
v_exp_f32 v44,v252
mm v[156:159],a[156:159],v[204:207],v[156:159]
s_waitcnt lgkmcnt(4)
v_exp_f32 v45,v253
cv v185,v46,v47
mm a[64:67],a[176:179],v[208:211],a[64:67]
v_exp_f32 v46,v254
mm a[68:71],a[176:179],v[212:215],a[68:71]
dt a[160:161],v24 offset:32768
v_add_f32 v38,v38,v56
mm a[72:75],a[176:179],v[216:219],a[72:75]
v_exp_f32 v47,v255
v_add_f32 v38,v38,v57
mm a[76:79],a[176:179],v[220:223],a[76:79]
s_add_u32 m0,s37,73728
s_add_u32 s59,s55,81920
dt a[162:163],v24 offset:36864
mm a[80:83],a[180:183],v[208:211],a[80:83]
cv v186,v56,v57
v_add_f32 v38,v38,v58
mm a[84:87],a[180:183],v[212:215],a[84:87]
dt a[164:165],v25 offset:32768
v_add_f32 v38,v38,v59
cv v187,v58,v59
mm a[88:91],a[180:183],v[216:219],a[88:91]
bl v16,s[24:27],s59 offen lds
mm a[92:95],a[180:183],v[220:223],a[92:95]
dt a[166:167],v25 offset:36864
v_add_f32 v35,v35,v39
v_add_f32 v39,v40,v41
mm a[96:99],a[184:187],v[208:211],a[96:99]
cv v188,v40,v41
v_add_f32 v39,v39,v42
mm a[100:103],a[184:187],v[212:215],a[100:103]
dt a[168:169],v26 offset:32768
v_add_f32 v39,v39,v43
mm a[104:107],a[184:187],v[216:219],a[104:107]
cv v189,v42,v43
v_add_f32 v39,v39,v44
v_add_f32 v39,v39,v45
mm a[108:111],a[184:187],v[220:223],a[108:111]
dt a[170:171],v26 offset:36864
cv v190,v44,v45
mm a[112:115],a[188:191],v[208:211],a[112:115]
v_add_f32 v39,v39,v46
v_add_f32 v39,v39,v47
mm a[116:119],a[188:191],v[212:215],a[116:119]
dt a[172:173],v27 offset:32768
cv v191,v46,v47
v_max3_f32 v48,v36,v37,v38
mm a[120:123],a[188:191],v[216:219],a[120:123]
s_add_u32 m0,s37,74752
v_max_f32 v48,v48,v39
v_cmp_nle_f32 vcc,v48,v49
mm a[124:127],a[188:191],v[220:223],a[124:127]
s_waitcnt lgkmcnt(7)
dt a[174:175],v27 offset:36864
s_cbranch_vccnz L_rares4
L_backs4:
mm v[224:227],a[128:131],v[96:99],v[80:83]
bl v17,s[24:27],s59 offen lds
mm v[224:227],a[132:135],v[128:131],v[224:227]
ds_read_b128 a[144:147],v20 offset:45056
v_exp_f32 v40,v112
mm v[224:227],a[136:139],v[160:163],v[224:227]
v_exp_f32 v41,v113
mm v[224:227],a[140:143],v[192:195],v[224:227]
v_exp_f32 v42,v114
v_add_f32 v32,v32,v36
mm v[228:231],a[128:131],v[100:103],v[84:87]
v_exp_f32 v43,v115
mm v[228:231],a[132:135],v[132:135],v[228:231]
ds_read_b128 a[148:151],v21 offset:45056
v_exp_f32 v44,v144
mm v[228:231],a[136:139],v[164:167],v[228:231]
v_exp_f32 v45,v145
mm v[228:231],a[140:143],v[196:199],v[228:231]
v_exp_f32 v46,v146
mm v[232:235],a[128:131],v[104:107],v[88:91]
s_add_u32 m0,s37,16384
s_add_u32 s56,s55,81920
v_exp_f32 v47,v147
mm v[232:235],a[132:135],v[136:139],v[232:235]
ds_read_b128 a[152:155],v22 offset:45056
v_add_f32 v36,v40,v41
mm v[232:235],a[136:139],v[168:171],v[232:235]
bl v18,s[28:31],s56 offen lds
cv v208,v40,v41
mm v[232:235],a[140:143],v[200:203],v[232:235]
v_exp_f32 v56,v116
mm v[236:239],a[128:131],v[108:111],v[92:95]
v_exp_f32 v57,v117
mm v[236:239],a[132:135],v[140:143],v[236:239]
ds_read_b128 a[156:159],v23 offset:45056
v_exp_f32 v58,v118
mm v[236:239],a[136:139],v[172:175],v[236:239]
v_exp_f32 v59,v119
mm v[236:239],a[140:143],v[204:207],v[236:239]
s_waitcnt lgkmcnt(4)
v_exp_f32 v40,v148
v_add_f32 v36,v36,v42
mm a[0:3],a[160:163],v[176:179],a[0:3]
v_exp_f32 v41,v149
mm a[4:7],a[160:163],v[180:183],a[4:7]
dt a[176:177],v28 offset:32768
v_add_f32 v36,v36,v43
cv v209,v42,v43
mm a[8:11],a[160:163],v[184:187],a[8:11]
s_add_u32 m0,s37,17408
v_exp_f32 v42,v150
mm a[12:15],a[160:163],v[188:191],a[12:15]
dt a[178:179],v28 offset:36864
v_add_f32 v36,v36,v44
mm a[16:19],a[164:167],v[176:179],a[16:19]
bl v19,s[28:31],s56 offen lds
v_add_f32 v36,v36,v45
mm a[20:23],a[164:167],v[180:183],a[20:23]
dt a[180:181],v29 offset:32768
cv v210,v44,v45
mm a[24:27],a[164:167],v[184:187],a[24:27]
v_exp_f32 v43,v151
v_add_f32 v36,v36,v46
mm a[28:31],a[164:167],v[188:191],a[28:31]
dt a[182:183],v29 offset:36864
v_add_f32 v36,v36,v47
mm a[32:35],a[168:171],v[176:179],a[32:35]
v_exp_f32 v44,v120
mm a[36:39],a[168:171],v[180:183],a[36:39]
dt a[184:185],v30 offset:32768
v_exp_f32 v45,v121
mm a[40:43],a[168:171],v[184:187],a[40:43]
cv v211,v46,v47
v_add_f32 v33,v33,v37
mm a[44:47],a[168:171],v[188:191],a[44:47]
dt a[186:187],v30 offset:36864
v_exp_f32 v46,v122
mm a[48:51],a[172:175],v[176:179],a[48:51]
v_exp_f32 v47,v123
mm a[52:55],a[172:175],v[180:183],a[52:55]
dt a[188:189],v31 offset:32768
v_add_f32 v37,v56,v57
mm a[56:59],a[172:175],v[184:187],a[56:59]
s_add_u32 m0,s37,81920
s_add_u32 s57,s55,90112
cv v212,v56,v57
v_add_f32 v37,v37,v58
mm a[60:63],a[172:175],v[188:191],a[60:63]
s_waitcnt lgkmcnt(7)
dt a[190:191],v31 offset:36864
v_add_f32 v37,v37,v59
mm v[240:243],a[144:147],v[96:99],v[80:83]
bl v16,s[24:27],s57 offen lds
cv v213,v58,v59
mm v[240:243],a[148:151],v[128:131],v[240:243]
ds_read_b128 a[128:131],v20 offset:49152
v_add_f32 v37,v37,v40
mm v[240:243],a[152:155],v[160:163],v[240:243]
v_exp_f32 v56,v152
v_add_f32 v37,v37,v41
mm v[240:243],a[156:159],v[192:195],v[240:243]
v_exp_f32 v57,v153
mm v[244:247],a[144:147],v[100:103],v[84:87]
v_exp_f32 v58,v154
mm v[244:247],a[148:151],v[132:135],v[244:247]
ds_read_b128 a[132:135],v21 offset:49152
v_exp_f32 v59,v155
mm v[244:247],a[152:155],v[164:167],v[244:247]
cv v214,v40,v41
v_add_f32 v37,v37,v42
mm v[244:247],a[156:159],v[196:199],v[244:247]
v_exp_f32 v40,v124
v_add_f32 v37,v37,v43
mm v[248:251],a[144:147],v[104:107],v[88:91]
s_add_u32 m0,s37,82944
v_exp_f32 v41,v125
mm v[248:251],a[148:151],v[136:139],v[248:251]
ds_read_b128 a[136:139],v22 offset:49152
cv v215,v42,v43
mm v[248:251],a[152:155],v[168:171],v[248:251]
bl v17,s[24:27],s57 offen lds
v_add_f32 v34,v34,v38
mm v[248:251],a[156:159],v[200:203],v[248:251]
v_exp_f32 v42,v126
mm v[252:255],a[144:147],v[108:111],v[92:95]
v_exp_f32 v43,v127
v_add_f32 v38,v44,v45
mm v[252:255],a[148:151],v[140:143],v[252:255]
ds_read_b128 a[140:143],v23 offset:49152
cv v216,v44,v45
mm v[252:255],a[152:155],v[172:175],v[252:255]
v_exp_f32 v44,v156
mm v[252:255],a[156:159],v[204:207],v[252:255]
s_waitcnt lgkmcnt(4)
v_exp_f32 v45,v157
v_add_f32 v38,v38,v46
mm a[64:67],a[176:179],v[176:179],a[64:67]
v_add_f32 v38,v38,v47
cv v217,v46,v47
mm a[68:71],a[176:179],v[180:183],a[68:71]
dt a[160:161],v24 offset:40960
v_exp_f32 v46,v158
mm a[72:75],a[176:179],v[184:187],a[72:75]
s_add_u32 s82,s82,8192
v_exp_f32 v47,v159
mm a[76:79],a[176:179],v[188:191],a[76:79]
dt a[162:163],v24 offset:45056
v_add_f32 v38,v38,v56
v_add_f32 v38,v38,v57
mm a[80:83],a[180:183],v[176:179],a[80:83]
buffer_load_dword v55,v54,s[96:99],s82 offen
mm a[84:87],a[180:183],v[180:183],a[84:87]
dt a[164:165],v25 offset:40960
cv v218,v56,v57
mm a[88:91],a[180:183],v[184:187],a[88:91]
v_add_f32 v38,v38,v58
v_add_f32 v38,v38,v59
cv v219,v58,v59
mm a[92:95],a[180:183],v[188:191],a[92:95]
dt a[166:167],v25 offset:45056
v_add_f32 v35,v35,v39
mm a[96:99],a[184:187],v[176:179],a[96:99]
v_add_f32 v39,v40,v41
cv v220,v40,v41
v_add_f32 v39,v39,v42
mm a[100:103],a[184:187],v[180:183],a[100:103]
dt a[168:169],v26 offset:40960
v_add_f32 v39,v39,v43
mm a[104:107],a[184:187],v[184:187],a[104:107]
cv v221,v42,v43
v_add_f32 v39,v39,v44
mm a[108:111],a[184:187],v[188:191],a[108:111]
dt a[170:171],v26 offset:45056
v_add_f32 v39,v39,v45
cv v222,v44,v45
mm a[112:115],a[188:191],v[176:179],a[112:115]
v_add_f32 v39,v39,v46
v_add_f32 v39,v39,v47
mm a[116:119],a[188:191],v[180:183],a[116:119]
s_add_u32 s82,s82,8192
dt a[172:173],v27 offset:40960
cv v223,v46,v47
v_max3_f32 v48,v36,v37,v38
mm a[120:123],a[188:191],v[184:187],a[120:123]
v_max_f32 v48,v48,v39
v_cmp_nle_f32 vcc,v48,v49
mm a[124:127],a[188:191],v[188:191],a[124:127]
s_waitcnt lgkmcnt(7)
dt a[174:175],v27 offset:45056
s_cbranch_vccnz L_rares5
L_backs5:
mm v[112:115],a[128:131],v[96:99],v[80:83]
buffer_load_dword v55,v54,s[96:99],s82 offen
mm v[112:115],a[132:135],v[128:131],v[112:115]
ds_read_b128 a[144:147],v20 offset:53248
v_exp_f32 v40,v224
mm v[112:115],a[136:139],v[160:163],v[112:115]
v_exp_f32 v41,v225
mm v[112:115],a[140:143],v[192:195],v[112:115]
v_exp_f32 v42,v226
v_add_f32 v32,v32,v36
mm v[116:119],a[128:131],v[100:103],v[84:87]
v_exp_f32 v43,v227
mm v[116:119],a[132:135],v[132:135],v[116:119]
ds_read_b128 a[148:151],v21 offset:53248
v_add_f32 v36,v40,v41
mm v[116:119],a[136:139],v[164:167],v[116:119]
v_exp_f32 v44,v240
cv v176,v40,v41
mm v[116:119],a[140:143],v[196:199],v[116:119]
s_add_u32 s82,s82,8192
v_exp_f32 v45,v241
mm v[120:123],a[128:131],v[104:107],v[88:91]
v_exp_f32 v46,v242
v_add_f32 v36,v36,v42
mm v[120:123],a[132:135],v[136:139],v[120:123]
ds_read_b128 a[152:155],v22 offset:53248
v_add_f32 v36,v36,v43
mm v[120:123],a[136:139],v[168:171],v[120:123]
buffer_load_dword v55,v54,s[96:99],s82 offen
mm v[120:123],a[140:143],v[200:203],v[120:123]
v_exp_f32 v47,v243
cv v177,v42,v43
mm v[124:127],a[128:131],v[108:111],v[92:95]
v_exp_f32 v56,v228
mm v[124:127],a[132:135],v[140:143],v[124:127]
ds_read_b128 a[156:159],v23 offset:53248
v_add_f32 v36,v36,v44
mm v[124:127],a[136:139],v[172:175],v[124:127]
v_exp_f32 v57,v229
v_add_f32 v36,v36,v45
mm v[124:127],a[140:143],v[204:207],v[124:127]
s_waitcnt lgkmcnt(4)
v_exp_f32 v58,v230
mm a[0:3],a[160:163],v[208:211],a[0:3]
v_exp_f32 v59,v231
cv v178,v44,v45
mm a[4:7],a[160:163],v[212:215],a[4:7]
s_add_u32 s82,s82,8192
dt a[176:177],v28 offset:40960
v_add_f32 v36,v36,v46
mm a[8:11],a[160:163],v[216:219],a[8:11]
v_exp_f32 v40,v244
mm a[12:15],a[160:163],v[220:223],a[12:15]
dt a[178:179],v28 offset:45056
v_exp_f32 v41,v245
mm a[16:19],a[164:167],v[208:211],a[16:19]
buffer_load_dword v55,v54,s[96:99],s82 offen
mm a[20:23],a[164:167],v[212:215],a[20:23]
dt a[180:181],v29 offset:40960
v_add_f32 v36,v36,v47
mm a[24:27],a[164:167],v[216:219],a[24:27]
v_exp_f32 v42,v246
cv v179,v46,v47
mm a[28:31],a[164:167],v[220:223],a[28:31]
dt a[182:183],v29 offset:45056
v_add_f32 v33,v33,v37
mm a[32:35],a[168:171],v[208:211],a[32:35]
v_exp_f32 v43,v247
v_add_f32 v37,v56,v57
mm a[36:39],a[168:171],v[212:215],a[36:39]
dt a[184:185],v30 offset:40960
cv v180,v56,v57
mm a[40:43],a[168:171],v[216:219],a[40:43]
v_exp_f32 v44,v232
mm a[44:47],a[168:171],v[220:223],a[44:47]
dt a[186:187],v30 offset:45056
v_exp_f32 v45,v233
mm a[48:51],a[172:175],v[208:211],a[48:51]
v_exp_f32 v46,v234
mm a[52:55],a[172:175],v[212:215],a[52:55]
dt a[188:189],v31 offset:40960
v_exp_f32 v47,v235
mm a[56:59],a[172:175],v[216:219],a[56:59]
v_exp_f32 v56,v248
mm a[60:63],a[172:175],v[220:223],a[60:63]
s_waitcnt lgkmcnt(7)
s_waitcnt vmcnt(22)
dt a[190:191],v31 offset:45056
mm v[144:147],a[144:147],v[96:99],v[80:83]
s_barrier
v_exp_f32 v57,v249
v_add_f32 v37,v37,v58
mm v[144:147],a[148:151],v[128:131],v[144:147]
s_add_u32 m0,s37,24576
s_add_u32 s58,s55,90112
ds_read_b128 a[128:131],v20 offset:57344
mm v[144:147],a[152:155],v[160:163],v[144:147]
bl v18,s[28:31],s58 offen lds
mm v[144:147],a[156:159],v[192:195],v[144:147]
v_add_f32 v37,v37,v59
cv v181,v58,v59
v_add_f32 v37,v37,v40
mm v[148:151],a[144:147],v[100:103],v[84:87]
v_exp_f32 v58,v250
mm v[148:151],a[148:151],v[132:135],v[148:151]
ds_read_b128 a[132:135],v21 offset:57344
v_exp_f32 v59,v251
mm v[148:151],a[152:155],v[164:167],v[148:151]
v_add_f32 v37,v37,v41
cv v182,v40,v41
mm v[148:151],a[156:159],v[196:199],v[148:151]
v_exp_f32 v40,v236
mm v[152:155],a[144:147],v[104:107],v[88:91]
v_exp_f32 v41,v237
v_add_f32 v37,v37,v42
mm v[152:155],a[148:151],v[136:139],v[152:155]
ds_read_b128 a[136:139],v22 offset:57344
v_add_f32 v37,v37,v43
mm v[152:155],a[152:155],v[168:171],v[152:155]
cv v183,v42,v43
v_add_f32 v34,v34,v38
mm v[152:155],a[156:159],v[200:203],v[152:155]
v_exp_f32 v42,v238
v_add_f32 v38,v44,v45
mm v[156:159],a[144:147],v[108:111],v[92:95]
v_exp_f32 v43,v239
mm v[156:159],a[148:151],v[140:143],v[156:159]
ds_read_b128 a[140:143],v23 offset:57344
cv v184,v44,v45
v_add_f32 v38,v38,v46
mm v[156:159],a[152:155],v[172:175],v[156:159]
v_exp_f32 v44,v252
mm v[156:159],a[156:159],v[204:207],v[156:159]
s_waitcnt lgkmcnt(4)
v_exp_f32 v45,v253
mm a[64:67],a[176:179],v[208:211],a[64:67]
v_add_f32 v38,v38,v47
cv v185,v46,v47
v_add_f32 v38,v38,v56
mm a[68:71],a[176:179],v[212:215],a[68:71]
dt a[160:161],v24 offset:49152
v_add_f32 v38,v38,v57
mm a[72:75],a[176:179],v[216:219],a[72:75]
s_add_u32 m0,s37,25600
v_exp_f32 v46,v254
cv v186,v56,v57
mm a[76:79],a[176:179],v[220:223],a[76:79]
dt a[162:163],v24 offset:53248
v_add_f32 v38,v38,v58
mm a[80:83],a[180:183],v[208:211],a[80:83]
bl v19,s[28:31],s58 offen lds
mm a[84:87],a[180:183],v[212:215],a[84:87]
dt a[164:165],v25 offset:49152
v_exp_f32 v47,v255
mm a[88:91],a[180:183],v[216:219],a[88:91]
v_add_f32 v38,v38,v59
cv v187,v58,v59
mm a[92:95],a[180:183],v[220:223],a[92:95]
dt a[166:167],v25 offset:53248
v_add_f32 v35,v35,v39
mm a[96:99],a[184:187],v[208:211],a[96:99]
v_add_f32 v39,v40,v41
cv v188,v40,v41
v_add_f32 v39,v39,v42
mm a[100:103],a[184:187],v[212:215],a[100:103]
dt a[168:169],v26 offset:49152
v_add_f32 v39,v39,v43
mm a[104:107],a[184:187],v[216:219],a[104:107]
cv v189,v42,v43
v_add_f32 v39,v39,v44
v_add_f32 v39,v39,v45
mm a[108:111],a[184:187],v[220:223],a[108:111]
dt a[170:171],v26 offset:53248
cv v190,v44,v45
mm a[112:115],a[188:191],v[208:211],a[112:115]
v_add_f32 v39,v39,v46
v_add_f32 v39,v39,v47
mm a[116:119],a[188:191],v[212:215],a[116:119]
dt a[172:173],v27 offset:49152
cv v191,v46,v47
v_max3_f32 v48,v36,v37,v38
mm a[120:123],a[188:191],v[216:219],a[120:123]
v_max_f32 v48,v48,v39
v_cmp_nle_f32 vcc,v48,v49
mm a[124:127],a[188:191],v[220:223],a[124:127]
s_waitcnt lgkmcnt(7)
dt a[174:175],v27 offset:53248
s_cbranch_vccnz L_rares6
L_backs6:
mm v[224:227],a[128:131],v[96:99],v[80:83]
v_exp_f32 v40,v112
mm v[224:227],a[132:135],v[128:131],v[224:227]
ds_read_b128 a[144:147],v20 offset:61440
v_exp_f32 v41,v113
mm v[224:227],a[136:139],v[160:163],v[224:227]
v_exp_f32 v42,v114
mm v[224:227],a[140:143],v[192:195],v[224:227]
v_exp_f32 v43,v115
mm v[228:231],a[128:131],v[100:103],v[84:87]
v_exp_f32 v44,v144
v_add_f32 v32,v32,v36
mm v[228:231],a[132:135],v[132:135],v[228:231]
ds_read_b128 a[148:151],v21 offset:61440
v_add_f32 v36,v40,v41
mm v[228:231],a[136:139],v[164:167],v[228:231]
v_exp_f32 v45,v145
mm v[228:231],a[140:143],v[196:199],v[228:231]
v_exp_f32 v46,v146
mm v[232:235],a[128:131],v[104:107],v[88:91]
s_getpc_b64 s[0:1]
L_cpf5:
s_add_u32 s100,s47,4096
s_min_u32 s100,s100,L_mid-1024-L_cpf5
s_add_u32 s0,s0,s100
s_addc_u32 s1,s1,0
v_exp_f32 v47,v147
cv v208,v40,v41
mm v[232:235],a[132:135],v[136:139],v[232:235]
ds_read_b128 a[152:155],v22 offset:61440
v_add_f32 v36,v36,v42
mm v[232:235],a[136:139],v[168:171],v[232:235]
global_load_dword v55,v3,s[0:1]
mm v[232:235],a[140:143],v[200:203],v[232:235]
v_exp_f32 v56,v116
mm v[236:239],a[128:131],v[108:111],v[92:95]
v_exp_f32 v57,v117
v_add_f32 v36,v36,v43
mm v[236:239],a[132:135],v[140:143],v[236:239]
ds_read_b128 a[156:159],v23 offset:61440
cv v209,v42,v43
mm v[236:239],a[136:139],v[172:175],v[236:239]
v_exp_f32 v58,v118
mm v[236:239],a[140:143],v[204:207],v[236:239]
s_waitcnt lgkmcnt(4)
v_exp_f32 v59,v119
mm a[0:3],a[160:163],v[176:179],a[0:3]
v_exp_f32 v40,v148
v_add_f32 v36,v36,v44
mm a[4:7],a[160:163],v[180:183],a[4:7]
dt a[176:177],v28 offset:49152
v_add_f32 v36,v36,v45
mm a[8:11],a[160:163],v[184:187],a[8:11]
v_exp_f32 v41,v149
mm a[12:15],a[160:163],v[188:191],a[12:15]
dt a[178:179],v28 offset:53248
cv v210,v44,v45
mm a[16:19],a[164:167],v[176:179],a[16:19]
v_exp_f32 v42,v150
v_add_f32 v36,v36,v46
mm a[20:23],a[164:167],v[180:183],a[20:23]
dt a[180:181],v29 offset:49152
v_add_f32 v36,v36,v47
mm a[24:27],a[164:167],v[184:187],a[24:27]
v_exp_f32 v43,v151
mm a[28:31],a[164:167],v[188:191],a[28:31]
dt a[182:183],v29 offset:53248
cv v211,v46,v47
mm a[32:35],a[168:171],v[176:179],a[32:35]
v_exp_f32 v44,v120
v_add_f32 v33,v33,v37
mm a[36:39],a[168:171],v[180:183],a[36:39]
dt a[184:185],v30 offset:49152
v_add_f32 v37,v56,v57
mm a[40:43],a[168:171],v[184:187],a[40:43]
v_exp_f32 v45,v121
mm a[44:47],a[168:171],v[188:191],a[44:47]
dt a[186:187],v30 offset:53248
cv v212,v56,v57
mm a[48:51],a[172:175],v[176:179],a[48:51]
v_exp_f32 v46,v122
v_add_f32 v37,v37,v58
mm a[52:55],a[172:175],v[180:183],a[52:55]
dt a[188:189],v31 offset:49152
v_add_f32 v37,v37,v59
mm a[56:59],a[172:175],v[184:187],a[56:59]
v_exp_f32 v47,v123
mm a[60:63],a[172:175],v[188:191],a[60:63]
s_waitcnt lgkmcnt(7)
s_waitcnt vmcnt(18)
dt a[190:191],v31 offset:53248
mm v[240:243],a[144:147],v[96:99],v[80:83]
s_barrier
v_exp_f32 v56,v152
cv v213,v58,v59
mm v[240:243],a[148:151],v[128:131],v[240:243]
ds_read_b128 a[128:131],v20 offset:0
v_add_f32 v37,v37,v40
mm v[240:243],a[152:155],v[160:163],v[240:243]
v_exp_f32 v57,v153
mm v[240:243],a[156:159],v[192:195],v[240:243]
v_exp_f32 v58,v154
mm v[244:247],a[144:147],v[100:103],v[84:87]
v_exp_f32 v59,v155
v_add_f32 v37,v37,v41
mm v[244:247],a[148:151],v[132:135],v[244:247]
ds_read_b128 a[132:135],v21 offset:0
cv v214,v40,v41
mm v[244:247],a[152:155],v[164:167],v[244:247]
v_exp_f32 v40,v124
mm v[244:247],a[156:159],v[196:199],v[244:247]
v_exp_f32 v41,v125
mm v[248:251],a[144:147],v[104:107],v[88:91]
v_add_f32 v37,v37,v42
v_add_f32 v37,v37,v43
cv v215,v42,v43
mm v[248:251],a[148:151],v[136:139],v[248:251]
ds_read_b128 a[136:139],v22 offset:0
v_add_f32 v34,v34,v38
mm v[248:251],a[152:155],v[168:171],v[248:251]
v_exp_f32 v42,v126
mm v[248:251],a[156:159],v[200:203],v[248:251]
v_exp_f32 v43,v127
mm v[252:255],a[144:147],v[108:111],v[92:95]
v_add_f32 v38,v44,v45
cv v216,v44,v45
v_add_f32 v38,v38,v46
mm v[252:255],a[148:151],v[140:143],v[252:255]
ds_read_b128 a[140:143],v23 offset:0
v_add_f32 v38,v38,v47
mm v[252:255],a[152:155],v[172:175],v[252:255]
v_exp_f32 v44,v156
mm v[252:255],a[156:159],v[204:207],v[252:255]
s_waitcnt lgkmcnt(4)
v_exp_f32 v45,v157
mm a[64:67],a[176:179],v[176:179],a[64:67]
cv v217,v46,v47
v_exp_f32 v46,v158
mm a[68:71],a[176:179],v[180:183],a[68:71]
dt a[160:161],v24 offset:57344
v_add_f32 v38,v38,v56
mm a[72:75],a[176:179],v[184:187],a[72:75]
v_exp_f32 v47,v159
mm a[76:79],a[176:179],v[188:191],a[76:79]
dt a[162:163],v24 offset:61440
v_add_f32 v38,v38,v57
mm a[80:83],a[180:183],v[176:179],a[80:83]
cv v218,v56,v57
v_add_f32 v38,v38,v58
v_add_f32 v38,v38,v59
mm a[84:87],a[180:183],v[180:183],a[84:87]
dt a[164:165],v25 offset:57344
cv v219,v58,v59
mm a[88:91],a[180:183],v[184:187],a[88:91]
v_add_f32 v35,v35,v39
v_add_f32 v39,v40,v41
mm a[92:95],a[180:183],v[188:191],a[92:95]
dt a[166:167],v25 offset:61440
cv v220,v40,v41
mm a[96:99],a[184:187],v[176:179],a[96:99]
v_add_f32 v39,v39,v42
v_add_f32 v39,v39,v43
cv v221,v42,v43
mm a[100:103],a[184:187],v[180:183],a[100:103]
dt a[168:169],v26 offset:57344
v_add_f32 v39,v39,v44
mm a[104:107],a[184:187],v[184:187],a[104:107]
v_add_f32 v39,v39,v45
cv v222,v44,v45
mm a[108:111],a[184:187],v[188:191],a[108:111]
dt a[170:171],v26 offset:61440
v_add_f32 v39,v39,v46
mm a[112:115],a[188:191],v[176:179],a[112:115]
v_add_f32 v39,v39,v47
cv v223,v46,v47
v_max3_f32 v48,v36,v37,v38
mm a[116:119],a[188:191],v[180:183],a[116:119]
dt a[172:173],v27 offset:57344
v_max_f32 v48,v48,v39
mm a[120:123],a[188:191],v[184:187],a[120:123]
v_cmp_nle_f32 vcc,v48,v49
mm a[124:127],a[188:191],v[188:191],a[124:127]
s_waitcnt lgkmcnt(7)
dt a[174:175],v27 offset:61440
s_cbranch_vccnz L_rares7
L_backs7:
mm v[112:115],a[128:131],v[96:99],v[80:83]
v_exp_f32 v40,v224
mm v[112:115],a[132:135],v[128:131],v[112:115]
ds_read_b128 a[144:147],v20 offset:4096
v_exp_f32 v41,v225
mm v[112:115],a[136:139],v[160:163],v[112:115]
v_exp_f32 v42,v226
mm v[112:115],a[140:143],v[192:195],v[112:115]
v_exp_f32 v43,v227
v_add_f32 v32,v32,v36
mm v[116:119],a[128:131],v[100:103],v[84:87]
v_exp_f32 v44,v240
mm v[116:119],a[132:135],v[132:135],v[116:119]
ds_read_b128 a[148:151],v21 offset:4096
v_add_f32 v36,v40,v41
mm v[116:119],a[136:139],v[164:167],v[116:119]
v_exp_f32 v45,v241
cv v176,v40,v41
mm v[116:119],a[140:143],v[196:199],v[116:119]
v_exp_f32 v46,v242
mm v[120:123],a[128:131],v[104:107],v[88:91]
v_exp_f32 v47,v243
v_add_f32 v36,v36,v42
mm v[120:123],a[132:135],v[136:139],v[120:123]
ds_read_b128 a[152:155],v22 offset:4096
v_add_f32 v36,v36,v43
mm v[120:123],a[136:139],v[168:171],v[120:123]
v_exp_f32 v56,v228
mm v[120:123],a[140:143],v[200:203],v[120:123]
v_exp_f32 v57,v229
cv v177,v42,v43
mm v[124:127],a[128:131],v[108:111],v[92:95]
v_exp_f32 v58,v230
mm v[124:127],a[132:135],v[140:143],v[124:127]
ds_read_b128 a[156:159],v23 offset:4096
v_exp_f32 v59,v231
mm v[124:127],a[136:139],v[172:175],v[124:127]
v_exp_f32 v40,v244
mm v[124:127],a[140:143],v[204:207],v[124:127]
s_waitcnt lgkmcnt(4)
v_exp_f32 v41,v245
mm a[0:3],a[160:163],v[208:211],a[0:3]
v_exp_f32 v42,v246
v_add_f32 v36,v36,v44
mm a[4:7],a[160:163],v[212:215],a[4:7]
dt a[176:177],v28 offset:57344
v_add_f32 v36,v36,v45
mm a[8:11],a[160:163],v[216:219],a[8:11]
v_exp_f32 v43,v247
cv v178,v44,v45
mm a[12:15],a[160:163],v[220:223],a[12:15]
dt a[178:179],v28 offset:61440
v_add_f32 v36,v36,v46
mm a[16:19],a[164:167],v[208:211],a[16:19]
v_exp_f32 v44,v232
mm a[20:23],a[164:167],v[212:215],a[20:23]
dt a[180:181],v29 offset:57344
v_exp_f32 v45,v233
mm a[24:27],a[164:167],v[216:219],a[24:27]
v_add_f32 v36,v36,v47
cv v179,v46,v47
mm a[28:31],a[164:167],v[220:223],a[28:31]
dt a[182:183],v29 offset:61440
v_exp_f32 v46,v234
mm a[32:35],a[168:171],v[208:211],a[32:35]
v_exp_f32 v47,v235
mm a[36:39],a[168:171],v[212:215],a[36:39]
dt a[184:185],v30 offset:57344
v_add_f32 v33,v33,v37
mm a[40:43],a[168:171],v[216:219],a[40:43]
v_add_f32 v37,v56,v57
cv v180,v56,v57
v_add_f32 v37,v37,v58
mm a[44:47],a[168:171],v[220:223],a[44:47]
dt a[186:187],v30 offset:61440
v_add_f32 v37,v37,v59
mm a[48:51],a[172:175],v[208:211],a[48:51]
v_exp_f32 v56,v248
cv v181,v58,v59
mm a[52:55],a[172:175],v[212:215],a[52:55]
dt a[188:189],v31 offset:57344
v_add_f32 v37,v37,v40
mm a[56:59],a[172:175],v[216:219],a[56:59]
v_exp_f32 v57,v249
mm a[60:63],a[172:175],v[220:223],a[60:63]
s_waitcnt lgkmcnt(7)
s_waitcnt vmcnt(11)
dt a[190:191],v31 offset:61440
v_add_f32 v37,v37,v41
mm v[144:147],a[144:147],v[96:99],v[80:83]
s_barrier
v_exp_f32 v58,v250
mm v[144:147],a[148:151],v[128:131],v[144:147]
s_mov_b32 s79,s69
s_mul_i32 s79,s79,147456
ds_read_b128 a[128:131],v20 offset:8192
cv v182,v40,v41
mm v[144:147],a[152:155],v[160:163],v[144:147]
s_add_u32 s79,s79,s70
s_add_u32 m0,s71,126976
v_add_f32 v37,v37,v42
mm v[144:147],a[156:159],v[192:195],v[144:147]
bl v4,s[32:35],s79 offen lds
mm v[148:151],a[144:147],v[100:103],v[84:87]
v_exp_f32 v59,v251
v_add_f32 v37,v37,v43
mm v[148:151],a[148:151],v[132:135],v[148:151]
s_add_u32 m0,s71,128000
ds_read_b128 a[132:135],v21 offset:8192
cv v183,v42,v43
mm v[148:151],a[152:155],v[164:167],v[148:151]
v_exp_f32 v40,v236
v_add_f32 v34,v34,v38
mm v[148:151],a[156:159],v[196:199],v[148:151]
bl v5,s[32:35],s79 offen lds
mm v[152:155],a[144:147],v[104:107],v[88:91]
v_exp_f32 v41,v237
mm v[152:155],a[148:151],v[136:139],v[152:155]
ds_read_b128 a[136:139],v22 offset:8192
v_exp_f32 v42,v238
mm v[152:155],a[152:155],v[168:171],v[152:155]
v_exp_f32 v43,v239
mm v[152:155],a[156:159],v[200:203],v[152:155]
v_add_f32 v38,v44,v45
cv v184,v44,v45
v_add_f32 v38,v38,v46
mm v[156:159],a[144:147],v[108:111],v[92:95]
s_add_u32 m0,s71,129024
v_exp_f32 v44,v252
mm v[156:159],a[148:151],v[140:143],v[156:159]
ds_read_b128 a[140:143],v23 offset:8192
v_add_f32 v38,v38,v47
mm v[156:159],a[152:155],v[172:175],v[156:159]
bl v6,s[32:35],s79 offen lds
cv v185,v46,v47
mm v[156:159],a[156:159],v[204:207],v[156:159]
s_waitcnt lgkmcnt(4)
v_exp_f32 v45,v253
mm a[64:67],a[176:179],v[208:211],a[64:67]
v_exp_f32 v46,v254
v_add_f32 v38,v38,v56
mm a[68:71],a[176:179],v[212:215],a[68:71]
dt a[160:161],v24 offset:0
v_add_f32 v38,v38,v57
mm a[72:75],a[176:179],v[216:219],a[72:75]
s_add_u32 m0,s71,130048
v_exp_f32 v47,v255
mm a[76:79],a[176:179],v[220:223],a[76:79]
dt a[162:163],v24 offset:4096
cv v186,v56,v57
v_add_f32 v38,v38,v58
mm a[80:83],a[180:183],v[208:211],a[80:83]
bl v7,s[32:35],s79 offen lds
mm a[84:87],a[180:183],v[212:215],a[84:87]
dt a[164:165],v25 offset:0
v_add_f32 v38,v38,v59
cv v187,v58,v59
mm a[88:91],a[180:183],v[216:219],a[88:91]
v_add_f32 v35,v35,v39
v_add_f32 v39,v40,v41
mm a[92:95],a[180:183],v[220:223],a[92:95]
dt a[166:167],v25 offset:4096
cv v188,v40,v41
mm a[96:99],a[184:187],v[208:211],a[96:99]
v_add_f32 v39,v39,v42
v_add_f32 v39,v39,v43
cv v189,v42,v43
mm a[100:103],a[184:187],v[212:215],a[100:103]
dt a[168:169],v26 offset:0
v_add_f32 v39,v39,v44
mm a[104:107],a[184:187],v[216:219],a[104:107]
s_add_u32 m0,s71,131072
v_add_f32 v39,v39,v45
cv v190,v44,v45
v_add_f32 v39,v39,v46
mm a[108:111],a[184:187],v[220:223],a[108:111]
dt a[170:171],v26 offset:4096
v_add_f32 v39,v39,v47
mm a[112:115],a[188:191],v[208:211],a[112:115]
bl v8,s[32:35],s79 offen lds
mm a[116:119],a[188:191],v[212:215],a[116:119]
dt a[172:173],v27 offset:0
cv v191,v46,v47
v_max3_f32 v48,v36,v37,v38
mm a[120:123],a[188:191],v[216:219],a[120:123]
v_max_f32 v48,v48,v39
v_cmp_nle_f32 vcc,v48,v49
mm a[124:127],a[188:191],v[220:223],a[124:127]
s_waitcnt lgkmcnt(7)
dt a[174:175],v27 offset:4096
s_cbranch_vccnz L_rares8
L_backs8:
mm v[224:227],a[128:131],v[96:99],v[80:83]
v_exp_f32 v40,v112
mm v[224:227],a[132:135],v[128:131],v[224:227]
s_add_u32 m0,s71,132096
ds_read_b128 a[144:147],v20 offset:12288
v_exp_f32 v41,v113
mm v[224:227],a[136:139],v[160:163],v[224:227]
v_exp_f32 v42,v114
mm v[224:227],a[140:143],v[192:195],v[224:227]
bl v9,s[32:35],s79 offen lds
v_add_f32 v32,v32,v36
mm v[228:231],a[128:131],v[100:103],v[84:87]
v_exp_f32 v43,v115
mm v[228:231],a[132:135],v[132:135],v[228:231]
ds_read_b128 a[148:151],v21 offset:12288
v_exp_f32 v44,v144
mm v[228:231],a[136:139],v[164:167],v[228:231]
v_exp_f32 v45,v145
mm v[228:231],a[140:143],v[196:199],v[228:231]
v_exp_f32 v46,v146
mm v[232:235],a[128:131],v[104:107],v[88:91]
s_add_u32 m0,s71,133120
v_exp_f32 v47,v147
v_add_f32 v36,v40,v41
mm v[232:235],a[132:135],v[136:139],v[232:235]
ds_read_b128 a[152:155],v22 offset:12288
cv v208,v40,v41
mm v[232:235],a[136:139],v[168:171],v[232:235]
bl v10,s[32:35],s79 offen lds
v_add_f32 v36,v36,v42
mm v[232:235],a[140:143],v[200:203],v[232:235]
v_exp_f32 v56,v116
mm v[236:239],a[128:131],v[108:111],v[92:95]
v_exp_f32 v57,v117
v_add_f32 v36,v36,v43
mm v[236:239],a[132:135],v[140:143],v[236:239]
ds_read_b128 a[156:159],v23 offset:12288
cv v209,v42,v43
mm v[236:239],a[136:139],v[172:175],v[236:239]
s_add_u32 m0,s71,134144
v_exp_f32 v58,v118
mm v[236:239],a[140:143],v[204:207],v[236:239]
s_waitcnt lgkmcnt(4)
v_exp_f32 v59,v119
v_add_f32 v36,v36,v44
mm a[0:3],a[160:163],v[176:179],a[0:3]
bl v11,s[32:35],s79 offen lds
mm a[4:7],a[160:163],v[180:183],a[4:7]
dt a[176:177],v28 offset:0
v_exp_f32 v40,v148
mm a[8:11],a[160:163],v[184:187],a[8:11]
v_exp_f32 v41,v149
mm a[12:15],a[160:163],v[188:191],a[12:15]
dt a[178:179],v28 offset:4096
v_exp_f32 v42,v150
mm a[16:19],a[164:167],v[176:179],a[16:19]
v_exp_f32 v43,v151
mm a[20:23],a[164:167],v[180:183],a[20:23]
s_add_u32 m0,s71,135168
dt a[180:181],v29 offset:0
v_add_f32 v36,v36,v45
mm a[24:27],a[164:167],v[184:187],a[24:27]
cv v210,v44,v45
v_exp_f32 v44,v120
mm a[28:31],a[164:167],v[188:191],a[28:31]
dt a[182:183],v29 offset:4096
v_add_f32 v36,v36,v46
mm a[32:35],a[168:171],v[176:179],a[32:35]
bl v12,s[32:35],s79 offen lds
v_add_f32 v36,v36,v47
mm a[36:39],a[168:171],v[180:183],a[36:39]
dt a[184:185],v30 offset:0
cv v211,v46,v47
mm a[40:43],a[168:171],v[184:187],a[40:43]
v_exp_f32 v45,v121
v_add_f32 v33,v33,v37
mm a[44:47],a[168:171],v[188:191],a[44:47]
dt a[186:187],v30 offset:4096
v_add_f32 v37,v56,v57
mm a[48:51],a[172:175],v[176:179],a[48:51]
v_exp_f32 v46,v122
mm a[52:55],a[172:175],v[180:183],a[52:55]
dt a[188:189],v31 offset:0
v_exp_f32 v47,v123
mm a[56:59],a[172:175],v[184:187],a[56:59]
cv v212,v56,v57
v_add_f32 v37,v37,v58
mm a[60:63],a[172:175],v[188:191],a[60:63]
s_waitcnt lgkmcnt(7)
s_waitcnt vmcnt(16)
dt a[190:191],v31 offset:4096
v_add_f32 v37,v37,v59
mm v[240:243],a[144:147],v[96:99],v[80:83]
s_barrier
v_exp_f32 v56,v152
mm v[240:243],a[148:151],v[128:131],v[240:243]
s_add_u32 m0,s37,65536
s_add_u32 s59,s55,98304
ds_read_b128 a[128:131],v20 offset:16384
cv v213,v58,v59
mm v[240:243],a[152:155],v[160:163],v[240:243]
bl v16,s[24:27],s59 offen lds
mm v[240:243],a[156:159],v[192:195],v[240:243]
v_exp_f32 v57,v153
mm v[244:247],a[144:147],v[100:103],v[84:87]
v_exp_f32 v58,v154
v_add_f32 v37,v37,v40
mm v[244:247],a[148:151],v[132:135],v[244:247]
ds_read_b128 a[132:135],v21 offset:16384
v_add_f32 v37,v37,v41
mm v[244:247],a[152:155],v[164:167],v[244:247]
v_exp_f32 v59,v155
cv v214,v40,v41
mm v[244:247],a[156:159],v[196:199],v[244:247]
v_exp_f32 v40,v124
mm v[248:251],a[144:147],v[104:107],v[88:91]
v_exp_f32 v41,v125
v_add_f32 v37,v37,v42
mm v[248:251],a[148:151],v[136:139],v[248:251]
ds_read_b128 a[136:139],v22 offset:16384
v_add_f32 v37,v37,v43
mm v[248:251],a[152:155],v[168:171],v[248:251]
cv v215,v42,v43
v_add_f32 v34,v34,v38
mm v[248:251],a[156:159],v[200:203],v[248:251]
v_exp_f32 v42,v126
v_add_f32 v38,v44,v45
mm v[252:255],a[144:147],v[108:111],v[92:95]
v_exp_f32 v43,v127
mm v[252:255],a[148:151],v[140:143],v[252:255]
s_add_u32 m0,s37,66560
ds_read_b128 a[140:143],v23 offset:16384
cv v216,v44,v45
v_add_f32 v38,v38,v46
mm v[252:255],a[152:155],v[172:175],v[252:255]
v_exp_f32 v44,v156
mm v[252:255],a[156:159],v[204:207],v[252:255]
s_waitcnt lgkmcnt(4)
bl v17,s[24:27],s59 offen lds
v_add_f32 v38,v38,v47
mm a[64:67],a[176:179],v[176:179],a[64:67]
v_exp_f32 v45,v157
mm a[68:71],a[176:179],v[180:183],a[68:71]
dt a[160:161],v24 offset:8192
cv v217,v46,v47
mm a[72:75],a[176:179],v[184:187],a[72:75]
v_exp_f32 v46,v158
v_add_f32 v38,v38,v56
mm a[76:79],a[176:179],v[188:191],a[76:79]
dt a[162:163],v24 offset:12288
v_add_f32 v38,v38,v57
mm a[80:83],a[180:183],v[176:179],a[80:83]
v_exp_f32 v47,v159
cv v218,v56,v57
mm a[84:87],a[180:183],v[180:183],a[84:87]
dt a[164:165],v25 offset:8192
v_add_f32 v38,v38,v58
mm a[88:91],a[180:183],v[184:187],a[88:91]
v_add_f32 v38,v38,v59
cv v219,v58,v59
v_add_f32 v35,v35,v39
mm a[92:95],a[180:183],v[188:191],a[92:95]
dt a[166:167],v25 offset:12288
v_add_f32 v39,v40,v41
mm a[96:99],a[184:187],v[176:179],a[96:99]
cv v220,v40,v41
v_add_f32 v39,v39,v42
mm a[100:103],a[184:187],v[180:183],a[100:103]
dt a[168:169],v26 offset:8192
v_add_f32 v39,v39,v43
cv v221,v42,v43
mm a[104:107],a[184:187],v[184:187],a[104:107]
v_add_f32 v39,v39,v44
v_add_f32 v39,v39,v45
mm a[108:111],a[184:187],v[188:191],a[108:111]
dt a[170:171],v26 offset:12288
cv v222,v44,v45
v_add_f32 v39,v39,v46
mm a[112:115],a[188:191],v[176:179],a[112:115]
v_add_f32 v39,v39,v47
cv v223,v46,v47
mm a[116:119],a[188:191],v[180:183],a[116:119]
dt a[172:173],v27 offset:8192
v_max3_f32 v48,v36,v37,v38
v_max_f32 v48,v48,v39
mm a[120:123],a[188:191],v[184:187],a[120:123]
s_add_u32 m0,s37,32768
s_add_u32 s56,s55,98304
v_cmp_nle_f32 vcc,v48,v49
mm a[124:127],a[188:191],v[188:191],a[124:127]
s_waitcnt lgkmcnt(7)
dt a[174:175],v27 offset:12288
s_cbranch_vccnz L_rares9
L_backs9:
mm v[112:115],a[128:131],v[96:99],v[80:83]
bl v18,s[28:31],s56 offen lds
mm v[112:115],a[132:135],v[128:131],v[112:115]
ds_read_b128 a[144:147],v20 offset:20480
v_exp_f32 v40,v224
mm v[112:115],a[136:139],v[160:163],v[112:115]
v_exp_f32 v41,v225
mm v[112:115],a[140:143],v[192:195],v[112:115]
v_exp_f32 v42,v226
v_add_f32 v32,v32,v36
mm v[116:119],a[128:131],v[100:103],v[84:87]
v_exp_f32 v43,v227
mm v[116:119],a[132:135],v[132:135],v[116:119]
ds_read_b128 a[148:151],v21 offset:20480
v_add_f32 v36,v40,v41
mm v[116:119],a[136:139],v[164:167],v[116:119]
v_exp_f32 v44,v240
cv v176,v40,v41
mm v[116:119],a[140:143],v[196:199],v[116:119]
v_exp_f32 v45,v241
mm v[120:123],a[128:131],v[104:107],v[88:91]
v_exp_f32 v46,v242
mm v[120:123],a[132:135],v[136:139],v[120:123]
ds_read_b128 a[152:155],v22 offset:20480
v_exp_f32 v47,v243
mm v[120:123],a[136:139],v[168:171],v[120:123]
v_exp_f32 v56,v228
mm v[120:123],a[140:143],v[200:203],v[120:123]
v_exp_f32 v57,v229
v_add_f32 v36,v36,v42
mm v[124:127],a[128:131],v[108:111],v[92:95]
s_add_u32 m0,s37,33792
v_exp_f32 v58,v230
mm v[124:127],a[132:135],v[140:143],v[124:127]
ds_read_b128 a[156:159],v23 offset:20480
v_add_f32 v36,v36,v43
mm v[124:127],a[136:139],v[172:175],v[124:127]
bl v19,s[28:31],s56 offen lds
cv v177,v42,v43
mm v[124:127],a[140:143],v[204:207],v[124:127]
s_waitcnt lgkmcnt(4)
v_exp_f32 v59,v231
mm a[0:3],a[160:163],v[208:211],a[0:3]
v_exp_f32 v40,v244
mm a[4:7],a[160:163],v[212:215],a[4:7]
dt a[176:177],v28 offset:8192
v_exp_f32 v41,v245
mm a[8:11],a[160:163],v[216:219],a[8:11]
v_exp_f32 v42,v246
mm a[12:15],a[160:163],v[220:223],a[12:15]
dt a[178:179],v28 offset:12288
v_add_f32 v36,v36,v44
mm a[16:19],a[164:167],v[208:211],a[16:19]
v_exp_f32 v43,v247
v_add_f32 v36,v36,v45
mm a[20:23],a[164:167],v[212:215],a[20:23]
dt a[180:181],v29 offset:8192
cv v178,v44,v45
mm a[24:27],a[164:167],v[216:219],a[24:27]
v_exp_f32 v44,v232
v_add_f32 v36,v36,v46
mm a[28:31],a[164:167],v[220:223],a[28:31]
dt a[182:183],v29 offset:12288
v_add_f32 v36,v36,v47
mm a[32:35],a[168:171],v[208:211],a[32:35]
v_exp_f32 v45,v233
mm a[36:39],a[168:171],v[212:215],a[36:39]
dt a[184:185],v30 offset:8192
cv v179,v46,v47
v_add_f32 v33,v33,v37
mm a[40:43],a[168:171],v[216:219],a[40:43]
v_exp_f32 v46,v234
mm a[44:47],a[168:171],v[220:223],a[44:47]
dt a[186:187],v30 offset:12288
v_add_f32 v37,v56,v57
mm a[48:51],a[172:175],v[208:211],a[48:51]
v_exp_f32 v47,v235
cv v180,v56,v57
mm a[52:55],a[172:175],v[212:215],a[52:55]
dt a[188:189],v31 offset:8192
v_add_f32 v37,v37,v58
mm a[56:59],a[172:175],v[216:219],a[56:59]
v_exp_f32 v56,v248
mm a[60:63],a[172:175],v[220:223],a[60:63]
s_waitcnt lgkmcnt(7)
s_waitcnt vmcnt(2)
dt a[190:191],v31 offset:12288
v_add_f32 v37,v37,v59
mm v[144:147],a[144:147],v[96:99],v[80:83]
s_barrier
v_exp_f32 v57,v249
mm v[144:147],a[148:151],v[128:131],v[144:147]
s_add_u32 m0,s37,73728
s_add_u32 s57,s55,106496
ds_read_b128 a[128:131],v20 offset:0
cv v181,v58,v59
mm v[144:147],a[152:155],v[160:163],v[144:147]
bl v16,s[24:27],s57 offen lds
mm v[144:147],a[156:159],v[192:195],v[144:147]
v_exp_f32 v58,v250
mm v[148:151],a[144:147],v[100:103],v[84:87]
v_exp_f32 v59,v251
v_add_f32 v37,v37,v40
mm v[148:151],a[148:151],v[132:135],v[148:151]
ds_read_b128 a[132:135],v21 offset:0
v_add_f32 v37,v37,v41
mm v[148:151],a[152:155],v[164:167],v[148:151]
cv v182,v40,v41
v_add_f32 v37,v37,v42
mm v[148:151],a[156:159],v[196:199],v[148:151]
v_exp_f32 v40,v236
v_add_f32 v37,v37,v43
mm v[152:155],a[144:147],v[104:107],v[88:91]
v_exp_f32 v41,v237
mm v[152:155],a[148:151],v[136:139],v[152:155]
ds_read_b128 a[136:139],v22 offset:0
cv v183,v42,v43
mm v[152:155],a[152:155],v[168:171],v[152:155]
v_exp_f32 v42,v238
v_add_f32 v34,v34,v38
mm v[152:155],a[156:159],v[200:203],v[152:155]
v_exp_f32 v43,v239
mm v[156:159],a[144:147],v[108:111],v[92:95]
v_add_f32 v38,v44,v45
cv v184,v44,v45
v_add_f32 v38,v38,v46
mm v[156:159],a[148:151],v[140:143],v[156:159]
s_add_u32 m0,s37,74752
ds_read_b128 a[140:143],v23 offset:0
v_add_f32 v38,v38,v47
mm v[156:159],a[152:155],v[172:175],v[156:159]
v_exp_f32 v44,v252
mm v[156:159],a[156:159],v[204:207],v[156:159]
s_waitcnt lgkmcnt(4)
bl v17,s[24:27],s57 offen lds
cv v185,v46,v47
mm a[64:67],a[176:179],v[208:211],a[64:67]
v_exp_f32 v45,v253
mm a[68:71],a[176:179],v[212:215],a[68:71]
dt a[160:161],v24 offset:16384
v_add_f32 v38,v38,v56
mm a[72:75],a[176:179],v[216:219],a[72:75]
v_exp_f32 v46,v254
v_add_f32 v38,v38,v57
mm a[76:79],a[176:179],v[220:223],a[76:79]
dt a[162:163],v24 offset:20480
cv v186,v56,v57
mm a[80:83],a[180:183],v[208:211],a[80:83]
v_exp_f32 v47,v255
mm a[84:87],a[180:183],v[212:215],a[84:87]
dt a[164:165],v25 offset:16384
v_add_f32 v38,v38,v58
v_add_f32 v38,v38,v59
mm a[88:91],a[180:183],v[216:219],a[88:91]
cv v187,v58,v59
v_add_f32 v35,v35,v39
mm a[92:95],a[180:183],v[220:223],a[92:95]
dt a[166:167],v25 offset:20480
v_add_f32 v39,v40,v41
cv v188,v40,v41
mm a[96:99],a[184:187],v[208:211],a[96:99]
v_add_f32 v39,v39,v42
v_add_f32 v39,v39,v43
mm a[100:103],a[184:187],v[212:215],a[100:103]
dt a[168:169],v26 offset:16384
cv v189,v42,v43
mm a[104:107],a[184:187],v[216:219],a[104:107]
v_add_f32 v39,v39,v44
v_add_f32 v39,v39,v45
cv v190,v44,v45
mm a[108:111],a[184:187],v[220:223],a[108:111]
dt a[170:171],v26 offset:20480
v_add_f32 v39,v39,v46
mm a[112:115],a[188:191],v[208:211],a[112:115]
v_add_f32 v39,v39,v47
cv v191,v46,v47
mm a[116:119],a[188:191],v[212:215],a[116:119]
dt a[172:173],v27 offset:16384
v_max3_f32 v48,v36,v37,v38
v_max_f32 v48,v48,v39
mm a[120:123],a[188:191],v[216:219],a[120:123]
s_add_u32 m0,s37,40960
s_add_u32 s58,s55,106496
v_cmp_nle_f32 vcc,v48,v49
mm a[124:127],a[188:191],v[220:223],a[124:127]
s_waitcnt lgkmcnt(7)
dt a[174:175],v27 offset:20480
s_cbranch_vccnz L_rares10
L_backs10:
mm v[224:227],a[128:131],v[96:99],v[80:83]
bl v18,s[28:31],s58 offen lds
v_add_f32 v32,v32,v36
mm v[224:227],a[132:135],v[128:131],v[224:227]
ds_read_b128 a[144:147],v20 offset:4096
v_exp_f32 v40,v112
mm v[224:227],a[136:139],v[160:163],v[224:227]
v_exp_f32 v41,v113
mm v[224:227],a[140:143],v[192:195],v[224:227]
v_exp_f32 v42,v114
mm v[228:231],a[128:131],v[100:103],v[84:87]
v_exp_f32 v43,v115
mm v[228:231],a[132:135],v[132:135],v[228:231]
ds_read_b128 a[148:151],v21 offset:4096
v_exp_f32 v44,v144
mm v[228:231],a[136:139],v[164:167],v[228:231]
v_exp_f32 v45,v145
v_add_f32 v36,v40,v41
mm v[228:231],a[140:143],v[196:199],v[228:231]
v_exp_f32 v46,v146
mm v[232:235],a[128:131],v[104:107],v[88:91]
v_exp_f32 v47,v147
cv v208,v40,v41
mm v[232:235],a[132:135],v[136:139],v[232:235]
ds_read_b128 a[152:155],v22 offset:4096
v_add_f32 v36,v36,v42
mm v[232:235],a[136:139],v[168:171],v[232:235]
v_exp_f32 v56,v116
v_add_f32 v36,v36,v43
mm v[232:235],a[140:143],v[200:203],v[232:235]
v_exp_f32 v57,v117
cv v209,v42,v43
mm v[236:239],a[128:131],v[108:111],v[92:95]
s_add_u32 m0,s37,41984
v_exp_f32 v58,v118
mm v[236:239],a[132:135],v[140:143],v[236:239]
ds_read_b128 a[156:159],v23 offset:4096
v_exp_f32 v59,v119
mm v[236:239],a[136:139],v[172:175],v[236:239]
bl v19,s[28:31],s58 offen lds
mm v[236:239],a[140:143],v[204:207],v[236:239]
s_waitcnt lgkmcnt(4)
v_exp_f32 v40,v148
v_add_f32 v36,v36,v44
mm a[0:3],a[160:163],v[176:179],a[0:3]
v_exp_f32 v41,v149
mm a[4:7],a[160:163],v[180:183],a[4:7]
dt a[176:177],v28 offset:16384
v_exp_f32 v42,v150
mm a[8:11],a[160:163],v[184:187],a[8:11]
v_exp_f32 v43,v151
v_add_f32 v36,v36,v45
mm a[12:15],a[160:163],v[188:191],a[12:15]
dt a[178:179],v28 offset:20480
cv v210,v44,v45
mm a[16:19],a[164:167],v[176:179],a[16:19]
v_exp_f32 v44,v120
v_add_f32 v36,v36,v46
mm a[20:23],a[164:167],v[180:183],a[20:23]
dt a[180:181],v29 offset:16384
v_add_f32 v36,v36,v47
mm a[24:27],a[164:167],v[184:187],a[24:27]
v_exp_f32 v45,v121
cv v211,v46,v47
mm a[28:31],a[164:167],v[188:191],a[28:31]
dt a[182:183],v29 offset:20480
v_exp_f32 v46,v122
mm a[32:35],a[168:171],v[176:179],a[32:35]
v_exp_f32 v47,v123
mm a[36:39],a[168:171],v[180:183],a[36:39]
dt a[184:185],v30 offset:16384
v_add_f32 v33,v33,v37
v_add_f32 v37,v56,v57
mm a[40:43],a[168:171],v[184:187],a[40:43]
cv v212,v56,v57
v_add_f32 v37,v37,v58
mm a[44:47],a[168:171],v[188:191],a[44:47]
dt a[186:187],v30 offset:20480
v_exp_f32 v56,v152
mm a[48:51],a[172:175],v[176:179],a[48:51]
v_exp_f32 v57,v153
v_add_f32 v37,v37,v59
mm a[52:55],a[172:175],v[180:183],a[52:55]
dt a[188:189],v31 offset:16384
cv v213,v58,v59
mm a[56:59],a[172:175],v[184:187],a[56:59]
v_exp_f32 v58,v154
v_add_f32 v37,v37,v40
mm a[60:63],a[172:175],v[188:191],a[60:63]
s_waitcnt lgkmcnt(7)
s_waitcnt vmcnt(2)
dt a[190:191],v31 offset:20480
mm v[240:243],a[144:147],v[96:99],v[80:83]
s_barrier
v_exp_f32 v59,v155
v_add_f32 v37,v37,v41
mm v[240:243],a[148:151],v[128:131],v[240:243]
s_add_u32 m0,s37,81920
s_add_u32 s59,s55,114688
ds_read_b128 a[128:131],v20 offset:8192
mm v[240:243],a[152:155],v[160:163],v[240:243]
bl v16,s[24:27],s59 offen lds
cv v214,v40,v41
mm v[240:243],a[156:159],v[192:195],v[240:243]
s_add_u32 m0,s37,82944
v_exp_f32 v40,v124
v_add_f32 v37,v37,v42
mm v[244:247],a[144:147],v[100:103],v[84:87]
v_exp_f32 v41,v125
mm v[244:247],a[148:151],v[132:135],v[244:247]
ds_read_b128 a[132:135],v21 offset:8192
v_add_f32 v37,v37,v43
cv v215,v42,v43
mm v[244:247],a[152:155],v[164:167],v[244:247]
bl v17,s[24:27],s59 offen lds
mm v[244:247],a[156:159],v[196:199],v[244:247]
s_add_u32 m0,s37,49152
s_add_u32 s56,s55,114688
v_exp_f32 v42,v126
mm v[248:251],a[144:147],v[104:107],v[88:91]
v_exp_f32 v43,v127
v_add_f32 v34,v34,v38
mm v[248:251],a[148:151],v[136:139],v[248:251]
ds_read_b128 a[136:139],v22 offset:8192
v_add_f32 v38,v44,v45
mm v[248:251],a[152:155],v[168:171],v[248:251]
bl v18,s[28:31],s56 offen lds
cv v216,v44,v45
mm v[248:251],a[156:159],v[200:203],v[248:251]
s_add_u32 m0,s37,50176
v_exp_f32 v44,v156
mm v[252:255],a[144:147],v[108:111],v[92:95]
v_exp_f32 v45,v157
v_add_f32 v38,v38,v46
mm v[252:255],a[148:151],v[140:143],v[252:255]
ds_read_b128 a[140:143],v23 offset:8192
v_add_f32 v38,v38,v47
cv v217,v46,v47
mm v[252:255],a[152:155],v[172:175],v[252:255]
bl v19,s[28:31],s56 offen lds
mm v[252:255],a[156:159],v[204:207],v[252:255]
s_waitcnt lgkmcnt(4)
s_bfe_u32 s79,s81,0x40004
s_mul_i32 s79,s79,147456
v_add_f32 v38,v38,v56
mm a[64:67],a[176:179],v[176:179],a[64:67]
s_add_u32 s79,s79,s70
s_add_u32 m0,s71,90112
v_add_f32 v38,v38,v57
mm a[68:71],a[176:179],v[180:183],a[68:71]
dt a[160:161],v24 offset:24576
v_exp_f32 v46,v158
mm a[72:75],a[176:179],v[184:187],a[72:75]
bl v4,s[32:35],s79 offen lds
mm a[76:79],a[176:179],v[188:191],a[76:79]
dt a[162:163],v24 offset:28672
v_exp_f32 v47,v159
mm a[80:83],a[180:183],v[176:179],a[80:83]
s_add_u32 m0,s71,91136
cv v218,v56,v57
v_add_f32 v38,v38,v58
v_add_f32 v38,v38,v59
mm a[84:87],a[180:183],v[180:183],a[84:87]
dt a[164:165],v25 offset:24576
cv v219,v58,v59
mm a[88:91],a[180:183],v[184:187],a[88:91]
bl v5,s[32:35],s79 offen lds
v_add_f32 v35,v35,v39
mm a[92:95],a[180:183],v[188:191],a[92:95]
dt a[166:167],v25 offset:28672
v_add_f32 v39,v40,v41
mm a[96:99],a[184:187],v[176:179],a[96:99]
cv v220,v40,v41
v_add_f32 v39,v39,v42
v_add_f32 v39,v39,v43
mm a[100:103],a[184:187],v[180:183],a[100:103]
s_add_u32 m0,s71,92160
dt a[168:169],v26 offset:24576
cv v221,v42,v43
v_add_f32 v39,v39,v44
mm a[104:107],a[184:187],v[184:187],a[104:107]
v_add_f32 v39,v39,v45
cv v222,v44,v45
mm a[108:111],a[184:187],v[188:191],a[108:111]
dt a[170:171],v26 offset:28672
v_add_f32 v39,v39,v46
v_add_f32 v39,v39,v47
mm a[112:115],a[188:191],v[176:179],a[112:115]
bl v6,s[32:35],s79 offen lds
mm a[116:119],a[188:191],v[180:183],a[116:119]
dt a[172:173],v27 offset:24576
cv v223,v46,v47
v_max3_f32 v48,v36,v37,v38
mm a[120:123],a[188:191],v[184:187],a[120:123]
s_add_u32 m0,s71,93184
v_max_f32 v48,v48,v39
v_cmp_nle_f32 vcc,v48,v49
mm a[124:127],a[188:191],v[188:191],a[124:127]
s_waitcnt lgkmcnt(7)
dt a[174:175],v27 offset:28672
s_cbranch_vccnz L_rares11
L_backs11:
mm v[112:115],a[128:131],v[96:99],v[80:83]
bl v7,s[32:35],s79 offen lds
v_add_f32 v32,v32,v36
mm v[112:115],a[132:135],v[128:131],v[112:115]
ds_read_b128 a[144:147],v20 offset:12288
v_exp_f32 v40,v224
mm v[112:115],a[136:139],v[160:163],v[112:115]
s_add_u32 m0,s71,94208
v_exp_f32 v41,v225
mm v[112:115],a[140:143],v[192:195],v[112:115]
v_exp_f32 v42,v226
mm v[116:119],a[128:131],v[100:103],v[84:87]
bl v8,s[32:35],s79 offen lds
mm v[116:119],a[132:135],v[132:135],v[116:119]
ds_read_b128 a[148:151],v21 offset:12288
v_exp_f32 v43,v227
mm v[116:119],a[136:139],v[164:167],v[116:119]
s_add_u32 m0,s71,95232
v_exp_f32 v44,v240
mm v[116:119],a[140:143],v[196:199],v[116:119]
v_exp_f32 v45,v241
v_add_f32 v36,v40,v41
mm v[120:123],a[128:131],v[104:107],v[88:91]
bl v9,s[32:35],s79 offen lds
mm v[120:123],a[132:135],v[136:139],v[120:123]
ds_read_b128 a[152:155],v22 offset:12288
v_exp_f32 v46,v242
mm v[120:123],a[136:139],v[168:171],v[120:123]
s_add_u32 m0,s71,96256
v_exp_f32 v47,v243
mm v[120:123],a[140:143],v[200:203],v[120:123]
v_exp_f32 v56,v228
cv v176,v40,v41
mm v[124:127],a[128:131],v[108:111],v[92:95]
bl v10,s[32:35],s79 offen lds
v_add_f32 v36,v36,v42
mm v[124:127],a[132:135],v[140:143],v[124:127]
ds_read_b128 a[156:159],v23 offset:12288
v_add_f32 v36,v36,v43
mm v[124:127],a[136:139],v[172:175],v[124:127]
s_add_u32 m0,s71,97280
v_exp_f32 v57,v229
cv v177,v42,v43
mm v[124:127],a[140:143],v[204:207],v[124:127]
s_waitcnt lgkmcnt(4)
v_exp_f32 v58,v230
mm a[0:3],a[160:163],v[208:211],a[0:3]
bl v11,s[32:35],s79 offen lds
v_add_f32 v36,v36,v44
mm a[4:7],a[160:163],v[212:215],a[4:7]
dt a[176:177],v28 offset:24576
v_add_f32 v36,v36,v45
mm a[8:11],a[160:163],v[216:219],a[8:11]
v_exp_f32 v59,v231
cv v178,v44,v45
mm a[12:15],a[160:163],v[220:223],a[12:15]
s_add_u32 m0,s71,98304
dt a[178:179],v28 offset:28672
v_add_f32 v36,v36,v46
mm a[16:19],a[164:167],v[208:211],a[16:19]
v_exp_f32 v40,v244
v_add_f32 v36,v36,v47
mm a[20:23],a[164:167],v[212:215],a[20:23]
dt a[180:181],v29 offset:24576
cv v179,v46,v47
mm a[24:27],a[164:167],v[216:219],a[24:27]
bl v12,s[32:35],s79 offen lds
v_add_f32 v33,v33,v37
mm a[28:31],a[164:167],v[220:223],a[28:31]
dt a[182:183],v29 offset:28672
v_add_f32 v37,v56,v57
mm a[32:35],a[168:171],v[208:211],a[32:35]
s_getpc_b64 s[0:1]
L_cpf6:
s_add_u32 s100,s47,4096
s_min_u32 s100,s100,L_mid-1024-L_cpf6
s_add_u32 s0,s0,s100
s_addc_u32 s1,s1,0
v_exp_f32 v41,v245
cv v180,v56,v57
mm a[36:39],a[168:171],v[212:215],a[36:39]
dt a[184:185],v30 offset:24576
v_exp_f32 v42,v246
mm a[40:43],a[168:171],v[216:219],a[40:43]
global_load_dword v55,v3,s[0:1]
mm a[44:47],a[168:171],v[220:223],a[44:47]
dt a[186:187],v30 offset:28672
v_exp_f32 v43,v247
mm a[48:51],a[172:175],v[208:211],a[48:51]
v_exp_f32 v44,v232
mm a[52:55],a[172:175],v[212:215],a[52:55]
dt a[188:189],v31 offset:24576
v_exp_f32 v45,v233
mm a[56:59],a[172:175],v[216:219],a[56:59]
v_exp_f32 v46,v234
mm a[60:63],a[172:175],v[220:223],a[60:63]
s_waitcnt lgkmcnt(7)
s_waitcnt vmcnt(12)
dt a[190:191],v31 offset:28672
v_add_f32 v37,v37,v58
mm v[144:147],a[144:147],v[96:99],v[80:83]
s_barrier
v_exp_f32 v47,v235
mm v[144:147],a[148:151],v[128:131],v[144:147]
s_add_u32 m0,s37,65536
s_add_u32 s57,s55,122880
ds_read_b128 a[128:131],v20 offset:16384
v_add_f32 v37,v37,v59
mm v[144:147],a[152:155],v[160:163],v[144:147]
bl v16,s[24:27],s57 offen lds
mm v[144:147],a[156:159],v[192:195],v[144:147]
v_exp_f32 v56,v248
cv v181,v58,v59
mm v[148:151],a[144:147],v[100:103],v[84:87]
v_exp_f32 v57,v249
mm v[148:151],a[148:151],v[132:135],v[148:151]
ds_read_b128 a[132:135],v21 offset:16384
v_exp_f32 v58,v250
mm v[148:151],a[152:155],v[164:167],v[148:151]
v_exp_f32 v59,v251
v_add_f32 v37,v37,v40
mm v[148:151],a[156:159],v[196:199],v[148:151]
v_add_f32 v37,v37,v41
cv v182,v40,v41
mm v[152:155],a[144:147],v[104:107],v[88:91]
v_exp_f32 v40,v236
v_add_f32 v37,v37,v42
mm v[152:155],a[148:151],v[136:139],v[152:155]
ds_read_b128 a[136:139],v22 offset:16384
v_add_f32 v37,v37,v43
mm v[152:155],a[152:155],v[168:171],v[152:155]
v_exp_f32 v41,v237
cv v183,v42,v43
mm v[152:155],a[156:159],v[200:203],v[152:155]
v_exp_f32 v42,v238
mm v[156:159],a[144:147],v[108:111],v[92:95]
v_exp_f32 v43,v239
v_add_f32 v34,v34,v38
mm v[156:159],a[148:151],v[140:143],v[156:159]
s_add_u32 m0,s37,66560
ds_read_b128 a[140:143],v23 offset:16384
v_add_f32 v38,v44,v45
mm v[156:159],a[152:155],v[172:175],v[156:159]
cv v184,v44,v45
v_exp_f32 v44,v252
mm v[156:159],a[156:159],v[204:207],v[156:159]
s_waitcnt lgkmcnt(4)
bl v17,s[24:27],s57 offen lds
mm a[64:67],a[176:179],v[208:211],a[64:67]
v_exp_f32 v45,v253
v_add_f32 v38,v38,v46
mm a[68:71],a[176:179],v[212:215],a[68:71]
dt a[160:161],v24 offset:32768
v_add_f32 v38,v38,v47
mm a[72:75],a[176:179],v[216:219],a[72:75]
cv v185,v46,v47
v_exp_f32 v46,v254
mm a[76:79],a[176:179],v[220:223],a[76:79]
dt a[162:163],v24 offset:36864
v_exp_f32 v47,v255
mm a[80:83],a[180:183],v[208:211],a[80:83]
v_add_f32 v38,v38,v56
v_add_f32 v38,v38,v57
mm a[84:87],a[180:183],v[212:215],a[84:87]
dt a[164:165],v25 offset:32768
cv v186,v56,v57
v_add_f32 v38,v38,v58
mm a[88:91],a[180:183],v[216:219],a[88:91]
v_add_f32 v38,v38,v59
cv v187,v58,v59
mm a[92:95],a[180:183],v[220:223],a[92:95]
dt a[166:167],v25 offset:36864
v_add_f32 v35,v35,v39
v_add_f32 v39,v40,v41
mm a[96:99],a[184:187],v[208:211],a[96:99]
cv v188,v40,v41
v_add_f32 v39,v39,v42
mm a[100:103],a[184:187],v[212:215],a[100:103]
dt a[168:169],v26 offset:32768
v_add_f32 v39,v39,v43
cv v189,v42,v43
mm a[104:107],a[184:187],v[216:219],a[104:107]
v_add_f32 v39,v39,v44
v_add_f32 v39,v39,v45
mm a[108:111],a[184:187],v[220:223],a[108:111]
dt a[170:171],v26 offset:36864
cv v190,v44,v45
v_add_f32 v39,v39,v46
mm a[112:115],a[188:191],v[208:211],a[112:115]
v_add_f32 v39,v39,v47
cv v191,v46,v47
mm a[116:119],a[188:191],v[212:215],a[116:119]
dt a[172:173],v27 offset:32768
v_max3_f32 v48,v36,v37,v38
v_max_f32 v48,v48,v39
mm a[120:123],a[188:191],v[216:219],a[120:123]
s_add_u32 m0,s37,57344
s_add_u32 s58,s55,122880
v_cmp_nle_f32 vcc,v48,v49
mm a[124:127],a[188:191],v[220:223],a[124:127]
s_waitcnt lgkmcnt(7)
dt a[174:175],v27 offset:36864
s_cbranch_vccnz L_rares12
L_backs12:
mm v[224:227],a[128:131],v[96:99],v[80:83]
bl v18,s[28:31],s58 offen lds
mm v[224:227],a[132:135],v[128:131],v[224:227]
ds_read_b128 a[144:147],v20 offset:20480
v_exp_f32 v40,v112
mm v[224:227],a[136:139],v[160:163],v[224:227]
v_exp_f32 v41,v113
mm v[224:227],a[140:143],v[192:195],v[224:227]
v_exp_f32 v42,v114
mm v[228:231],a[128:131],v[100:103],v[84:87]
v_exp_f32 v43,v115
v_add_f32 v32,v32,v36
mm v[228:231],a[132:135],v[132:135],v[228:231]
ds_read_b128 a[148:151],v21 offset:20480
v_add_f32 v36,v40,v41
mm v[228:231],a[136:139],v[164:167],v[228:231]
v_exp_f32 v44,v144
mm v[228:231],a[140:143],v[196:199],v[228:231]
v_exp_f32 v45,v145
mm v[232:235],a[128:131],v[104:107],v[88:91]
v_exp_f32 v46,v146
cv v208,v40,v41
mm v[232:235],a[132:135],v[136:139],v[232:235]
ds_read_b128 a[152:155],v22 offset:20480
v_add_f32 v36,v36,v42
mm v[232:235],a[136:139],v[168:171],v[232:235]
v_exp_f32 v47,v147
mm v[232:235],a[140:143],v[200:203],v[232:235]
v_exp_f32 v56,v116
mm v[236:239],a[128:131],v[108:111],v[92:95]
s_add_u32 m0,s37,58368
v_exp_f32 v57,v117
v_add_f32 v36,v36,v43
mm v[236:239],a[132:135],v[140:143],v[236:239]
ds_read_b128 a[156:159],v23 offset:20480
cv v209,v42,v43
mm v[236:239],a[136:139],v[172:175],v[236:239]
bl v19,s[28:31],s58 offen lds
mm v[236:239],a[140:143],v[204:207],v[236:239]
s_waitcnt lgkmcnt(4)
v_exp_f32 v58,v118
v_add_f32 v36,v36,v44
mm a[0:3],a[160:163],v[176:179],a[0:3]
v_exp_f32 v59,v119
mm a[4:7],a[160:163],v[180:183],a[4:7]
dt a[176:177],v28 offset:32768
v_add_f32 v36,v36,v45
mm a[8:11],a[160:163],v[184:187],a[8:11]
v_exp_f32 v40,v148
mm a[12:15],a[160:163],v[188:191],a[12:15]
dt a[178:179],v28 offset:36864
v_exp_f32 v41,v149
mm a[16:19],a[164:167],v[176:179],a[16:19]
v_exp_f32 v42,v150
mm a[20:23],a[164:167],v[180:183],a[20:23]
dt a[180:181],v29 offset:32768
cv v210,v44,v45
mm a[24:27],a[164:167],v[184:187],a[24:27]
v_exp_f32 v43,v151
mm a[28:31],a[164:167],v[188:191],a[28:31]
dt a[182:183],v29 offset:36864
v_exp_f32 v44,v120
mm a[32:35],a[168:171],v[176:179],a[32:35]
v_exp_f32 v45,v121
mm a[36:39],a[168:171],v[180:183],a[36:39]
dt a[184:185],v30 offset:32768
v_add_f32 v36,v36,v46
mm a[40:43],a[168:171],v[184:187],a[40:43]
v_add_f32 v36,v36,v47
cv v211,v46,v47
v_add_f32 v33,v33,v37
mm a[44:47],a[168:171],v[188:191],a[44:47]
dt a[186:187],v30 offset:36864
v_add_f32 v37,v56,v57
mm a[48:51],a[172:175],v[176:179],a[48:51]
v_exp_f32 v46,v122
mm a[52:55],a[172:175],v[180:183],a[52:55]
dt a[188:189],v31 offset:32768
cv v212,v56,v57
mm a[56:59],a[172:175],v[184:187],a[56:59]
v_exp_f32 v47,v123
v_add_f32 v37,v37,v58
mm a[60:63],a[172:175],v[188:191],a[60:63]
s_waitcnt lgkmcnt(7)
s_waitcnt vmcnt(2)
dt a[190:191],v31 offset:36864
mm v[240:243],a[144:147],v[96:99],v[80:83]
s_barrier
v_exp_f32 v56,v152
mm v[240:243],a[148:151],v[128:131],v[240:243]
ds_read_b128 a[128:131],v20 offset:0
v_add_f32 v37,v37,v59
mm v[240:243],a[152:155],v[160:163],v[240:243]
v_exp_f32 v57,v153
cv v213,v58,v59
mm v[240:243],a[156:159],v[192:195],v[240:243]
v_exp_f32 v58,v154
mm v[244:247],a[144:147],v[100:103],v[84:87]
v_exp_f32 v59,v155
mm v[244:247],a[148:151],v[132:135],v[244:247]
ds_read_b128 a[132:135],v21 offset:0
v_add_f32 v37,v37,v40
mm v[244:247],a[152:155],v[164:167],v[244:247]
v_add_f32 v37,v37,v41
cv v214,v40,v41
v_add_f32 v37,v37,v42
mm v[244:247],a[156:159],v[196:199],v[244:247]
v_exp_f32 v40,v124
mm v[248:251],a[144:147],v[104:107],v[88:91]
v_exp_f32 v41,v125
mm v[248:251],a[148:151],v[136:139],v[248:251]
ds_read_b128 a[136:139],v22 offset:0
v_add_f32 v37,v37,v43
cv v215,v42,v43
mm v[248:251],a[152:155],v[168:171],v[248:251]
v_exp_f32 v42,v126
mm v[248:251],a[156:159],v[200:203],v[248:251]
v_exp_f32 v43,v127
mm v[252:255],a[144:147],v[108:111],v[92:95]
v_add_f32 v34,v34,v38
v_add_f32 v38,v44,v45
mm v[252:255],a[148:151],v[140:143],v[252:255]
ds_read_b128 a[140:143],v23 offset:0
cv v216,v44,v45
v_add_f32 v38,v38,v46
mm v[252:255],a[152:155],v[172:175],v[252:255]
v_exp_f32 v44,v156
mm v[252:255],a[156:159],v[204:207],v[252:255]
s_waitcnt lgkmcnt(4)
v_exp_f32 v45,v157
mm a[64:67],a[176:179],v[176:179],a[64:67]
v_add_f32 v38,v38,v47
cv v217,v46,v47
mm a[68:71],a[176:179],v[180:183],a[68:71]
dt a[160:161],v24 offset:40960
v_exp_f32 v46,v158
mm a[72:75],a[176:179],v[184:187],a[72:75]
v_exp_f32 v47,v159
mm a[76:79],a[176:179],v[188:191],a[76:79]
dt a[162:163],v24 offset:45056
v_add_f32 v38,v38,v56
mm a[80:83],a[180:183],v[176:179],a[80:83]
v_add_f32 v38,v38,v57
cv v218,v56,v57
v_add_f32 v38,v38,v58
mm a[84:87],a[180:183],v[180:183],a[84:87]
dt a[164:165],v25 offset:40960
v_add_f32 v38,v38,v59
mm a[88:91],a[180:183],v[184:187],a[88:91]
cv v219,v58,v59
v_add_f32 v35,v35,v39
mm a[92:95],a[180:183],v[188:191],a[92:95]
dt a[166:167],v25 offset:45056
v_add_f32 v39,v40,v41
mm a[96:99],a[184:187],v[176:179],a[96:99]
cv v220,v40,v41
v_add_f32 v39,v39,v42
v_add_f32 v39,v39,v43
mm a[100:103],a[184:187],v[180:183],a[100:103]
dt a[168:169],v26 offset:40960
cv v221,v42,v43
mm a[104:107],a[184:187],v[184:187],a[104:107]
v_add_f32 v39,v39,v44
v_add_f32 v39,v39,v45
mm a[108:111],a[184:187],v[188:191],a[108:111]
dt a[170:171],v26 offset:45056
cv v222,v44,v45
mm a[112:115],a[188:191],v[176:179],a[112:115]
v_add_f32 v39,v39,v46
v_add_f32 v39,v39,v47
cv v223,v46,v47
mm a[116:119],a[188:191],v[180:183],a[116:119]
dt a[172:173],v27 offset:40960
v_max3_f32 v48,v36,v37,v38
mm a[120:123],a[188:191],v[184:187],a[120:123]
v_max_f32 v48,v48,v39
v_cmp_nle_f32 vcc,v48,v49
mm a[124:127],a[188:191],v[188:191],a[124:127]
s_waitcnt lgkmcnt(7)
dt a[174:175],v27 offset:45056
s_cbranch_vccnz L_rares13
L_backs13:
mm v[112:115],a[128:131],v[96:99],v[80:83]
v_exp_f32 v40,v224
mm v[112:115],a[132:135],v[128:131],v[112:115]
ds_read_b128 a[144:147],v20 offset:4096
v_add_f32 v32,v32,v36
mm v[112:115],a[136:139],v[160:163],v[112:115]
v_exp_f32 v41,v225
mm v[112:115],a[140:143],v[192:195],v[112:115]
v_exp_f32 v42,v226
mm v[116:119],a[128:131],v[100:103],v[84:87]
v_exp_f32 v43,v227
mm v[116:119],a[132:135],v[132:135],v[116:119]
ds_read_b128 a[148:151],v21 offset:4096
v_add_f32 v36,v40,v41
mm v[116:119],a[136:139],v[164:167],v[116:119]
v_exp_f32 v44,v240
mm v[116:119],a[140:143],v[196:199],v[116:119]
v_exp_f32 v45,v241
mm v[120:123],a[128:131],v[104:107],v[88:91]
v_exp_f32 v46,v242
mm v[120:123],a[132:135],v[136:139],v[120:123]
ds_read_b128 a[152:155],v22 offset:4096
v_exp_f32 v47,v243
mm v[120:123],a[136:139],v[168:171],v[120:123]
v_exp_f32 v56,v228
mm v[120:123],a[140:143],v[200:203],v[120:123]
v_exp_f32 v57,v229
mm v[124:127],a[128:131],v[108:111],v[92:95]
v_exp_f32 v58,v230
mm v[124:127],a[132:135],v[140:143],v[124:127]
ds_read_b128 a[156:159],v23 offset:4096
cv v176,v40,v41
mm v[124:127],a[136:139],v[172:175],v[124:127]
v_exp_f32 v59,v231
mm v[124:127],a[140:143],v[204:207],v[124:127]
s_waitcnt lgkmcnt(4)
v_exp_f32 v40,v244
v_add_f32 v36,v36,v42
mm a[0:3],a[160:163],v[208:211],a[0:3]
v_exp_f32 v41,v245
mm a[4:7],a[160:163],v[212:215],a[4:7]
dt a[176:177],v28 offset:40960
v_add_f32 v36,v36,v43
mm a[8:11],a[160:163],v[216:219],a[8:11]
cv v177,v42,v43
v_add_f32 v36,v36,v44
mm a[12:15],a[160:163],v[220:223],a[12:15]
dt a[178:179],v28 offset:45056
v_add_f32 v36,v36,v45
mm a[16:19],a[164:167],v[208:211],a[16:19]
v_exp_f32 v42,v246
mm a[20:23],a[164:167],v[212:215],a[20:23]
dt a[180:181],v29 offset:40960
v_exp_f32 v43,v247
mm a[24:27],a[164:167],v[216:219],a[24:27]
cv v178,v44,v45
v_add_f32 v36,v36,v46
mm a[28:31],a[164:167],v[220:223],a[28:31]
dt a[182:183],v29 offset:45056
v_add_f32 v36,v36,v47
mm a[32:35],a[168:171],v[208:211],a[32:35]
v_exp_f32 v44,v232
mm a[36:39],a[168:171],v[212:215],a[36:39]
dt a[184:185],v30 offset:40960
cv v179,v46,v47
mm a[40:43],a[168:171],v[216:219],a[40:43]
v_exp_f32 v45,v233
mm a[44:47],a[168:171],v[220:223],a[44:47]
dt a[186:187],v30 offset:45056
v_add_f32 v33,v33,v37
mm a[48:51],a[172:175],v[208:211],a[48:51]
v_exp_f32 v46,v234
v_add_f32 v37,v56,v57
mm a[52:55],a[172:175],v[212:215],a[52:55]
dt a[188:189],v31 offset:40960
cv v180,v56,v57
mm a[56:59],a[172:175],v[216:219],a[56:59]
v_exp_f32 v47,v235
mm a[60:63],a[172:175],v[220:223],a[60:63]
s_waitcnt lgkmcnt(7)
dt a[190:191],v31 offset:45056
v_add_f32 v37,v37,v58
mm v[144:147],a[144:147],v[96:99],v[80:83]
v_exp_f32 v56,v248
mm v[144:147],a[148:151],v[128:131],v[144:147]
dt a[160:161],v24 offset:49152
v_add_f32 v37,v37,v59
mm v[144:147],a[152:155],v[160:163],v[144:147]
v_exp_f32 v57,v249
cv v181,v58,v59
mm v[144:147],a[156:159],v[192:195],v[144:147]
dt a[162:163],v24 offset:53248
v_add_f32 v37,v37,v40
mm v[148:151],a[144:147],v[100:103],v[84:87]
v_exp_f32 v58,v250
mm v[148:151],a[148:151],v[132:135],v[148:151]
dt a[164:165],v25 offset:49152
v_add_f32 v37,v37,v41
mm v[148:151],a[152:155],v[164:167],v[148:151]
v_exp_f32 v59,v251
mm v[148:151],a[156:159],v[196:199],v[148:151]
dt a[166:167],v25 offset:53248
cv v182,v40,v41
mm v[152:155],a[144:147],v[104:107],v[88:91]
v_exp_f32 v40,v236
v_add_f32 v37,v37,v42
mm v[152:155],a[148:151],v[136:139],v[152:155]
dt a[168:169],v26 offset:49152
v_add_f32 v37,v37,v43
mm v[152:155],a[152:155],v[168:171],v[152:155]
v_exp_f32 v41,v237
mm v[152:155],a[156:159],v[200:203],v[152:155]
dt a[170:171],v26 offset:53248
cv v183,v42,v43
mm v[156:159],a[144:147],v[108:111],v[92:95]
v_exp_f32 v42,v238
mm v[156:159],a[148:151],v[140:143],v[156:159]
dt a[172:173],v27 offset:49152
v_add_f32 v34,v34,v38
mm v[156:159],a[152:155],v[172:175],v[156:159]
v_exp_f32 v43,v239
mm v[156:159],a[156:159],v[204:207],v[156:159]
s_waitcnt lgkmcnt(7)
dt a[174:175],v27 offset:53248
v_add_f32 v38,v44,v45
cv v184,v44,v45
mm a[64:67],a[176:179],v[208:211],a[64:67]
v_exp_f32 v44,v252
mm a[68:71],a[176:179],v[212:215],a[68:71]
v_exp_f32 v45,v253
mm a[72:75],a[176:179],v[216:219],a[72:75]
v_add_f32 v38,v38,v46
v_add_f32 v38,v38,v47
mm a[76:79],a[176:179],v[220:223],a[76:79]
cv v185,v46,v47
v_add_f32 v38,v38,v56
mm a[80:83],a[180:183],v[208:211],a[80:83]
v_exp_f32 v46,v254
mm a[84:87],a[180:183],v[212:215],a[84:87]
v_exp_f32 v47,v255
v_add_f32 v38,v38,v57
mm a[88:91],a[180:183],v[216:219],a[88:91]
cv v186,v56,v57
v_add_f32 v38,v38,v58
mm a[92:95],a[180:183],v[220:223],a[92:95]
v_add_f32 v38,v38,v59
cv v187,v58,v59
mm a[96:99],a[184:187],v[208:211],a[96:99]
v_add_f32 v35,v35,v39
v_add_f32 v39,v40,v41
mm a[100:103],a[184:187],v[212:215],a[100:103]
cv v188,v40,v41
v_add_f32 v39,v39,v42
mm a[104:107],a[184:187],v[216:219],a[104:107]
v_add_f32 v39,v39,v43
cv v189,v42,v43
mm a[108:111],a[184:187],v[220:223],a[108:111]
v_add_f32 v39,v39,v44
v_add_f32 v39,v39,v45
cv v190,v44,v45
mm a[112:115],a[188:191],v[208:211],a[112:115]
v_add_f32 v39,v39,v46
v_add_f32 v39,v39,v47
mm a[116:119],a[188:191],v[212:215],a[116:119]
cv v191,v46,v47
v_max3_f32 v48,v36,v37,v38
mm a[120:123],a[188:191],v[216:219],a[120:123]
v_max_f32 v48,v48,v39
v_cmp_nle_f32 vcc,v48,v49
mm a[124:127],a[188:191],v[220:223],a[124:127]
s_waitcnt lgkmcnt(0)
dt a[176:177],v28 offset:49152
s_cbranch_vccnz L_rares14
L_backs14:
mm a[0:3],a[160:163],v[176:179],a[0:3]
dt a[178:179],v28 offset:53248
v_exp_f32 v40,v112
v_exp_f32 v41,v113
mm a[4:7],a[160:163],v[180:183],a[4:7]
v_exp_f32 v42,v114
v_exp_f32 v43,v115
v_add_f32 v32,v32,v36
mm a[8:11],a[160:163],v[184:187],a[8:11]
dt a[180:181],v29 offset:49152
v_exp_f32 v44,v144
v_exp_f32 v45,v145
mm a[12:15],a[160:163],v[188:191],a[12:15]
dt a[182:183],v29 offset:53248
v_exp_f32 v46,v146
v_exp_f32 v47,v147
mm a[16:19],a[164:167],v[176:179],a[16:19]
v_exp_f32 v56,v116
v_exp_f32 v57,v117
v_add_f32 v36,v40,v41
mm a[20:23],a[164:167],v[180:183],a[20:23]
dt a[184:185],v30 offset:49152
v_exp_f32 v58,v118
v_exp_f32 v59,v119
mm a[24:27],a[164:167],v[184:187],a[24:27]
cv v208,v40,v41
v_exp_f32 v40,v148
v_exp_f32 v41,v149
mm a[28:31],a[164:167],v[188:191],a[28:31]
dt a[186:187],v30 offset:53248
v_add_f32 v36,v36,v42
v_add_f32 v36,v36,v43
cv v209,v42,v43
mm a[32:35],a[168:171],v[176:179],a[32:35]
dt a[188:189],v31 offset:49152
v_exp_f32 v42,v150
v_add_f32 v36,v36,v44
mm a[36:39],a[168:171],v[180:183],a[36:39]
v_exp_f32 v43,v151
v_add_f32 v36,v36,v45
cv v210,v44,v45
mm a[40:43],a[168:171],v[184:187],a[40:43]
dt a[190:191],v31 offset:53248
v_exp_f32 v44,v120
v_add_f32 v36,v36,v46
mm a[44:47],a[168:171],v[188:191],a[44:47]
v_exp_f32 v45,v121
v_add_f32 v36,v36,v47
cv v211,v46,v47
mm a[48:51],a[172:175],v[176:179],a[48:51]
v_exp_f32 v46,v122
v_exp_f32 v47,v123
mm a[52:55],a[172:175],v[180:183],a[52:55]
v_add_f32 v33,v33,v37
v_add_f32 v37,v56,v57
cv v212,v56,v57
v_add_f32 v37,v37,v58
mm a[56:59],a[172:175],v[184:187],a[56:59]
s_waitcnt vmcnt(0)
v_exp_f32 v56,v152
v_exp_f32 v57,v153
mm a[60:63],a[172:175],v[188:191],a[60:63]
s_waitcnt lgkmcnt(0)
s_barrier
dt a[160:161],v24 offset:57344
v_add_f32 v37,v37,v59
cv v213,v58,v59
mm a[64:67],a[176:179],v[176:179],a[64:67]
dt a[162:163],v24 offset:61440
v_exp_f32 v58,v154
v_add_f32 v37,v37,v40
mm a[68:71],a[176:179],v[180:183],a[68:71]
v_exp_f32 v59,v155
v_add_f32 v37,v37,v41
cv v214,v40,v41
mm a[72:75],a[176:179],v[184:187],a[72:75]
dt a[164:165],v25 offset:57344
v_exp_f32 v40,v124
v_add_f32 v37,v37,v42
mm a[76:79],a[176:179],v[188:191],a[76:79]
dt a[166:167],v25 offset:61440
v_exp_f32 v41,v125
v_add_f32 v37,v37,v43
mm a[80:83],a[180:183],v[176:179],a[80:83]
cv v215,v42,v43
v_exp_f32 v42,v126
v_add_f32 v34,v34,v38
mm a[84:87],a[180:183],v[180:183],a[84:87]
dt a[168:169],v26 offset:57344
v_exp_f32 v43,v127
v_add_f32 v38,v44,v45
mm a[88:91],a[180:183],v[184:187],a[88:91]
cv v216,v44,v45
v_exp_f32 v44,v156
v_add_f32 v38,v38,v46
mm a[92:95],a[180:183],v[188:191],a[92:95]
dt a[170:171],v26 offset:61440
v_exp_f32 v45,v157
v_add_f32 v38,v38,v47
mm a[96:99],a[184:187],v[176:179],a[96:99]
dt a[172:173],v27 offset:57344
cv v217,v46,v47
v_exp_f32 v46,v158
mm a[100:103],a[184:187],v[180:183],a[100:103]
v_exp_f32 v47,v159
v_add_f32 v38,v38,v56
v_add_f32 v38,v38,v57
mm a[104:107],a[184:187],v[184:187],a[104:107]
dt a[174:175],v27 offset:61440
cv v218,v56,v57
v_add_f32 v38,v38,v58
v_add_f32 v38,v38,v59
mm a[108:111],a[184:187],v[188:191],a[108:111]
cv v219,v58,v59
v_add_f32 v35,v35,v39
v_add_f32 v39,v40,v41
cv v220,v40,v41
mm a[112:115],a[188:191],v[176:179],a[112:115]
v_add_f32 v39,v39,v42
v_add_f32 v39,v39,v43
cv v221,v42,v43
v_add_f32 v39,v39,v44
mm a[116:119],a[188:191],v[180:183],a[116:119]
v_add_f32 v39,v39,v45
cv v222,v44,v45
v_add_f32 v39,v39,v46
v_add_f32 v39,v39,v47
mm a[120:123],a[188:191],v[184:187],a[120:123]
cv v223,v46,v47
v_max3_f32 v48,v36,v37,v38
v_max_f32 v48,v48,v39
v_cmp_nle_f32 vcc,v48,v49
mm a[124:127],a[188:191],v[188:191],a[124:127]
s_waitcnt lgkmcnt(0)
dt a[176:177],v28 offset:57344
s_cbranch_vccnz L_rares15
L_backs15:
mm a[0:3],a[160:163],v[208:211],a[0:3]
dt a[178:179],v28 offset:61440
mm a[4:7],a[160:163],v[212:215],a[4:7]
v_add_f32 v32,v32,v36
v_add_f32 v33,v33,v37
mm a[8:11],a[160:163],v[216:219],a[8:11]
dt a[180:181],v29 offset:57344
v_add_f32 v34,v34,v38
mm a[12:15],a[160:163],v[220:223],a[12:15]
dt a[182:183],v29 offset:61440
mm a[16:19],a[164:167],v[208:211],a[16:19]
v_add_f32 v35,v35,v39
v_mov_b32 v50,v32
mm a[20:23],a[164:167],v[212:215],a[20:23]
dt a[184:185],v30 offset:57344
mm a[24:27],a[164:167],v[216:219],a[24:27]
v_mov_b32 v51,v33
v_mov_b32 v52,v34
mm a[28:31],a[164:167],v[220:223],a[28:31]
dt a[186:187],v30 offset:61440
mm a[32:35],a[168:171],v[208:211],a[32:35]
dt a[188:189],v31 offset:57344
v_mov_b32 v53,v35
mm a[36:39],a[168:171],v[212:215],a[36:39]
v_permlane16_swap_b32 v32,v50
v_permlane16_swap_b32 v33,v51
mm a[40:43],a[168:171],v[216:219],a[40:43]
dt a[190:191],v31 offset:61440
mm a[44:47],a[168:171],v[220:223],a[44:47]
v_permlane16_swap_b32 v34,v52
v_permlane16_swap_b32 v35,v53
mm a[48:51],a[172:175],v[208:211],a[48:51]
v_add_f32 v32,v32,v50
mm a[52:55],a[172:175],v[212:215],a[52:55]
v_add_f32 v33,v33,v51
mm a[56:59],a[172:175],v[216:219],a[56:59]
v_add_f32 v34,v34,v52
v_add_f32 v35,v35,v53
mm a[60:63],a[172:175],v[220:223],a[60:63]
s_waitcnt lgkmcnt(0)
v_mov_b32 v50,v32
mm a[64:67],a[176:179],v[208:211],a[64:67]
s_barrier
v_mov_b32 v51,v33
v_mov_b32 v52,v34
mm a[68:71],a[176:179],v[212:215],a[68:71]
dt v[64:65],v14 offset:45056
v_mov_b32 v53,v35
mm a[72:75],a[176:179],v[216:219],a[72:75]
v_permlane32_swap_b32 v32,v50
mm a[76:79],a[176:179],v[220:223],a[76:79]
dt v[66:67],v14 offset:49664
v_permlane32_swap_b32 v33,v51
v_permlane32_swap_b32 v34,v52
mm a[80:83],a[180:183],v[208:211],a[80:83]
v_permlane32_swap_b32 v35,v53
mm a[84:87],a[180:183],v[212:215],a[84:87]
dt v[68:69],v14 offset:54272
v_add_f32 v32,v32,v50
mm a[88:91],a[180:183],v[216:219],a[88:91]
v_add_f32 v33,v33,v51
v_add_f32 v34,v34,v52
mm a[92:95],a[180:183],v[220:223],a[92:95]
dt v[70:71],v14 offset:58880
v_add_f32 v35,v35,v53
mm a[96:99],a[184:187],v[208:211],a[96:99]
v_rcp_f32 v32,v32
mm a[100:103],a[184:187],v[212:215],a[100:103]
dt v[72:73],v14 offset:45088
v_rcp_f32 v33,v33
mm a[104:107],a[184:187],v[216:219],a[104:107]
mm a[108:111],a[184:187],v[220:223],a[108:111]
dt v[74:75],v14 offset:49696
v_rcp_f32 v34,v34
mm a[112:115],a[188:191],v[208:211],a[112:115]
v_rcp_f32 v35,v35
mm a[116:119],a[188:191],v[212:215],a[116:119]
dt v[76:77],v14 offset:54304
mm a[120:123],a[188:191],v[216:219],a[120:123]
mm a[124:127],a[188:191],v[220:223],a[124:127]
dt v[78:79],v14 offset:58912
s_barrier
v_and_b32 v56,0x180,v3
v_lshlrev_b32 v56,1,v56
v_or_b32 v56,0x80,v56
buffer_load_dword v0,v56,s[8:11],s73 offen offset:20 sc1
s_bfe_u32 s79,s81,0x40008
s_mul_i32 s79,s79,147456
s_add_u32 s79,s79,s70
s_add_u32 m0,s71,16384
s_nop 0
bl v4,s[32:35],s79 offen lds
ar v40,a0
ar v41,a1
ar v42,a2
ar v43,a3
ar v44,a16
ar v45,a17
ar v46,a18
ar v47,a19
v_pk_mul_f32 v[40:41],v[40:41],v[32:33] op_sel_hi:[1,0]
v_pk_mul_f32 v[42:43],v[42:43],v[32:33] op_sel_hi:[1,0]
v_pk_mul_f32 v[44:45],v[44:45],v[32:33] op_sel_hi:[1,0]
v_pk_mul_f32 v[46:47],v[46:47],v[32:33] op_sel_hi:[1,0]
cv v96,v40,v41
cv v97,v42,v43
cv v98,v44,v45
cv v99,v46,v47
s_add_u32 m0,s71,17408
s_nop 0
bl v5,s[32:35],s79 offen lds
ar v48,a4
ar v49,a5
ar v50,a6
ar v51,a7
ar v52,a20
ar v53,a21
ar v54,a22
ar v55,a23
v_pk_mul_f32 v[48:49],v[48:49],v[32:33] op_sel:[0,1] op_sel_hi:[1,1]
v_pk_mul_f32 v[50:51],v[50:51],v[32:33] op_sel:[0,1] op_sel_hi:[1,1]
v_pk_mul_f32 v[52:53],v[52:53],v[32:33] op_sel:[0,1] op_sel_hi:[1,1]
v_pk_mul_f32 v[54:55],v[54:55],v[32:33] op_sel:[0,1] op_sel_hi:[1,1]
cv v100,v48,v49
cv v101,v50,v51
cv v102,v52,v53
cv v103,v54,v55
s_add_u32 m0,s71,18432
s_nop 0
bl v6,s[32:35],s79 offen lds
ar v40,a8
ar v41,a9
ar v42,a10
ar v43,a11
ar v44,a24
ar v45,a25
ar v46,a26
ar v47,a27
v_pk_mul_f32 v[40:41],v[40:41],v[34:35] op_sel_hi:[1,0]
v_pk_mul_f32 v[42:43],v[42:43],v[34:35] op_sel_hi:[1,0]
v_pk_mul_f32 v[44:45],v[44:45],v[34:35] op_sel_hi:[1,0]
v_pk_mul_f32 v[46:47],v[46:47],v[34:35] op_sel_hi:[1,0]
cv v104,v40,v41
cv v105,v42,v43
cv v106,v44,v45
cv v107,v46,v47
s_add_u32 m0,s71,19456
s_nop 0
bl v7,s[32:35],s79 offen lds
ar v48,a12
ar v49,a13
ar v50,a14
ar v51,a15
ar v52,a28
ar v53,a29
ar v54,a30
ar v55,a31
v_pk_mul_f32 v[48:49],v[48:49],v[34:35] op_sel:[0,1] op_sel_hi:[1,1]
v_pk_mul_f32 v[50:51],v[50:51],v[34:35] op_sel:[0,1] op_sel_hi:[1,1]
v_pk_mul_f32 v[52:53],v[52:53],v[34:35] op_sel:[0,1] op_sel_hi:[1,1]
v_pk_mul_f32 v[54:55],v[54:55],v[34:35] op_sel:[0,1] op_sel_hi:[1,1]
cv v108,v48,v49
cv v109,v50,v51
cv v110,v52,v53
cv v111,v54,v55
s_add_u32 m0,s71,20480
s_nop 0
bl v8,s[32:35],s79 offen lds
s_add_u32 m0,s71,21504
s_nop 0
bl v9,s[32:35],s79 offen lds
ar v40,a32
ar v41,a33
ar v42,a34
ar v43,a35
ar v44,a48
ar v45,a49
ar v46,a50
ar v47,a51
v_pk_mul_f32 v[40:41],v[40:41],v[32:33] op_sel_hi:[1,0]
v_pk_mul_f32 v[42:43],v[42:43],v[32:33] op_sel_hi:[1,0]
v_pk_mul_f32 v[44:45],v[44:45],v[32:33] op_sel_hi:[1,0]
v_pk_mul_f32 v[46:47],v[46:47],v[32:33] op_sel_hi:[1,0]
cv v112,v40,v41
cv v113,v42,v43
cv v114,v44,v45
cv v115,v46,v47
s_add_u32 m0,s71,22528
s_nop 0
bl v10,s[32:35],s79 offen lds
ar v48,a36
ar v49,a37
ar v50,a38
ar v51,a39
ar v52,a52
ar v53,a53
ar v54,a54
ar v55,a55
v_pk_mul_f32 v[48:49],v[48:49],v[32:33] op_sel:[0,1] op_sel_hi:[1,1]
v_pk_mul_f32 v[50:51],v[50:51],v[32:33] op_sel:[0,1] op_sel_hi:[1,1]
v_pk_mul_f32 v[52:53],v[52:53],v[32:33] op_sel:[0,1] op_sel_hi:[1,1]
v_pk_mul_f32 v[54:55],v[54:55],v[32:33] op_sel:[0,1] op_sel_hi:[1,1]
cv v116,v48,v49
cv v117,v50,v51
cv v118,v52,v53
cv v119,v54,v55
s_add_u32 m0,s71,23552
s_nop 0
bl v11,s[32:35],s79 offen lds
ar v40,a40
ar v41,a41
ar v42,a42
ar v43,a43
ar v44,a56
ar v45,a57
ar v46,a58
ar v47,a59
v_pk_mul_f32 v[40:41],v[40:41],v[34:35] op_sel_hi:[1,0]
v_pk_mul_f32 v[42:43],v[42:43],v[34:35] op_sel_hi:[1,0]
v_pk_mul_f32 v[44:45],v[44:45],v[34:35] op_sel_hi:[1,0]
v_pk_mul_f32 v[46:47],v[46:47],v[34:35] op_sel_hi:[1,0]
cv v120,v40,v41
cv v121,v42,v43
cv v122,v44,v45
cv v123,v46,v47
s_add_u32 m0,s71,24576
s_nop 0
bl v12,s[32:35],s79 offen lds
ar v48,a44
ar v49,a45
ar v50,a46
ar v51,a47
ar v52,a60
ar v53,a61
ar v54,a62
ar v55,a63
v_pk_mul_f32 v[48:49],v[48:49],v[34:35] op_sel:[0,1] op_sel_hi:[1,1]
v_pk_mul_f32 v[50:51],v[50:51],v[34:35] op_sel:[0,1] op_sel_hi:[1,1]
v_pk_mul_f32 v[52:53],v[52:53],v[34:35] op_sel:[0,1] op_sel_hi:[1,1]
v_pk_mul_f32 v[54:55],v[54:55],v[34:35] op_sel:[0,1] op_sel_hi:[1,1]
cv v124,v48,v49
cv v125,v50,v51
cv v126,v52,v53
cv v127,v54,v55
s_waitcnt vmcnt(9)
v_cmp_ne_u32 vcc,v1,v0
s_nop 1
s_cbranch_vccnz L_spin_fo
L_ok_fo:
s_bfe_u32 s82,s81,0x40004
s_lshl_b32 s82,s82,12
s_add_u32 s82,s82,s68
bl a[144:147],v60,s[8:11],s82 offen offset:0 sc1
bl a[148:151],v61,s[8:11],s82 offen offset:0 sc1
ar v40,a64
ar v41,a65
ar v42,a66
ar v43,a67
ar v44,a80
ar v45,a81
ar v46,a82
ar v47,a83
v_pk_mul_f32 v[40:41],v[40:41],v[32:33] op_sel_hi:[1,0]
v_pk_mul_f32 v[42:43],v[42:43],v[32:33] op_sel_hi:[1,0]
v_pk_mul_f32 v[44:45],v[44:45],v[32:33] op_sel_hi:[1,0]
v_pk_mul_f32 v[46:47],v[46:47],v[32:33] op_sel_hi:[1,0]
cv v128,v40,v41
cv v129,v42,v43
cv v130,v44,v45
cv v131,v46,v47
bl a[152:155],v62,s[8:11],s82 offen offset:0 sc1
bl a[156:159],v63,s[8:11],s82 offen offset:0 sc1
ar v48,a68
ar v49,a69
ar v50,a70
ar v51,a71
ar v52,a84
ar v53,a85
ar v54,a86
ar v55,a87
v_pk_mul_f32 v[48:49],v[48:49],v[32:33] op_sel:[0,1] op_sel_hi:[1,1]
v_pk_mul_f32 v[50:51],v[50:51],v[32:33] op_sel:[0,1] op_sel_hi:[1,1]
v_pk_mul_f32 v[52:53],v[52:53],v[32:33] op_sel:[0,1] op_sel_hi:[1,1]
v_pk_mul_f32 v[54:55],v[54:55],v[32:33] op_sel:[0,1] op_sel_hi:[1,1]
cv v132,v48,v49
cv v133,v50,v51
cv v134,v52,v53
cv v135,v54,v55
bl a[160:163],v60,s[8:11],s82 offen offset:1024 sc1
bl a[164:167],v61,s[8:11],s82 offen offset:1024 sc1
ar v40,a72
ar v41,a73
ar v42,a74
ar v43,a75
ar v44,a88
ar v45,a89
ar v46,a90
ar v47,a91
v_pk_mul_f32 v[40:41],v[40:41],v[34:35] op_sel_hi:[1,0]
v_pk_mul_f32 v[42:43],v[42:43],v[34:35] op_sel_hi:[1,0]
v_pk_mul_f32 v[44:45],v[44:45],v[34:35] op_sel_hi:[1,0]
v_pk_mul_f32 v[46:47],v[46:47],v[34:35] op_sel_hi:[1,0]
cv v136,v40,v41
cv v137,v42,v43
cv v138,v44,v45
cv v139,v46,v47
bl a[168:171],v62,s[8:11],s82 offen offset:1024 sc1
bl a[172:175],v63,s[8:11],s82 offen offset:1024 sc1
ar v48,a76
ar v49,a77
ar v50,a78
ar v51,a79
ar v52,a92
ar v53,a93
ar v54,a94
ar v55,a95
v_pk_mul_f32 v[48:49],v[48:49],v[34:35] op_sel:[0,1] op_sel_hi:[1,1]
v_pk_mul_f32 v[50:51],v[50:51],v[34:35] op_sel:[0,1] op_sel_hi:[1,1]
v_pk_mul_f32 v[52:53],v[52:53],v[34:35] op_sel:[0,1] op_sel_hi:[1,1]
v_pk_mul_f32 v[54:55],v[54:55],v[34:35] op_sel:[0,1] op_sel_hi:[1,1]
cv v140,v48,v49
cv v141,v50,v51
cv v142,v52,v53
cv v143,v54,v55
bl a[176:179],v60,s[8:11],s82 offen offset:2048 sc1
bl a[180:183],v61,s[8:11],s82 offen offset:2048 sc1
ar v40,a96
ar v41,a97
ar v42,a98
ar v43,a99
ar v44,a112
ar v45,a113
ar v46,a114
ar v47,a115
v_pk_mul_f32 v[40:41],v[40:41],v[32:33] op_sel_hi:[1,0]
v_pk_mul_f32 v[42:43],v[42:43],v[32:33] op_sel_hi:[1,0]
v_pk_mul_f32 v[44:45],v[44:45],v[32:33] op_sel_hi:[1,0]
v_pk_mul_f32 v[46:47],v[46:47],v[32:33] op_sel_hi:[1,0]
cv v144,v40,v41
cv v145,v42,v43
cv v146,v44,v45
cv v147,v46,v47
bl a[184:187],v62,s[8:11],s82 offen offset:2048 sc1
bl a[188:191],v63,s[8:11],s82 offen offset:2048 sc1
ar v48,a100
ar v49,a101
ar v50,a102
ar v51,a103
ar v52,a116
ar v53,a117
ar v54,a118
ar v55,a119
v_pk_mul_f32 v[48:49],v[48:49],v[32:33] op_sel:[0,1] op_sel_hi:[1,1]
v_pk_mul_f32 v[50:51],v[50:51],v[32:33] op_sel:[0,1] op_sel_hi:[1,1]
v_pk_mul_f32 v[52:53],v[52:53],v[32:33] op_sel:[0,1] op_sel_hi:[1,1]
v_pk_mul_f32 v[54:55],v[54:55],v[32:33] op_sel:[0,1] op_sel_hi:[1,1]
cv v148,v48,v49
cv v149,v50,v51
cv v150,v52,v53
cv v151,v54,v55
bl v[176:179],v60,s[8:11],s82 offen offset:3072 sc1
bl v[180:183],v61,s[8:11],s82 offen offset:3072 sc1
ar v40,a104
ar v41,a105
ar v42,a106
ar v43,a107
ar v44,a120
ar v45,a121
ar v46,a122
ar v47,a123
v_pk_mul_f32 v[40:41],v[40:41],v[34:35] op_sel_hi:[1,0]
v_pk_mul_f32 v[42:43],v[42:43],v[34:35] op_sel_hi:[1,0]
v_pk_mul_f32 v[44:45],v[44:45],v[34:35] op_sel_hi:[1,0]
v_pk_mul_f32 v[46:47],v[46:47],v[34:35] op_sel_hi:[1,0]
cv v152,v40,v41
cv v153,v42,v43
cv v154,v44,v45
cv v155,v46,v47
bl v[184:187],v62,s[8:11],s82 offen offset:3072 sc1
bl v[188:191],v63,s[8:11],s82 offen offset:3072 sc1
ar v48,a108
ar v49,a109
ar v50,a110
ar v51,a111
ar v52,a124
ar v53,a125
ar v54,a126
ar v55,a127
v_pk_mul_f32 v[48:49],v[48:49],v[34:35] op_sel:[0,1] op_sel_hi:[1,1]
v_pk_mul_f32 v[50:51],v[50:51],v[34:35] op_sel:[0,1] op_sel_hi:[1,1]
v_pk_mul_f32 v[52:53],v[52:53],v[34:35] op_sel:[0,1] op_sel_hi:[1,1]
v_pk_mul_f32 v[54:55],v[54:55],v[34:35] op_sel:[0,1] op_sel_hi:[1,1]
cv v156,v48,v49
cv v157,v50,v51
cv v158,v52,v53
cv v159,v54,v55
s_waitcnt lgkmcnt(4)
mm a[0:3],v[64:67],v[96:99],0
dt v[80:81],v14 offset:45120
mm a[0:3],v[68:71],v[112:115],a[0:3]
mm a[4:7],v[64:67],v[100:103],0
dt v[82:83],v14 offset:49728
mm a[4:7],v[68:71],v[116:119],a[4:7]
buffer_store_dwordx4 v[96:99],v2,s[8:11],s48 offen offset:0 sc1
mm a[8:11],v[64:67],v[104:107],0
dt v[84:85],v14 offset:54336
mm a[8:11],v[68:71],v[120:123],a[8:11]
s_bfe_u32 s82,s81,0x40008
s_lshl_b32 s82,s82,12
s_add_u32 s82,s82,s68
mm a[12:15],v[64:67],v[108:111],0
dt v[86:87],v14 offset:58944
mm a[12:15],v[68:71],v[124:127],a[12:15]
s_waitcnt lgkmcnt(4)
bl v[208:211],v60,s[8:11],s82 offen offset:0 sc1
mm a[16:19],v[72:75],v[96:99],0
dt v[88:89],v14 offset:45152
mm a[16:19],v[76:79],v[112:115],a[16:19]
mm a[20:23],v[72:75],v[100:103],0
dt v[90:91],v14 offset:49760
mm a[20:23],v[76:79],v[116:119],a[20:23]
mm a[24:27],v[72:75],v[104:107],0
dt v[92:93],v14 offset:54368
mm a[24:27],v[76:79],v[120:123],a[24:27]
buffer_store_dwordx4 v[100:103],v2,s[8:11],s49 offen offset:0 sc1
mm a[28:31],v[72:75],v[108:111],0
dt v[94:95],v14 offset:58976
mm a[28:31],v[76:79],v[124:127],a[28:31]
s_waitcnt lgkmcnt(4)
mm a[32:35],v[80:83],v[96:99],0
dt v[64:65],v14 offset:45184
mm a[32:35],v[84:87],v[112:115],a[32:35]
mm a[36:39],v[80:83],v[100:103],0
dt v[66:67],v14 offset:49792
mm a[36:39],v[84:87],v[116:119],a[36:39]
bl v[212:215],v61,s[8:11],s82 offen offset:0 sc1
mm a[40:43],v[80:83],v[104:107],0
dt v[68:69],v14 offset:54400
mm a[40:43],v[84:87],v[120:123],a[40:43]
mm a[44:47],v[80:83],v[108:111],0
dt v[70:71],v14 offset:59008
mm a[44:47],v[84:87],v[124:127],a[44:47]
s_waitcnt lgkmcnt(4)
mm a[48:51],v[88:91],v[96:99],0
dt v[72:73],v14 offset:45216
mm a[48:51],v[92:95],v[112:115],a[48:51]
buffer_store_dwordx4 v[104:107],v2,s[8:11],s50 offen offset:0 sc1
mm a[52:55],v[88:91],v[100:103],0
dt v[74:75],v14 offset:49824
mm a[52:55],v[92:95],v[116:119],a[52:55]
mm a[56:59],v[88:91],v[104:107],0
dt v[76:77],v14 offset:54432
mm a[56:59],v[92:95],v[120:123],a[56:59]
mm a[60:63],v[88:91],v[108:111],0
dt v[78:79],v14 offset:59040
mm a[60:63],v[92:95],v[124:127],a[60:63]
s_waitcnt lgkmcnt(4)
bl v[216:219],v62,s[8:11],s82 offen offset:0 sc1
mm a[64:67],v[64:67],v[96:99],0
dt v[88:89],v14 offset:45248
mm a[64:67],v[68:71],v[112:115],a[64:67]
mm a[68:71],v[64:67],v[100:103],0
dt v[90:91],v14 offset:49856
mm a[68:71],v[68:71],v[116:119],a[68:71]
buffer_store_dwordx4 v[108:111],v2,s[8:11],s51 offen offset:0 sc1
mm a[72:75],v[64:67],v[104:107],0
dt v[92:93],v14 offset:54464
mm a[72:75],v[68:71],v[120:123],a[72:75]
mm a[76:79],v[64:67],v[108:111],0
dt v[94:95],v14 offset:59072
mm a[76:79],v[68:71],v[124:127],a[76:79]
s_waitcnt lgkmcnt(4)
mm a[80:83],v[72:75],v[96:99],0
dt v[64:65],v14 offset:45280
mm a[80:83],v[76:79],v[112:115],a[80:83]
bl v[220:223],v63,s[8:11],s82 offen offset:0 sc1
mm a[84:87],v[72:75],v[100:103],0
dt v[66:67],v14 offset:49888
mm a[84:87],v[76:79],v[116:119],a[84:87]
mm a[88:91],v[72:75],v[104:107],0
dt v[68:69],v14 offset:54496
mm a[88:91],v[76:79],v[120:123],a[88:91]
mm a[92:95],v[72:75],v[108:111],0
dt v[70:71],v14 offset:59104
mm a[92:95],v[76:79],v[124:127],a[92:95]
s_waitcnt lgkmcnt(4)
buffer_store_dwordx4 v[112:115],v2,s[8:11],s48 offen offset:1024 sc1
mm a[96:99],v[88:91],v[96:99],0
dt v[72:73],v14 offset:45312
mm a[96:99],v[92:95],v[112:115],a[96:99]
mm a[100:103],v[88:91],v[100:103],0
dt v[74:75],v14 offset:49920
mm a[100:103],v[92:95],v[116:119],a[100:103]
mm a[104:107],v[88:91],v[104:107],0
dt v[76:77],v14 offset:54528
mm a[104:107],v[92:95],v[120:123],a[104:107]
bl a[192:195],v60,s[8:11],s82 offen offset:1024 sc1
mm a[108:111],v[88:91],v[108:111],0
dt v[78:79],v14 offset:59136
mm a[108:111],v[92:95],v[124:127],a[108:111]
s_waitcnt lgkmcnt(4)
mm a[112:115],v[64:67],v[96:99],0
dt v[80:81],v14 offset:63488
mm a[112:115],v[68:71],v[112:115],a[112:115]
mm a[116:119],v[64:67],v[100:103],0
dt v[82:83],v15 offset:2560
mm a[116:119],v[68:71],v[116:119],a[116:119]
buffer_store_dwordx4 v[116:119],v2,s[8:11],s49 offen offset:1024 sc1
mm a[120:123],v[64:67],v[104:107],0
dt v[84:85],v15 offset:7168
mm a[120:123],v[68:71],v[120:123],a[120:123]
mm a[124:127],v[64:67],v[108:111],0
dt v[86:87],v15 offset:11776
mm a[124:127],v[68:71],v[124:127],a[124:127]
s_waitcnt lgkmcnt(4)
mm a[128:131],v[72:75],v[96:99],0
dt v[88:89],v14 offset:63520
mm a[128:131],v[76:79],v[112:115],a[128:131]
bl a[196:199],v61,s[8:11],s82 offen offset:1024 sc1
mm a[132:135],v[72:75],v[100:103],0
dt v[90:91],v15 offset:2592
mm a[132:135],v[76:79],v[116:119],a[132:135]
mm a[136:139],v[72:75],v[104:107],0
dt v[92:93],v15 offset:7200
mm a[136:139],v[76:79],v[120:123],a[136:139]
buffer_store_dwordx4 v[120:123],v2,s[8:11],s50 offen offset:1024 sc1
mm a[140:143],v[72:75],v[108:111],0
dt v[94:95],v15 offset:11808
mm a[140:143],v[76:79],v[124:127],a[140:143]
s_waitcnt lgkmcnt(4)
mm a[0:3],v[80:83],v[128:131],a[0:3]
dt v[64:65],v14 offset:63552
mm a[0:3],v[84:87],v[144:147],a[0:3]
mm a[4:7],v[80:83],v[132:135],a[4:7]
dt v[66:67],v15 offset:2624
mm a[4:7],v[84:87],v[148:151],a[4:7]
bl a[200:203],v62,s[8:11],s82 offen offset:1024 sc1
mm a[8:11],v[80:83],v[136:139],a[8:11]
dt v[68:69],v15 offset:7232
mm a[8:11],v[84:87],v[152:155],a[8:11]
mm a[12:15],v[80:83],v[140:143],a[12:15]
dt v[70:71],v15 offset:11840
mm a[12:15],v[84:87],v[156:159],a[12:15]
s_waitcnt lgkmcnt(4)
mm a[16:19],v[88:91],v[128:131],a[16:19]
dt v[80:81],v14 offset:63584
mm a[16:19],v[92:95],v[144:147],a[16:19]
buffer_store_dwordx4 v[124:127],v2,s[8:11],s51 offen offset:1024 sc1
mm a[20:23],v[88:91],v[132:135],a[20:23]
dt v[82:83],v15 offset:2656
mm a[20:23],v[92:95],v[148:151],a[20:23]
mm a[24:27],v[88:91],v[136:139],a[24:27]
dt v[84:85],v15 offset:7264
mm a[24:27],v[92:95],v[152:155],a[24:27]
mm a[28:31],v[88:91],v[140:143],a[28:31]
dt v[86:87],v15 offset:11872
mm a[28:31],v[92:95],v[156:159],a[28:31]
s_waitcnt lgkmcnt(4)
bl a[204:207],v63,s[8:11],s82 offen offset:1024 sc1
mm a[32:35],v[64:67],v[128:131],a[32:35]
dt v[88:89],v14 offset:63616
mm a[32:35],v[68:71],v[144:147],a[32:35]
mm a[36:39],v[64:67],v[132:135],a[36:39]
dt v[90:91],v15 offset:2688
mm a[36:39],v[68:71],v[148:151],a[36:39]
mm a[40:43],v[64:67],v[136:139],a[40:43]
dt v[92:93],v15 offset:7296
mm a[40:43],v[68:71],v[152:155],a[40:43]
buffer_store_dwordx4 v[128:131],v2,s[8:11],s48 offen offset:2048 sc1
mm a[44:47],v[64:67],v[140:143],a[44:47]
dt v[94:95],v15 offset:11904
mm a[44:47],v[68:71],v[156:159],a[44:47]
s_waitcnt lgkmcnt(4)
mm a[48:51],v[80:83],v[128:131],a[48:51]
dt v[64:65],v14 offset:63648
mm a[48:51],v[84:87],v[144:147],a[48:51]
mm a[52:55],v[80:83],v[132:135],a[52:55]
dt v[66:67],v15 offset:2720
mm a[52:55],v[84:87],v[148:151],a[52:55]
bl a[208:211],v60,s[8:11],s82 offen offset:2048 sc1
mm a[56:59],v[80:83],v[136:139],a[56:59]
dt v[68:69],v15 offset:7328
mm a[56:59],v[84:87],v[152:155],a[56:59]
mm a[60:63],v[80:83],v[140:143],a[60:63]
dt v[70:71],v15 offset:11936
mm a[60:63],v[84:87],v[156:159],a[60:63]
s_waitcnt lgkmcnt(4)
buffer_store_dwordx4 v[132:135],v2,s[8:11],s49 offen offset:2048 sc1
mm a[64:67],v[88:91],v[128:131],a[64:67]
dt v[72:73],v14 offset:63680
mm a[64:67],v[92:95],v[144:147],a[64:67]
mm a[68:71],v[88:91],v[132:135],a[68:71]
dt v[74:75],v15 offset:2752
mm a[68:71],v[92:95],v[148:151],a[68:71]
mm a[72:75],v[88:91],v[136:139],a[72:75]
dt v[76:77],v15 offset:7360
mm a[72:75],v[92:95],v[152:155],a[72:75]
bl a[212:215],v61,s[8:11],s82 offen offset:2048 sc1
mm a[76:79],v[88:91],v[140:143],a[76:79]
dt v[78:79],v15 offset:11968
mm a[76:79],v[92:95],v[156:159],a[76:79]
s_waitcnt lgkmcnt(4)
mm a[80:83],v[64:67],v[128:131],a[80:83]
dt v[80:81],v14 offset:63712
mm a[80:83],v[68:71],v[144:147],a[80:83]
mm a[84:87],v[64:67],v[132:135],a[84:87]
dt v[82:83],v15 offset:2784
mm a[84:87],v[68:71],v[148:151],a[84:87]
buffer_store_dwordx4 v[136:139],v2,s[8:11],s50 offen offset:2048 sc1
mm a[88:91],v[64:67],v[136:139],a[88:91]
dt v[84:85],v15 offset:7392
mm a[88:91],v[68:71],v[152:155],a[88:91]
mm a[92:95],v[64:67],v[140:143],a[92:95]
dt v[86:87],v15 offset:12000
mm a[92:95],v[68:71],v[156:159],a[92:95]
s_waitcnt lgkmcnt(4)
mm a[96:99],v[72:75],v[128:131],a[96:99]
dt v[88:89],v14 offset:63744
mm a[96:99],v[76:79],v[144:147],a[96:99]
bl a[216:219],v62,s[8:11],s82 offen offset:2048 sc1
mm a[100:103],v[72:75],v[132:135],a[100:103]
dt v[90:91],v15 offset:2816
mm a[100:103],v[76:79],v[148:151],a[100:103]
mm a[104:107],v[72:75],v[136:139],a[104:107]
dt v[92:93],v15 offset:7424
mm a[104:107],v[76:79],v[152:155],a[104:107]
mm a[108:111],v[72:75],v[140:143],a[108:111]
dt v[94:95],v15 offset:12032
mm a[108:111],v[76:79],v[156:159],a[108:111]
s_waitcnt lgkmcnt(4)
s_waitcnt lgkmcnt(0)
mm a[112:115],v[80:83],v[128:131],a[112:115]
s_barrier
dt v[64:65],v14 offset:8192
mm a[112:115],v[84:87],v[144:147],a[112:115]
buffer_store_dwordx4 v[140:143],v2,s[8:11],s51 offen offset:2048 sc1
mm a[116:119],v[80:83],v[132:135],a[116:119]
dt v[66:67],v14 offset:12800
mm a[116:119],v[84:87],v[148:151],a[116:119]
mm a[120:123],v[80:83],v[136:139],a[120:123]
dt v[68:69],v14 offset:17408
mm a[120:123],v[84:87],v[152:155],a[120:123]
bl a[220:223],v63,s[8:11],s82 offen offset:2048 sc1
mm a[124:127],v[80:83],v[140:143],a[124:127]
dt v[70:71],v14 offset:22016
mm a[124:127],v[84:87],v[156:159],a[124:127]
mm a[128:131],v[88:91],v[128:131],a[128:131]
dt v[72:73],v14 offset:8224
mm a[128:131],v[92:95],v[144:147],a[128:131]
mm a[132:135],v[88:91],v[132:135],a[132:135]
dt v[74:75],v14 offset:12832
mm a[132:135],v[92:95],v[148:151],a[132:135]
buffer_store_dwordx4 v[144:147],v2,s[8:11],s48 offen offset:3072 sc1
mm a[136:139],v[88:91],v[136:139],a[136:139]
dt v[76:77],v14 offset:17440
mm a[136:139],v[92:95],v[152:155],a[136:139]
mm a[140:143],v[88:91],v[140:143],a[140:143]
dt v[78:79],v14 offset:22048
mm a[140:143],v[92:95],v[156:159],a[140:143]
s_waitcnt vmcnt(33) lgkmcnt(4)
mm a[0:3],v[64:67],a[144:147],a[0:3]
dt v[80:81],v14 offset:8256
mm a[0:3],v[68:71],a[160:163],a[0:3]
bl a[224:227],v60,s[8:11],s82 offen offset:3072 sc1
mm a[4:7],v[64:67],a[148:151],a[4:7]
dt v[82:83],v14 offset:12864
mm a[4:7],v[68:71],a[164:167],a[4:7]
mm a[8:11],v[64:67],a[152:155],a[8:11]
dt v[84:85],v14 offset:17472
mm a[8:11],v[68:71],a[168:171],a[8:11]
buffer_store_dwordx4 v[148:151],v2,s[8:11],s49 offen offset:3072 sc1
mm a[12:15],v[64:67],a[156:159],a[12:15]
dt v[86:87],v14 offset:22080
mm a[12:15],v[68:71],a[172:175],a[12:15]
s_waitcnt lgkmcnt(4)
mm a[16:19],v[72:75],a[144:147],a[16:19]
dt v[88:89],v14 offset:8288
mm a[16:19],v[76:79],a[160:163],a[16:19]
mm a[20:23],v[72:75],a[148:151],a[20:23]
dt v[90:91],v14 offset:12896
mm a[20:23],v[76:79],a[164:167],a[20:23]
bl a[228:231],v61,s[8:11],s82 offen offset:3072 sc1
mm a[24:27],v[72:75],a[152:155],a[24:27]
dt v[92:93],v14 offset:17504
mm a[24:27],v[76:79],a[168:171],a[24:27]
mm a[28:31],v[72:75],a[156:159],a[28:31]
dt v[94:95],v14 offset:22112
mm a[28:31],v[76:79],a[172:175],a[28:31]
s_waitcnt lgkmcnt(4)
mm a[32:35],v[80:83],a[144:147],a[32:35]
dt v[64:65],v14 offset:8320
mm a[32:35],v[84:87],a[160:163],a[32:35]
buffer_store_dwordx4 v[152:155],v2,s[8:11],s50 offen offset:3072 sc1
mm a[36:39],v[80:83],a[148:151],a[36:39]
dt v[66:67],v14 offset:12928
mm a[36:39],v[84:87],a[164:167],a[36:39]
mm a[40:43],v[80:83],a[152:155],a[40:43]
dt v[68:69],v14 offset:17536
mm a[40:43],v[84:87],a[168:171],a[40:43]
mm a[44:47],v[80:83],a[156:159],a[44:47]
dt v[70:71],v14 offset:22144
mm a[44:47],v[84:87],a[172:175],a[44:47]
s_waitcnt lgkmcnt(4)
bl a[232:235],v62,s[8:11],s82 offen offset:3072 sc1
mm a[48:51],v[88:91],a[144:147],a[48:51]
dt v[72:73],v14 offset:8352
mm a[48:51],v[92:95],a[160:163],a[48:51]
mm a[52:55],v[88:91],a[148:151],a[52:55]
dt v[74:75],v14 offset:12960
mm a[52:55],v[92:95],a[164:167],a[52:55]
mm a[56:59],v[88:91],a[152:155],a[56:59]
dt v[76:77],v14 offset:17568
mm a[56:59],v[92:95],a[168:171],a[56:59]
buffer_store_dwordx4 v[156:159],v2,s[8:11],s51 offen offset:3072 sc1
mm a[60:63],v[88:91],a[156:159],a[60:63]
dt v[78:79],v14 offset:22176
mm a[60:63],v[92:95],a[172:175],a[60:63]
s_waitcnt lgkmcnt(4)
mm a[64:67],v[64:67],a[144:147],a[64:67]
dt v[80:81],v14 offset:8384
mm a[64:67],v[68:71],a[160:163],a[64:67]
mm a[68:71],v[64:67],a[148:151],a[68:71]
dt v[82:83],v14 offset:12992
mm a[68:71],v[68:71],a[164:167],a[68:71]
bl a[236:239],v63,s[8:11],s82 offen offset:3072 sc1
mm a[72:75],v[64:67],a[152:155],a[72:75]
dt v[84:85],v14 offset:17600
mm a[72:75],v[68:71],a[168:171],a[72:75]
mm a[76:79],v[64:67],a[156:159],a[76:79]
dt v[86:87],v14 offset:22208
mm a[76:79],v[68:71],a[172:175],a[76:79]
s_waitcnt lgkmcnt(4)
mm a[80:83],v[72:75],a[144:147],a[80:83]
dt v[88:89],v14 offset:8416
mm a[80:83],v[76:79],a[160:163],a[80:83]
mm a[84:87],v[72:75],a[148:151],a[84:87]
dt v[90:91],v14 offset:13024
mm a[84:87],v[76:79],a[164:167],a[84:87]
mm a[88:91],v[72:75],a[152:155],a[88:91]
dt v[92:93],v14 offset:17632
mm a[88:91],v[76:79],a[168:171],a[88:91]
mm a[92:95],v[72:75],a[156:159],a[92:95]
dt v[94:95],v14 offset:22240
mm a[92:95],v[76:79],a[172:175],a[92:95]
s_waitcnt lgkmcnt(4)
mm a[96:99],v[80:83],a[144:147],a[96:99]
dt v[64:65],v14 offset:8448
mm a[96:99],v[84:87],a[160:163],a[96:99]
mm a[100:103],v[80:83],a[148:151],a[100:103]
dt v[66:67],v14 offset:13056
mm a[100:103],v[84:87],a[164:167],a[100:103]
mm a[104:107],v[80:83],a[152:155],a[104:107]
dt v[68:69],v14 offset:17664
mm a[104:107],v[84:87],a[168:171],a[104:107]
mm a[108:111],v[80:83],a[156:159],a[108:111]
dt v[70:71],v14 offset:22272
mm a[108:111],v[84:87],a[172:175],a[108:111]
s_waitcnt lgkmcnt(4)
s_waitcnt vmcnt(1)
mm a[112:115],v[88:91],a[144:147],a[112:115]
s_barrier
dt v[72:73],v14 offset:26624
mm a[112:115],v[92:95],a[160:163],a[112:115]
buffer_store_dword v1,off,s[8:11],s74 offset:20 sc1
mm a[116:119],v[88:91],a[148:151],a[116:119]
s_bfe_u32 s79,s81,0x4000c
s_mul_i32 s79,s79,147456
dt v[74:75],v14 offset:31232
mm a[116:119],v[92:95],a[164:167],a[116:119]
s_add_u32 s79,s79,s70
s_add_u32 m0,s71,126976
mm a[120:123],v[88:91],a[152:155],a[120:123]
dt v[76:77],v14 offset:35840
mm a[120:123],v[92:95],a[168:171],a[120:123]
bl v4,s[32:35],s79 offen lds
mm a[124:127],v[88:91],a[156:159],a[124:127]
s_add_u32 m0,s71,128000
dt v[78:79],v14 offset:40448
mm a[124:127],v[92:95],a[172:175],a[124:127]
s_waitcnt lgkmcnt(4)
bl v5,s[32:35],s79 offen lds
mm a[128:131],v[64:67],a[144:147],a[128:131]
s_add_u32 m0,s71,129024
dt v[80:81],v14 offset:26656
mm a[128:131],v[68:71],a[160:163],a[128:131]
mm a[132:135],v[64:67],a[148:151],a[132:135]
dt v[82:83],v14 offset:31264
mm a[132:135],v[68:71],a[164:167],a[132:135]
bl v6,s[32:35],s79 offen lds
mm a[136:139],v[64:67],a[152:155],a[136:139]
s_add_u32 m0,s71,130048
dt v[84:85],v14 offset:35872
mm a[136:139],v[68:71],a[168:171],a[136:139]
bl v7,s[32:35],s79 offen lds
mm a[140:143],v[64:67],a[156:159],a[140:143]
dt v[86:87],v14 offset:40480
mm a[140:143],v[68:71],a[172:175],a[140:143]
s_waitcnt lgkmcnt(4)
s_add_u32 m0,s71,131072
mm a[0:3],v[72:75],a[176:179],a[0:3]
dt v[88:89],v14 offset:26688
mm a[0:3],v[76:79],v[176:179],a[0:3]
bl v8,s[32:35],s79 offen lds
mm a[4:7],v[72:75],a[180:183],a[4:7]
s_add_u32 m0,s71,132096
dt v[90:91],v14 offset:31296
mm a[4:7],v[76:79],v[180:183],a[4:7]
mm a[8:11],v[72:75],a[184:187],a[8:11]
dt v[92:93],v14 offset:35904
mm a[8:11],v[76:79],v[184:187],a[8:11]
bl v9,s[32:35],s79 offen lds
mm a[12:15],v[72:75],a[188:191],a[12:15]
s_add_u32 m0,s71,133120
dt v[94:95],v14 offset:40512
mm a[12:15],v[76:79],v[188:191],a[12:15]
s_waitcnt lgkmcnt(4)
bl v10,s[32:35],s79 offen lds
mm a[16:19],v[80:83],a[176:179],a[16:19]
dt v[64:65],v14 offset:26720
mm a[16:19],v[84:87],v[176:179],a[16:19]
s_add_u32 m0,s71,134144
mm a[20:23],v[80:83],a[180:183],a[20:23]
dt v[66:67],v14 offset:31328
mm a[20:23],v[84:87],v[180:183],a[20:23]
bl v11,s[32:35],s79 offen lds
mm a[24:27],v[80:83],a[184:187],a[24:27]
s_add_u32 m0,s71,135168
dt v[68:69],v14 offset:35936
mm a[24:27],v[84:87],v[184:187],a[24:27]
bl v12,s[32:35],s79 offen lds
mm a[28:31],v[80:83],a[188:191],a[28:31]
dt v[70:71],v14 offset:40544
mm a[28:31],v[84:87],v[188:191],a[28:31]
s_waitcnt lgkmcnt(4)
s_bfe_u32 s82,s81,0x4000c
s_lshl_b32 s82,s82,12
mm a[32:35],v[88:91],a[176:179],a[32:35]
s_add_u32 s82,s82,s68
dt v[72:73],v14 offset:26752
mm a[32:35],v[92:95],v[176:179],a[32:35]
bl a[240:243],v60,s[8:11],s82 offen offset:0 sc1
mm a[36:39],v[88:91],a[180:183],a[36:39]
dt v[74:75],v14 offset:31360
mm a[36:39],v[92:95],v[180:183],a[36:39]
mm a[40:43],v[88:91],a[184:187],a[40:43]
dt v[76:77],v14 offset:35968
mm a[40:43],v[92:95],v[184:187],a[40:43]
bl a[244:247],v61,s[8:11],s82 offen offset:0 sc1
mm a[44:47],v[88:91],a[188:191],a[44:47]
dt v[78:79],v14 offset:40576
mm a[44:47],v[92:95],v[188:191],a[44:47]
s_waitcnt lgkmcnt(4)
bl a[248:251],v62,s[8:11],s82 offen offset:0 sc1
mm a[48:51],v[64:67],a[176:179],a[48:51]
dt v[80:81],v14 offset:26784
mm a[48:51],v[68:71],v[176:179],a[48:51]
mm a[52:55],v[64:67],a[180:183],a[52:55]
dt v[82:83],v14 offset:31392
mm a[52:55],v[68:71],v[180:183],a[52:55]
bl a[252:255],v63,s[8:11],s82 offen offset:0 sc1
mm a[56:59],v[64:67],a[184:187],a[56:59]
dt v[84:85],v14 offset:36000
mm a[56:59],v[68:71],v[184:187],a[56:59]
mm a[60:63],v[64:67],a[188:191],a[60:63]
dt v[86:87],v14 offset:40608
mm a[60:63],v[68:71],v[188:191],a[60:63]
s_waitcnt lgkmcnt(4)
bl v[160:163],v60,s[8:11],s82 offen offset:1024 sc1
mm a[64:67],v[72:75],a[176:179],a[64:67]
dt v[88:89],v14 offset:26816
mm a[64:67],v[76:79],v[176:179],a[64:67]
bl v[164:167],v61,s[8:11],s82 offen offset:1024 sc1
mm a[68:71],v[72:75],a[180:183],a[68:71]
dt v[90:91],v14 offset:31424
mm a[68:71],v[76:79],v[180:183],a[68:71]
mm a[72:75],v[72:75],a[184:187],a[72:75]
dt v[92:93],v14 offset:36032
mm a[72:75],v[76:79],v[184:187],a[72:75]
bl v[168:171],v62,s[8:11],s82 offen offset:1024 sc1
mm a[76:79],v[72:75],a[188:191],a[76:79]
dt v[94:95],v14 offset:40640
mm a[76:79],v[76:79],v[188:191],a[76:79]
s_waitcnt lgkmcnt(4)
mm a[80:83],v[80:83],a[176:179],a[80:83]
dt v[64:65],v14 offset:26848
mm a[80:83],v[84:87],v[176:179],a[80:83]
bl v[172:175],v63,s[8:11],s82 offen offset:1024 sc1
mm a[84:87],v[80:83],a[180:183],a[84:87]
dt v[66:67],v14 offset:31456
mm a[84:87],v[84:87],v[180:183],a[84:87]
bl v[192:195],v60,s[8:11],s82 offen offset:2048 sc1
mm a[88:91],v[80:83],a[184:187],a[88:91]
dt v[68:69],v14 offset:36064
mm a[88:91],v[84:87],v[184:187],a[88:91]
mm a[92:95],v[80:83],a[188:191],a[92:95]
dt v[70:71],v14 offset:40672
mm a[92:95],v[84:87],v[188:191],a[92:95]
s_waitcnt lgkmcnt(4)
bl v[196:199],v61,s[8:11],s82 offen offset:2048 sc1
mm a[96:99],v[88:91],a[176:179],a[96:99]
dt v[72:73],v14 offset:26880
mm a[96:99],v[92:95],v[176:179],a[96:99]
bl v[200:203],v62,s[8:11],s82 offen offset:2048 sc1
mm a[100:103],v[88:91],a[180:183],a[100:103]
dt v[74:75],v14 offset:31488
mm a[100:103],v[92:95],v[180:183],a[100:103]
mm a[104:107],v[88:91],a[184:187],a[104:107]
dt v[76:77],v14 offset:36096
mm a[104:107],v[92:95],v[184:187],a[104:107]
bl v[204:207],v63,s[8:11],s82 offen offset:2048 sc1
mm a[108:111],v[88:91],a[188:191],a[108:111]
dt v[78:79],v14 offset:40704
mm a[108:111],v[92:95],v[188:191],a[108:111]
s_waitcnt lgkmcnt(4)
s_waitcnt lgkmcnt(0)
mm a[112:115],v[64:67],a[176:179],a[112:115]
s_barrier
dt v[80:81],v13 offset:0
mm a[112:115],v[68:71],v[176:179],a[112:115]
bl v[224:227],v60,s[8:11],s82 offen offset:3072 sc1
mm a[116:119],v[64:67],a[180:183],a[116:119]
dt v[82:83],v13 offset:4608
mm a[116:119],v[68:71],v[180:183],a[116:119]
mm a[120:123],v[64:67],a[184:187],a[120:123]
dt v[84:85],v13 offset:9216
mm a[120:123],v[68:71],v[184:187],a[120:123]
bl v[228:231],v61,s[8:11],s82 offen offset:3072 sc1
mm a[124:127],v[64:67],a[188:191],a[124:127]
dt v[86:87],v13 offset:13824
mm a[124:127],v[68:71],v[188:191],a[124:127]
bl v[232:235],v62,s[8:11],s82 offen offset:3072 sc1
mm a[128:131],v[72:75],a[176:179],a[128:131]
dt v[88:89],v13 offset:32
mm a[128:131],v[76:79],v[176:179],a[128:131]
mm a[132:135],v[72:75],a[180:183],a[132:135]
dt v[90:91],v13 offset:4640
mm a[132:135],v[76:79],v[180:183],a[132:135]
bl v[236:239],v63,s[8:11],s82 offen offset:3072 sc1
mm a[136:139],v[72:75],a[184:187],a[136:139]
dt v[92:93],v13 offset:9248
mm a[136:139],v[76:79],v[184:187],a[136:139]
mm a[140:143],v[72:75],a[188:191],a[140:143]
dt v[94:95],v13 offset:13856
mm a[140:143],v[76:79],v[188:191],a[140:143]
s_branch L_p2_join
L_mid:
L_spin_ln:
s_mov_b32 s63,0x40000
L_spin2_ln:
buffer_load_dword v216,v220,s[8:11],s93 offen offset:0 sc1
s_waitcnt vmcnt(0)
v_cmp_ne_u32 vcc,v1,v216
s_sub_u32 s63,s63,1
s_cbranch_scc1 L_ok_ln
s_nop 0
s_cbranch_vccz L_ok_ln
s_sleep 1
s_branch L_spin2_ln
L_spin_fo:
s_mov_b32 s63,0x40000
L_spin2_fo:
buffer_load_dword v0,v56,s[8:11],s73 offen offset:20 sc1
s_waitcnt vmcnt(0)
v_cmp_ne_u32 vcc,v1,v0
s_sub_u32 s63,s63,1
s_cbranch_scc1 L_ok_fo
s_nop 0
s_cbranch_vccz L_ok_fo
s_sleep 1
s_branch L_spin2_fo
L_spin_f1:
s_mov_b32 s63,0x40000
L_spin2_f1:
buffer_load_dword v0,v3,s[8:11],s73 offen offset:16 sc1
s_waitcnt vmcnt(0)
v_cmp_ne_u32 vcc,v1,v0
s_sub_u32 s63,s63,1
s_cbranch_scc1 L_ok_f1
s_nop 0
s_cbranch_vccz L_ok_f1
s_sleep 8
s_branch L_spin2_f1
L_rares1:
s_mov_b32 s60,1
s_branch L_rarebody1
L_rares2:
s_mov_b32 s60,2
s_branch L_rarebody0
L_rares3:
s_mov_b32 s60,3
s_branch L_rarebody1
L_rares4:
s_mov_b32 s60,4
s_branch L_rarebody0
L_rares5:
s_mov_b32 s60,5
s_branch L_rarebody1
L_rares6:
s_mov_b32 s60,6
s_branch L_rarebody0
L_rares7:
s_mov_b32 s60,7
s_branch L_rarebody1
L_rares8:
s_mov_b32 s60,8
s_branch L_rarebody0
L_rares9:
s_mov_b32 s60,9
s_branch L_rarebody1
L_rares10:
s_mov_b32 s60,10
s_branch L_rarebody0
L_rares11:
s_mov_b32 s60,11
s_branch L_rarebody1
L_rares12:
s_mov_b32 s60,12
s_branch L_rarebody0
L_rares13:
s_mov_b32 s60,13
s_branch L_rarebody1
L_rares14:
s_mov_b32 s60,14
s_branch L_rarebody0
L_rares15:
s_mov_b32 s60,15
s_branch L_rarebody1
L_rareg1:
s_mov_b32 s60,17
s_branch L_rarebody1
L_rareg2:
s_mov_b32 s60,18
s_branch L_rarebody0
L_rareg3:
s_mov_b32 s60,19
s_branch L_rarebody1
L_rareg4:
s_mov_b32 s60,20
s_branch L_rarebody0
L_rareg5:
s_mov_b32 s60,21
s_branch L_rarebody1
L_rareg6:
s_mov_b32 s60,22
s_branch L_rarebody0
L_rareg7:
s_mov_b32 s60,23
s_branch L_rarebody1
L_rareg8:
s_mov_b32 s60,24
s_branch L_rarebody0
L_rareg9:
s_mov_b32 s60,25
s_branch L_rarebody1
L_rareg10:
s_mov_b32 s60,26
s_branch L_rarebody0
L_rareg11:
s_mov_b32 s60,27
s_branch L_rarebody1
L_rareg12:
s_mov_b32 s60,28
s_branch L_rarebody0
L_rareg13:
s_mov_b32 s60,29
s_branch L_rarebody1
L_rareg14:
s_mov_b32 s60,30
s_branch L_rarebody0
L_rareg15:
s_mov_b32 s60,31
s_branch L_rarebody1
L_rarebody0:
s_nop 15
v_max3_f32 v40,v224,v225,v226
v_max3_f32 v40,v40,v227,v240
v_max3_f32 v40,v40,v241,v242
v_max_f32 v40,v40,v243
v_max3_f32 v41,v228,v229,v230
v_max3_f32 v41,v41,v231,v244
v_max3_f32 v41,v41,v245,v246
v_max_f32 v41,v41,v247
v_max3_f32 v42,v232,v233,v234
v_max3_f32 v42,v42,v235,v248
v_max3_f32 v42,v42,v249,v250
v_max_f32 v42,v42,v251
v_max3_f32 v43,v236,v237,v238
v_max3_f32 v43,v43,v239,v252
v_max3_f32 v43,v43,v253,v254
v_max_f32 v43,v43,v255
v_mov_b32 v50,v40
v_mov_b32 v51,v41
v_mov_b32 v52,v42
v_mov_b32 v53,v43
v_permlane16_swap_b32 v40,v50
v_permlane16_swap_b32 v41,v51
v_permlane16_swap_b32 v42,v52
v_permlane16_swap_b32 v43,v53
v_max_f32 v40,v40,v50
v_max_f32 v41,v41,v51
v_max_f32 v42,v42,v52
v_max_f32 v43,v43,v53
v_mov_b32 v50,v40
v_mov_b32 v51,v41
v_mov_b32 v52,v42
v_mov_b32 v53,v43
v_permlane32_swap_b32 v40,v50
v_permlane32_swap_b32 v41,v51
v_permlane32_swap_b32 v42,v52
v_permlane32_swap_b32 v43,v53
v_max_f32 v40,v40,v50
v_max_f32 v41,v41,v51
v_max_f32 v42,v42,v52
v_max_f32 v43,v43,v53
v_max_f32 v40,0,v40
v_max_f32 v41,0,v41
v_max_f32 v42,0,v42
v_max_f32 v43,0,v43
v_sub_f32 v44,0,v40
v_sub_f32 v45,0,v41
v_sub_f32 v46,0,v42
v_sub_f32 v47,0,v43
v_exp_f32 v44,v44
v_exp_f32 v45,v45
v_exp_f32 v46,v46
v_exp_f32 v47,v47
v_sub_f32 v80,v80,v40
v_sub_f32 v81,v81,v40
v_sub_f32 v82,v82,v40
v_sub_f32 v83,v83,v40
v_sub_f32 v224,v224,v40
v_sub_f32 v225,v225,v40
v_sub_f32 v226,v226,v40
v_sub_f32 v227,v227,v40
v_sub_f32 v240,v240,v40
v_sub_f32 v241,v241,v40
v_sub_f32 v242,v242,v40
v_sub_f32 v243,v243,v40
v_sub_f32 v112,v112,v40
v_sub_f32 v113,v113,v40
v_sub_f32 v114,v114,v40
v_sub_f32 v115,v115,v40
v_sub_f32 v144,v144,v40
v_sub_f32 v145,v145,v40
v_sub_f32 v146,v146,v40
v_sub_f32 v147,v147,v40
v_mul_f32 v32,v32,v44
ar v48,a0
v_mul_f32 v48,v48,v44
v_accvgpr_write_b32 a0,v48
ar v48,a1
v_mul_f32 v48,v48,v44
v_accvgpr_write_b32 a1,v48
ar v48,a2
v_mul_f32 v48,v48,v44
v_accvgpr_write_b32 a2,v48
ar v48,a3
v_mul_f32 v48,v48,v44
v_accvgpr_write_b32 a3,v48
ar v48,a16
v_mul_f32 v48,v48,v44
v_accvgpr_write_b32 a16,v48
ar v48,a17
v_mul_f32 v48,v48,v44
v_accvgpr_write_b32 a17,v48
ar v48,a18
v_mul_f32 v48,v48,v44
v_accvgpr_write_b32 a18,v48
ar v48,a19
v_mul_f32 v48,v48,v44
v_accvgpr_write_b32 a19,v48
ar v48,a32
v_mul_f32 v48,v48,v44
v_accvgpr_write_b32 a32,v48
ar v48,a33
v_mul_f32 v48,v48,v44
v_accvgpr_write_b32 a33,v48
ar v48,a34
v_mul_f32 v48,v48,v44
v_accvgpr_write_b32 a34,v48
ar v48,a35
v_mul_f32 v48,v48,v44
v_accvgpr_write_b32 a35,v48
ar v48,a48
v_mul_f32 v48,v48,v44
v_accvgpr_write_b32 a48,v48
ar v48,a49
v_mul_f32 v48,v48,v44
v_accvgpr_write_b32 a49,v48
ar v48,a50
v_mul_f32 v48,v48,v44
v_accvgpr_write_b32 a50,v48
ar v48,a51
v_mul_f32 v48,v48,v44
v_accvgpr_write_b32 a51,v48
ar v48,a64
v_mul_f32 v48,v48,v44
v_accvgpr_write_b32 a64,v48
ar v48,a65
v_mul_f32 v48,v48,v44
v_accvgpr_write_b32 a65,v48
ar v48,a66
v_mul_f32 v48,v48,v44
v_accvgpr_write_b32 a66,v48
ar v48,a67
v_mul_f32 v48,v48,v44
v_accvgpr_write_b32 a67,v48
ar v48,a80
v_mul_f32 v48,v48,v44
v_accvgpr_write_b32 a80,v48
ar v48,a81
v_mul_f32 v48,v48,v44
v_accvgpr_write_b32 a81,v48
ar v48,a82
v_mul_f32 v48,v48,v44
v_accvgpr_write_b32 a82,v48
ar v48,a83
v_mul_f32 v48,v48,v44
v_accvgpr_write_b32 a83,v48
ar v48,a96
v_mul_f32 v48,v48,v44
v_accvgpr_write_b32 a96,v48
ar v48,a97
v_mul_f32 v48,v48,v44
v_accvgpr_write_b32 a97,v48
ar v48,a98
v_mul_f32 v48,v48,v44
v_accvgpr_write_b32 a98,v48
ar v48,a99
v_mul_f32 v48,v48,v44
v_accvgpr_write_b32 a99,v48
ar v48,a112
v_mul_f32 v48,v48,v44
v_accvgpr_write_b32 a112,v48
ar v48,a113
v_mul_f32 v48,v48,v44
v_accvgpr_write_b32 a113,v48
ar v48,a114
v_mul_f32 v48,v48,v44
v_accvgpr_write_b32 a114,v48
ar v48,a115
v_mul_f32 v48,v48,v44
v_accvgpr_write_b32 a115,v48
v_sub_f32 v84,v84,v41
v_sub_f32 v85,v85,v41
v_sub_f32 v86,v86,v41
v_sub_f32 v87,v87,v41
v_sub_f32 v228,v228,v41
v_sub_f32 v229,v229,v41
v_sub_f32 v230,v230,v41
v_sub_f32 v231,v231,v41
v_sub_f32 v244,v244,v41
v_sub_f32 v245,v245,v41
v_sub_f32 v246,v246,v41
v_sub_f32 v247,v247,v41
v_sub_f32 v116,v116,v41
v_sub_f32 v117,v117,v41
v_sub_f32 v118,v118,v41
v_sub_f32 v119,v119,v41
v_sub_f32 v148,v148,v41
v_sub_f32 v149,v149,v41
v_sub_f32 v150,v150,v41
v_sub_f32 v151,v151,v41
v_mul_f32 v33,v33,v45
ar v48,a4
v_mul_f32 v48,v48,v45
v_accvgpr_write_b32 a4,v48
ar v48,a5
v_mul_f32 v48,v48,v45
v_accvgpr_write_b32 a5,v48
ar v48,a6
v_mul_f32 v48,v48,v45
v_accvgpr_write_b32 a6,v48
ar v48,a7
v_mul_f32 v48,v48,v45
v_accvgpr_write_b32 a7,v48
ar v48,a20
v_mul_f32 v48,v48,v45
v_accvgpr_write_b32 a20,v48
ar v48,a21
v_mul_f32 v48,v48,v45
v_accvgpr_write_b32 a21,v48
ar v48,a22
v_mul_f32 v48,v48,v45
v_accvgpr_write_b32 a22,v48
ar v48,a23
v_mul_f32 v48,v48,v45
v_accvgpr_write_b32 a23,v48
ar v48,a36
v_mul_f32 v48,v48,v45
v_accvgpr_write_b32 a36,v48
ar v48,a37
v_mul_f32 v48,v48,v45
v_accvgpr_write_b32 a37,v48
ar v48,a38
v_mul_f32 v48,v48,v45
v_accvgpr_write_b32 a38,v48
ar v48,a39
v_mul_f32 v48,v48,v45
v_accvgpr_write_b32 a39,v48
ar v48,a52
v_mul_f32 v48,v48,v45
v_accvgpr_write_b32 a52,v48
ar v48,a53
v_mul_f32 v48,v48,v45
v_accvgpr_write_b32 a53,v48
ar v48,a54
v_mul_f32 v48,v48,v45
v_accvgpr_write_b32 a54,v48
ar v48,a55
v_mul_f32 v48,v48,v45
v_accvgpr_write_b32 a55,v48
ar v48,a68
v_mul_f32 v48,v48,v45
v_accvgpr_write_b32 a68,v48
ar v48,a69
v_mul_f32 v48,v48,v45
v_accvgpr_write_b32 a69,v48
ar v48,a70
v_mul_f32 v48,v48,v45
v_accvgpr_write_b32 a70,v48
ar v48,a71
v_mul_f32 v48,v48,v45
v_accvgpr_write_b32 a71,v48
ar v48,a84
v_mul_f32 v48,v48,v45
v_accvgpr_write_b32 a84,v48
ar v48,a85
v_mul_f32 v48,v48,v45
v_accvgpr_write_b32 a85,v48
ar v48,a86
v_mul_f32 v48,v48,v45
v_accvgpr_write_b32 a86,v48
ar v48,a87
v_mul_f32 v48,v48,v45
v_accvgpr_write_b32 a87,v48
ar v48,a100
v_mul_f32 v48,v48,v45
v_accvgpr_write_b32 a100,v48
ar v48,a101
v_mul_f32 v48,v48,v45
v_accvgpr_write_b32 a101,v48
ar v48,a102
v_mul_f32 v48,v48,v45
v_accvgpr_write_b32 a102,v48
ar v48,a103
v_mul_f32 v48,v48,v45
v_accvgpr_write_b32 a103,v48
ar v48,a116
v_mul_f32 v48,v48,v45
v_accvgpr_write_b32 a116,v48
ar v48,a117
v_mul_f32 v48,v48,v45
v_accvgpr_write_b32 a117,v48
ar v48,a118
v_mul_f32 v48,v48,v45
v_accvgpr_write_b32 a118,v48
ar v48,a119
v_mul_f32 v48,v48,v45
v_accvgpr_write_b32 a119,v48
v_sub_f32 v88,v88,v42
v_sub_f32 v89,v89,v42
v_sub_f32 v90,v90,v42
v_sub_f32 v91,v91,v42
v_sub_f32 v232,v232,v42
v_sub_f32 v233,v233,v42
v_sub_f32 v234,v234,v42
v_sub_f32 v235,v235,v42
v_sub_f32 v248,v248,v42
v_sub_f32 v249,v249,v42
v_sub_f32 v250,v250,v42
v_sub_f32 v251,v251,v42
v_sub_f32 v120,v120,v42
v_sub_f32 v121,v121,v42
v_sub_f32 v122,v122,v42
v_sub_f32 v123,v123,v42
v_sub_f32 v152,v152,v42
v_sub_f32 v153,v153,v42
v_sub_f32 v154,v154,v42
v_sub_f32 v155,v155,v42
v_mul_f32 v34,v34,v46
ar v48,a8
v_mul_f32 v48,v48,v46
v_accvgpr_write_b32 a8,v48
ar v48,a9
v_mul_f32 v48,v48,v46
v_accvgpr_write_b32 a9,v48
ar v48,a10
v_mul_f32 v48,v48,v46
v_accvgpr_write_b32 a10,v48
ar v48,a11
v_mul_f32 v48,v48,v46
v_accvgpr_write_b32 a11,v48
ar v48,a24
v_mul_f32 v48,v48,v46
v_accvgpr_write_b32 a24,v48
ar v48,a25
v_mul_f32 v48,v48,v46
v_accvgpr_write_b32 a25,v48
ar v48,a26
v_mul_f32 v48,v48,v46
v_accvgpr_write_b32 a26,v48
ar v48,a27
v_mul_f32 v48,v48,v46
v_accvgpr_write_b32 a27,v48
ar v48,a40
v_mul_f32 v48,v48,v46
v_accvgpr_write_b32 a40,v48
ar v48,a41
v_mul_f32 v48,v48,v46
v_accvgpr_write_b32 a41,v48
ar v48,a42
v_mul_f32 v48,v48,v46
v_accvgpr_write_b32 a42,v48
ar v48,a43
v_mul_f32 v48,v48,v46
v_accvgpr_write_b32 a43,v48
ar v48,a56
v_mul_f32 v48,v48,v46
v_accvgpr_write_b32 a56,v48
ar v48,a57
v_mul_f32 v48,v48,v46
v_accvgpr_write_b32 a57,v48
ar v48,a58
v_mul_f32 v48,v48,v46
v_accvgpr_write_b32 a58,v48
ar v48,a59
v_mul_f32 v48,v48,v46
v_accvgpr_write_b32 a59,v48
ar v48,a72
v_mul_f32 v48,v48,v46
v_accvgpr_write_b32 a72,v48
ar v48,a73
v_mul_f32 v48,v48,v46
v_accvgpr_write_b32 a73,v48
ar v48,a74
v_mul_f32 v48,v48,v46
v_accvgpr_write_b32 a74,v48
ar v48,a75
v_mul_f32 v48,v48,v46
v_accvgpr_write_b32 a75,v48
ar v48,a88
v_mul_f32 v48,v48,v46
v_accvgpr_write_b32 a88,v48
ar v48,a89
v_mul_f32 v48,v48,v46
v_accvgpr_write_b32 a89,v48
ar v48,a90
v_mul_f32 v48,v48,v46
v_accvgpr_write_b32 a90,v48
ar v48,a91
v_mul_f32 v48,v48,v46
v_accvgpr_write_b32 a91,v48
ar v48,a104
v_mul_f32 v48,v48,v46
v_accvgpr_write_b32 a104,v48
ar v48,a105
v_mul_f32 v48,v48,v46
v_accvgpr_write_b32 a105,v48
ar v48,a106
v_mul_f32 v48,v48,v46
v_accvgpr_write_b32 a106,v48
ar v48,a107
v_mul_f32 v48,v48,v46
v_accvgpr_write_b32 a107,v48
ar v48,a120
v_mul_f32 v48,v48,v46
v_accvgpr_write_b32 a120,v48
ar v48,a121
v_mul_f32 v48,v48,v46
v_accvgpr_write_b32 a121,v48
ar v48,a122
v_mul_f32 v48,v48,v46
v_accvgpr_write_b32 a122,v48
ar v48,a123
v_mul_f32 v48,v48,v46
v_accvgpr_write_b32 a123,v48
v_sub_f32 v92,v92,v43
v_sub_f32 v93,v93,v43
v_sub_f32 v94,v94,v43
v_sub_f32 v95,v95,v43
v_sub_f32 v236,v236,v43
v_sub_f32 v237,v237,v43
v_sub_f32 v238,v238,v43
v_sub_f32 v239,v239,v43
v_sub_f32 v252,v252,v43
v_sub_f32 v253,v253,v43
v_sub_f32 v254,v254,v43
v_sub_f32 v255,v255,v43
v_sub_f32 v124,v124,v43
v_sub_f32 v125,v125,v43
v_sub_f32 v126,v126,v43
v_sub_f32 v127,v127,v43
v_sub_f32 v156,v156,v43
v_sub_f32 v157,v157,v43
v_sub_f32 v158,v158,v43
v_sub_f32 v159,v159,v43
v_mul_f32 v35,v35,v47
ar v48,a12
v_mul_f32 v48,v48,v47
v_accvgpr_write_b32 a12,v48
ar v48,a13
v_mul_f32 v48,v48,v47
v_accvgpr_write_b32 a13,v48
ar v48,a14
v_mul_f32 v48,v48,v47
v_accvgpr_write_b32 a14,v48
ar v48,a15
v_mul_f32 v48,v48,v47
v_accvgpr_write_b32 a15,v48
ar v48,a28
v_mul_f32 v48,v48,v47
v_accvgpr_write_b32 a28,v48
ar v48,a29
v_mul_f32 v48,v48,v47
v_accvgpr_write_b32 a29,v48
ar v48,a30
v_mul_f32 v48,v48,v47
v_accvgpr_write_b32 a30,v48
ar v48,a31
v_mul_f32 v48,v48,v47
v_accvgpr_write_b32 a31,v48
ar v48,a44
v_mul_f32 v48,v48,v47
v_accvgpr_write_b32 a44,v48
ar v48,a45
v_mul_f32 v48,v48,v47
v_accvgpr_write_b32 a45,v48
ar v48,a46
v_mul_f32 v48,v48,v47
v_accvgpr_write_b32 a46,v48
ar v48,a47
v_mul_f32 v48,v48,v47
v_accvgpr_write_b32 a47,v48
ar v48,a60
v_mul_f32 v48,v48,v47
v_accvgpr_write_b32 a60,v48
ar v48,a61
v_mul_f32 v48,v48,v47
v_accvgpr_write_b32 a61,v48
ar v48,a62
v_mul_f32 v48,v48,v47
v_accvgpr_write_b32 a62,v48
ar v48,a63
v_mul_f32 v48,v48,v47
v_accvgpr_write_b32 a63,v48
ar v48,a76
v_mul_f32 v48,v48,v47
v_accvgpr_write_b32 a76,v48
ar v48,a77
v_mul_f32 v48,v48,v47
v_accvgpr_write_b32 a77,v48
ar v48,a78
v_mul_f32 v48,v48,v47
v_accvgpr_write_b32 a78,v48
ar v48,a79
v_mul_f32 v48,v48,v47
v_accvgpr_write_b32 a79,v48
ar v48,a92
v_mul_f32 v48,v48,v47
v_accvgpr_write_b32 a92,v48
ar v48,a93
v_mul_f32 v48,v48,v47
v_accvgpr_write_b32 a93,v48
ar v48,a94
v_mul_f32 v48,v48,v47
v_accvgpr_write_b32 a94,v48
ar v48,a95
v_mul_f32 v48,v48,v47
v_accvgpr_write_b32 a95,v48
ar v48,a108
v_mul_f32 v48,v48,v47
v_accvgpr_write_b32 a108,v48
ar v48,a109
v_mul_f32 v48,v48,v47
v_accvgpr_write_b32 a109,v48
ar v48,a110
v_mul_f32 v48,v48,v47
v_accvgpr_write_b32 a110,v48
ar v48,a111
v_mul_f32 v48,v48,v47
v_accvgpr_write_b32 a111,v48
ar v48,a124
v_mul_f32 v48,v48,v47
v_accvgpr_write_b32 a124,v48
ar v48,a125
v_mul_f32 v48,v48,v47
v_accvgpr_write_b32 a125,v48
ar v48,a126
v_mul_f32 v48,v48,v47
v_accvgpr_write_b32 a126,v48
ar v48,a127
v_mul_f32 v48,v48,v47
v_accvgpr_write_b32 a127,v48
v_exp_f32 v40,v224
v_exp_f32 v41,v225
v_exp_f32 v42,v226
v_exp_f32 v43,v227
v_add_f32 v36,v40,v41
cv v176,v40,v41
v_exp_f32 v44,v240
v_add_f32 v36,v36,v42
v_exp_f32 v45,v241
v_add_f32 v36,v36,v43
cv v177,v42,v43
v_exp_f32 v46,v242
v_add_f32 v36,v36,v44
v_exp_f32 v47,v243
v_add_f32 v36,v36,v45
cv v178,v44,v45
v_exp_f32 v56,v228
v_add_f32 v36,v36,v46
v_exp_f32 v57,v229
v_add_f32 v36,v36,v47
cv v179,v46,v47
v_exp_f32 v58,v230
v_exp_f32 v59,v231
v_add_f32 v37,v56,v57
cv v180,v56,v57
v_exp_f32 v40,v244
v_add_f32 v37,v37,v58
v_exp_f32 v41,v245
v_add_f32 v37,v37,v59
cv v181,v58,v59
v_exp_f32 v42,v246
v_add_f32 v37,v37,v40
v_exp_f32 v43,v247
v_add_f32 v37,v37,v41
cv v182,v40,v41
v_exp_f32 v44,v232
v_add_f32 v37,v37,v42
v_exp_f32 v45,v233
v_add_f32 v37,v37,v43
cv v183,v42,v43
v_exp_f32 v46,v234
v_exp_f32 v47,v235
v_add_f32 v38,v44,v45
cv v184,v44,v45
v_exp_f32 v56,v248
v_add_f32 v38,v38,v46
v_exp_f32 v57,v249
v_add_f32 v38,v38,v47
cv v185,v46,v47
v_exp_f32 v58,v250
v_add_f32 v38,v38,v56
v_exp_f32 v59,v251
v_add_f32 v38,v38,v57
cv v186,v56,v57
v_exp_f32 v40,v236
v_add_f32 v38,v38,v58
v_exp_f32 v41,v237
v_add_f32 v38,v38,v59
cv v187,v58,v59
v_exp_f32 v42,v238
v_exp_f32 v43,v239
v_add_f32 v39,v40,v41
cv v188,v40,v41
v_exp_f32 v44,v252
v_add_f32 v39,v39,v42
v_exp_f32 v45,v253
v_add_f32 v39,v39,v43
cv v189,v42,v43
v_exp_f32 v46,v254
v_add_f32 v39,v39,v44
v_exp_f32 v47,v255
v_add_f32 v39,v39,v45
cv v190,v44,v45
v_add_f32 v39,v39,v46
v_add_f32 v39,v39,v47
cv v191,v46,v47
s_nop 3
s_cmp_eq_u32 s60,2
s_cbranch_scc1 L_backs2
s_cmp_eq_u32 s60,4
s_cbranch_scc1 L_backs4
s_cmp_eq_u32 s60,6
s_cbranch_scc1 L_backs6
s_cmp_eq_u32 s60,8
s_cbranch_scc1 L_backs8
s_cmp_eq_u32 s60,10
s_cbranch_scc1 L_backs10
s_cmp_eq_u32 s60,12
s_cbranch_scc1 L_backs12
s_cmp_eq_u32 s60,14
s_cbranch_scc1 L_backs14
s_cmp_eq_u32 s60,18
s_cbranch_scc1 L_backg2
s_cmp_eq_u32 s60,20
s_cbranch_scc1 L_backg4
s_cmp_eq_u32 s60,22
s_cbranch_scc1 L_backg6
s_cmp_eq_u32 s60,24
s_cbranch_scc1 L_backg8
s_cmp_eq_u32 s60,26
s_cbranch_scc1 L_backg10
s_cmp_eq_u32 s60,28
s_cbranch_scc1 L_backg12
s_cmp_eq_u32 s60,30
s_cbranch_scc1 L_backg14
s_endpgm
L_rarebody1:
s_nop 15
v_max3_f32 v40,v112,v113,v114
v_max3_f32 v40,v40,v115,v144
v_max3_f32 v40,v40,v145,v146
v_max_f32 v40,v40,v147
v_max3_f32 v41,v116,v117,v118
v_max3_f32 v41,v41,v119,v148
v_max3_f32 v41,v41,v149,v150
v_max_f32 v41,v41,v151
v_max3_f32 v42,v120,v121,v122
v_max3_f32 v42,v42,v123,v152
v_max3_f32 v42,v42,v153,v154
v_max_f32 v42,v42,v155
v_max3_f32 v43,v124,v125,v126
v_max3_f32 v43,v43,v127,v156
v_max3_f32 v43,v43,v157,v158
v_max_f32 v43,v43,v159
v_mov_b32 v50,v40
v_mov_b32 v51,v41
v_mov_b32 v52,v42
v_mov_b32 v53,v43
v_permlane16_swap_b32 v40,v50
v_permlane16_swap_b32 v41,v51
v_permlane16_swap_b32 v42,v52
v_permlane16_swap_b32 v43,v53
v_max_f32 v40,v40,v50
v_max_f32 v41,v41,v51
v_max_f32 v42,v42,v52
v_max_f32 v43,v43,v53
v_mov_b32 v50,v40
v_mov_b32 v51,v41
v_mov_b32 v52,v42
v_mov_b32 v53,v43
v_permlane32_swap_b32 v40,v50
v_permlane32_swap_b32 v41,v51
v_permlane32_swap_b32 v42,v52
v_permlane32_swap_b32 v43,v53
v_max_f32 v40,v40,v50
v_max_f32 v41,v41,v51
v_max_f32 v42,v42,v52
v_max_f32 v43,v43,v53
v_max_f32 v40,0,v40
v_max_f32 v41,0,v41
v_max_f32 v42,0,v42
v_max_f32 v43,0,v43
v_sub_f32 v44,0,v40
v_sub_f32 v45,0,v41
v_sub_f32 v46,0,v42
v_sub_f32 v47,0,v43
v_exp_f32 v44,v44
v_exp_f32 v45,v45
v_exp_f32 v46,v46
v_exp_f32 v47,v47
v_sub_f32 v80,v80,v40
v_sub_f32 v81,v81,v40
v_sub_f32 v82,v82,v40
v_sub_f32 v83,v83,v40
v_sub_f32 v224,v224,v40
v_sub_f32 v225,v225,v40
v_sub_f32 v226,v226,v40
v_sub_f32 v227,v227,v40
v_sub_f32 v240,v240,v40
v_sub_f32 v241,v241,v40
v_sub_f32 v242,v242,v40
v_sub_f32 v243,v243,v40
v_sub_f32 v112,v112,v40
v_sub_f32 v113,v113,v40
v_sub_f32 v114,v114,v40
v_sub_f32 v115,v115,v40
v_sub_f32 v144,v144,v40
v_sub_f32 v145,v145,v40
v_sub_f32 v146,v146,v40
v_sub_f32 v147,v147,v40
v_mul_f32 v32,v32,v44
ar v48,a0
v_mul_f32 v48,v48,v44
v_accvgpr_write_b32 a0,v48
ar v48,a1
v_mul_f32 v48,v48,v44
v_accvgpr_write_b32 a1,v48
ar v48,a2
v_mul_f32 v48,v48,v44
v_accvgpr_write_b32 a2,v48
ar v48,a3
v_mul_f32 v48,v48,v44
v_accvgpr_write_b32 a3,v48
ar v48,a16
v_mul_f32 v48,v48,v44
v_accvgpr_write_b32 a16,v48
ar v48,a17
v_mul_f32 v48,v48,v44
v_accvgpr_write_b32 a17,v48
ar v48,a18
v_mul_f32 v48,v48,v44
v_accvgpr_write_b32 a18,v48
ar v48,a19
v_mul_f32 v48,v48,v44
v_accvgpr_write_b32 a19,v48
ar v48,a32
v_mul_f32 v48,v48,v44
v_accvgpr_write_b32 a32,v48
ar v48,a33
v_mul_f32 v48,v48,v44
v_accvgpr_write_b32 a33,v48
ar v48,a34
v_mul_f32 v48,v48,v44
v_accvgpr_write_b32 a34,v48
ar v48,a35
v_mul_f32 v48,v48,v44
v_accvgpr_write_b32 a35,v48
ar v48,a48
v_mul_f32 v48,v48,v44
v_accvgpr_write_b32 a48,v48
ar v48,a49
v_mul_f32 v48,v48,v44
v_accvgpr_write_b32 a49,v48
ar v48,a50
v_mul_f32 v48,v48,v44
v_accvgpr_write_b32 a50,v48
ar v48,a51
v_mul_f32 v48,v48,v44
v_accvgpr_write_b32 a51,v48
ar v48,a64
v_mul_f32 v48,v48,v44
v_accvgpr_write_b32 a64,v48
ar v48,a65
v_mul_f32 v48,v48,v44
v_accvgpr_write_b32 a65,v48
ar v48,a66
v_mul_f32 v48,v48,v44
v_accvgpr_write_b32 a66,v48
ar v48,a67
v_mul_f32 v48,v48,v44
v_accvgpr_write_b32 a67,v48
ar v48,a80
v_mul_f32 v48,v48,v44
v_accvgpr_write_b32 a80,v48
ar v48,a81
v_mul_f32 v48,v48,v44
v_accvgpr_write_b32 a81,v48
ar v48,a82
v_mul_f32 v48,v48,v44
v_accvgpr_write_b32 a82,v48
ar v48,a83
v_mul_f32 v48,v48,v44
v_accvgpr_write_b32 a83,v48
ar v48,a96
v_mul_f32 v48,v48,v44
v_accvgpr_write_b32 a96,v48
ar v48,a97
v_mul_f32 v48,v48,v44
v_accvgpr_write_b32 a97,v48
ar v48,a98
v_mul_f32 v48,v48,v44
v_accvgpr_write_b32 a98,v48
ar v48,a99
v_mul_f32 v48,v48,v44
v_accvgpr_write_b32 a99,v48
ar v48,a112
v_mul_f32 v48,v48,v44
v_accvgpr_write_b32 a112,v48
ar v48,a113
v_mul_f32 v48,v48,v44
v_accvgpr_write_b32 a113,v48
ar v48,a114
v_mul_f32 v48,v48,v44
v_accvgpr_write_b32 a114,v48
ar v48,a115
v_mul_f32 v48,v48,v44
v_accvgpr_write_b32 a115,v48
v_sub_f32 v84,v84,v41
v_sub_f32 v85,v85,v41
v_sub_f32 v86,v86,v41
v_sub_f32 v87,v87,v41
v_sub_f32 v228,v228,v41
v_sub_f32 v229,v229,v41
v_sub_f32 v230,v230,v41
v_sub_f32 v231,v231,v41
v_sub_f32 v244,v244,v41
v_sub_f32 v245,v245,v41
v_sub_f32 v246,v246,v41
v_sub_f32 v247,v247,v41
v_sub_f32 v116,v116,v41
v_sub_f32 v117,v117,v41
v_sub_f32 v118,v118,v41
v_sub_f32 v119,v119,v41
v_sub_f32 v148,v148,v41
v_sub_f32 v149,v149,v41
v_sub_f32 v150,v150,v41
v_sub_f32 v151,v151,v41
v_mul_f32 v33,v33,v45
ar v48,a4
v_mul_f32 v48,v48,v45
v_accvgpr_write_b32 a4,v48
ar v48,a5
v_mul_f32 v48,v48,v45
v_accvgpr_write_b32 a5,v48
ar v48,a6
v_mul_f32 v48,v48,v45
v_accvgpr_write_b32 a6,v48
ar v48,a7
v_mul_f32 v48,v48,v45
v_accvgpr_write_b32 a7,v48
ar v48,a20
v_mul_f32 v48,v48,v45
v_accvgpr_write_b32 a20,v48
ar v48,a21
v_mul_f32 v48,v48,v45
v_accvgpr_write_b32 a21,v48
ar v48,a22
v_mul_f32 v48,v48,v45
v_accvgpr_write_b32 a22,v48
ar v48,a23
v_mul_f32 v48,v48,v45
v_accvgpr_write_b32 a23,v48
ar v48,a36
v_mul_f32 v48,v48,v45
v_accvgpr_write_b32 a36,v48
ar v48,a37
v_mul_f32 v48,v48,v45
v_accvgpr_write_b32 a37,v48
ar v48,a38
v_mul_f32 v48,v48,v45
v_accvgpr_write_b32 a38,v48
ar v48,a39
v_mul_f32 v48,v48,v45
v_accvgpr_write_b32 a39,v48
ar v48,a52
v_mul_f32 v48,v48,v45
v_accvgpr_write_b32 a52,v48
ar v48,a53
v_mul_f32 v48,v48,v45
v_accvgpr_write_b32 a53,v48
ar v48,a54
v_mul_f32 v48,v48,v45
v_accvgpr_write_b32 a54,v48
ar v48,a55
v_mul_f32 v48,v48,v45
v_accvgpr_write_b32 a55,v48
ar v48,a68
v_mul_f32 v48,v48,v45
v_accvgpr_write_b32 a68,v48
ar v48,a69
v_mul_f32 v48,v48,v45
v_accvgpr_write_b32 a69,v48
ar v48,a70
v_mul_f32 v48,v48,v45
v_accvgpr_write_b32 a70,v48
ar v48,a71
v_mul_f32 v48,v48,v45
v_accvgpr_write_b32 a71,v48
ar v48,a84
v_mul_f32 v48,v48,v45
v_accvgpr_write_b32 a84,v48
ar v48,a85
v_mul_f32 v48,v48,v45
v_accvgpr_write_b32 a85,v48
ar v48,a86
v_mul_f32 v48,v48,v45
v_accvgpr_write_b32 a86,v48
ar v48,a87
v_mul_f32 v48,v48,v45
v_accvgpr_write_b32 a87,v48
ar v48,a100
v_mul_f32 v48,v48,v45
v_accvgpr_write_b32 a100,v48
ar v48,a101
v_mul_f32 v48,v48,v45
v_accvgpr_write_b32 a101,v48
ar v48,a102
v_mul_f32 v48,v48,v45
v_accvgpr_write_b32 a102,v48
ar v48,a103
v_mul_f32 v48,v48,v45
v_accvgpr_write_b32 a103,v48
ar v48,a116
v_mul_f32 v48,v48,v45
v_accvgpr_write_b32 a116,v48
ar v48,a117
v_mul_f32 v48,v48,v45
v_accvgpr_write_b32 a117,v48
ar v48,a118
v_mul_f32 v48,v48,v45
v_accvgpr_write_b32 a118,v48
ar v48,a119
v_mul_f32 v48,v48,v45
v_accvgpr_write_b32 a119,v48
v_sub_f32 v88,v88,v42
v_sub_f32 v89,v89,v42
v_sub_f32 v90,v90,v42
v_sub_f32 v91,v91,v42
v_sub_f32 v232,v232,v42
v_sub_f32 v233,v233,v42
v_sub_f32 v234,v234,v42
v_sub_f32 v235,v235,v42
v_sub_f32 v248,v248,v42
v_sub_f32 v249,v249,v42
v_sub_f32 v250,v250,v42
v_sub_f32 v251,v251,v42
v_sub_f32 v120,v120,v42
v_sub_f32 v121,v121,v42
v_sub_f32 v122,v122,v42
v_sub_f32 v123,v123,v42
v_sub_f32 v152,v152,v42
v_sub_f32 v153,v153,v42
v_sub_f32 v154,v154,v42
v_sub_f32 v155,v155,v42
v_mul_f32 v34,v34,v46
ar v48,a8
v_mul_f32 v48,v48,v46
v_accvgpr_write_b32 a8,v48
ar v48,a9
v_mul_f32 v48,v48,v46
v_accvgpr_write_b32 a9,v48
ar v48,a10
v_mul_f32 v48,v48,v46
v_accvgpr_write_b32 a10,v48
ar v48,a11
v_mul_f32 v48,v48,v46
v_accvgpr_write_b32 a11,v48
ar v48,a24
v_mul_f32 v48,v48,v46
v_accvgpr_write_b32 a24,v48
ar v48,a25
v_mul_f32 v48,v48,v46
v_accvgpr_write_b32 a25,v48
ar v48,a26
v_mul_f32 v48,v48,v46
v_accvgpr_write_b32 a26,v48
ar v48,a27
v_mul_f32 v48,v48,v46
v_accvgpr_write_b32 a27,v48
ar v48,a40
v_mul_f32 v48,v48,v46
v_accvgpr_write_b32 a40,v48
ar v48,a41
v_mul_f32 v48,v48,v46
v_accvgpr_write_b32 a41,v48
ar v48,a42
v_mul_f32 v48,v48,v46
v_accvgpr_write_b32 a42,v48
ar v48,a43
v_mul_f32 v48,v48,v46
v_accvgpr_write_b32 a43,v48
ar v48,a56
v_mul_f32 v48,v48,v46
v_accvgpr_write_b32 a56,v48
ar v48,a57
v_mul_f32 v48,v48,v46
v_accvgpr_write_b32 a57,v48
ar v48,a58
v_mul_f32 v48,v48,v46
v_accvgpr_write_b32 a58,v48
ar v48,a59
v_mul_f32 v48,v48,v46
v_accvgpr_write_b32 a59,v48
ar v48,a72
v_mul_f32 v48,v48,v46
v_accvgpr_write_b32 a72,v48
ar v48,a73
v_mul_f32 v48,v48,v46
v_accvgpr_write_b32 a73,v48
ar v48,a74
v_mul_f32 v48,v48,v46
v_accvgpr_write_b32 a74,v48
ar v48,a75
v_mul_f32 v48,v48,v46
v_accvgpr_write_b32 a75,v48
ar v48,a88
v_mul_f32 v48,v48,v46
v_accvgpr_write_b32 a88,v48
ar v48,a89
v_mul_f32 v48,v48,v46
v_accvgpr_write_b32 a89,v48
ar v48,a90
v_mul_f32 v48,v48,v46
v_accvgpr_write_b32 a90,v48
ar v48,a91
v_mul_f32 v48,v48,v46
v_accvgpr_write_b32 a91,v48
ar v48,a104
v_mul_f32 v48,v48,v46
v_accvgpr_write_b32 a104,v48
ar v48,a105
v_mul_f32 v48,v48,v46
v_accvgpr_write_b32 a105,v48
ar v48,a106
v_mul_f32 v48,v48,v46
v_accvgpr_write_b32 a106,v48
ar v48,a107
v_mul_f32 v48,v48,v46
v_accvgpr_write_b32 a107,v48
ar v48,a120
v_mul_f32 v48,v48,v46
v_accvgpr_write_b32 a120,v48
ar v48,a121
v_mul_f32 v48,v48,v46
v_accvgpr_write_b32 a121,v48
ar v48,a122
v_mul_f32 v48,v48,v46
v_accvgpr_write_b32 a122,v48
ar v48,a123
v_mul_f32 v48,v48,v46
v_accvgpr_write_b32 a123,v48
v_sub_f32 v92,v92,v43
v_sub_f32 v93,v93,v43
v_sub_f32 v94,v94,v43
v_sub_f32 v95,v95,v43
v_sub_f32 v236,v236,v43
v_sub_f32 v237,v237,v43
v_sub_f32 v238,v238,v43
v_sub_f32 v239,v239,v43
v_sub_f32 v252,v252,v43
v_sub_f32 v253,v253,v43
v_sub_f32 v254,v254,v43
v_sub_f32 v255,v255,v43
v_sub_f32 v124,v124,v43
v_sub_f32 v125,v125,v43
v_sub_f32 v126,v126,v43
v_sub_f32 v127,v127,v43
v_sub_f32 v156,v156,v43
v_sub_f32 v157,v157,v43
v_sub_f32 v158,v158,v43
v_sub_f32 v159,v159,v43
v_mul_f32 v35,v35,v47
ar v48,a12
v_mul_f32 v48,v48,v47
v_accvgpr_write_b32 a12,v48
ar v48,a13
v_mul_f32 v48,v48,v47
v_accvgpr_write_b32 a13,v48
ar v48,a14
v_mul_f32 v48,v48,v47
v_accvgpr_write_b32 a14,v48
ar v48,a15
v_mul_f32 v48,v48,v47
v_accvgpr_write_b32 a15,v48
ar v48,a28
v_mul_f32 v48,v48,v47
v_accvgpr_write_b32 a28,v48
ar v48,a29
v_mul_f32 v48,v48,v47
v_accvgpr_write_b32 a29,v48
ar v48,a30
v_mul_f32 v48,v48,v47
v_accvgpr_write_b32 a30,v48
ar v48,a31
v_mul_f32 v48,v48,v47
v_accvgpr_write_b32 a31,v48
ar v48,a44
v_mul_f32 v48,v48,v47
v_accvgpr_write_b32 a44,v48
ar v48,a45
v_mul_f32 v48,v48,v47
v_accvgpr_write_b32 a45,v48
ar v48,a46
v_mul_f32 v48,v48,v47
v_accvgpr_write_b32 a46,v48
ar v48,a47
v_mul_f32 v48,v48,v47
v_accvgpr_write_b32 a47,v48
ar v48,a60
v_mul_f32 v48,v48,v47
v_accvgpr_write_b32 a60,v48
ar v48,a61
v_mul_f32 v48,v48,v47
v_accvgpr_write_b32 a61,v48
ar v48,a62
v_mul_f32 v48,v48,v47
v_accvgpr_write_b32 a62,v48
ar v48,a63
v_mul_f32 v48,v48,v47
v_accvgpr_write_b32 a63,v48
ar v48,a76
v_mul_f32 v48,v48,v47
v_accvgpr_write_b32 a76,v48
ar v48,a77
v_mul_f32 v48,v48,v47
v_accvgpr_write_b32 a77,v48
ar v48,a78
v_mul_f32 v48,v48,v47
v_accvgpr_write_b32 a78,v48
ar v48,a79
v_mul_f32 v48,v48,v47
v_accvgpr_write_b32 a79,v48
ar v48,a92
v_mul_f32 v48,v48,v47
v_accvgpr_write_b32 a92,v48
ar v48,a93
v_mul_f32 v48,v48,v47
v_accvgpr_write_b32 a93,v48
ar v48,a94
v_mul_f32 v48,v48,v47
v_accvgpr_write_b32 a94,v48
ar v48,a95
v_mul_f32 v48,v48,v47
v_accvgpr_write_b32 a95,v48
ar v48,a108
v_mul_f32 v48,v48,v47
v_accvgpr_write_b32 a108,v48
ar v48,a109
v_mul_f32 v48,v48,v47
v_accvgpr_write_b32 a109,v48
ar v48,a110
v_mul_f32 v48,v48,v47
v_accvgpr_write_b32 a110,v48
ar v48,a111
v_mul_f32 v48,v48,v47
v_accvgpr_write_b32 a111,v48
ar v48,a124
v_mul_f32 v48,v48,v47
v_accvgpr_write_b32 a124,v48
ar v48,a125
v_mul_f32 v48,v48,v47
v_accvgpr_write_b32 a125,v48
ar v48,a126
v_mul_f32 v48,v48,v47
v_accvgpr_write_b32 a126,v48
ar v48,a127
v_mul_f32 v48,v48,v47
v_accvgpr_write_b32 a127,v48
v_exp_f32 v40,v112
v_exp_f32 v41,v113
v_exp_f32 v42,v114
v_exp_f32 v43,v115
v_add_f32 v36,v40,v41
cv v208,v40,v41
v_exp_f32 v44,v144
v_add_f32 v36,v36,v42
v_exp_f32 v45,v145
v_add_f32 v36,v36,v43
cv v209,v42,v43
v_exp_f32 v46,v146
v_add_f32 v36,v36,v44
v_exp_f32 v47,v147
v_add_f32 v36,v36,v45
cv v210,v44,v45
v_exp_f32 v56,v116
v_add_f32 v36,v36,v46
v_exp_f32 v57,v117
v_add_f32 v36,v36,v47
cv v211,v46,v47
v_exp_f32 v58,v118
v_exp_f32 v59,v119
v_add_f32 v37,v56,v57
cv v212,v56,v57
v_exp_f32 v40,v148
v_add_f32 v37,v37,v58
v_exp_f32 v41,v149
v_add_f32 v37,v37,v59
cv v213,v58,v59
v_exp_f32 v42,v150
v_add_f32 v37,v37,v40
v_exp_f32 v43,v151
v_add_f32 v37,v37,v41
cv v214,v40,v41
v_exp_f32 v44,v120
v_add_f32 v37,v37,v42
v_exp_f32 v45,v121
v_add_f32 v37,v37,v43
cv v215,v42,v43
v_exp_f32 v46,v122
v_exp_f32 v47,v123
v_add_f32 v38,v44,v45
cv v216,v44,v45
v_exp_f32 v56,v152
v_add_f32 v38,v38,v46
v_exp_f32 v57,v153
v_add_f32 v38,v38,v47
cv v217,v46,v47
v_exp_f32 v58,v154
v_add_f32 v38,v38,v56
v_exp_f32 v59,v155
v_add_f32 v38,v38,v57
cv v218,v56,v57
v_exp_f32 v40,v124
v_add_f32 v38,v38,v58
v_exp_f32 v41,v125
v_add_f32 v38,v38,v59
cv v219,v58,v59
v_exp_f32 v42,v126
v_exp_f32 v43,v127
v_add_f32 v39,v40,v41
cv v220,v40,v41
v_exp_f32 v44,v156
v_add_f32 v39,v39,v42
v_exp_f32 v45,v157
v_add_f32 v39,v39,v43
cv v221,v42,v43
v_exp_f32 v46,v158
v_add_f32 v39,v39,v44
v_exp_f32 v47,v159
v_add_f32 v39,v39,v45
cv v222,v44,v45
v_add_f32 v39,v39,v46
v_add_f32 v39,v39,v47
cv v223,v46,v47
s_nop 3
s_cmp_eq_u32 s60,1
s_cbranch_scc1 L_backs1
s_cmp_eq_u32 s60,3
s_cbranch_scc1 L_backs3
s_cmp_eq_u32 s60,5
s_cbranch_scc1 L_backs5
s_cmp_eq_u32 s60,7
s_cbranch_scc1 L_backs7
s_cmp_eq_u32 s60,9
s_cbranch_scc1 L_backs9
s_cmp_eq_u32 s60,11
s_cbranch_scc1 L_backs11
s_cmp_eq_u32 s60,13
s_cbranch_scc1 L_backs13
s_cmp_eq_u32 s60,15
s_cbranch_scc1 L_backs15
s_cmp_eq_u32 s60,17
s_cbranch_scc1 L_backg1
s_cmp_eq_u32 s60,19
s_cbranch_scc1 L_backg3
s_cmp_eq_u32 s60,21
s_cbranch_scc1 L_backg5
s_cmp_eq_u32 s60,23
s_cbranch_scc1 L_backg7
s_cmp_eq_u32 s60,25
s_cbranch_scc1 L_backg9
s_cmp_eq_u32 s60,27
s_cbranch_scc1 L_backg11
s_cmp_eq_u32 s60,29
s_cbranch_scc1 L_backg13
s_cmp_eq_u32 s60,31
s_cbranch_scc1 L_backg15
s_endpgm
L_role_g:
mm v[96:99],v[64:67],a[0:3],0
s_add_u32 m0,s36,49152
s_add_u32 s56,s52,590016
dt v[80:81],v8 offset:12288
mm v[96:99],v[68:71],a[16:19],v[96:99]
bl v4,s[12:15],s56 offen lds
mm v[100:103],v[64:67],a[4:7],0
dt v[82:83],v8 offset:12544
mm v[100:103],v[68:71],a[20:23],v[100:103]
mm v[104:107],v[64:67],a[8:11],0
dt v[84:85],v8 offset:14336
mm v[104:107],v[68:71],a[24:27],v[104:107]
mm v[108:111],v[64:67],a[12:15],0
dt v[86:87],v8 offset:14592
v_mul_f32 v40,s61,v160
mm v[108:111],v[68:71],a[28:31],v[108:111]
s_waitcnt lgkmcnt(4)
v_mul_f32 v41,s61,v161
mm v[112:115],v[72:75],a[0:3],0
dt v[88:89],v9 offset:12288
mm v[112:115],v[76:79],a[16:19],v[112:115]
v_exp_f32 v40,v40
mm v[116:119],v[72:75],a[4:7],0
s_add_u32 m0,s36,53248
dt v[90:91],v9 offset:12544
v_mul_f32 v42,s61,v162
mm v[116:119],v[76:79],a[20:23],v[116:119]
v_exp_f32 v41,v41
mm v[120:123],v[72:75],a[8:11],0
dt v[92:93],v9 offset:14336
v_add_f32 v40,1.0,v40
mm v[120:123],v[76:79],a[24:27],v[120:123]
bl v4,s[16:19],s56 offen lds
mm v[124:127],v[72:75],a[12:15],0
dt v[94:95],v9 offset:14592
v_mul_f32 v48,v160,v192
mm v[124:127],v[76:79],a[28:31],v[124:127]
s_waitcnt lgkmcnt(4)
v_mul_f32 v43,s61,v163
mm v[128:131],v[80:83],a[0:3],0
dt v[64:65],v10 offset:8192
mm v[128:131],v[84:87],a[16:19],v[128:131]
v_exp_f32 v42,v42
mm v[132:135],v[80:83],a[4:7],0
dt v[66:67],v10 offset:8448
mm v[132:135],v[84:87],a[20:23],v[132:135]
v_rcp_f32 v40,v40
mm v[136:139],v[80:83],a[8:11],0
dt v[68:69],v10 offset:10240
v_add_f32 v41,1.0,v41
mm v[136:139],v[84:87],a[24:27],v[136:139]
v_mul_f32 v49,v161,v193
v_mul_f32 v44,s61,v176
mm v[140:143],v[80:83],a[12:15],0
s_add_u32 m0,s36,114688
s_add_u32 s57,s52,1179840
dt v[70:71],v10 offset:10496
mm v[140:143],v[84:87],a[28:31],v[140:143]
s_waitcnt lgkmcnt(4)
v_exp_f32 v43,v43
mm v[144:147],v[88:91],a[0:3],0
dt v[72:73],v11 offset:8192
mm v[144:147],v[92:95],a[16:19],v[144:147]
bl v4,s[12:15],s57 offen lds
mm v[148:151],v[88:91],a[4:7],0
dt v[74:75],v11 offset:8448
mm v[148:151],v[92:95],a[20:23],v[148:151]
v_rcp_f32 v41,v41
mm v[152:155],v[88:91],a[8:11],0
dt v[76:77],v11 offset:10240
v_add_f32 v42,1.0,v42
mm v[152:155],v[92:95],a[24:27],v[152:155]
v_mul_f32 v50,v162,v194
v_mul_f32 v45,s61,v177
mm v[156:159],v[88:91],a[12:15],0
dt v[78:79],v11 offset:10496
mm v[156:159],v[92:95],a[28:31],v[156:159]
s_waitcnt lgkmcnt(4)
v_exp_f32 v44,v44
mm v[96:99],v[64:67],a[32:35],v[96:99]
dt v[80:81],v10 offset:12288
mm v[96:99],v[68:71],a[48:51],v[96:99]
v_rcp_f32 v42,v42
mm v[100:103],v[64:67],a[36:39],v[100:103]
dt v[82:83],v10 offset:12544
v_add_f32 v43,1.0,v43
mm v[100:103],v[68:71],a[52:55],v[100:103]
s_add_u32 m0,s36,118784
v_mul_f32 v51,v163,v195
v_mul_f32 v48,v48,v40
mm v[104:107],v[64:67],a[40:43],v[104:107]
dt v[84:85],v10 offset:14336
v_mul_f32 v46,s61,v178
mm v[104:107],v[68:71],a[56:59],v[104:107]
bl v4,s[16:19],s57 offen lds
mm v[108:111],v[64:67],a[44:47],v[108:111]
dt v[86:87],v10 offset:14592
mm v[108:111],v[68:71],a[60:63],v[108:111]
s_waitcnt lgkmcnt(4)
v_exp_f32 v45,v45
mm v[112:115],v[72:75],a[32:35],v[112:115]
dt v[88:89],v11 offset:12288
v_lshrrev_b32 v32,4,v2
mm v[112:115],v[76:79],a[48:51],v[112:115]
v_rcp_f32 v43,v43
mm v[116:119],v[72:75],a[36:39],v[116:119]
dt v[90:91],v11 offset:12544
v_add_f32 v44,1.0,v44
mm v[116:119],v[76:79],a[52:55],v[116:119]
v_mul_f32 v52,v176,v208
v_mul_f32 v49,v49,v41
mm v[120:123],v[72:75],a[40:43],v[120:123]
dt v[92:93],v11 offset:14336
cv v56,v48,v49
mm v[120:123],v[76:79],a[56:59],v[120:123]
v_mul_f32 v47,s61,v179
v_lshrrev_b32 v33,4,v32
mm v[124:127],v[72:75],a[44:47],v[124:127]
dt v[94:95],v11 offset:14592
v_lshrrev_b32 v39,8,v7
mm v[124:127],v[76:79],a[60:63],v[124:127]
s_waitcnt lgkmcnt(4)
s_add_u32 m0,s36,57344
s_add_u32 s58,s52,1769664
mm v[128:131],v[80:83],a[32:35],v[128:131]
dt v[64:65],v8 offset:16384
v_bfe_u32 v39,v39,4,2
mm v[128:131],v[84:87],a[48:51],v[128:131]
bl v4,s[12:15],s58 offen lds
mm v[132:135],v[80:83],a[36:39],v[132:135]
dt v[66:67],v8 offset:16640
mm v[132:135],v[84:87],a[52:55],v[132:135]
v_exp_f32 v46,v46
mm v[136:139],v[80:83],a[40:43],v[136:139]
dt v[68:69],v8 offset:18432
v_lshl_add_u32 v33,v39,3,v33
mm v[136:139],v[84:87],a[56:59],v[136:139]
v_rcp_f32 v44,v44
mm v[140:143],v[80:83],a[44:47],v[140:143]
dt v[70:71],v8 offset:18688
v_add_f32 v45,1.0,v45
mm v[140:143],v[84:87],a[60:63],v[140:143]
s_waitcnt lgkmcnt(4)
v_mul_f32 v53,v177,v209
v_mul_f32 v50,v50,v42
mm v[144:147],v[88:91],a[32:35],v[144:147]
dt v[72:73],v9 offset:16384
v_and_b32 v34,15,v32
mm v[144:147],v[92:95],a[48:51],v[144:147]
v_exp_f32 v47,v47
mm v[148:151],v[88:91],a[36:39],v[148:151]
dt v[74:75],v9 offset:16640
v_xor_b32 v35,v34,v33
mm v[148:151],v[92:95],a[52:55],v[148:151]
s_add_u32 m0,s36,61440
v_rcp_f32 v45,v45
mm v[152:155],v[88:91],a[40:43],v[152:155]
dt v[76:77],v9 offset:18432
v_add_f32 v46,1.0,v46
mm v[152:155],v[92:95],a[56:59],v[152:155]
bl v4,s[16:19],s58 offen lds
mm v[156:159],v[88:91],a[44:47],v[156:159]
dt v[78:79],v9 offset:18688
v_mul_f32 v54,v178,v210
mm v[156:159],v[92:95],a[60:63],v[156:159]
s_waitcnt lgkmcnt(4)
v_mul_f32 v51,v51,v43
cv v57,v50,v51
mm v[96:99],v[64:67],a[64:67],v[96:99]
dt v[80:81],v8 offset:20480
v_and_b32 v35,15,v35
mm v[96:99],v[68:71],a[80:83],v[96:99]
v_rcp_f32 v46,v46
mm v[100:103],v[64:67],a[68:71],v[100:103]
dt v[82:83],v8 offset:20736
v_add_f32 v47,1.0,v47
mm v[100:103],v[68:71],a[84:87],v[100:103]
v_mul_f32 v55,v179,v211
v_mul_f32 v52,v52,v44
mm v[104:107],v[64:67],a[72:75],v[104:107]
dt v[84:85],v8 offset:22528
mm v[104:107],v[68:71],a[88:91],v[104:107]
v_rcp_f32 v47,v47
mm v[108:111],v[64:67],a[76:79],v[108:111]
dt v[86:87],v8 offset:22784
v_mul_f32 v53,v53,v45
mm v[108:111],v[68:71],a[92:95],v[108:111]
s_waitcnt lgkmcnt(4)
s_add_u32 m0,s36,122880
s_add_u32 s59,s52,2359488
mm v[112:115],v[72:75],a[64:67],v[112:115]
dt v[88:89],v9 offset:20480
cv v58,v52,v53
mm v[112:115],v[76:79],a[80:83],v[112:115]
bl v4,s[12:15],s59 offen lds
mm v[116:119],v[72:75],a[68:71],v[116:119]
dt v[90:91],v9 offset:20736
v_mul_f32 v54,v54,v46
mm v[116:119],v[76:79],a[84:87],v[116:119]
v_mul_f32 v55,v55,v47
cv v59,v54,v55
mm v[120:123],v[72:75],a[72:75],v[120:123]
dt v[92:93],v9 offset:22528
v_lshlrev_b32 v35,4,v35
mm v[120:123],v[76:79],a[88:91],v[120:123]
buffer_store_dwordx4 v[56:59],v2,s[8:11],s42 offen offset:1024 sc1
mm v[124:127],v[72:75],a[76:79],v[124:127]
dt v[94:95],v9 offset:22784
v_mul_f32 v40,s61,v164
mm v[124:127],v[76:79],a[92:95],v[124:127]
s_waitcnt lgkmcnt(4)
v_mul_f32 v41,s61,v165
v_lshl_add_u32 v16,v33,8,v35
mm v[128:131],v[80:83],a[64:67],v[128:131]
dt v[64:65],v10 offset:16384
v_lshrrev_b32 v35,1,v34
mm v[128:131],v[84:87],a[80:83],v[128:131]
v_exp_f32 v40,v40
mm v[132:135],v[80:83],a[68:71],v[132:135]
dt v[66:67],v10 offset:16640
v_mul_f32 v42,s61,v166
mm v[132:135],v[84:87],a[84:87],v[132:135]
v_exp_f32 v41,v41
mm v[136:139],v[80:83],a[72:75],v[136:139]
s_add_u32 m0,s36,126976
dt v[68:69],v10 offset:18432
v_add_f32 v40,1.0,v40
mm v[136:139],v[84:87],a[88:91],v[136:139]
v_mul_f32 v48,v164,v196
v_mul_f32 v43,s61,v167
mm v[140:143],v[80:83],a[76:79],v[140:143]
dt v[70:71],v10 offset:18688
mm v[140:143],v[84:87],a[92:95],v[140:143]
s_waitcnt lgkmcnt(4)
bl v4,s[16:19],s59 offen lds
mm v[144:147],v[88:91],a[64:67],v[144:147]
dt v[72:73],v11 offset:16384
v_xor_b32 v35,v35,v33
mm v[144:147],v[92:95],a[80:83],v[144:147]
v_exp_f32 v42,v42
mm v[148:151],v[88:91],a[68:71],v[148:151]
dt v[74:75],v11 offset:16640
v_and_b32 v35,7,v35
mm v[148:151],v[92:95],a[84:87],v[148:151]
v_rcp_f32 v40,v40
mm v[152:155],v[88:91],a[72:75],v[152:155]
dt v[76:77],v11 offset:18432
v_add_f32 v41,1.0,v41
mm v[152:155],v[92:95],a[88:91],v[152:155]
v_mul_f32 v49,v165,v197
v_mul_f32 v44,s61,v180
mm v[156:159],v[88:91],a[76:79],v[156:159]
dt v[78:79],v11 offset:18688
v_lshlrev_b32 v35,5,v35
mm v[156:159],v[92:95],a[92:95],v[156:159]
s_waitcnt lgkmcnt(4)
v_exp_f32 v43,v43
mm v[96:99],v[64:67],a[96:99],v[96:99]
s_getpc_b64 s[0:1]
L_cpf7:
s_add_u32 s100,s47,4096
s_min_u32 s100,s100,L_code_end-1024-L_cpf7
s_add_u32 s0,s0,s100
s_addc_u32 s1,s1,0
dt v[80:81],v10 offset:20480
v_and_b32 v36,1,v34
mm v[96:99],v[68:71],a[112:115],v[96:99]
v_rcp_f32 v41,v41
mm v[100:103],v[64:67],a[100:103],v[100:103]
dt v[82:83],v10 offset:20736
v_add_f32 v42,1.0,v42
mm v[100:103],v[68:71],a[116:119],v[100:103]
global_load_dword v0,v3,s[0:1]
mm v[104:107],v[64:67],a[104:107],v[104:107]
dt v[84:85],v10 offset:22528
v_mul_f32 v50,v166,v198
mm v[104:107],v[68:71],a[120:123],v[104:107]
v_mul_f32 v45,s61,v181
mm v[108:111],v[64:67],a[108:111],v[108:111]
dt v[86:87],v10 offset:22784
v_lshl_add_u32 v35,v36,4,v35
mm v[108:111],v[68:71],a[124:127],v[108:111]
s_waitcnt lgkmcnt(4)
v_exp_f32 v44,v44
mm v[112:115],v[72:75],a[96:99],v[112:115]
dt v[88:89],v11 offset:20480
v_lshl_add_u32 v18,v33,8,v35
mm v[112:115],v[76:79],a[112:115],v[112:115]
v_rcp_f32 v42,v42
mm v[116:119],v[72:75],a[100:103],v[116:119]
dt v[90:91],v11 offset:20736
v_add_f32 v43,1.0,v43
mm v[116:119],v[76:79],a[116:119],v[116:119]
v_mul_f32 v51,v167,v199
v_mul_f32 v48,v48,v40
mm v[120:123],v[72:75],a[104:107],v[120:123]
dt v[92:93],v11 offset:22528
v_mul_f32 v46,s61,v182
mm v[120:123],v[76:79],a[120:123],v[120:123]
v_exp_f32 v45,v45
v_rcp_f32 v43,v43
mm v[124:127],v[72:75],a[108:111],v[124:127]
dt v[94:95],v11 offset:22784
v_add_f32 v44,1.0,v44
mm v[124:127],v[76:79],a[124:127],v[124:127]
s_waitcnt lgkmcnt(4)
s_waitcnt vmcnt(18)
v_add_u32 v33,4,v33
mm v[128:131],v[80:83],a[96:99],v[128:131]
s_barrier
dt v[64:65],v8 offset:24576
v_mul_f32 v52,v180,v212
mm v[128:131],v[84:87],a[112:115],v[128:131]
s_add_u32 m0,s36,0
s_add_u32 s56,s52,2949312
v_mul_f32 v49,v49,v41
mm v[132:135],v[80:83],a[100:103],v[132:135]
dt v[66:67],v8 offset:24832
cv v60,v48,v49
mm v[132:135],v[84:87],a[116:119],v[132:135]
bl v4,s[12:15],s56 offen lds
mm v[136:139],v[80:83],a[104:107],v[136:139]
dt v[68:69],v8 offset:26624
mm v[136:139],v[84:87],a[120:123],v[136:139]
v_mul_f32 v47,s61,v183
v_xor_b32 v35,v34,v33
mm v[140:143],v[80:83],a[108:111],v[140:143]
dt v[70:71],v8 offset:26880
v_and_b32 v35,15,v35
mm v[140:143],v[84:87],a[124:127],v[140:143]
s_waitcnt lgkmcnt(4)
v_exp_f32 v46,v46
mm v[144:147],v[88:91],a[96:99],v[144:147]
dt v[72:73],v9 offset:24576
v_lshlrev_b32 v35,4,v35
mm v[144:147],v[92:95],a[112:115],v[144:147]
v_rcp_f32 v44,v44
mm v[148:151],v[88:91],a[100:103],v[148:151]
dt v[74:75],v9 offset:24832
v_add_f32 v45,1.0,v45
mm v[148:151],v[92:95],a[116:119],v[148:151]
s_add_u32 m0,s36,4096
v_mul_f32 v53,v181,v213
v_mul_f32 v50,v50,v42
mm v[152:155],v[88:91],a[104:107],v[152:155]
dt v[76:77],v9 offset:26624
v_lshl_add_u32 v17,v33,8,v35
mm v[152:155],v[92:95],a[120:123],v[152:155]
bl v4,s[16:19],s56 offen lds
mm v[156:159],v[88:91],a[108:111],v[156:159]
dt v[78:79],v9 offset:26880
mm v[156:159],v[92:95],a[124:127],v[156:159]
s_waitcnt lgkmcnt(4)
v_exp_f32 v47,v47
mm v[96:99],v[64:67],a[128:131],v[96:99]
dt v[80:81],v8 offset:28672
v_lshrrev_b32 v35,1,v34
mm v[96:99],v[68:71],a[144:147],v[96:99]
v_rcp_f32 v45,v45
mm v[100:103],v[64:67],a[132:135],v[100:103]
dt v[82:83],v8 offset:28928
v_add_f32 v46,1.0,v46
mm v[100:103],v[68:71],a[148:151],v[100:103]
v_mul_f32 v54,v182,v214
v_mul_f32 v51,v51,v43
mm v[104:107],v[64:67],a[136:139],v[104:107]
dt v[84:85],v8 offset:30720
cv v61,v50,v51
mm v[104:107],v[68:71],a[152:155],v[104:107]
v_rcp_f32 v46,v46
mm v[108:111],v[64:67],a[140:143],v[108:111]
dt v[86:87],v8 offset:30976
v_add_f32 v47,1.0,v47
mm v[108:111],v[68:71],a[156:159],v[108:111]
s_waitcnt lgkmcnt(4)
s_add_u32 m0,s36,65536
s_add_u32 s57,s52,3539136
mm v[112:115],v[72:75],a[128:131],v[112:115]
dt v[88:89],v9 offset:28672
v_mul_f32 v55,v183,v215
mm v[112:115],v[76:79],a[144:147],v[112:115]
bl v4,s[12:15],s57 offen lds
mm v[116:119],v[72:75],a[132:135],v[116:119]
dt v[90:91],v9 offset:28928
v_mul_f32 v52,v52,v44
mm v[116:119],v[76:79],a[148:151],v[116:119]
v_rcp_f32 v47,v47
mm v[120:123],v[72:75],a[136:139],v[120:123]
dt v[92:93],v9 offset:30720
v_mul_f32 v53,v53,v45
mm v[120:123],v[76:79],a[152:155],v[120:123]
cv v62,v52,v53
v_xor_b32 v35,v35,v33
mm v[124:127],v[72:75],a[140:143],v[124:127]
dt v[94:95],v9 offset:30976
v_mul_f32 v54,v54,v46
mm v[124:127],v[76:79],a[156:159],v[124:127]
s_waitcnt lgkmcnt(4)
v_mul_f32 v55,v55,v47
cv v63,v54,v55
mm v[128:131],v[80:83],a[128:131],v[128:131]
dt v[64:65],v10 offset:24576
v_and_b32 v35,7,v35
mm v[128:131],v[84:87],a[144:147],v[128:131]
buffer_store_dwordx4 v[60:63],v2,s[8:11],s43 offen offset:1024 sc1
mm v[132:135],v[80:83],a[132:135],v[132:135]
dt v[66:67],v10 offset:24832
v_mul_f32 v40,s61,v168
mm v[132:135],v[84:87],a[148:151],v[132:135]
v_mul_f32 v41,s61,v169
mm v[136:139],v[80:83],a[136:139],v[136:139]
s_add_u32 m0,s36,69632
dt v[68:69],v10 offset:26624
v_lshlrev_b32 v35,5,v35
mm v[136:139],v[84:87],a[152:155],v[136:139]
v_exp_f32 v40,v40
mm v[140:143],v[80:83],a[140:143],v[140:143]
dt v[70:71],v10 offset:26880
v_mul_f32 v42,s61,v170
mm v[140:143],v[84:87],a[156:159],v[140:143]
s_waitcnt lgkmcnt(4)
bl v4,s[16:19],s57 offen lds
mm v[144:147],v[88:91],a[128:131],v[144:147]
dt v[72:73],v11 offset:24576
v_and_b32 v36,1,v34
mm v[144:147],v[92:95],a[144:147],v[144:147]
v_exp_f32 v41,v41
mm v[148:151],v[88:91],a[132:135],v[148:151]
dt v[74:75],v11 offset:24832
v_add_f32 v40,1.0,v40
mm v[148:151],v[92:95],a[148:151],v[148:151]
v_mul_f32 v48,v168,v200
v_mul_f32 v43,s61,v171
mm v[152:155],v[88:91],a[136:139],v[152:155]
dt v[76:77],v11 offset:26624
v_lshl_add_u32 v35,v36,4,v35
mm v[152:155],v[92:95],a[152:155],v[152:155]
v_exp_f32 v42,v42
mm v[156:159],v[88:91],a[140:143],v[156:159]
dt v[78:79],v11 offset:26880
v_lshl_add_u32 v19,v33,8,v35
mm v[156:159],v[92:95],a[156:159],v[156:159]
s_waitcnt lgkmcnt(4)
v_rcp_f32 v40,v40
mm v[96:99],v[64:67],a[160:163],v[96:99]
dt v[80:81],v10 offset:28672
v_add_f32 v41,1.0,v41
mm v[96:99],v[68:71],a[176:179],v[96:99]
s_add_u32 m0,s36,8192
s_add_u32 s58,s52,4128960
v_mul_f32 v49,v169,v201
mm v[100:103],v[64:67],a[164:167],v[100:103]
dt v[82:83],v10 offset:28928
v_mul_f32 v44,s61,v184
mm v[100:103],v[68:71],a[180:183],v[100:103]
bl v4,s[12:15],s58 offen lds
mm v[104:107],v[64:67],a[168:171],v[104:107]
dt v[84:85],v10 offset:30720
mm v[104:107],v[68:71],a[184:187],v[104:107]
v_exp_f32 v43,v43
mm v[108:111],v[64:67],a[172:175],v[108:111]
dt v[86:87],v10 offset:30976
v_lshrrev_b32 v33,4,v32
mm v[108:111],v[68:71],a[188:191],v[108:111]
s_waitcnt lgkmcnt(4)
v_rcp_f32 v41,v41
mm v[112:115],v[72:75],a[160:163],v[112:115]
dt v[88:89],v11 offset:28672
v_add_f32 v42,1.0,v42
mm v[112:115],v[76:79],a[176:179],v[112:115]
v_mul_f32 v50,v170,v202
v_mul_f32 v45,s61,v185
mm v[116:119],v[72:75],a[164:167],v[116:119]
dt v[90:91],v11 offset:28928
v_bfe_u32 v34,v32,2,2
mm v[116:119],v[76:79],a[180:183],v[116:119]
v_exp_f32 v44,v44
mm v[120:123],v[72:75],a[168:171],v[120:123]
dt v[92:93],v11 offset:30720
v_and_b32 v35,3,v32
mm v[120:123],v[76:79],a[184:187],v[120:123]
s_add_u32 m0,s36,12288
v_rcp_f32 v42,v42
mm v[124:127],v[72:75],a[172:175],v[124:127]
dt v[94:95],v11 offset:30976
v_add_f32 v43,1.0,v43
mm v[124:127],v[76:79],a[188:191],v[124:127]
s_waitcnt lgkmcnt(4)
bl v4,s[16:19],s58 offen lds
mm v[128:131],v[80:83],a[160:163],v[128:131]
dt v[64:65],v8 offset:32768
v_mul_f32 v51,v171,v203
mm v[128:131],v[84:87],a[176:179],v[128:131]
v_mul_f32 v48,v48,v40
v_mul_f32 v46,s61,v186
mm v[132:135],v[80:83],a[164:167],v[132:135]
dt v[66:67],v8 offset:33024
mm v[132:135],v[84:87],a[180:183],v[132:135]
v_exp_f32 v45,v45
mm v[136:139],v[80:83],a[168:171],v[136:139]
dt v[68:69],v8 offset:34816
v_and_b32 v37,15,v32
mm v[136:139],v[84:87],a[184:187],v[136:139]
v_rcp_f32 v43,v43
mm v[140:143],v[80:83],a[172:175],v[140:143]
dt v[70:71],v8 offset:35072
v_add_f32 v44,1.0,v44
mm v[140:143],v[84:87],a[188:191],v[140:143]
s_waitcnt lgkmcnt(4)
v_mul_f32 v52,v184,v216
v_mul_f32 v49,v49,v41
mm v[144:147],v[88:91],a[160:163],v[144:147]
dt v[72:73],v9 offset:32768
cv v56,v48,v49
mm v[144:147],v[92:95],a[176:179],v[144:147]
v_mul_f32 v47,s61,v187
v_xor_b32 v38,v33,v37
mm v[148:151],v[88:91],a[164:167],v[148:151]
s_add_u32 m0,s36,73728
s_add_u32 s59,s52,4718784
dt v[74:75],v9 offset:33024
mm v[148:151],v[92:95],a[180:183],v[148:151]
v_exp_f32 v46,v46
mm v[152:155],v[88:91],a[168:171],v[152:155]
dt v[76:77],v9 offset:34816
v_lshlrev_b32 v38,4,v38
mm v[152:155],v[92:95],a[184:187],v[152:155]
bl v4,s[12:15],s59 offen lds
mm v[156:159],v[88:91],a[172:175],v[156:159]
dt v[78:79],v9 offset:35072
v_lshl_add_u32 v38,v37,8,v38
mm v[156:159],v[92:95],a[188:191],v[156:159]
s_waitcnt lgkmcnt(4)
v_rcp_f32 v44,v44
mm v[96:99],v[64:67],a[192:195],v[96:99]
dt v[80:81],v8 offset:36864
v_add_f32 v45,1.0,v45
mm v[96:99],v[68:71],a[208:211],v[96:99]
v_mul_f32 v53,v185,v217
v_mul_f32 v50,v50,v42
mm v[100:103],v[64:67],a[196:199],v[100:103]
dt v[82:83],v8 offset:37120
mm v[100:103],v[68:71],a[212:215],v[100:103]
v_exp_f32 v47,v47
mm v[104:107],v[64:67],a[200:203],v[104:107]
dt v[84:85],v8 offset:38912
v_add_u32 v20,0x10000,v38
mm v[104:107],v[68:71],a[216:219],v[104:107]
v_rcp_f32 v45,v45
mm v[108:111],v[64:67],a[204:207],v[108:111]
dt v[86:87],v8 offset:39168
v_add_f32 v46,1.0,v46
mm v[108:111],v[68:71],a[220:223],v[108:111]
s_waitcnt lgkmcnt(4)
s_add_u32 m0,s36,77824
v_mul_f32 v54,v186,v218
mm v[112:115],v[72:75],a[192:195],v[112:115]
dt v[88:89],v9 offset:36864
v_mul_f32 v51,v51,v43
mm v[112:115],v[76:79],a[208:211],v[112:115]
bl v4,s[16:19],s59 offen lds
mm v[116:119],v[72:75],a[196:199],v[116:119]
dt v[90:91],v9 offset:37120
cv v57,v50,v51
mm v[116:119],v[76:79],a[212:215],v[116:119]
v_rcp_f32 v46,v46
mm v[120:123],v[72:75],a[200:203],v[120:123]
dt v[92:93],v9 offset:38912
v_add_f32 v47,1.0,v47
mm v[120:123],v[76:79],a[216:219],v[120:123]
v_mul_f32 v55,v187,v219
v_xor_b32 v21,64,v20
mm v[124:127],v[72:75],a[204:207],v[124:127]
dt v[94:95],v9 offset:39168
v_mul_f32 v52,v52,v44
mm v[124:127],v[76:79],a[220:223],v[124:127]
s_waitcnt lgkmcnt(4)
v_rcp_f32 v47,v47
mm v[128:131],v[80:83],a[192:195],v[128:131]
dt v[64:65],v10 offset:32768
v_xor_b32 v22,128,v20
mm v[128:131],v[84:87],a[208:211],v[128:131]
v_mul_f32 v53,v53,v45
cv v58,v52,v53
mm v[132:135],v[80:83],a[196:199],v[132:135]
dt v[66:67],v10 offset:33024
v_mul_f32 v54,v54,v46
mm v[132:135],v[84:87],a[212:215],v[132:135]
s_add_u32 m0,s37,16384
s_add_u32 s56,s54,0
mm v[136:139],v[80:83],a[200:203],v[136:139]
dt v[68:69],v10 offset:34816
v_mul_f32 v55,v55,v47
mm v[136:139],v[84:87],a[216:219],v[136:139]
bl v5,s[20:23],s56 offen lds
mm v[140:143],v[80:83],a[204:207],v[140:143]
dt v[70:71],v10 offset:35072
cv v59,v54,v55
mm v[140:143],v[84:87],a[220:223],v[140:143]
s_waitcnt lgkmcnt(4)
buffer_store_dwordx4 v[56:59],v2,s[8:11],s44 offen offset:1024 sc1
mm v[144:147],v[88:91],a[192:195],v[144:147]
dt v[72:73],v11 offset:32768
v_xor_b32 v23,192,v20
mm v[144:147],v[92:95],a[208:211],v[144:147]
v_mul_f32 v40,s61,v172
v_mul_f32 v41,s61,v173
mm v[148:151],v[88:91],a[196:199],v[148:151]
dt v[74:75],v11 offset:33024
v_lshl_add_u32 v36,v33,2,v34
mm v[148:151],v[92:95],a[212:215],v[148:151]
v_exp_f32 v40,v40
mm v[152:155],v[88:91],a[200:203],v[152:155]
dt v[76:77],v11 offset:34816
v_mul_f32 v42,s61,v174
mm v[152:155],v[92:95],a[216:219],v[152:155]
v_exp_f32 v41,v41
mm v[156:159],v[88:91],a[204:207],v[156:159]
dt v[78:79],v11 offset:35072
v_and_b32 v37,7,v36
mm v[156:159],v[92:95],a[220:223],v[156:159]
s_waitcnt lgkmcnt(4)
v_add_f32 v40,1.0,v40
v_mul_f32 v48,v172,v204
mm v[96:99],v[64:67],a[224:227],v[96:99]
s_add_u32 m0,s37,17408
dt v[80:81],v10 offset:36864
v_mul_f32 v43,s61,v175
mm v[96:99],v[68:71],a[240:243],v[96:99]
v_exp_f32 v42,v42
mm v[100:103],v[64:67],a[228:231],v[100:103]
dt v[82:83],v10 offset:37120
v_lshlrev_b32 v37,5,v37
mm v[100:103],v[68:71],a[244:247],v[100:103]
bl v6,s[20:23],s56 offen lds
mm v[104:107],v[64:67],a[232:235],v[104:107]
dt v[84:85],v10 offset:38912
mm v[104:107],v[68:71],a[248:251],v[104:107]
v_rcp_f32 v40,v40
mm v[108:111],v[64:67],a[236:239],v[108:111]
dt v[86:87],v10 offset:39168
v_add_f32 v41,1.0,v41
mm v[108:111],v[68:71],a[252:255],v[108:111]
s_waitcnt lgkmcnt(4)
v_mul_f32 v49,v173,v205
v_mul_f32 v44,s61,v188
mm v[112:115],v[72:75],a[224:227],v[112:115]
dt v[88:89],v11 offset:36864
v_lshl_add_u32 v37,v36,8,v37
mm v[112:115],v[76:79],a[240:243],v[112:115]
v_exp_f32 v43,v43
mm v[116:119],v[72:75],a[228:231],v[116:119]
dt v[90:91],v11 offset:37120
v_lshl_add_u32 v24,v35,3,v37
mm v[116:119],v[76:79],a[244:247],v[116:119]
v_rcp_f32 v41,v41
mm v[120:123],v[72:75],a[232:235],v[120:123]
dt v[92:93],v11 offset:38912
v_add_f32 v42,1.0,v42
mm v[120:123],v[76:79],a[248:251],v[120:123]
v_mul_f32 v50,v174,v206
v_mul_f32 v45,s61,v189
mm v[124:127],v[72:75],a[236:239],v[124:127]
dt v[94:95],v11 offset:39168
v_xor_b32 v25,32,v24
mm v[124:127],v[76:79],a[252:255],v[124:127]
s_waitcnt lgkmcnt(4)
s_waitcnt vmcnt(18)
mm v[128:131],v[80:83],a[224:227],v[128:131]
s_barrier
dt v[64:65],v8 offset:40960
v_xor_b32 v26,64,v24
mm v[128:131],v[84:87],a[240:243],v[128:131]
s_add_u32 m0,s37,81920
s_add_u32 s57,s54,524288
v_xor_b32 v27,96,v24
mm v[132:135],v[80:83],a[228:231],v[132:135]
dt v[66:67],v8 offset:41216
v_xor_b32 v28,128,v24
mm v[132:135],v[84:87],a[244:247],v[132:135]
bl v5,s[20:23],s57 offen lds
mm v[136:139],v[80:83],a[232:235],v[136:139]
dt v[68:69],v8 offset:43008
v_xor_b32 v29,160,v24
mm v[136:139],v[84:87],a[248:251],v[136:139]
v_exp_f32 v44,v44
mm v[140:143],v[80:83],a[236:239],v[140:143]
dt v[70:71],v8 offset:43264
mm v[140:143],v[84:87],a[252:255],v[140:143]
s_waitcnt lgkmcnt(4)
v_rcp_f32 v42,v42
mm v[144:147],v[88:91],a[224:227],v[144:147]
dt v[72:73],v9 offset:40960
v_add_f32 v43,1.0,v43
mm v[144:147],v[92:95],a[240:243],v[144:147]
v_mul_f32 v51,v175,v207
v_mul_f32 v48,v48,v40
mm v[148:151],v[88:91],a[228:231],v[148:151]
dt v[74:75],v9 offset:41216
v_mul_f32 v46,s61,v190
mm v[148:151],v[92:95],a[244:247],v[148:151]
v_exp_f32 v45,v45
mm v[152:155],v[88:91],a[232:235],v[152:155]
dt v[76:77],v9 offset:43008
v_xor_b32 v30,192,v24
mm v[152:155],v[92:95],a[248:251],v[152:155]
v_rcp_f32 v43,v43
mm v[156:159],v[88:91],a[236:239],v[156:159]
s_add_u32 m0,s37,82944
dt v[78:79],v9 offset:43264
v_add_f32 v44,1.0,v44
mm v[156:159],v[92:95],a[252:255],v[156:159]
s_waitcnt lgkmcnt(4)
v_mul_f32 v52,v188,v220
v_mul_f32 v49,v49,v41
mm v[96:99],v[64:67],v[224:227],v[96:99]
dt v[80:81],v8 offset:45056
cv v60,v48,v49
mm v[96:99],v[68:71],v[240:243],v[96:99]
bl v6,s[20:23],s57 offen lds
mm v[100:103],v[64:67],v[228:231],v[100:103]
dt v[82:83],v8 offset:45312
v_mul_f32 v47,s61,v191
mm v[100:103],v[68:71],v[244:247],v[100:103]
v_exp_f32 v46,v46
mm v[104:107],v[64:67],v[232:235],v[104:107]
dt v[84:85],v8 offset:47104
v_xor_b32 v31,224,v24
mm v[104:107],v[68:71],v[248:251],v[104:107]
v_rcp_f32 v44,v44
mm v[108:111],v[64:67],v[236:239],v[108:111]
dt v[86:87],v8 offset:47360
v_add_f32 v45,1.0,v45
mm v[108:111],v[68:71],v[252:255],v[108:111]
s_waitcnt lgkmcnt(4)
v_mul_f32 v53,v189,v221
v_mul_f32 v50,v50,v42
mm v[112:115],v[72:75],v[224:227],v[112:115]
dt v[88:89],v9 offset:45056
v_lshrrev_b32 v39,6,v7
mm v[112:115],v[76:79],v[240:243],v[112:115]
v_exp_f32 v47,v47
mm v[116:119],v[72:75],v[228:231],v[116:119]
dt v[90:91],v9 offset:45312
mm v[116:119],v[76:79],v[244:247],v[116:119]
v_rcp_f32 v45,v45
mm v[120:123],v[72:75],v[232:235],v[120:123]
dt v[92:93],v9 offset:47104
v_add_f32 v46,1.0,v46
mm v[120:123],v[76:79],v[248:251],v[120:123]
v_mul_f32 v54,v190,v222
v_mul_f32 v51,v51,v43
mm v[124:127],v[72:75],v[236:239],v[124:127]
s_add_u32 m0,s37,24576
s_add_u32 s58,s54,1048576
dt v[94:95],v9 offset:47360
mm v[124:127],v[76:79],v[252:255],v[124:127]
s_waitcnt lgkmcnt(4)
cv v61,v50,v51
v_subrev_u32 v39,2048,v39
mm v[128:131],v[80:83],v[224:227],v[128:131]
dt v[64:65],v10 offset:40960
v_min_u32 v39,143,v39
mm v[128:131],v[84:87],v[240:243],v[128:131]
bl v5,s[20:23],s58 offen lds
mm v[132:135],v[80:83],v[228:231],v[132:135]
dt v[66:67],v10 offset:41216
v_lshlrev_b32 v39,13,v39
mm v[132:135],v[84:87],v[244:247],v[132:135]
v_rcp_f32 v46,v46
mm v[136:139],v[80:83],v[232:235],v[136:139]
dt v[68:69],v10 offset:43008
v_add_f32 v47,1.0,v47
mm v[136:139],v[84:87],v[248:251],v[136:139]
v_mul_f32 v55,v191,v223
v_mul_f32 v52,v52,v44
mm v[140:143],v[80:83],v[236:239],v[140:143]
dt v[70:71],v10 offset:43264
mm v[140:143],v[84:87],v[252:255],v[140:143]
s_waitcnt lgkmcnt(4)
v_rcp_f32 v47,v47
mm v[144:147],v[88:91],v[224:227],v[144:147]
dt v[72:73],v11 offset:40960
v_mul_f32 v53,v53,v45
mm v[144:147],v[92:95],v[240:243],v[144:147]
cv v62,v52,v53
v_mul_f32 v54,v54,v46
mm v[148:151],v[88:91],v[228:231],v[148:151]
dt v[74:75],v11 offset:41216
v_mul_f32 v55,v55,v47
mm v[148:151],v[92:95],v[244:247],v[148:151]
cv v63,v54,v55
buffer_store_dwordx4 v[60:63],v2,s[8:11],s45 offen offset:1024 sc1
mm v[152:155],v[88:91],v[232:235],v[152:155]
dt v[76:77],v11 offset:43008
mm v[152:155],v[92:95],v[248:251],v[152:155]
s_add_u32 m0,s37,25600
mm v[156:159],v[88:91],v[236:239],v[156:159]
dt v[78:79],v11 offset:43264
mm v[156:159],v[92:95],v[252:255],v[156:159]
s_waitcnt lgkmcnt(4)
bl v6,s[20:23],s58 offen lds
mm v[160:163],v[64:67],a[0:3],0
dt v[80:81],v10 offset:45056
mm v[160:163],v[68:71],a[16:19],v[160:163]
mm v[164:167],v[64:67],a[4:7],0
dt v[82:83],v10 offset:45312
mm v[164:167],v[68:71],a[20:23],v[164:167]
mm v[168:171],v[64:67],a[8:11],0
dt v[84:85],v10 offset:47104
mm v[168:171],v[68:71],a[24:27],v[168:171]
mm v[172:175],v[64:67],a[12:15],0
dt v[86:87],v10 offset:47360
v_mul_f32 v40,s61,v96
mm v[172:175],v[68:71],a[28:31],v[172:175]
s_waitcnt lgkmcnt(4)
v_mul_f32 v41,s61,v97
mm v[176:179],v[72:75],a[0:3],0
dt v[88:89],v11 offset:45056
mm v[176:179],v[76:79],a[16:19],v[176:179]
v_exp_f32 v40,v40
mm v[180:183],v[72:75],a[4:7],0
dt v[90:91],v11 offset:45312
v_mul_f32 v42,s61,v98
mm v[180:183],v[76:79],a[20:23],v[180:183]
v_exp_f32 v41,v41
mm v[184:187],v[72:75],a[8:11],0
dt v[92:93],v11 offset:47104
v_add_f32 v40,1.0,v40
mm v[184:187],v[76:79],a[24:27],v[184:187]
s_add_u32 m0,s37,90112
s_add_u32 s59,s54,1572864
v_mul_f32 v48,v96,v128
mm v[188:191],v[72:75],a[12:15],0
dt v[94:95],v11 offset:47360
v_mul_f32 v43,s61,v99
mm v[188:191],v[76:79],a[28:31],v[188:191]
s_waitcnt lgkmcnt(4)
bl v5,s[20:23],s59 offen lds
mm v[192:195],v[80:83],a[0:3],0
dt v[64:65],v8 offset:49152
mm v[192:195],v[84:87],a[16:19],v[192:195]
v_exp_f32 v42,v42
mm v[196:199],v[80:83],a[4:7],0
dt v[66:67],v8 offset:49408
mm v[196:199],v[84:87],a[20:23],v[196:199]
v_rcp_f32 v40,v40
mm v[200:203],v[80:83],a[8:11],0
dt v[68:69],v8 offset:51200
v_add_f32 v41,1.0,v41
mm v[200:203],v[84:87],a[24:27],v[200:203]
v_mul_f32 v49,v97,v129
mm v[204:207],v[80:83],a[12:15],0
dt v[70:71],v8 offset:51456
v_mul_f32 v44,s61,v112
mm v[204:207],v[84:87],a[28:31],v[204:207]
s_waitcnt lgkmcnt(4)
v_exp_f32 v43,v43
mm v[208:211],v[88:91],a[0:3],0
dt v[72:73],v9 offset:49152
mm v[208:211],v[92:95],a[16:19],v[208:211]
v_rcp_f32 v41,v41
mm v[212:215],v[88:91],a[4:7],0
dt v[74:75],v9 offset:49408
v_add_f32 v42,1.0,v42
mm v[212:215],v[92:95],a[20:23],v[212:215]
v_mul_f32 v50,v98,v130
mm v[216:219],v[88:91],a[8:11],0
dt v[76:77],v9 offset:51200
v_mul_f32 v45,s61,v113
mm v[216:219],v[92:95],a[24:27],v[216:219]
s_add_u32 m0,s37,91136
v_exp_f32 v44,v44
mm v[220:223],v[88:91],a[12:15],0
dt v[78:79],v9 offset:51456
mm v[220:223],v[92:95],a[28:31],v[220:223]
s_waitcnt lgkmcnt(4)
bl v6,s[20:23],s59 offen lds
mm v[160:163],v[64:67],a[32:35],v[160:163]
dt v[80:81],v8 offset:53248
mm v[160:163],v[68:71],a[48:51],v[160:163]
v_rcp_f32 v42,v42
mm v[164:167],v[64:67],a[36:39],v[164:167]
dt v[82:83],v8 offset:53504
v_add_f32 v43,1.0,v43
mm v[164:167],v[68:71],a[52:55],v[164:167]
v_mul_f32 v51,v99,v131
v_mul_f32 v48,v48,v40
mm v[168:171],v[64:67],a[40:43],v[168:171]
dt v[84:85],v8 offset:55296
v_mul_f32 v46,s61,v114
mm v[168:171],v[68:71],a[56:59],v[168:171]
v_exp_f32 v45,v45
mm v[172:175],v[64:67],a[44:47],v[172:175]
dt v[86:87],v8 offset:55552
mm v[172:175],v[68:71],a[60:63],v[172:175]
s_waitcnt lgkmcnt(4)
v_rcp_f32 v43,v43
mm v[176:179],v[72:75],a[32:35],v[176:179]
dt v[88:89],v9 offset:53248
mm v[176:179],v[76:79],a[48:51],v[176:179]
v_add_f32 v44,1.0,v44
v_mul_f32 v52,v112,v144
mm v[180:183],v[72:75],a[36:39],v[180:183]
dt v[90:91],v9 offset:53504
mm v[180:183],v[76:79],a[52:55],v[180:183]
v_mul_f32 v49,v49,v41
cv v56,v48,v49
mm v[184:187],v[72:75],a[40:43],v[184:187]
dt v[92:93],v9 offset:55296
v_mul_f32 v47,s61,v115
mm v[184:187],v[76:79],a[56:59],v[184:187]
s_add_u32 m0,s37,32768
s_add_u32 s56,s54,2097152
mm v[188:191],v[72:75],a[44:47],v[188:191]
dt v[94:95],v9 offset:55552
mm v[188:191],v[76:79],a[60:63],v[188:191]
s_waitcnt lgkmcnt(4)
bl v5,s[20:23],s56 offen lds
mm v[192:195],v[80:83],a[32:35],v[192:195]
dt v[64:65],v10 offset:49152
mm v[192:195],v[84:87],a[48:51],v[192:195]
v_exp_f32 v46,v46
mm v[196:199],v[80:83],a[36:39],v[196:199]
dt v[66:67],v10 offset:49408
mm v[196:199],v[84:87],a[52:55],v[196:199]
v_rcp_f32 v44,v44
mm v[200:203],v[80:83],a[40:43],v[200:203]
dt v[68:69],v10 offset:51200
v_add_f32 v45,1.0,v45
mm v[200:203],v[84:87],a[56:59],v[200:203]
v_mul_f32 v53,v113,v145
v_mul_f32 v50,v50,v42
mm v[204:207],v[80:83],a[44:47],v[204:207]
dt v[70:71],v10 offset:51456
mm v[204:207],v[84:87],a[60:63],v[204:207]
s_waitcnt lgkmcnt(4)
v_exp_f32 v47,v47
mm v[208:211],v[88:91],a[32:35],v[208:211]
dt v[72:73],v11 offset:49152
mm v[208:211],v[92:95],a[48:51],v[208:211]
v_rcp_f32 v45,v45
mm v[212:215],v[88:91],a[36:39],v[212:215]
dt v[74:75],v11 offset:49408
v_add_f32 v46,1.0,v46
mm v[212:215],v[92:95],a[52:55],v[212:215]
v_mul_f32 v54,v114,v146
v_mul_f32 v51,v51,v43
mm v[216:219],v[88:91],a[40:43],v[216:219]
dt v[76:77],v11 offset:51200
cv v57,v50,v51
mm v[216:219],v[92:95],a[56:59],v[216:219]
s_add_u32 m0,s37,33792
v_rcp_f32 v46,v46
mm v[220:223],v[88:91],a[44:47],v[220:223]
dt v[78:79],v11 offset:51456
v_add_f32 v47,1.0,v47
mm v[220:223],v[92:95],a[60:63],v[220:223]
s_waitcnt lgkmcnt(4)
bl v6,s[20:23],s56 offen lds
mm v[160:163],v[64:67],a[64:67],v[160:163]
dt v[80:81],v10 offset:53248
v_mul_f32 v55,v115,v147
mm v[160:163],v[68:71],a[80:83],v[160:163]
v_mul_f32 v52,v52,v44
mm v[164:167],v[64:67],a[68:71],v[164:167]
dt v[82:83],v10 offset:53504
mm v[164:167],v[68:71],a[84:87],v[164:167]
v_rcp_f32 v47,v47
mm v[168:171],v[64:67],a[72:75],v[168:171]
dt v[84:85],v10 offset:55296
v_mul_f32 v53,v53,v45
mm v[168:171],v[68:71],a[88:91],v[168:171]
cv v58,v52,v53
v_mul_f32 v54,v54,v46
mm v[172:175],v[64:67],a[76:79],v[172:175]
dt v[86:87],v10 offset:55552
mm v[172:175],v[68:71],a[92:95],v[172:175]
s_waitcnt lgkmcnt(4)
v_mul_f32 v55,v55,v47
cv v59,v54,v55
mm v[176:179],v[72:75],a[64:67],v[176:179]
dt v[88:89],v11 offset:53248
mm v[176:179],v[76:79],a[80:83],v[176:179]
buffer_store_dwordx4 v[56:59],v2,s[8:11],s42 offen offset:2048 sc1
mm v[180:183],v[72:75],a[68:71],v[180:183]
dt v[90:91],v11 offset:53504
v_mul_f32 v40,s61,v100
mm v[180:183],v[76:79],a[84:87],v[180:183]
v_mul_f32 v41,s61,v101
mm v[184:187],v[72:75],a[72:75],v[184:187]
dt v[92:93],v11 offset:55296
mm v[184:187],v[76:79],a[88:91],v[184:187]
v_exp_f32 v40,v40
mm v[188:191],v[72:75],a[76:79],v[188:191]
dt v[94:95],v11 offset:55552
v_mul_f32 v42,s61,v102
mm v[188:191],v[76:79],a[92:95],v[188:191]
s_waitcnt lgkmcnt(4)
s_waitcnt vmcnt(17)
mm v[192:195],v[80:83],a[64:67],v[192:195]
s_barrier
dt v[64:65],v8 offset:57344
mm v[192:195],v[84:87],a[80:83],v[192:195]
s_add_u32 m0,s37,98304
s_add_u32 s57,s54,2621440
mm v[196:199],v[80:83],a[68:71],v[196:199]
dt v[66:67],v8 offset:57600
mm v[196:199],v[84:87],a[84:87],v[196:199]
bl v5,s[20:23],s57 offen lds
mm v[200:203],v[80:83],a[72:75],v[200:203]
dt v[68:69],v8 offset:59392
mm v[200:203],v[84:87],a[88:91],v[200:203]
v_exp_f32 v41,v41
mm v[204:207],v[80:83],a[76:79],v[204:207]
dt v[70:71],v8 offset:59648
v_add_f32 v40,1.0,v40
mm v[204:207],v[84:87],a[92:95],v[204:207]
s_waitcnt lgkmcnt(4)
v_mul_f32 v48,v100,v132
v_mul_f32 v43,s61,v103
mm v[208:211],v[88:91],a[64:67],v[208:211]
dt v[72:73],v9 offset:57344
mm v[208:211],v[92:95],a[80:83],v[208:211]
v_exp_f32 v42,v42
mm v[212:215],v[88:91],a[68:71],v[212:215]
dt v[74:75],v9 offset:57600
mm v[212:215],v[92:95],a[84:87],v[212:215]
v_rcp_f32 v40,v40
mm v[216:219],v[88:91],a[72:75],v[216:219]
dt v[76:77],v9 offset:59392
v_add_f32 v41,1.0,v41
mm v[216:219],v[92:95],a[88:91],v[216:219]
v_mul_f32 v49,v101,v133
v_mul_f32 v44,s61,v116
mm v[220:223],v[88:91],a[76:79],v[220:223]
s_add_u32 m0,s37,99328
dt v[78:79],v9 offset:59648
mm v[220:223],v[92:95],a[92:95],v[220:223]
s_waitcnt lgkmcnt(4)
v_exp_f32 v43,v43
mm v[160:163],v[64:67],a[96:99],v[160:163]
dt v[80:81],v8 offset:61440
mm v[160:163],v[68:71],a[112:115],v[160:163]
bl v6,s[20:23],s57 offen lds
mm v[164:167],v[64:67],a[100:103],v[164:167]
dt v[82:83],v8 offset:61696
mm v[164:167],v[68:71],a[116:119],v[164:167]
v_rcp_f32 v41,v41
mm v[168:171],v[64:67],a[104:107],v[168:171]
dt v[84:85],v8 offset:63488
v_add_f32 v42,1.0,v42
mm v[168:171],v[68:71],a[120:123],v[168:171]
v_mul_f32 v50,v102,v134
v_mul_f32 v45,s61,v117
mm v[172:175],v[64:67],a[108:111],v[172:175]
dt v[86:87],v8 offset:63744
mm v[172:175],v[68:71],a[124:127],v[172:175]
s_waitcnt lgkmcnt(4)
v_exp_f32 v44,v44
mm v[176:179],v[72:75],a[96:99],v[176:179]
dt v[88:89],v9 offset:61440
mm v[176:179],v[76:79],a[112:115],v[176:179]
v_rcp_f32 v42,v42
mm v[180:183],v[72:75],a[100:103],v[180:183]
dt v[90:91],v9 offset:61696
v_add_f32 v43,1.0,v43
mm v[180:183],v[76:79],a[116:119],v[180:183]
v_mul_f32 v51,v103,v135
v_mul_f32 v48,v48,v40
mm v[184:187],v[72:75],a[104:107],v[184:187]
dt v[92:93],v9 offset:63488
v_mul_f32 v46,s61,v118
mm v[184:187],v[76:79],a[120:123],v[184:187]
v_exp_f32 v45,v45
mm v[188:191],v[72:75],a[108:111],v[188:191]
s_add_u32 m0,s37,40960
s_add_u32 s58,s54,3145728
dt v[94:95],v9 offset:63744
mm v[188:191],v[76:79],a[124:127],v[188:191]
s_waitcnt lgkmcnt(4)
v_rcp_f32 v43,v43
mm v[192:195],v[80:83],a[96:99],v[192:195]
dt v[64:65],v10 offset:57344
v_add_f32 v44,1.0,v44
mm v[192:195],v[84:87],a[112:115],v[192:195]
bl v5,s[20:23],s58 offen lds
mm v[196:199],v[80:83],a[100:103],v[196:199]
dt v[66:67],v10 offset:57600
v_mul_f32 v52,v116,v148
mm v[196:199],v[84:87],a[116:119],v[196:199]
v_mul_f32 v49,v49,v41
cv v60,v48,v49
mm v[200:203],v[80:83],a[104:107],v[200:203]
dt v[68:69],v10 offset:59392
v_mul_f32 v47,s61,v119
mm v[200:203],v[84:87],a[120:123],v[200:203]
v_exp_f32 v46,v46
mm v[204:207],v[80:83],a[108:111],v[204:207]
dt v[70:71],v10 offset:59648
mm v[204:207],v[84:87],a[124:127],v[204:207]
s_waitcnt lgkmcnt(4)
v_rcp_f32 v44,v44
mm v[208:211],v[88:91],a[96:99],v[208:211]
dt v[72:73],v11 offset:57344
v_add_f32 v45,1.0,v45
mm v[208:211],v[92:95],a[112:115],v[208:211]
v_mul_f32 v53,v117,v149
v_mul_f32 v50,v50,v42
mm v[212:215],v[88:91],a[100:103],v[212:215]
dt v[74:75],v11 offset:57600
mm v[212:215],v[92:95],a[116:119],v[212:215]
v_exp_f32 v47,v47
mm v[216:219],v[88:91],a[104:107],v[216:219]
dt v[76:77],v11 offset:59392
mm v[216:219],v[92:95],a[120:123],v[216:219]
s_add_u32 m0,s37,41984
v_rcp_f32 v45,v45
mm v[220:223],v[88:91],a[108:111],v[220:223]
dt v[78:79],v11 offset:59648
v_add_f32 v46,1.0,v46
mm v[220:223],v[92:95],a[124:127],v[220:223]
s_waitcnt lgkmcnt(4)
bl v6,s[20:23],s58 offen lds
mm v[160:163],v[64:67],a[128:131],v[160:163]
dt v[80:81],v10 offset:61440
v_mul_f32 v54,v118,v150
mm v[160:163],v[68:71],a[144:147],v[160:163]
v_mul_f32 v51,v51,v43
mm v[164:167],v[64:67],a[132:135],v[164:167]
dt v[82:83],v10 offset:61696
cv v61,v50,v51
mm v[164:167],v[68:71],a[148:151],v[164:167]
v_rcp_f32 v46,v46
mm v[168:171],v[64:67],a[136:139],v[168:171]
dt v[84:85],v10 offset:63488
mm v[168:171],v[68:71],a[152:155],v[168:171]
v_add_f32 v47,1.0,v47
v_mul_f32 v55,v119,v151
mm v[172:175],v[64:67],a[140:143],v[172:175]
dt v[86:87],v10 offset:63744
v_mul_f32 v52,v52,v44
mm v[172:175],v[68:71],a[156:159],v[172:175]
s_waitcnt lgkmcnt(4)
v_rcp_f32 v47,v47
mm v[176:179],v[72:75],a[128:131],v[176:179]
dt v[88:89],v11 offset:61440
mm v[176:179],v[76:79],a[144:147],v[176:179]
v_mul_f32 v53,v53,v45
mm v[180:183],v[72:75],a[132:135],v[180:183]
dt v[90:91],v11 offset:61696
cv v62,v52,v53
mm v[180:183],v[76:79],a[148:151],v[180:183]
v_mul_f32 v54,v54,v46
v_mul_f32 v55,v55,v47
mm v[184:187],v[72:75],a[136:139],v[184:187]
dt v[92:93],v11 offset:63488
mm v[184:187],v[76:79],a[152:155],v[184:187]
s_add_u32 m0,s37,106496
s_add_u32 s59,s54,3670016
cv v63,v54,v55
mm v[188:191],v[72:75],a[140:143],v[188:191]
dt v[94:95],v11 offset:63744
mm v[188:191],v[76:79],a[156:159],v[188:191]
s_waitcnt lgkmcnt(4)
bl v5,s[20:23],s59 offen lds
mm v[192:195],v[80:83],a[128:131],v[192:195]
dt v[64:65],v8 offset:0
mm v[192:195],v[84:87],a[144:147],v[192:195]
buffer_store_dwordx4 v[60:63],v2,s[8:11],s43 offen offset:2048 sc1
mm v[196:199],v[80:83],a[132:135],v[196:199]
dt v[66:67],v8 offset:256
v_mul_f32 v40,s61,v104
mm v[196:199],v[84:87],a[148:151],v[196:199]
v_mul_f32 v41,s61,v105
mm v[200:203],v[80:83],a[136:139],v[200:203]
dt v[68:69],v8 offset:2048
mm v[200:203],v[84:87],a[152:155],v[200:203]
v_exp_f32 v40,v40
mm v[204:207],v[80:83],a[140:143],v[204:207]
dt v[70:71],v8 offset:2304
v_mul_f32 v42,s61,v106
mm v[204:207],v[84:87],a[156:159],v[204:207]
s_waitcnt lgkmcnt(4)
v_exp_f32 v41,v41
mm v[208:211],v[88:91],a[128:131],v[208:211]
dt v[72:73],v9 offset:0
v_add_f32 v40,1.0,v40
mm v[208:211],v[92:95],a[144:147],v[208:211]
v_mul_f32 v48,v104,v136
v_mul_f32 v43,s61,v107
mm v[212:215],v[88:91],a[132:135],v[212:215]
dt v[74:75],v9 offset:256
mm v[212:215],v[92:95],a[148:151],v[212:215]
v_exp_f32 v42,v42
mm v[216:219],v[88:91],a[136:139],v[216:219]
dt v[76:77],v9 offset:2048
mm v[216:219],v[92:95],a[152:155],v[216:219]
s_add_u32 m0,s37,107520
v_rcp_f32 v40,v40
mm v[220:223],v[88:91],a[140:143],v[220:223]
dt v[78:79],v9 offset:2304
v_add_f32 v41,1.0,v41
mm v[220:223],v[92:95],a[156:159],v[220:223]
s_waitcnt lgkmcnt(4)
bl v6,s[20:23],s59 offen lds
mm v[160:163],v[64:67],a[160:163],v[160:163]
dt v[80:81],v8 offset:4096
v_mul_f32 v49,v105,v137
mm v[160:163],v[68:71],a[176:179],v[160:163]
v_mul_f32 v44,s61,v120
mm v[164:167],v[64:67],a[164:167],v[164:167]
dt v[82:83],v8 offset:4352
mm v[164:167],v[68:71],a[180:183],v[164:167]
v_exp_f32 v43,v43
mm v[168:171],v[64:67],a[168:171],v[168:171]
dt v[84:85],v8 offset:6144
mm v[168:171],v[68:71],a[184:187],v[168:171]
v_rcp_f32 v41,v41
mm v[172:175],v[64:67],a[172:175],v[172:175]
dt v[86:87],v8 offset:6400
v_add_f32 v42,1.0,v42
mm v[172:175],v[68:71],a[188:191],v[172:175]
s_waitcnt lgkmcnt(4)
v_mul_f32 v50,v106,v138
v_mul_f32 v45,s61,v121
mm v[176:179],v[72:75],a[160:163],v[176:179]
dt v[88:89],v9 offset:4096
mm v[176:179],v[76:79],a[176:179],v[176:179]
v_exp_f32 v44,v44
mm v[180:183],v[72:75],a[164:167],v[180:183]
dt v[90:91],v9 offset:4352
mm v[180:183],v[76:79],a[180:183],v[180:183]
v_rcp_f32 v42,v42
mm v[184:187],v[72:75],a[168:171],v[184:187]
dt v[92:93],v9 offset:6144
v_add_f32 v43,1.0,v43
mm v[184:187],v[76:79],a[184:187],v[184:187]
s_add_u32 m0,s37,49152
s_add_u32 s56,s54,4194304
v_mul_f32 v51,v107,v139
mm v[188:191],v[72:75],a[172:175],v[188:191]
dt v[94:95],v9 offset:6400
v_mul_f32 v48,v48,v40
mm v[188:191],v[76:79],a[188:191],v[188:191]
s_waitcnt lgkmcnt(4)
bl v5,s[20:23],s56 offen lds
mm v[192:195],v[80:83],a[160:163],v[192:195]
dt v[64:65],v10 offset:0
v_mul_f32 v46,s61,v122
mm v[192:195],v[84:87],a[176:179],v[192:195]
v_exp_f32 v45,v45
mm v[196:199],v[80:83],a[164:167],v[196:199]
dt v[66:67],v10 offset:256
mm v[196:199],v[84:87],a[180:183],v[196:199]
v_rcp_f32 v43,v43
mm v[200:203],v[80:83],a[168:171],v[200:203]
dt v[68:69],v10 offset:2048
v_add_f32 v44,1.0,v44
mm v[200:203],v[84:87],a[184:187],v[200:203]
v_mul_f32 v52,v120,v152
mm v[204:207],v[80:83],a[172:175],v[204:207]
dt v[70:71],v10 offset:2304
v_mul_f32 v49,v49,v41
mm v[204:207],v[84:87],a[188:191],v[204:207]
s_waitcnt lgkmcnt(4)
cv v56,v48,v49
v_mul_f32 v47,s61,v123
mm v[208:211],v[88:91],a[160:163],v[208:211]
dt v[72:73],v11 offset:0
mm v[208:211],v[92:95],a[176:179],v[208:211]
v_exp_f32 v46,v46
mm v[212:215],v[88:91],a[164:167],v[212:215]
dt v[74:75],v11 offset:256
mm v[212:215],v[92:95],a[180:183],v[212:215]
v_rcp_f32 v44,v44
mm v[216:219],v[88:91],a[168:171],v[216:219]
dt v[76:77],v11 offset:2048
v_add_f32 v45,1.0,v45
mm v[216:219],v[92:95],a[184:187],v[216:219]
s_add_u32 m0,s37,50176
v_mul_f32 v53,v121,v153
mm v[220:223],v[88:91],a[172:175],v[220:223]
dt v[78:79],v11 offset:2304
v_mul_f32 v50,v50,v42
mm v[220:223],v[92:95],a[188:191],v[220:223]
s_waitcnt lgkmcnt(4)
bl v6,s[20:23],s56 offen lds
mm v[160:163],v[64:67],a[192:195],v[160:163]
dt v[80:81],v10 offset:4096
mm v[160:163],v[68:71],a[208:211],v[160:163]
v_exp_f32 v47,v47
mm v[164:167],v[64:67],a[196:199],v[164:167]
dt v[82:83],v10 offset:4352
mm v[164:167],v[68:71],a[212:215],v[164:167]
v_rcp_f32 v45,v45
mm v[168:171],v[64:67],a[200:203],v[168:171]
dt v[84:85],v10 offset:6144
v_add_f32 v46,1.0,v46
mm v[168:171],v[68:71],a[216:219],v[168:171]
v_mul_f32 v54,v122,v154
v_mul_f32 v51,v51,v43
mm v[172:175],v[64:67],a[204:207],v[172:175]
dt v[86:87],v10 offset:6400
cv v57,v50,v51
mm v[172:175],v[68:71],a[220:223],v[172:175]
s_waitcnt lgkmcnt(4)
v_rcp_f32 v46,v46
mm v[176:179],v[72:75],a[192:195],v[176:179]
dt v[88:89],v11 offset:4096
mm v[176:179],v[76:79],a[208:211],v[176:179]
v_add_f32 v47,1.0,v47
v_mul_f32 v55,v123,v155
mm v[180:183],v[72:75],a[196:199],v[180:183]
dt v[90:91],v11 offset:4352
mm v[180:183],v[76:79],a[212:215],v[180:183]
v_mul_f32 v52,v52,v44
mm v[184:187],v[72:75],a[200:203],v[184:187]
dt v[92:93],v11 offset:6144
mm v[184:187],v[76:79],a[216:219],v[184:187]
v_rcp_f32 v47,v47
mm v[188:191],v[72:75],a[204:207],v[188:191]
dt v[94:95],v11 offset:6400
v_mul_f32 v53,v53,v45
mm v[188:191],v[76:79],a[220:223],v[188:191]
s_waitcnt lgkmcnt(4)
s_waitcnt vmcnt(17)
cv v58,v52,v53
mm v[192:195],v[80:83],a[192:195],v[192:195]
s_barrier
dt v[64:65],v8 offset:8192
v_mul_f32 v54,v54,v46
mm v[192:195],v[84:87],a[208:211],v[192:195]
s_add_u32 m0,s37,114688
s_add_u32 s57,s54,128
v_mul_f32 v55,v55,v47
mm v[196:199],v[80:83],a[196:199],v[196:199]
dt v[66:67],v8 offset:8448
cv v59,v54,v55
mm v[196:199],v[84:87],a[212:215],v[196:199]
bl v5,s[20:23],s57 offen lds
mm v[200:203],v[80:83],a[200:203],v[200:203]
dt v[68:69],v8 offset:10240
mm v[200:203],v[84:87],a[216:219],v[200:203]
buffer_store_dwordx4 v[56:59],v2,s[8:11],s44 offen offset:2048 sc1
mm v[204:207],v[80:83],a[204:207],v[204:207]
dt v[70:71],v8 offset:10496
v_mul_f32 v40,s61,v108
mm v[204:207],v[84:87],a[220:223],v[204:207]
s_waitcnt lgkmcnt(4)
v_mul_f32 v41,s61,v109
mm v[208:211],v[88:91],a[192:195],v[208:211]
dt v[72:73],v9 offset:8192
mm v[208:211],v[92:95],a[208:211],v[208:211]
v_exp_f32 v40,v40
mm v[212:215],v[88:91],a[196:199],v[212:215]
dt v[74:75],v9 offset:8448
v_mul_f32 v42,s61,v110
mm v[212:215],v[92:95],a[212:215],v[212:215]
v_exp_f32 v41,v41
mm v[216:219],v[88:91],a[200:203],v[216:219]
s_add_u32 m0,s37,115712
dt v[76:77],v9 offset:10240
v_add_f32 v40,1.0,v40
mm v[216:219],v[92:95],a[216:219],v[216:219]
v_mul_f32 v48,v108,v140
mm v[220:223],v[88:91],a[204:207],v[220:223]
dt v[78:79],v9 offset:10496
v_mul_f32 v43,s61,v111
mm v[220:223],v[92:95],a[220:223],v[220:223]
s_waitcnt lgkmcnt(4)
bl v6,s[20:23],s57 offen lds
mm v[160:163],v[64:67],a[224:227],v[160:163]
dt v[80:81],v8 offset:12288
mm v[160:163],v[68:71],a[240:243],v[160:163]
v_exp_f32 v42,v42
mm v[164:167],v[64:67],a[228:231],v[164:167]
dt v[82:83],v8 offset:12544
mm v[164:167],v[68:71],a[244:247],v[164:167]
v_rcp_f32 v40,v40
mm v[168:171],v[64:67],a[232:235],v[168:171]
dt v[84:85],v8 offset:14336
v_add_f32 v41,1.0,v41
mm v[168:171],v[68:71],a[248:251],v[168:171]
v_mul_f32 v49,v109,v141
v_mul_f32 v44,s61,v124
mm v[172:175],v[64:67],a[236:239],v[172:175]
dt v[86:87],v8 offset:14592
mm v[172:175],v[68:71],a[252:255],v[172:175]
s_waitcnt lgkmcnt(4)
v_exp_f32 v43,v43
mm v[176:179],v[72:75],a[224:227],v[176:179]
dt v[88:89],v9 offset:12288
mm v[176:179],v[76:79],a[240:243],v[176:179]
v_rcp_f32 v41,v41
mm v[180:183],v[72:75],a[228:231],v[180:183]
s_add_u32 m0,s37,57344
s_add_u32 s58,s54,524416
dt v[90:91],v9 offset:12544
mm v[180:183],v[76:79],a[244:247],v[180:183]
v_add_f32 v42,1.0,v42
v_mul_f32 v50,v110,v142
mm v[184:187],v[72:75],a[232:235],v[184:187]
dt v[92:93],v9 offset:14336
v_mul_f32 v45,s61,v125
mm v[184:187],v[76:79],a[248:251],v[184:187]
bl v5,s[20:23],s58 offen lds
mm v[188:191],v[72:75],a[236:239],v[188:191]
dt v[94:95],v9 offset:14592
mm v[188:191],v[76:79],a[252:255],v[188:191]
s_waitcnt lgkmcnt(4)
v_exp_f32 v44,v44
mm v[192:195],v[80:83],a[224:227],v[192:195]
dt v[64:65],v10 offset:8192
mm v[192:195],v[84:87],a[240:243],v[192:195]
v_rcp_f32 v42,v42
mm v[196:199],v[80:83],a[228:231],v[196:199]
dt v[66:67],v10 offset:8448
v_add_f32 v43,1.0,v43
mm v[196:199],v[84:87],a[244:247],v[196:199]
v_mul_f32 v51,v111,v143
mm v[200:203],v[80:83],a[232:235],v[200:203]
dt v[68:69],v10 offset:10240
v_mul_f32 v48,v48,v40
mm v[200:203],v[84:87],a[248:251],v[200:203]
v_mul_f32 v46,s61,v126
mm v[204:207],v[80:83],a[236:239],v[204:207]
dt v[70:71],v10 offset:10496
mm v[204:207],v[84:87],a[252:255],v[204:207]
s_waitcnt lgkmcnt(4)
v_exp_f32 v45,v45
mm v[208:211],v[88:91],a[224:227],v[208:211]
s_add_u32 m0,s37,58368
dt v[72:73],v11 offset:8192
mm v[208:211],v[92:95],a[240:243],v[208:211]
v_rcp_f32 v43,v43
mm v[212:215],v[88:91],a[228:231],v[212:215]
dt v[74:75],v11 offset:8448
v_add_f32 v44,1.0,v44
mm v[212:215],v[92:95],a[244:247],v[212:215]
bl v6,s[20:23],s58 offen lds
mm v[216:219],v[88:91],a[232:235],v[216:219]
dt v[76:77],v11 offset:10240
v_mul_f32 v52,v124,v156
mm v[216:219],v[92:95],a[248:251],v[216:219]
v_mul_f32 v49,v49,v41
cv v60,v48,v49
mm v[220:223],v[88:91],a[236:239],v[220:223]
dt v[78:79],v11 offset:10496
v_mul_f32 v47,s61,v127
mm v[220:223],v[92:95],a[252:255],v[220:223]
s_waitcnt lgkmcnt(4)
v_exp_f32 v46,v46
mm v[160:163],v[64:67],v[224:227],v[160:163]
dt v[80:81],v10 offset:12288
mm v[160:163],v[68:71],v[240:243],v[160:163]
v_rcp_f32 v44,v44
mm v[164:167],v[64:67],v[228:231],v[164:167]
dt v[82:83],v10 offset:12544
v_add_f32 v45,1.0,v45
mm v[164:167],v[68:71],v[244:247],v[164:167]
v_mul_f32 v53,v125,v157
mm v[168:171],v[64:67],v[232:235],v[168:171]
dt v[84:85],v10 offset:14336
v_mul_f32 v50,v50,v42
mm v[168:171],v[68:71],v[248:251],v[168:171]
v_exp_f32 v47,v47
mm v[172:175],v[64:67],v[236:239],v[172:175]
s_add_u32 m0,s37,122880
s_add_u32 s59,s54,1048704
dt v[86:87],v10 offset:14592
mm v[172:175],v[68:71],v[252:255],v[172:175]
s_waitcnt lgkmcnt(4)
v_rcp_f32 v45,v45
mm v[176:179],v[72:75],v[224:227],v[176:179]
dt v[88:89],v11 offset:12288
mm v[176:179],v[76:79],v[240:243],v[176:179]
bl v5,s[20:23],s59 offen lds
mm v[180:183],v[72:75],v[228:231],v[180:183]
dt v[90:91],v11 offset:12544
mm v[180:183],v[76:79],v[244:247],v[180:183]
v_add_f32 v46,1.0,v46
v_mul_f32 v54,v126,v158
mm v[184:187],v[72:75],v[232:235],v[184:187]
dt v[92:93],v11 offset:14336
v_mul_f32 v51,v51,v43
mm v[184:187],v[76:79],v[248:251],v[184:187]
cv v61,v50,v51
mm v[188:191],v[72:75],v[236:239],v[188:191]
dt v[94:95],v11 offset:14592
mm v[188:191],v[76:79],v[252:255],v[188:191]
s_waitcnt lgkmcnt(4)
v_rcp_f32 v46,v46
mm v[192:195],v[80:83],v[224:227],v[192:195]
dt v[64:65],v12 offset:16384
v_add_f32 v47,1.0,v47
mm v[192:195],v[84:87],v[240:243],v[192:195]
v_mul_f32 v55,v127,v159
v_mul_f32 v52,v52,v44
mm v[196:199],v[80:83],v[228:231],v[196:199]
dt v[66:67],v12 offset:16896
mm v[196:199],v[84:87],v[244:247],v[196:199]
v_rcp_f32 v47,v47
mm v[200:203],v[80:83],v[232:235],v[200:203]
s_add_u32 m0,s37,123904
dt v[68:69],v12 offset:20480
v_mul_f32 v53,v53,v45
mm v[200:203],v[84:87],v[248:251],v[200:203]
cv v62,v52,v53
mm v[204:207],v[80:83],v[236:239],v[204:207]
dt v[70:71],v12 offset:20992
v_mul_f32 v54,v54,v46
mm v[204:207],v[84:87],v[252:255],v[204:207]
s_waitcnt lgkmcnt(4)
bl v6,s[20:23],s59 offen lds
mm v[208:211],v[88:91],v[224:227],v[208:211]
dt v[72:73],v12 offset:16392
v_mul_f32 v55,v55,v47
mm v[208:211],v[92:95],v[240:243],v[208:211]
cv v63,v54,v55
mm v[212:215],v[88:91],v[228:231],v[212:215]
dt v[74:75],v12 offset:16904
mm v[212:215],v[92:95],v[244:247],v[212:215]
buffer_store_dwordx4 v[60:63],v2,s[8:11],s45 offen offset:2048 sc1
mm v[216:219],v[88:91],v[232:235],v[216:219]
dt v[76:77],v12 offset:20488
mm v[216:219],v[92:95],v[248:251],v[216:219]
mm v[220:223],v[88:91],v[236:239],v[220:223]
dt v[78:79],v12 offset:21000
mm v[220:223],v[92:95],v[252:255],v[220:223]
s_waitcnt lgkmcnt(4)
mm v[96:99],v[64:67],a[0:3],0
dt v[80:81],v13 offset:16384
mm v[96:99],v[68:71],a[16:19],v[96:99]
mm v[100:103],v[64:67],a[4:7],0
s_add_u32 m0,s37,0
s_add_u32 s56,s54,1572992
dt v[82:83],v13 offset:16896
mm v[100:103],v[68:71],a[20:23],v[100:103]
mm v[104:107],v[64:67],a[8:11],0
dt v[84:85],v13 offset:20480
mm v[104:107],v[68:71],a[24:27],v[104:107]
bl v5,s[20:23],s56 offen lds
mm v[108:111],v[64:67],a[12:15],0
dt v[86:87],v13 offset:20992
v_mul_f32 v40,s61,v160
mm v[108:111],v[68:71],a[28:31],v[108:111]
s_waitcnt lgkmcnt(4)
v_mul_f32 v41,s61,v161
mm v[112:115],v[72:75],a[0:3],0
dt v[88:89],v13 offset:16392
mm v[112:115],v[76:79],a[16:19],v[112:115]
v_exp_f32 v40,v40
mm v[116:119],v[72:75],a[4:7],0
dt v[90:91],v13 offset:16904
v_mul_f32 v42,s61,v162
mm v[116:119],v[76:79],a[20:23],v[116:119]
v_exp_f32 v41,v41
mm v[120:123],v[72:75],a[8:11],0
dt v[92:93],v13 offset:20488
v_add_f32 v40,1.0,v40
mm v[120:123],v[76:79],a[24:27],v[120:123]
v_mul_f32 v48,v160,v192
mm v[124:127],v[72:75],a[12:15],0
dt v[94:95],v13 offset:21000
v_mul_f32 v43,s61,v163
mm v[124:127],v[76:79],a[28:31],v[124:127]
s_waitcnt lgkmcnt(4)
v_exp_f32 v42,v42
mm v[128:131],v[80:83],a[0:3],0
s_add_u32 m0,s37,1024
dt v[64:65],v14 offset:16384
mm v[128:131],v[84:87],a[16:19],v[128:131]
v_rcp_f32 v40,v40
mm v[132:135],v[80:83],a[4:7],0
dt v[66:67],v14 offset:16896
v_add_f32 v41,1.0,v41
mm v[132:135],v[84:87],a[20:23],v[132:135]
bl v6,s[20:23],s56 offen lds
mm v[136:139],v[80:83],a[8:11],0
dt v[68:69],v14 offset:20480
mm v[136:139],v[84:87],a[24:27],v[136:139]
v_mul_f32 v49,v161,v193
v_mul_f32 v44,s61,v176
mm v[140:143],v[80:83],a[12:15],0
dt v[70:71],v14 offset:20992
mm v[140:143],v[84:87],a[28:31],v[140:143]
s_waitcnt lgkmcnt(4)
v_exp_f32 v43,v43
mm v[144:147],v[88:91],a[0:3],0
dt v[72:73],v14 offset:16392
mm v[144:147],v[92:95],a[16:19],v[144:147]
v_rcp_f32 v41,v41
mm v[148:151],v[88:91],a[4:7],0
dt v[74:75],v14 offset:16904
v_add_f32 v42,1.0,v42
mm v[148:151],v[92:95],a[20:23],v[148:151]
v_mul_f32 v50,v162,v194
v_mul_f32 v45,s61,v177
mm v[152:155],v[88:91],a[8:11],0
dt v[76:77],v14 offset:20488
mm v[152:155],v[92:95],a[24:27],v[152:155]
v_exp_f32 v44,v44
mm v[156:159],v[88:91],a[12:15],0
s_getpc_b64 s[0:1]
L_cpf8:
s_add_u32 s100,s47,4096
s_min_u32 s100,s100,L_code_end-1024-L_cpf8
s_add_u32 s0,s0,s100
s_addc_u32 s1,s1,0
dt v[78:79],v14 offset:21000
mm v[156:159],v[92:95],a[28:31],v[156:159]
s_waitcnt lgkmcnt(4)
v_rcp_f32 v42,v42
mm v[96:99],v[64:67],a[32:35],v[96:99]
dt v[80:81],v15 offset:16384
v_add_f32 v43,1.0,v43
mm v[96:99],v[68:71],a[48:51],v[96:99]
global_load_dword v0,v3,s[0:1]
mm v[100:103],v[64:67],a[36:39],v[100:103]
dt v[82:83],v15 offset:16896
v_mul_f32 v51,v163,v195
mm v[100:103],v[68:71],a[52:55],v[100:103]
v_mul_f32 v48,v48,v40
mm v[104:107],v[64:67],a[40:43],v[104:107]
dt v[84:85],v15 offset:20480
v_mul_f32 v46,s61,v178
mm v[104:107],v[68:71],a[56:59],v[104:107]
v_exp_f32 v45,v45
mm v[108:111],v[64:67],a[44:47],v[108:111]
dt v[86:87],v15 offset:20992
mm v[108:111],v[68:71],a[60:63],v[108:111]
s_waitcnt lgkmcnt(4)
v_rcp_f32 v43,v43
mm v[112:115],v[72:75],a[32:35],v[112:115]
dt v[88:89],v15 offset:16392
mm v[112:115],v[76:79],a[48:51],v[112:115]
v_add_f32 v44,1.0,v44
v_mul_f32 v52,v176,v208
mm v[116:119],v[72:75],a[36:39],v[116:119]
dt v[90:91],v15 offset:16904
v_mul_f32 v49,v49,v41
mm v[116:119],v[76:79],a[52:55],v[116:119]
cv v56,v48,v49
mm v[120:123],v[72:75],a[40:43],v[120:123]
dt v[92:93],v15 offset:20488
v_mul_f32 v47,s61,v179
mm v[120:123],v[76:79],a[56:59],v[120:123]
v_exp_f32 v46,v46
mm v[124:127],v[72:75],a[44:47],v[124:127]
dt v[94:95],v15 offset:21000
mm v[124:127],v[76:79],a[60:63],v[124:127]
s_waitcnt lgkmcnt(4)
s_waitcnt vmcnt(18)
mm v[128:131],v[80:83],a[32:35],v[128:131]
s_barrier
dt v[64:65],v12 offset:24576
mm v[128:131],v[84:87],a[48:51],v[128:131]
s_add_u32 m0,s37,65536
s_add_u32 s57,s54,2097280
mm v[132:135],v[80:83],a[36:39],v[132:135]
dt v[66:67],v12 offset:25088
mm v[132:135],v[84:87],a[52:55],v[132:135]
bl v5,s[20:23],s57 offen lds
mm v[136:139],v[80:83],a[40:43],v[136:139]
dt v[68:69],v12 offset:28672
mm v[136:139],v[84:87],a[56:59],v[136:139]
v_rcp_f32 v44,v44
mm v[140:143],v[80:83],a[44:47],v[140:143]
dt v[70:71],v12 offset:29184
v_add_f32 v45,1.0,v45
mm v[140:143],v[84:87],a[60:63],v[140:143]
s_waitcnt lgkmcnt(4)
v_mul_f32 v53,v177,v209
v_mul_f32 v50,v50,v42
mm v[144:147],v[88:91],a[32:35],v[144:147]
dt v[72:73],v12 offset:24584
mm v[144:147],v[92:95],a[48:51],v[144:147]
v_exp_f32 v47,v47
mm v[148:151],v[88:91],a[36:39],v[148:151]
dt v[74:75],v12 offset:25096
mm v[148:151],v[92:95],a[52:55],v[148:151]
v_rcp_f32 v45,v45
mm v[152:155],v[88:91],a[40:43],v[152:155]
dt v[76:77],v12 offset:28680
v_add_f32 v46,1.0,v46
mm v[152:155],v[92:95],a[56:59],v[152:155]
v_mul_f32 v54,v178,v210
v_mul_f32 v51,v51,v43
mm v[156:159],v[88:91],a[44:47],v[156:159]
s_add_u32 m0,s37,66560
dt v[78:79],v12 offset:29192
cv v57,v50,v51
mm v[156:159],v[92:95],a[60:63],v[156:159]
s_waitcnt lgkmcnt(4)
v_rcp_f32 v46,v46
mm v[96:99],v[64:67],a[64:67],v[96:99]
dt v[80:81],v13 offset:24576
v_add_f32 v47,1.0,v47
mm v[96:99],v[68:71],a[80:83],v[96:99]
bl v6,s[20:23],s57 offen lds
mm v[100:103],v[64:67],a[68:71],v[100:103]
dt v[82:83],v13 offset:25088
v_mul_f32 v55,v179,v211
mm v[100:103],v[68:71],a[84:87],v[100:103]
v_mul_f32 v52,v52,v44
mm v[104:107],v[64:67],a[72:75],v[104:107]
dt v[84:85],v13 offset:28672
mm v[104:107],v[68:71],a[88:91],v[104:107]
v_rcp_f32 v47,v47
mm v[108:111],v[64:67],a[76:79],v[108:111]
dt v[86:87],v13 offset:29184
v_mul_f32 v53,v53,v45
mm v[108:111],v[68:71],a[92:95],v[108:111]
s_waitcnt lgkmcnt(4)
cv v58,v52,v53
v_mul_f32 v54,v54,v46
mm v[112:115],v[72:75],a[64:67],v[112:115]
dt v[88:89],v13 offset:24584
v_mul_f32 v55,v55,v47
mm v[112:115],v[76:79],a[80:83],v[112:115]
cv v59,v54,v55
mm v[116:119],v[72:75],a[68:71],v[116:119]
dt v[90:91],v13 offset:25096
mm v[116:119],v[76:79],a[84:87],v[116:119]
buffer_store_dwordx4 v[56:59],v2,s[8:11],s42 offen offset:3072 sc1
mm v[120:123],v[72:75],a[72:75],v[120:123]
dt v[92:93],v13 offset:28680
v_mul_f32 v40,s61,v164
mm v[120:123],v[76:79],a[88:91],v[120:123]
v_mul_f32 v41,s61,v165
mm v[124:127],v[72:75],a[76:79],v[124:127]
s_add_u32 m0,s37,8192
s_add_u32 s58,s54,2621568
dt v[94:95],v13 offset:29192
mm v[124:127],v[76:79],a[92:95],v[124:127]
s_waitcnt lgkmcnt(4)
v_exp_f32 v40,v40
mm v[128:131],v[80:83],a[64:67],v[128:131]
dt v[64:65],v14 offset:24576
v_mul_f32 v42,s61,v166
mm v[128:131],v[84:87],a[80:83],v[128:131]
bl v5,s[20:23],s58 offen lds
mm v[132:135],v[80:83],a[68:71],v[132:135]
dt v[66:67],v14 offset:25088
mm v[132:135],v[84:87],a[84:87],v[132:135]
v_exp_f32 v41,v41
mm v[136:139],v[80:83],a[72:75],v[136:139]
dt v[68:69],v14 offset:28672
v_add_f32 v40,1.0,v40
mm v[136:139],v[84:87],a[88:91],v[136:139]
v_mul_f32 v48,v164,v196
v_mul_f32 v43,s61,v167
mm v[140:143],v[80:83],a[76:79],v[140:143]
dt v[70:71],v14 offset:29184
mm v[140:143],v[84:87],a[92:95],v[140:143]
s_waitcnt lgkmcnt(4)
v_exp_f32 v42,v42
mm v[144:147],v[88:91],a[64:67],v[144:147]
dt v[72:73],v14 offset:24584
mm v[144:147],v[92:95],a[80:83],v[144:147]
v_rcp_f32 v40,v40
mm v[148:151],v[88:91],a[68:71],v[148:151]
dt v[74:75],v14 offset:25096
v_add_f32 v41,1.0,v41
mm v[148:151],v[92:95],a[84:87],v[148:151]
v_mul_f32 v49,v165,v197
v_mul_f32 v44,s61,v180
mm v[152:155],v[88:91],a[72:75],v[152:155]
dt v[76:77],v14 offset:28680
mm v[152:155],v[92:95],a[88:91],v[152:155]
s_add_u32 m0,s37,9216
v_exp_f32 v43,v43
mm v[156:159],v[88:91],a[76:79],v[156:159]
dt v[78:79],v14 offset:29192
mm v[156:159],v[92:95],a[92:95],v[156:159]
s_waitcnt lgkmcnt(4)
bl v6,s[20:23],s58 offen lds
mm v[96:99],v[64:67],a[96:99],v[96:99]
dt v[80:81],v15 offset:24576
mm v[96:99],v[68:71],a[112:115],v[96:99]
v_rcp_f32 v41,v41
mm v[100:103],v[64:67],a[100:103],v[100:103]
dt v[82:83],v15 offset:25088
v_add_f32 v42,1.0,v42
mm v[100:103],v[68:71],a[116:119],v[100:103]
v_mul_f32 v50,v166,v198
v_mul_f32 v45,s61,v181
mm v[104:107],v[64:67],a[104:107],v[104:107]
dt v[84:85],v15 offset:28672
mm v[104:107],v[68:71],a[120:123],v[104:107]
v_exp_f32 v44,v44
mm v[108:111],v[64:67],a[108:111],v[108:111]
dt v[86:87],v15 offset:29184
mm v[108:111],v[68:71],a[124:127],v[108:111]
s_waitcnt lgkmcnt(4)
v_rcp_f32 v42,v42
mm v[112:115],v[72:75],a[96:99],v[112:115]
dt v[88:89],v15 offset:24584
v_add_f32 v43,1.0,v43
mm v[112:115],v[76:79],a[112:115],v[112:115]
v_mul_f32 v51,v167,v199
v_mul_f32 v48,v48,v40
mm v[116:119],v[72:75],a[100:103],v[116:119]
dt v[90:91],v15 offset:25096
v_mul_f32 v46,s61,v182
mm v[116:119],v[76:79],a[116:119],v[116:119]
v_exp_f32 v45,v45
mm v[120:123],v[72:75],a[104:107],v[120:123]
dt v[92:93],v15 offset:28680
mm v[120:123],v[76:79],a[120:123],v[120:123]
s_add_u32 m0,s37,73728
s_add_u32 s59,s54,3145856
mm v[124:127],v[72:75],a[108:111],v[124:127]
dt v[94:95],v15 offset:29192
mm v[124:127],v[76:79],a[124:127],v[124:127]
s_waitcnt lgkmcnt(4)
bl v5,s[20:23],s59 offen lds
mm v[128:131],v[80:83],a[96:99],v[128:131]
dt v[64:65],v12 offset:32768
mm v[128:131],v[84:87],a[112:115],v[128:131]
v_rcp_f32 v43,v43
mm v[132:135],v[80:83],a[100:103],v[132:135]
dt v[66:67],v12 offset:33280
v_add_f32 v44,1.0,v44
mm v[132:135],v[84:87],a[116:119],v[132:135]
v_mul_f32 v52,v180,v212
v_mul_f32 v49,v49,v41
mm v[136:139],v[80:83],a[104:107],v[136:139]
dt v[68:69],v12 offset:36864
cv v60,v48,v49
mm v[136:139],v[84:87],a[120:123],v[136:139]
v_mul_f32 v47,s61,v183
mm v[140:143],v[80:83],a[108:111],v[140:143]
dt v[70:71],v12 offset:37376
mm v[140:143],v[84:87],a[124:127],v[140:143]
s_waitcnt lgkmcnt(4)
v_exp_f32 v46,v46
mm v[144:147],v[88:91],a[96:99],v[144:147]
dt v[72:73],v12 offset:32776
mm v[144:147],v[92:95],a[112:115],v[144:147]
v_rcp_f32 v44,v44
mm v[148:151],v[88:91],a[100:103],v[148:151]
dt v[74:75],v12 offset:33288
v_add_f32 v45,1.0,v45
mm v[148:151],v[92:95],a[116:119],v[148:151]
v_mul_f32 v53,v181,v213
v_mul_f32 v50,v50,v42
mm v[152:155],v[88:91],a[104:107],v[152:155]
dt v[76:77],v12 offset:36872
mm v[152:155],v[92:95],a[120:123],v[152:155]
s_add_u32 m0,s37,74752
v_exp_f32 v47,v47
mm v[156:159],v[88:91],a[108:111],v[156:159]
dt v[78:79],v12 offset:37384
mm v[156:159],v[92:95],a[124:127],v[156:159]
s_waitcnt lgkmcnt(4)
bl v6,s[20:23],s59 offen lds
mm v[96:99],v[64:67],a[128:131],v[96:99]
dt v[80:81],v13 offset:32768
mm v[96:99],v[68:71],a[144:147],v[96:99]
v_rcp_f32 v45,v45
mm v[100:103],v[64:67],a[132:135],v[100:103]
dt v[82:83],v13 offset:33280
v_add_f32 v46,1.0,v46
mm v[100:103],v[68:71],a[148:151],v[100:103]
v_mul_f32 v54,v182,v214
v_mul_f32 v51,v51,v43
mm v[104:107],v[64:67],a[136:139],v[104:107]
dt v[84:85],v13 offset:36864
cv v61,v50,v51
mm v[104:107],v[68:71],a[152:155],v[104:107]
v_rcp_f32 v46,v46
mm v[108:111],v[64:67],a[140:143],v[108:111]
dt v[86:87],v13 offset:37376
v_add_f32 v47,1.0,v47
mm v[108:111],v[68:71],a[156:159],v[108:111]
s_waitcnt lgkmcnt(4)
v_mul_f32 v55,v183,v215
v_mul_f32 v52,v52,v44
mm v[112:115],v[72:75],a[128:131],v[112:115]
dt v[88:89],v13 offset:32776
mm v[112:115],v[76:79],a[144:147],v[112:115]
v_rcp_f32 v47,v47
mm v[116:119],v[72:75],a[132:135],v[116:119]
dt v[90:91],v13 offset:33288
v_mul_f32 v53,v53,v45
mm v[116:119],v[76:79],a[148:151],v[116:119]
cv v62,v52,v53
v_mul_f32 v54,v54,v46
mm v[120:123],v[72:75],a[136:139],v[120:123]
dt v[92:93],v13 offset:36872
mm v[120:123],v[76:79],a[152:155],v[120:123]
s_add_u32 m0,s37,16384
s_add_u32 s56,s54,3670144
v_mul_f32 v55,v55,v47
mm v[124:127],v[72:75],a[140:143],v[124:127]
dt v[94:95],v13 offset:37384
cv v63,v54,v55
mm v[124:127],v[76:79],a[156:159],v[124:127]
s_waitcnt lgkmcnt(4)
bl v5,s[20:23],s56 offen lds
mm v[128:131],v[80:83],a[128:131],v[128:131]
dt v[64:65],v14 offset:32768
mm v[128:131],v[84:87],a[144:147],v[128:131]
buffer_store_dwordx4 v[60:63],v2,s[8:11],s43 offen offset:3072 sc1
mm v[132:135],v[80:83],a[132:135],v[132:135]
dt v[66:67],v14 offset:33280
v_mul_f32 v40,s61,v168
mm v[132:135],v[84:87],a[148:151],v[132:135]
v_mul_f32 v41,s61,v169
mm v[136:139],v[80:83],a[136:139],v[136:139]
dt v[68:69],v14 offset:36864
mm v[136:139],v[84:87],a[152:155],v[136:139]
v_exp_f32 v40,v40
mm v[140:143],v[80:83],a[140:143],v[140:143]
dt v[70:71],v14 offset:37376
v_mul_f32 v42,s61,v170
mm v[140:143],v[84:87],a[156:159],v[140:143]
s_waitcnt lgkmcnt(4)
v_exp_f32 v41,v41
mm v[144:147],v[88:91],a[128:131],v[144:147]
dt v[72:73],v14 offset:32776
v_add_f32 v40,1.0,v40
mm v[144:147],v[92:95],a[144:147],v[144:147]
v_mul_f32 v48,v168,v200
mm v[148:151],v[88:91],a[132:135],v[148:151]
dt v[74:75],v14 offset:33288
v_mul_f32 v43,s61,v171
mm v[148:151],v[92:95],a[148:151],v[148:151]
v_exp_f32 v42,v42
mm v[152:155],v[88:91],a[136:139],v[152:155]
dt v[76:77],v14 offset:36872
mm v[152:155],v[92:95],a[152:155],v[152:155]
s_add_u32 m0,s37,17408
v_rcp_f32 v40,v40
mm v[156:159],v[88:91],a[140:143],v[156:159]
dt v[78:79],v14 offset:37384
mm v[156:159],v[92:95],a[156:159],v[156:159]
s_waitcnt lgkmcnt(4)
bl v6,s[20:23],s56 offen lds
mm v[96:99],v[64:67],a[160:163],v[96:99]
dt v[80:81],v15 offset:32768
v_add_f32 v41,1.0,v41
mm v[96:99],v[68:71],a[176:179],v[96:99]
v_mul_f32 v49,v169,v201
v_mul_f32 v44,s61,v184
mm v[100:103],v[64:67],a[164:167],v[100:103]
dt v[82:83],v15 offset:33280
mm v[100:103],v[68:71],a[180:183],v[100:103]
v_exp_f32 v43,v43
mm v[104:107],v[64:67],a[168:171],v[104:107]
dt v[84:85],v15 offset:36864
mm v[104:107],v[68:71],a[184:187],v[104:107]
v_rcp_f32 v41,v41
mm v[108:111],v[64:67],a[172:175],v[108:111]
dt v[86:87],v15 offset:37376
v_add_f32 v42,1.0,v42
mm v[108:111],v[68:71],a[188:191],v[108:111]
s_waitcnt lgkmcnt(4)
v_mul_f32 v50,v170,v202
mm v[112:115],v[72:75],a[160:163],v[112:115]
dt v[88:89],v15 offset:32776
v_mul_f32 v45,s61,v185
mm v[112:115],v[76:79],a[176:179],v[112:115]
v_exp_f32 v44,v44
mm v[116:119],v[72:75],a[164:167],v[116:119]
dt v[90:91],v15 offset:33288
mm v[116:119],v[76:79],a[180:183],v[116:119]
v_rcp_f32 v42,v42
mm v[120:123],v[72:75],a[168:171],v[120:123]
dt v[92:93],v15 offset:36872
v_add_f32 v43,1.0,v43
mm v[120:123],v[76:79],a[184:187],v[120:123]
v_mul_f32 v51,v171,v203
mm v[124:127],v[72:75],a[172:175],v[124:127]
dt v[94:95],v15 offset:37384
v_mul_f32 v48,v48,v40
mm v[124:127],v[76:79],a[188:191],v[124:127]
s_waitcnt lgkmcnt(4)
s_waitcnt vmcnt(18)
mm v[128:131],v[80:83],a[160:163],v[128:131]
s_barrier
dt v[64:65],v12 offset:40960
v_mul_f32 v46,s61,v186
mm v[128:131],v[84:87],a[176:179],v[128:131]
s_add_u32 m0,s37,81920
s_add_u32 s57,s54,4194432
mm v[132:135],v[80:83],a[164:167],v[132:135]
dt v[66:67],v12 offset:41472
mm v[132:135],v[84:87],a[180:183],v[132:135]
bl v5,s[20:23],s57 offen lds
mm v[136:139],v[80:83],a[168:171],v[136:139]
dt v[68:69],v12 offset:45056
mm v[136:139],v[84:87],a[184:187],v[136:139]
v_exp_f32 v45,v45
mm v[140:143],v[80:83],a[172:175],v[140:143]
dt v[70:71],v12 offset:45568
mm v[140:143],v[84:87],a[188:191],v[140:143]
s_waitcnt lgkmcnt(4)
v_rcp_f32 v43,v43
mm v[144:147],v[88:91],a[160:163],v[144:147]
dt v[72:73],v12 offset:40968
v_add_f32 v44,1.0,v44
mm v[144:147],v[92:95],a[176:179],v[144:147]
v_mul_f32 v52,v184,v216
v_mul_f32 v49,v49,v41
mm v[148:151],v[88:91],a[164:167],v[148:151]
dt v[74:75],v12 offset:41480
cv v56,v48,v49
mm v[148:151],v[92:95],a[180:183],v[148:151]
v_mul_f32 v47,s61,v187
mm v[152:155],v[88:91],a[168:171],v[152:155]
dt v[76:77],v12 offset:45064
mm v[152:155],v[92:95],a[184:187],v[152:155]
v_exp_f32 v46,v46
mm v[156:159],v[88:91],a[172:175],v[156:159]
dt v[78:79],v12 offset:45576
mm v[156:159],v[92:95],a[188:191],v[156:159]
s_waitcnt lgkmcnt(4)
v_rcp_f32 v44,v44
mm v[96:99],v[64:67],a[192:195],v[96:99]
dt v[80:81],v13 offset:40960
v_add_f32 v45,1.0,v45
mm v[96:99],v[68:71],a[208:211],v[96:99]
v_mul_f32 v53,v185,v217
v_mul_f32 v50,v50,v42
mm v[100:103],v[64:67],a[196:199],v[100:103]
dt v[82:83],v13 offset:41472
mm v[100:103],v[68:71],a[212:215],v[100:103]
s_add_u32 m0,s37,82944
v_exp_f32 v47,v47
mm v[104:107],v[64:67],a[200:203],v[104:107]
dt v[84:85],v13 offset:45056
mm v[104:107],v[68:71],a[216:219],v[104:107]
bl v6,s[20:23],s57 offen lds
mm v[108:111],v[64:67],a[204:207],v[108:111]
dt v[86:87],v13 offset:45568
mm v[108:111],v[68:71],a[220:223],v[108:111]
s_waitcnt lgkmcnt(4)
v_rcp_f32 v45,v45
mm v[112:115],v[72:75],a[192:195],v[112:115]
dt v[88:89],v13 offset:40968
v_add_f32 v46,1.0,v46
mm v[112:115],v[76:79],a[208:211],v[112:115]
v_mul_f32 v54,v186,v218
v_mul_f32 v51,v51,v43
mm v[116:119],v[72:75],a[196:199],v[116:119]
dt v[90:91],v13 offset:41480
cv v57,v50,v51
mm v[116:119],v[76:79],a[212:215],v[116:119]
v_rcp_f32 v46,v46
mm v[120:123],v[72:75],a[200:203],v[120:123]
dt v[92:93],v13 offset:45064
v_add_f32 v47,1.0,v47
mm v[120:123],v[76:79],a[216:219],v[120:123]
v_mul_f32 v55,v187,v219
v_mul_f32 v52,v52,v44
mm v[124:127],v[72:75],a[204:207],v[124:127]
dt v[94:95],v13 offset:45576
mm v[124:127],v[76:79],a[220:223],v[124:127]
s_waitcnt lgkmcnt(4)
v_rcp_f32 v47,v47
mm v[128:131],v[80:83],a[192:195],v[128:131]
dt v[64:65],v14 offset:40960
v_mul_f32 v53,v53,v45
mm v[128:131],v[84:87],a[208:211],v[128:131]
cv v58,v52,v53
v_mul_f32 v54,v54,v46
mm v[132:135],v[80:83],a[196:199],v[132:135]
dt v[66:67],v14 offset:41472
v_mul_f32 v55,v55,v47
mm v[132:135],v[84:87],a[212:215],v[132:135]
cv v59,v54,v55
mm v[136:139],v[80:83],a[200:203],v[136:139]
dt v[68:69],v14 offset:45056
mm v[136:139],v[84:87],a[216:219],v[136:139]
buffer_store_dwordx4 v[56:59],v2,s[8:11],s44 offen offset:3072 sc1
mm v[140:143],v[80:83],a[204:207],v[140:143]
dt v[70:71],v14 offset:45568
v_mul_f32 v40,s61,v172
mm v[140:143],v[84:87],a[220:223],v[140:143]
s_waitcnt lgkmcnt(4)
v_mul_f32 v41,s61,v173
mm v[144:147],v[88:91],a[192:195],v[144:147]
s_add_u32 m0,s37,90112
s_add_u32 s58,s55,0
dt v[72:73],v14 offset:40968
mm v[144:147],v[92:95],a[208:211],v[144:147]
v_exp_f32 v40,v40
mm v[148:151],v[88:91],a[196:199],v[148:151]
dt v[74:75],v14 offset:41480
v_mul_f32 v42,s61,v174
mm v[148:151],v[92:95],a[212:215],v[148:151]
bl v16,s[24:27],s58 offen lds
mm v[152:155],v[88:91],a[200:203],v[152:155]
dt v[76:77],v14 offset:45064
mm v[152:155],v[92:95],a[216:219],v[152:155]
v_exp_f32 v41,v41
mm v[156:159],v[88:91],a[204:207],v[156:159]
dt v[78:79],v14 offset:45576
v_add_f32 v40,1.0,v40
mm v[156:159],v[92:95],a[220:223],v[156:159]
s_waitcnt lgkmcnt(4)
v_mul_f32 v48,v172,v204
mm v[96:99],v[64:67],a[224:227],v[96:99]
dt v[80:81],v15 offset:40960
v_mul_f32 v43,s61,v175
mm v[96:99],v[68:71],a[240:243],v[96:99]
v_exp_f32 v42,v42
mm v[100:103],v[64:67],a[228:231],v[100:103]
dt v[82:83],v15 offset:41472
mm v[100:103],v[68:71],a[244:247],v[100:103]
v_rcp_f32 v40,v40
mm v[104:107],v[64:67],a[232:235],v[104:107]
dt v[84:85],v15 offset:45056
v_add_f32 v41,1.0,v41
mm v[104:107],v[68:71],a[248:251],v[104:107]
v_mul_f32 v49,v173,v205
mm v[108:111],v[64:67],a[236:239],v[108:111]
dt v[86:87],v15 offset:45568
v_mul_f32 v44,s61,v188
mm v[108:111],v[68:71],a[252:255],v[108:111]
s_waitcnt lgkmcnt(4)
v_exp_f32 v43,v43
mm v[112:115],v[72:75],a[224:227],v[112:115]
dt v[88:89],v15 offset:40968
mm v[112:115],v[76:79],a[240:243],v[112:115]
v_rcp_f32 v41,v41
mm v[116:119],v[72:75],a[228:231],v[116:119]
dt v[90:91],v15 offset:41480
mm v[116:119],v[76:79],a[244:247],v[116:119]
v_add_f32 v42,1.0,v42
v_mul_f32 v50,v174,v206
mm v[120:123],v[72:75],a[232:235],v[120:123]
dt v[92:93],v15 offset:45064
mm v[120:123],v[76:79],a[248:251],v[120:123]
s_add_u32 m0,s37,91136
v_mul_f32 v45,s61,v189
mm v[124:127],v[72:75],a[236:239],v[124:127]
dt v[94:95],v15 offset:45576
mm v[124:127],v[76:79],a[252:255],v[124:127]
s_waitcnt lgkmcnt(4)
bl v17,s[24:27],s58 offen lds
mm v[128:131],v[80:83],a[224:227],v[128:131]
dt v[64:65],v12 offset:49152
mm v[128:131],v[84:87],a[240:243],v[128:131]
v_exp_f32 v44,v44
mm v[132:135],v[80:83],a[228:231],v[132:135]
dt v[66:67],v12 offset:49664
mm v[132:135],v[84:87],a[244:247],v[132:135]
v_rcp_f32 v42,v42
mm v[136:139],v[80:83],a[232:235],v[136:139]
dt v[68:69],v12 offset:53248
v_add_f32 v43,1.0,v43
mm v[136:139],v[84:87],a[248:251],v[136:139]
v_mul_f32 v51,v175,v207
v_mul_f32 v48,v48,v40
mm v[140:143],v[80:83],a[236:239],v[140:143]
dt v[70:71],v12 offset:53760
v_mul_f32 v46,s61,v190
mm v[140:143],v[84:87],a[252:255],v[140:143]
s_waitcnt lgkmcnt(4)
v_exp_f32 v45,v45
mm v[144:147],v[88:91],a[224:227],v[144:147]
dt v[72:73],v12 offset:49160
mm v[144:147],v[92:95],a[240:243],v[144:147]
v_rcp_f32 v43,v43
mm v[148:151],v[88:91],a[228:231],v[148:151]
dt v[74:75],v12 offset:49672
v_add_f32 v44,1.0,v44
mm v[148:151],v[92:95],a[244:247],v[148:151]
v_mul_f32 v52,v188,v220
v_mul_f32 v49,v49,v41
mm v[152:155],v[88:91],a[232:235],v[152:155]
dt v[76:77],v12 offset:53256
cv v60,v48,v49
mm v[152:155],v[92:95],a[248:251],v[152:155]
v_mul_f32 v47,s61,v191
mm v[156:159],v[88:91],a[236:239],v[156:159]
dt v[78:79],v12 offset:53768
mm v[156:159],v[92:95],a[252:255],v[156:159]
s_waitcnt lgkmcnt(4)
v_exp_f32 v46,v46
mm v[96:99],v[64:67],v[224:227],v[96:99]
dt v[80:81],v13 offset:49152
mm v[96:99],v[68:71],v[240:243],v[96:99]
v_rcp_f32 v44,v44
mm v[100:103],v[64:67],v[228:231],v[100:103]
s_add_u32 m0,s37,24576
s_add_u32 s59,s55,0
dt v[82:83],v13 offset:49664
mm v[100:103],v[68:71],v[244:247],v[100:103]
v_add_f32 v45,1.0,v45
v_mul_f32 v53,v189,v221
mm v[104:107],v[64:67],v[232:235],v[104:107]
dt v[84:85],v13 offset:53248
v_mul_f32 v50,v50,v42
mm v[104:107],v[68:71],v[248:251],v[104:107]
bl v18,s[28:31],s59 offen lds
mm v[108:111],v[64:67],v[236:239],v[108:111]
dt v[86:87],v13 offset:53760
mm v[108:111],v[68:71],v[252:255],v[108:111]
s_waitcnt lgkmcnt(4)
v_exp_f32 v47,v47
mm v[112:115],v[72:75],v[224:227],v[112:115]
dt v[88:89],v13 offset:49160
mm v[112:115],v[76:79],v[240:243],v[112:115]
v_rcp_f32 v45,v45
mm v[116:119],v[72:75],v[228:231],v[116:119]
dt v[90:91],v13 offset:49672
v_add_f32 v46,1.0,v46
mm v[116:119],v[76:79],v[244:247],v[116:119]
v_mul_f32 v54,v190,v222
v_mul_f32 v51,v51,v43
mm v[120:123],v[72:75],v[232:235],v[120:123]
dt v[92:93],v13 offset:53256
cv v61,v50,v51
mm v[120:123],v[76:79],v[248:251],v[120:123]
v_rcp_f32 v46,v46
mm v[124:127],v[72:75],v[236:239],v[124:127]
dt v[94:95],v13 offset:53768
mm v[124:127],v[76:79],v[252:255],v[124:127]
s_waitcnt lgkmcnt(4)
v_add_f32 v47,1.0,v47
mm v[128:131],v[80:83],v[224:227],v[128:131]
dt v[64:65],v14 offset:49152
v_mul_f32 v55,v191,v223
mm v[128:131],v[84:87],v[240:243],v[128:131]
v_mul_f32 v52,v52,v44
mm v[132:135],v[80:83],v[228:231],v[132:135]
dt v[66:67],v14 offset:49664
mm v[132:135],v[84:87],v[244:247],v[132:135]
v_rcp_f32 v47,v47
mm v[136:139],v[80:83],v[232:235],v[136:139]
dt v[68:69],v14 offset:53248
v_mul_f32 v53,v53,v45
mm v[136:139],v[84:87],v[248:251],v[136:139]
cv v62,v52,v53
v_mul_f32 v54,v54,v46
mm v[140:143],v[80:83],v[236:239],v[140:143]
dt v[70:71],v14 offset:53760
v_mul_f32 v55,v55,v47
mm v[140:143],v[84:87],v[252:255],v[140:143]
s_waitcnt lgkmcnt(4)
s_add_u32 m0,s37,25600
cv v63,v54,v55
mm v[144:147],v[88:91],v[224:227],v[144:147]
dt v[72:73],v14 offset:49160
mm v[144:147],v[92:95],v[240:243],v[144:147]
bl v19,s[28:31],s59 offen lds
mm v[148:151],v[88:91],v[228:231],v[148:151]
dt v[74:75],v14 offset:49672
mm v[148:151],v[92:95],v[244:247],v[148:151]
buffer_store_dwordx4 v[60:63],v2,s[8:11],s45 offen offset:3072 sc1
mm v[152:155],v[88:91],v[232:235],v[152:155]
dt v[76:77],v14 offset:53256
mm v[152:155],v[92:95],v[248:251],v[152:155]
mm v[156:159],v[88:91],v[236:239],v[156:159]
dt v[78:79],v14 offset:53768
mm v[156:159],v[92:95],v[252:255],v[156:159]
s_waitcnt lgkmcnt(4)
mm v[160:163],v[64:67],a[0:3],0
dt v[80:81],v15 offset:49152
mm v[160:163],v[68:71],a[16:19],v[160:163]
mm v[164:167],v[64:67],a[4:7],0
dt v[82:83],v15 offset:49664
mm v[164:167],v[68:71],a[20:23],v[164:167]
mm v[168:171],v[64:67],a[8:11],0
dt v[84:85],v15 offset:53248
mm v[168:171],v[68:71],a[24:27],v[168:171]
mm v[172:175],v[64:67],a[12:15],0
dt v[86:87],v15 offset:53760
v_mul_f32 v96,s62,v96
mm v[172:175],v[68:71],a[28:31],v[172:175]
s_waitcnt lgkmcnt(4)
mm v[176:179],v[72:75],a[0:3],0
dt v[88:89],v15 offset:49160
v_mul_f32 v97,s62,v97
mm v[176:179],v[76:79],a[16:19],v[176:179]
mm v[180:183],v[72:75],a[4:7],0
dt v[90:91],v15 offset:49672
mm v[180:183],v[76:79],a[20:23],v[180:183]
v_mul_f32 v98,s62,v98
mm v[184:187],v[72:75],a[8:11],0
dt v[92:93],v15 offset:53256
mm v[184:187],v[76:79],a[24:27],v[184:187]
v_mul_f32 v99,s62,v99
mm v[188:191],v[72:75],a[12:15],0
dt v[94:95],v15 offset:53768
mm v[188:191],v[76:79],a[28:31],v[188:191]
s_waitcnt lgkmcnt(4)
s_waitcnt vmcnt(16)
mm v[192:195],v[80:83],a[0:3],0
s_barrier
dt v[64:65],v12 offset:57344
mm v[192:195],v[84:87],a[16:19],v[192:195]
s_add_u32 m0,s37,98304
s_add_u32 s56,s55,8192
v_mul_f32 v112,s62,v112
mm v[196:199],v[80:83],a[4:7],0
dt v[66:67],v12 offset:57856
mm v[196:199],v[84:87],a[20:23],v[196:199]
bl v16,s[24:27],s56 offen lds
mm v[200:203],v[80:83],a[8:11],0
dt v[68:69],v12 offset:61440
mm v[200:203],v[84:87],a[24:27],v[200:203]
v_mul_f32 v113,s62,v113
mm v[204:207],v[80:83],a[12:15],0
dt v[70:71],v12 offset:61952
mm v[204:207],v[84:87],a[28:31],v[204:207]
s_waitcnt lgkmcnt(4)
v_mul_f32 v114,s62,v114
mm v[208:211],v[88:91],a[0:3],0
dt v[72:73],v12 offset:57352
mm v[208:211],v[92:95],a[16:19],v[208:211]
mm v[212:215],v[88:91],a[4:7],0
dt v[74:75],v12 offset:57864
v_mul_f32 v115,s62,v115
mm v[212:215],v[92:95],a[20:23],v[212:215]
mm v[216:219],v[88:91],a[8:11],0
dt v[76:77],v12 offset:61448
mm v[216:219],v[92:95],a[24:27],v[216:219]
cv v96,v96,v97
mm v[220:223],v[88:91],a[12:15],0
s_add_u32 m0,s37,99328
dt v[78:79],v12 offset:61960
mm v[220:223],v[92:95],a[28:31],v[220:223]
s_waitcnt lgkmcnt(4)
cv v97,v98,v99
mm v[160:163],v[64:67],a[32:35],v[160:163]
dt v[80:81],v13 offset:57344
mm v[160:163],v[68:71],a[48:51],v[160:163]
bl v17,s[24:27],s56 offen lds
mm v[164:167],v[64:67],a[36:39],v[164:167]
dt v[82:83],v13 offset:57856
mm v[164:167],v[68:71],a[52:55],v[164:167]
cv v98,v112,v113
mm v[168:171],v[64:67],a[40:43],v[168:171]
dt v[84:85],v13 offset:61440
mm v[168:171],v[68:71],a[56:59],v[168:171]
cv v99,v114,v115
mm v[172:175],v[64:67],a[44:47],v[172:175]
dt v[86:87],v13 offset:61952
mm v[172:175],v[68:71],a[60:63],v[172:175]
s_waitcnt lgkmcnt(4)
mm v[176:179],v[72:75],a[32:35],v[176:179]
dt v[88:89],v13 offset:57352
v_mul_f32 v128,s62,v128
mm v[176:179],v[76:79],a[48:51],v[176:179]
mm v[180:183],v[72:75],a[36:39],v[180:183]
dt v[90:91],v13 offset:57864
mm v[180:183],v[76:79],a[52:55],v[180:183]
v_mul_f32 v129,s62,v129
mm v[184:187],v[72:75],a[40:43],v[184:187]
dt v[92:93],v13 offset:61448
mm v[184:187],v[76:79],a[56:59],v[184:187]
v_mul_f32 v130,s62,v130
mm v[188:191],v[72:75],a[44:47],v[188:191]
s_add_u32 m0,s37,32768
s_add_u32 s57,s55,8192
dt v[94:95],v13 offset:61960
mm v[188:191],v[76:79],a[60:63],v[188:191]
s_waitcnt lgkmcnt(4)
mm v[192:195],v[80:83],a[32:35],v[192:195]
dt v[64:65],v14 offset:57344
v_mul_f32 v131,s62,v131
mm v[192:195],v[84:87],a[48:51],v[192:195]
bl v18,s[28:31],s57 offen lds
mm v[196:199],v[80:83],a[36:39],v[196:199]
dt v[66:67],v14 offset:57856
mm v[196:199],v[84:87],a[52:55],v[196:199]
mm v[200:203],v[80:83],a[40:43],v[200:203]
dt v[68:69],v14 offset:61440
v_mul_f32 v144,s62,v144
mm v[200:203],v[84:87],a[56:59],v[200:203]
mm v[204:207],v[80:83],a[44:47],v[204:207]
dt v[70:71],v14 offset:61952
mm v[204:207],v[84:87],a[60:63],v[204:207]
s_waitcnt lgkmcnt(4)
v_mul_f32 v145,s62,v145
mm v[208:211],v[88:91],a[32:35],v[208:211]
dt v[72:73],v14 offset:57352
mm v[208:211],v[92:95],a[48:51],v[208:211]
v_mul_f32 v146,s62,v146
mm v[212:215],v[88:91],a[36:39],v[212:215]
dt v[74:75],v14 offset:57864
mm v[212:215],v[92:95],a[52:55],v[212:215]
v_mul_f32 v147,s62,v147
mm v[216:219],v[88:91],a[40:43],v[216:219]
dt v[76:77],v14 offset:61448
mm v[216:219],v[92:95],a[56:59],v[216:219]
s_add_u32 m0,s37,33792
mm v[220:223],v[88:91],a[44:47],v[220:223]
dt v[78:79],v14 offset:61960
cv v128,v128,v129
mm v[220:223],v[92:95],a[60:63],v[220:223]
s_waitcnt lgkmcnt(4)
bl v19,s[28:31],s57 offen lds
mm v[160:163],v[64:67],a[64:67],v[160:163]
dt v[80:81],v15 offset:57344
mm v[160:163],v[68:71],a[80:83],v[160:163]
mm v[164:167],v[64:67],a[68:71],v[164:167]
dt v[82:83],v15 offset:57856
cv v129,v130,v131
mm v[164:167],v[68:71],a[84:87],v[164:167]
mm v[168:171],v[64:67],a[72:75],v[168:171]
dt v[84:85],v15 offset:61440
mm v[168:171],v[68:71],a[88:91],v[168:171]
cv v130,v144,v145
mm v[172:175],v[64:67],a[76:79],v[172:175]
dt v[86:87],v15 offset:61952
mm v[172:175],v[68:71],a[92:95],v[172:175]
s_waitcnt lgkmcnt(4)
cv v131,v146,v147
mm v[176:179],v[72:75],a[64:67],v[176:179]
dt v[88:89],v15 offset:57352
mm v[176:179],v[76:79],a[80:83],v[176:179]
v_mul_f32 v100,s62,v100
mm v[180:183],v[72:75],a[68:71],v[180:183]
dt v[90:91],v15 offset:57864
mm v[180:183],v[76:79],a[84:87],v[180:183]
mm v[184:187],v[72:75],a[72:75],v[184:187]
dt v[92:93],v15 offset:61448
v_mul_f32 v101,s62,v101
mm v[184:187],v[76:79],a[88:91],v[184:187]
s_add_u32 m0,s37,106496
s_add_u32 s58,s55,16384
mm v[188:191],v[72:75],a[76:79],v[188:191]
dt v[94:95],v15 offset:61960
mm v[188:191],v[76:79],a[92:95],v[188:191]
s_waitcnt lgkmcnt(4)
bl v16,s[24:27],s58 offen lds
mm v[192:195],v[80:83],a[64:67],v[192:195]
dt v[64:65],v12 offset:0
mm v[192:195],v[84:87],a[80:83],v[192:195]
v_mul_f32 v102,s62,v102
mm v[196:199],v[80:83],a[68:71],v[196:199]
dt v[66:67],v12 offset:512
mm v[196:199],v[84:87],a[84:87],v[196:199]
v_mul_f32 v103,s62,v103
mm v[200:203],v[80:83],a[72:75],v[200:203]
dt v[68:69],v12 offset:4096
mm v[200:203],v[84:87],a[88:91],v[200:203]
v_mul_f32 v116,s62,v116
mm v[204:207],v[80:83],a[76:79],v[204:207]
dt v[70:71],v12 offset:4608
mm v[204:207],v[84:87],a[92:95],v[204:207]
s_waitcnt lgkmcnt(4)
mm v[208:211],v[88:91],a[64:67],v[208:211]
dt v[72:73],v12 offset:8
v_mul_f32 v117,s62,v117
mm v[208:211],v[92:95],a[80:83],v[208:211]
mm v[212:215],v[88:91],a[68:71],v[212:215]
dt v[74:75],v12 offset:520
mm v[212:215],v[92:95],a[84:87],v[212:215]
v_mul_f32 v118,s62,v118
mm v[216:219],v[88:91],a[72:75],v[216:219]
dt v[76:77],v12 offset:4104
mm v[216:219],v[92:95],a[88:91],v[216:219]
s_add_u32 m0,s37,107520
v_mul_f32 v119,s62,v119
mm v[220:223],v[88:91],a[76:79],v[220:223]
dt v[78:79],v12 offset:4616
mm v[220:223],v[92:95],a[92:95],v[220:223]
s_waitcnt lgkmcnt(4)
bl v17,s[24:27],s58 offen lds
mm v[160:163],v[64:67],a[96:99],v[160:163]
dt v[80:81],v13 offset:0
mm v[160:163],v[68:71],a[112:115],v[160:163]
cv v100,v100,v101
mm v[164:167],v[64:67],a[100:103],v[164:167]
dt v[82:83],v13 offset:512
mm v[164:167],v[68:71],a[116:119],v[164:167]
cv v101,v102,v103
mm v[168:171],v[64:67],a[104:107],v[168:171]
dt v[84:85],v13 offset:4096
mm v[168:171],v[68:71],a[120:123],v[168:171]
mm v[172:175],v[64:67],a[108:111],v[172:175]
dt v[86:87],v13 offset:4608
cv v102,v116,v117
mm v[172:175],v[68:71],a[124:127],v[172:175]
s_waitcnt lgkmcnt(4)
mm v[176:179],v[72:75],a[96:99],v[176:179]
dt v[88:89],v13 offset:8
mm v[176:179],v[76:79],a[112:115],v[176:179]
cv v103,v118,v119
mm v[180:183],v[72:75],a[100:103],v[180:183]
dt v[90:91],v13 offset:520
mm v[180:183],v[76:79],a[116:119],v[180:183]
v_mul_f32 v132,s62,v132
mm v[184:187],v[72:75],a[104:107],v[184:187]
dt v[92:93],v13 offset:4104
mm v[184:187],v[76:79],a[120:123],v[184:187]
s_add_u32 m0,s37,40960
s_add_u32 s59,s55,16384
mm v[188:191],v[72:75],a[108:111],v[188:191]
dt v[94:95],v13 offset:4616
v_mul_f32 v133,s62,v133
mm v[188:191],v[76:79],a[124:127],v[188:191]
s_waitcnt lgkmcnt(4)
bl v18,s[28:31],s59 offen lds
mm v[192:195],v[80:83],a[96:99],v[192:195]
dt v[64:65],v14 offset:0
mm v[192:195],v[84:87],a[112:115],v[192:195]
mm v[196:199],v[80:83],a[100:103],v[196:199]
dt v[66:67],v14 offset:512
v_mul_f32 v134,s62,v134
mm v[196:199],v[84:87],a[116:119],v[196:199]
mm v[200:203],v[80:83],a[104:107],v[200:203]
dt v[68:69],v14 offset:4096
mm v[200:203],v[84:87],a[120:123],v[200:203]
v_mul_f32 v135,s62,v135
mm v[204:207],v[80:83],a[108:111],v[204:207]
dt v[70:71],v14 offset:4608
mm v[204:207],v[84:87],a[124:127],v[204:207]
s_waitcnt lgkmcnt(4)
v_mul_f32 v148,s62,v148
mm v[208:211],v[88:91],a[96:99],v[208:211]
dt v[72:73],v14 offset:8
mm v[208:211],v[92:95],a[112:115],v[208:211]
mm v[212:215],v[88:91],a[100:103],v[212:215]
dt v[74:75],v14 offset:520
v_mul_f32 v149,s62,v149
mm v[212:215],v[92:95],a[116:119],v[212:215]
mm v[216:219],v[88:91],a[104:107],v[216:219]
dt v[76:77],v14 offset:4104
v_mul_f32 v150,s62,v150
mm v[216:219],v[92:95],a[120:123],v[216:219]
s_add_u32 m0,s37,41984
mm v[220:223],v[88:91],a[108:111],v[220:223]
dt v[78:79],v14 offset:4616
mm v[220:223],v[92:95],a[124:127],v[220:223]
s_waitcnt lgkmcnt(4)
bl v19,s[28:31],s59 offen lds
mm v[160:163],v[64:67],a[128:131],v[160:163]
dt v[80:81],v15 offset:0
v_mul_f32 v151,s62,v151
mm v[160:163],v[68:71],a[144:147],v[160:163]
mm v[164:167],v[64:67],a[132:135],v[164:167]
dt v[82:83],v15 offset:512
mm v[164:167],v[68:71],a[148:151],v[164:167]
cv v132,v132,v133
mm v[168:171],v[64:67],a[136:139],v[168:171]
dt v[84:85],v15 offset:4096
mm v[168:171],v[68:71],a[152:155],v[168:171]
cv v133,v134,v135
mm v[172:175],v[64:67],a[140:143],v[172:175]
dt v[86:87],v15 offset:4608
mm v[172:175],v[68:71],a[156:159],v[172:175]
s_waitcnt lgkmcnt(4)
cv v134,v148,v149
mm v[176:179],v[72:75],a[128:131],v[176:179]
dt v[88:89],v15 offset:8
mm v[176:179],v[76:79],a[144:147],v[176:179]
mm v[180:183],v[72:75],a[132:135],v[180:183]
dt v[90:91],v15 offset:520
cv v135,v150,v151
mm v[180:183],v[76:79],a[148:151],v[180:183]
mm v[184:187],v[72:75],a[136:139],v[184:187]
dt v[92:93],v15 offset:4104
mm v[184:187],v[76:79],a[152:155],v[184:187]
v_mul_f32 v104,s62,v104
mm v[188:191],v[72:75],a[140:143],v[188:191]
dt v[94:95],v15 offset:4616
mm v[188:191],v[76:79],a[156:159],v[188:191]
s_waitcnt lgkmcnt(4)
s_waitcnt vmcnt(8)
mm v[192:195],v[80:83],a[128:131],v[192:195]
s_barrier
dt v[64:65],v12 offset:8192
v_mul_f32 v105,s62,v105
mm v[192:195],v[84:87],a[144:147],v[192:195]
s_add_u32 m0,s37,114688
s_add_u32 s56,s55,24576
buffer_store_dword v1,off,s[8:11],s74 offset:16 sc1
mm v[196:199],v[80:83],a[132:135],v[196:199]
dt v[66:67],v12 offset:8704
mm v[196:199],v[84:87],a[148:151],v[196:199]
bl v16,s[24:27],s56 offen lds
mm v[200:203],v[80:83],a[136:139],v[200:203]
dt v[68:69],v12 offset:12288
mm v[200:203],v[84:87],a[152:155],v[200:203]
v_mul_f32 v106,s62,v106
mm v[204:207],v[80:83],a[140:143],v[204:207]
dt v[70:71],v12 offset:12800
mm v[204:207],v[84:87],a[156:159],v[204:207]
s_waitcnt lgkmcnt(4)
v_mul_f32 v107,s62,v107
mm v[208:211],v[88:91],a[128:131],v[208:211]
dt v[72:73],v12 offset:8200
mm v[208:211],v[92:95],a[144:147],v[208:211]
v_mul_f32 v120,s62,v120
mm v[212:215],v[88:91],a[132:135],v[212:215]
dt v[74:75],v12 offset:8712
mm v[212:215],v[92:95],a[148:151],v[212:215]
mm v[216:219],v[88:91],a[136:139],v[216:219]
dt v[76:77],v12 offset:12296
v_mul_f32 v121,s62,v121
mm v[216:219],v[92:95],a[152:155],v[216:219]
mm v[220:223],v[88:91],a[140:143],v[220:223]
s_add_u32 m0,s37,115712
dt v[78:79],v12 offset:12808
mm v[220:223],v[92:95],a[156:159],v[220:223]
s_waitcnt lgkmcnt(4)
v_mul_f32 v122,s62,v122
mm v[160:163],v[64:67],a[160:163],v[160:163]
dt v[80:81],v13 offset:8192
mm v[160:163],v[68:71],a[176:179],v[160:163]
bl v17,s[24:27],s56 offen lds
mm v[164:167],v[64:67],a[164:167],v[164:167]
dt v[82:83],v13 offset:8704
v_mul_f32 v123,s62,v123
mm v[164:167],v[68:71],a[180:183],v[164:167]
mm v[168:171],v[64:67],a[168:171],v[168:171]
dt v[84:85],v13 offset:12288
mm v[168:171],v[68:71],a[184:187],v[168:171]
cv v104,v104,v105
mm v[172:175],v[64:67],a[172:175],v[172:175]
dt v[86:87],v13 offset:12800
mm v[172:175],v[68:71],a[188:191],v[172:175]
s_waitcnt lgkmcnt(4)
cv v105,v106,v107
mm v[176:179],v[72:75],a[160:163],v[176:179]
dt v[88:89],v13 offset:8200
mm v[176:179],v[76:79],a[176:179],v[176:179]
mm v[180:183],v[72:75],a[164:167],v[180:183]
dt v[90:91],v13 offset:8712
cv v106,v120,v121
mm v[180:183],v[76:79],a[180:183],v[180:183]
mm v[184:187],v[72:75],a[168:171],v[184:187]
dt v[92:93],v13 offset:12296
mm v[184:187],v[76:79],a[184:187],v[184:187]
cv v107,v122,v123
mm v[188:191],v[72:75],a[172:175],v[188:191]
s_add_u32 m0,s37,49152
s_add_u32 s57,s55,24576
dt v[94:95],v13 offset:12808
mm v[188:191],v[76:79],a[188:191],v[188:191]
s_waitcnt lgkmcnt(4)
v_mul_f32 v136,s62,v136
mm v[192:195],v[80:83],a[160:163],v[192:195]
dt v[64:65],v14 offset:8192
mm v[192:195],v[84:87],a[176:179],v[192:195]
bl v18,s[28:31],s57 offen lds
mm v[196:199],v[80:83],a[164:167],v[196:199]
dt v[66:67],v14 offset:8704
mm v[196:199],v[84:87],a[180:183],v[196:199]
v_mul_f32 v137,s62,v137
mm v[200:203],v[80:83],a[168:171],v[200:203]
dt v[68:69],v14 offset:12288
mm v[200:203],v[84:87],a[184:187],v[200:203]
mm v[204:207],v[80:83],a[172:175],v[204:207]
dt v[70:71],v14 offset:12800
v_mul_f32 v138,s62,v138
mm v[204:207],v[84:87],a[188:191],v[204:207]
s_waitcnt lgkmcnt(4)
mm v[208:211],v[88:91],a[160:163],v[208:211]
dt v[72:73],v14 offset:8200
mm v[208:211],v[92:95],a[176:179],v[208:211]
v_mul_f32 v139,s62,v139
mm v[212:215],v[88:91],a[164:167],v[212:215]
dt v[74:75],v14 offset:8712
mm v[212:215],v[92:95],a[180:183],v[212:215]
v_mul_f32 v152,s62,v152
mm v[216:219],v[88:91],a[168:171],v[216:219]
dt v[76:77],v14 offset:12296
mm v[216:219],v[92:95],a[184:187],v[216:219]
s_add_u32 m0,s37,50176
v_mul_f32 v153,s62,v153
mm v[220:223],v[88:91],a[172:175],v[220:223]
dt v[78:79],v14 offset:12808
mm v[220:223],v[92:95],a[188:191],v[220:223]
s_waitcnt lgkmcnt(4)
bl v19,s[28:31],s57 offen lds
mm v[160:163],v[64:67],a[192:195],v[160:163]
dt v[80:81],v15 offset:8192
mm v[160:163],v[68:71],a[208:211],v[160:163]
v_mul_f32 v154,s62,v154
mm v[164:167],v[64:67],a[196:199],v[164:167]
dt v[82:83],v15 offset:8704
mm v[164:167],v[68:71],a[212:215],v[164:167]
mm v[168:171],v[64:67],a[200:203],v[168:171]
dt v[84:85],v15 offset:12288
v_mul_f32 v155,s62,v155
mm v[168:171],v[68:71],a[216:219],v[168:171]
mm v[172:175],v[64:67],a[204:207],v[172:175]
dt v[86:87],v15 offset:12800
mm v[172:175],v[68:71],a[220:223],v[172:175]
s_waitcnt lgkmcnt(4)
cv v136,v136,v137
mm v[176:179],v[72:75],a[192:195],v[176:179]
dt v[88:89],v15 offset:8200
mm v[176:179],v[76:79],a[208:211],v[176:179]
cv v137,v138,v139
mm v[180:183],v[72:75],a[196:199],v[180:183]
dt v[90:91],v15 offset:8712
mm v[180:183],v[76:79],a[212:215],v[180:183]
cv v138,v152,v153
mm v[184:187],v[72:75],a[200:203],v[184:187]
dt v[92:93],v15 offset:12296
mm v[184:187],v[76:79],a[216:219],v[184:187]
s_add_u32 m0,s37,122880
s_add_u32 s58,s55,32768
mm v[188:191],v[72:75],a[204:207],v[188:191]
dt v[94:95],v15 offset:12808
mm v[188:191],v[76:79],a[220:223],v[188:191]
s_waitcnt lgkmcnt(4)
bl v16,s[24:27],s58 offen lds
mm v[192:195],v[80:83],a[192:195],v[192:195]
dt v[64:65],v12 offset:16384
cv v139,v154,v155
mm v[192:195],v[84:87],a[208:211],v[192:195]
mm v[196:199],v[80:83],a[196:199],v[196:199]
dt v[66:67],v12 offset:16896
mm v[196:199],v[84:87],a[212:215],v[196:199]
v_mul_f32 v108,s62,v108
mm v[200:203],v[80:83],a[200:203],v[200:203]
dt v[68:69],v12 offset:20480
mm v[200:203],v[84:87],a[216:219],v[200:203]
v_mul_f32 v109,s62,v109
mm v[204:207],v[80:83],a[204:207],v[204:207]
dt v[70:71],v12 offset:20992
mm v[204:207],v[84:87],a[220:223],v[204:207]
s_waitcnt lgkmcnt(4)
v_mul_f32 v110,s62,v110
mm v[208:211],v[88:91],a[192:195],v[208:211]
dt v[72:73],v12 offset:16392
mm v[208:211],v[92:95],a[208:211],v[208:211]
mm v[212:215],v[88:91],a[196:199],v[212:215]
dt v[74:75],v12 offset:16904
v_mul_f32 v111,s62,v111
mm v[212:215],v[92:95],a[212:215],v[212:215]
mm v[216:219],v[88:91],a[200:203],v[216:219]
dt v[76:77],v12 offset:20488
mm v[216:219],v[92:95],a[216:219],v[216:219]
s_add_u32 m0,s37,123904
v_mul_f32 v124,s62,v124
mm v[220:223],v[88:91],a[204:207],v[220:223]
dt v[78:79],v12 offset:21000
mm v[220:223],v[92:95],a[220:223],v[220:223]
s_waitcnt lgkmcnt(4)
bl v17,s[24:27],s58 offen lds
mm v[160:163],v[64:67],a[224:227],v[160:163]
dt v[80:81],v13 offset:16384
mm v[160:163],v[68:71],a[240:243],v[160:163]
v_mul_f32 v125,s62,v125
mm v[164:167],v[64:67],a[228:231],v[164:167]
dt v[82:83],v13 offset:16896
mm v[164:167],v[68:71],a[244:247],v[164:167]
v_mul_f32 v126,s62,v126
mm v[168:171],v[64:67],a[232:235],v[168:171]
dt v[84:85],v13 offset:20480
v_mov_b32 v49,0x44800000
mm v[168:171],v[68:71],a[248:251],v[168:171]
v_mul_f32 v127,s62,v127
mm v[172:175],v[64:67],a[236:239],v[172:175]
dt v[86:87],v13 offset:20992
mm v[172:175],v[68:71],a[252:255],v[172:175]
s_waitcnt lgkmcnt(4)
v_mov_b32 v32,0
mm v[176:179],v[72:75],a[224:227],v[176:179]
dt v[88:89],v13 offset:16392
cv v108,v108,v109
mm v[176:179],v[76:79],a[240:243],v[176:179]
mm v[180:183],v[72:75],a[228:231],v[180:183]
dt v[90:91],v13 offset:16904
v_mov_b32 v33,0
mm v[180:183],v[76:79],a[244:247],v[180:183]
cv v109,v110,v111
mm v[184:187],v[72:75],a[232:235],v[184:187]
dt v[92:93],v13 offset:20488
mm v[184:187],v[76:79],a[248:251],v[184:187]
s_add_u32 m0,s37,57344
s_add_u32 s59,s55,32768
mm v[188:191],v[72:75],a[236:239],v[188:191]
dt v[94:95],v13 offset:21000
cv v110,v124,v125
mm v[188:191],v[76:79],a[252:255],v[188:191]
s_waitcnt lgkmcnt(4)
bl v18,s[28:31],s59 offen lds
mm v[192:195],v[80:83],a[224:227],v[192:195]
dt v[64:65],v14 offset:16384
v_mov_b32 v34,0
mm v[192:195],v[84:87],a[240:243],v[192:195]
cv v111,v126,v127
mm v[196:199],v[80:83],a[228:231],v[196:199]
dt v[66:67],v14 offset:16896
mm v[196:199],v[84:87],a[244:247],v[196:199]
v_mov_b32 v35,0
mm v[200:203],v[80:83],a[232:235],v[200:203]
dt v[68:69],v14 offset:20480
v_mul_f32 v140,s62,v140
mm v[200:203],v[84:87],a[248:251],v[200:203]
mm v[204:207],v[80:83],a[236:239],v[204:207]
dt v[70:71],v14 offset:20992
mm v[204:207],v[84:87],a[252:255],v[204:207]
s_waitcnt lgkmcnt(4)
v_mul_f32 v141,s62,v141
mm v[208:211],v[88:91],a[224:227],v[208:211]
dt v[72:73],v14 offset:16392
v_bfe_u32 v55,v7,12,2
mm v[208:211],v[92:95],a[240:243],v[208:211]
mm v[212:215],v[88:91],a[228:231],v[212:215]
dt v[74:75],v14 offset:16904
v_mul_f32 v142,s62,v142
mm v[212:215],v[92:95],a[244:247],v[212:215]
mm v[216:219],v[88:91],a[232:235],v[216:219]
dt v[76:77],v14 offset:20488
v_min_u32 v54,0xf0,v2
mm v[216:219],v[92:95],a[248:251],v[216:219]
s_add_u32 m0,s37,58368
v_mul_f32 v143,s62,v143
mm v[220:223],v[88:91],a[236:239],v[220:223]
dt v[78:79],v14 offset:21000
mm v[220:223],v[92:95],a[252:255],v[220:223]
s_waitcnt lgkmcnt(4)
bl v19,s[28:31],s59 offen lds
mm v[160:163],v[64:67],v[224:227],v[160:163]
dt v[80:81],v15 offset:16384
mm v[160:163],v[68:71],v[240:243],v[160:163]
v_mul_f32 v156,s62,v156
mm v[164:167],v[64:67],v[228:231],v[164:167]
dt v[82:83],v15 offset:16896
v_lshlrev_b32 v55,11,v55
mm v[164:167],v[68:71],v[244:247],v[164:167]
mm v[168:171],v[64:67],v[232:235],v[168:171]
dt v[84:85],v15 offset:20480
v_mul_f32 v157,s62,v157
mm v[168:171],v[68:71],v[248:251],v[168:171]
mm v[172:175],v[64:67],v[236:239],v[172:175]
dt v[86:87],v15 offset:20992
mm v[172:175],v[68:71],v[252:255],v[172:175]
s_waitcnt lgkmcnt(4)
v_lshl_add_u32 v54,v54,3,v55
v_mul_f32 v158,s62,v158
mm v[176:179],v[72:75],v[224:227],v[176:179]
dt v[88:89],v15 offset:16392
mm v[176:179],v[76:79],v[240:243],v[176:179]
mm v[180:183],v[72:75],v[228:231],v[180:183]
dt v[90:91],v15 offset:16904
v_mul_f32 v159,s62,v159
mm v[180:183],v[76:79],v[244:247],v[180:183]
mm v[184:187],v[72:75],v[232:235],v[184:187]
dt v[92:93],v15 offset:20488
cv v140,v140,v141
mm v[184:187],v[76:79],v[248:251],v[184:187]
mm v[188:191],v[72:75],v[236:239],v[188:191]
dt v[94:95],v15 offset:21000
mm v[188:191],v[76:79],v[252:255],v[188:191]
s_waitcnt lgkmcnt(4)
s_waitcnt vmcnt(15)
cv v141,v142,v143
mm v[192:195],v[80:83],v[224:227],v[192:195]
s_barrier
ds_read_b128 a[128:131],v20 offset:24576
mm v[192:195],v[84:87],v[240:243],v[192:195]
s_add_u32 m0,s37,65536
s_add_u32 s56,s55,40960
ds_read_b128 a[132:135],v21 offset:24576
mm v[196:199],v[80:83],v[228:231],v[196:199]
ds_read_b128 a[136:139],v22 offset:24576
mm v[196:199],v[84:87],v[244:247],v[196:199]
ds_read_b128 a[140:143],v23 offset:24576
mm v[200:203],v[80:83],v[232:235],v[200:203]
ds_read_b128 a[144:147],v20 offset:28672
cv v142,v156,v157
mm v[200:203],v[84:87],v[248:251],v[200:203]
ds_read_b128 a[148:151],v21 offset:28672
mm v[204:207],v[80:83],v[236:239],v[204:207]
ds_read_b128 a[152:155],v22 offset:28672
mm v[204:207],v[84:87],v[252:255],v[204:207]
s_waitcnt lgkmcnt(7)
ds_read_b128 a[156:159],v23 offset:28672
mm v[208:211],v[88:91],v[224:227],v[208:211]
bl v16,s[24:27],s56 offen lds
mm v[208:211],v[92:95],v[240:243],v[208:211]
s_add_u32 m0,s37,66560
cv v143,v158,v159
mm v[212:215],v[88:91],v[228:231],v[212:215]
bl v17,s[24:27],s56 offen lds
mm v[212:215],v[92:95],v[244:247],v[212:215]
mm v[216:219],v[88:91],v[232:235],v[216:219]
s_add_u32 m0,s37,0
s_add_u32 s57,s55,40960
mm v[216:219],v[92:95],v[248:251],v[216:219]
mm v[220:223],v[88:91],v[236:239],v[220:223]
bl v18,s[28:31],s57 offen lds
mm v[220:223],v[92:95],v[252:255],v[220:223]
s_waitcnt lgkmcnt(0)
s_nop 7
v_mul_f32 v160,s62,v160
v_mul_f32 v161,s62,v161
v_mul_f32 v162,s62,v162
v_mul_f32 v163,s62,v163
v_mul_f32 v176,s62,v176
v_mul_f32 v177,s62,v177
v_mul_f32 v178,s62,v178
v_mul_f32 v179,s62,v179
cv v160,v160,v161
cv v161,v162,v163
cv v162,v176,v177
cv v163,v178,v179
v_mul_f32 v192,s62,v192
v_mul_f32 v193,s62,v193
v_mul_f32 v194,s62,v194
v_mul_f32 v195,s62,v195
v_mul_f32 v208,s62,v208
v_mul_f32 v209,s62,v209
mm v[224:227],a[128:131],v[96:99],0
v_mul_f32 v210,s62,v210
v_mul_f32 v211,s62,v211
cv v192,v192,v193
mm v[224:227],a[132:135],v[128:131],v[224:227]
s_add_u32 m0,s37,1024
ds_read_b128 a[160:163],v20 offset:32768
cv v193,v194,v195
mm v[240:243],a[144:147],v[96:99],0
cv v194,v208,v209
cv v195,v210,v211
mm v[240:243],a[148:151],v[128:131],v[240:243]
bl v19,s[28:31],s57 offen lds
v_mul_f32 v164,s62,v164
v_mul_f32 v165,s62,v165
mm v[224:227],a[136:139],v[160:163],v[224:227]
v_mul_f32 v166,s62,v166
v_mul_f32 v167,s62,v167
v_mul_f32 v180,s62,v180
v_mul_f32 v181,s62,v181
mm v[224:227],a[140:143],v[192:195],v[224:227]
ds_read_b128 a[164:167],v21 offset:32768
v_mul_f32 v182,s62,v182
v_mul_f32 v183,s62,v183
cv v164,v164,v165
mm v[240:243],a[152:155],v[160:163],v[240:243]
s_add_u32 m0,s37,73728
s_add_u32 s58,s55,49152
cv v165,v166,v167
cv v166,v180,v181
cv v167,v182,v183
mm v[240:243],a[156:159],v[192:195],v[240:243]
v_mul_f32 v196,s62,v196
v_mul_f32 v197,s62,v197
v_mul_f32 v198,s62,v198
v_mul_f32 v199,s62,v199
mm v[228:231],a[128:131],v[100:103],0
bl v16,s[24:27],s58 offen lds
v_mul_f32 v212,s62,v212
v_mul_f32 v213,s62,v213
mm v[228:231],a[132:135],v[132:135],v[228:231]
ds_read_b128 a[168:171],v22 offset:32768
v_mul_f32 v214,s62,v214
v_mul_f32 v215,s62,v215
cv v196,v196,v197
mm v[244:247],a[144:147],v[100:103],0
cv v197,v198,v199
cv v198,v212,v213
cv v199,v214,v215
mm v[244:247],a[148:151],v[132:135],v[244:247]
v_mul_f32 v168,s62,v168
v_mul_f32 v169,s62,v169
v_mul_f32 v170,s62,v170
v_mul_f32 v171,s62,v171
mm v[228:231],a[136:139],v[164:167],v[228:231]
s_add_u32 m0,s37,74752
v_mul_f32 v184,s62,v184
v_mul_f32 v185,s62,v185
v_mul_f32 v186,s62,v186
v_mul_f32 v187,s62,v187
mm v[228:231],a[140:143],v[196:199],v[228:231]
ds_read_b128 a[172:175],v23 offset:32768
cv v168,v168,v169
cv v169,v170,v171
mm v[244:247],a[152:155],v[164:167],v[244:247]
bl v17,s[24:27],s58 offen lds
cv v170,v184,v185
cv v171,v186,v187
mm v[244:247],a[156:159],v[196:199],v[244:247]
v_mul_f32 v200,s62,v200
v_mul_f32 v201,s62,v201
v_mul_f32 v202,s62,v202
v_mul_f32 v203,s62,v203
mm v[232:235],a[128:131],v[104:107],0
v_mul_f32 v216,s62,v216
v_mul_f32 v217,s62,v217
v_mul_f32 v218,s62,v218
mm v[232:235],a[132:135],v[136:139],v[232:235]
s_add_u32 m0,s37,8192
s_add_u32 s59,s55,49152
ds_read_b128 a[176:179],v20 offset:36864
v_mul_f32 v219,s62,v219
cv v200,v200,v201
mm v[248:251],a[144:147],v[104:107],0
cv v201,v202,v203
cv v202,v216,v217
cv v203,v218,v219
mm v[248:251],a[148:151],v[136:139],v[248:251]
bl v18,s[28:31],s59 offen lds
v_mul_f32 v172,s62,v172
v_mul_f32 v173,s62,v173
mm v[232:235],a[136:139],v[168:171],v[232:235]
v_mul_f32 v174,s62,v174
v_mul_f32 v175,s62,v175
v_mul_f32 v188,s62,v188
v_mul_f32 v189,s62,v189
mm v[232:235],a[140:143],v[200:203],v[232:235]
ds_read_b128 a[180:183],v21 offset:36864
v_mul_f32 v190,s62,v190
v_mul_f32 v191,s62,v191
cv v172,v172,v173
mm v[248:251],a[152:155],v[168:171],v[248:251]
cv v173,v174,v175
cv v174,v188,v189
cv v175,v190,v191
mm v[248:251],a[156:159],v[200:203],v[248:251]
s_add_u32 m0,s37,9216
v_mul_f32 v204,s62,v204
v_mul_f32 v205,s62,v205
v_mul_f32 v206,s62,v206
v_mul_f32 v207,s62,v207
mm v[236:239],a[128:131],v[108:111],0
v_mul_f32 v220,s62,v220
v_mul_f32 v221,s62,v221
v_mul_f32 v222,s62,v222
v_mul_f32 v223,s62,v223
mm v[236:239],a[132:135],v[140:143],v[236:239]
ds_read_b128 a[184:187],v22 offset:36864
cv v204,v204,v205
cv v205,v206,v207
cv v206,v220,v221
mm v[252:255],a[144:147],v[108:111],0
bl v19,s[28:31],s59 offen lds
cv v207,v222,v223
mm v[252:255],a[148:151],v[140:143],v[252:255]
v_max3_f32 v36,v224,v225,v226
v_max3_f32 v36,v36,v227,v240
v_max3_f32 v36,v36,v241,v242
mm v[236:239],a[136:139],v[172:175],v[236:239]
v_max_f32 v36,v36,v243
v_max3_f32 v37,v228,v229,v230
v_max3_f32 v37,v37,v231,v244
mm v[236:239],a[140:143],v[204:207],v[236:239]
ds_read_b128 a[188:191],v23 offset:36864
v_max3_f32 v37,v37,v245,v246
v_max_f32 v37,v37,v247
mm v[252:255],a[152:155],v[172:175],v[252:255]
v_max3_f32 v38,v232,v233,v234
v_max3_f32 v38,v38,v235,v248
v_max3_f32 v38,v38,v249,v250
mm v[252:255],a[156:159],v[204:207],v[252:255]
s_waitcnt lgkmcnt(4)
s_waitcnt vmcnt(14)
v_max_f32 v38,v38,v251
s_nop 6
v_max3_f32 v39,v236,v237,v238
v_max3_f32 v39,v39,v239,v252
v_max3_f32 v39,v39,v253,v254
v_max_f32 v39,v39,v255
v_mov_b32 v50,v36
v_mov_b32 v51,v37
v_mov_b32 v52,v38
v_mov_b32 v53,v39
v_permlane16_swap_b32 v36,v50
v_permlane16_swap_b32 v37,v51
v_permlane16_swap_b32 v38,v52
v_permlane16_swap_b32 v39,v53
v_max_f32 v36,v36,v50
v_max_f32 v37,v37,v51
v_max_f32 v38,v38,v52
v_max_f32 v39,v39,v53
v_mov_b32 v50,v36
v_mov_b32 v51,v37
v_mov_b32 v52,v38
v_mov_b32 v53,v39
v_permlane32_swap_b32 v36,v50
v_permlane32_swap_b32 v37,v51
v_permlane32_swap_b32 v38,v52
v_permlane32_swap_b32 v39,v53
v_max_f32 v36,v36,v50
v_max_f32 v37,v37,v51
v_max_f32 v38,v38,v52
v_max_f32 v39,v39,v53
v_sub_f32 v80,0,v36
v_sub_f32 v81,0,v36
v_sub_f32 v82,0,v36
v_sub_f32 v83,0,v36
v_sub_f32 v224,v224,v36
v_sub_f32 v225,v225,v36
mm v[112:115],a[160:163],v[96:99],v[80:83]
s_barrier
v_sub_f32 v84,0,v37
v_sub_f32 v85,0,v37
v_sub_f32 v86,0,v37
v_sub_f32 v87,0,v37
mm v[112:115],a[164:167],v[128:131],v[112:115]
s_add_u32 m0,s37,81920
s_add_u32 s56,s55,57344
ds_read_b128 a[128:131],v20 offset:40960
v_sub_f32 v226,v226,v36
mm v[112:115],a[168:171],v[160:163],v[112:115]
bl v16,s[24:27],s56 offen lds
v_sub_f32 v227,v227,v36
mm v[112:115],a[172:175],v[192:195],v[112:115]
v_sub_f32 v88,0,v38
v_sub_f32 v89,0,v38
v_sub_f32 v90,0,v38
mm v[116:119],a[160:163],v[100:103],v[84:87]
v_sub_f32 v91,0,v38
v_sub_f32 v240,v240,v36
mm v[116:119],a[164:167],v[132:135],v[116:119]
ds_read_b128 a[132:135],v21 offset:40960
v_sub_f32 v241,v241,v36
mm v[116:119],a[168:171],v[164:167],v[116:119]
v_sub_f32 v242,v242,v36
v_sub_f32 v243,v243,v36
mm v[116:119],a[172:175],v[196:199],v[116:119]
v_sub_f32 v92,0,v39
v_sub_f32 v93,0,v39
v_sub_f32 v94,0,v39
mm v[120:123],a[160:163],v[104:107],v[88:91]
v_sub_f32 v95,0,v39
v_sub_f32 v228,v228,v37
mm v[120:123],a[164:167],v[136:139],v[120:123]
ds_read_b128 a[136:139],v22 offset:40960
v_sub_f32 v229,v229,v37
mm v[120:123],a[168:171],v[168:171],v[120:123]
s_add_u32 m0,s37,82944
v_sub_f32 v230,v230,v37
v_sub_f32 v231,v231,v37
mm v[120:123],a[172:175],v[200:203],v[120:123]
v_sub_f32 v244,v244,v37
v_sub_f32 v245,v245,v37
v_sub_f32 v246,v246,v37
mm v[124:127],a[160:163],v[108:111],v[92:95]
bl v17,s[24:27],s56 offen lds
v_sub_f32 v247,v247,v37
mm v[124:127],a[164:167],v[140:143],v[124:127]
ds_read_b128 a[140:143],v23 offset:40960
mm v[124:127],a[168:171],v[172:175],v[124:127]
v_exp_f32 v40,v224
mm v[124:127],a[172:175],v[204:207],v[124:127]
s_waitcnt lgkmcnt(4)
v_exp_f32 v41,v225
mm v[144:147],a[176:179],v[96:99],v[80:83]
v_exp_f32 v42,v226
mm v[144:147],a[180:183],v[128:131],v[144:147]
dt a[160:161],v24 offset:24576
mm v[144:147],a[184:187],v[160:163],v[144:147]
v_exp_f32 v43,v227
v_add_f32 v36,v40,v41
mm v[144:147],a[188:191],v[192:195],v[144:147]
dt a[162:163],v24 offset:28672
cv v176,v40,v41
mm v[148:151],a[176:179],v[100:103],v[84:87]
v_exp_f32 v44,v240
v_add_f32 v36,v36,v42
mm v[148:151],a[180:183],v[132:135],v[148:151]
dt a[164:165],v25 offset:24576
mm v[148:151],a[184:187],v[164:167],v[148:151]
v_exp_f32 v45,v241
v_add_f32 v36,v36,v43
mm v[148:151],a[188:191],v[196:199],v[148:151]
s_add_u32 m0,s37,16384
s_add_u32 s57,s55,57344
dt a[166:167],v25 offset:28672
mm v[152:155],a[176:179],v[104:107],v[88:91]
cv v177,v42,v43
v_exp_f32 v46,v242
mm v[152:155],a[180:183],v[136:139],v[152:155]
dt a[168:169],v26 offset:24576
v_add_f32 v36,v36,v44
mm v[152:155],a[184:187],v[168:171],v[152:155]
bl v18,s[28:31],s57 offen lds
mm v[152:155],a[188:191],v[200:203],v[152:155]
dt a[170:171],v26 offset:28672
mm v[156:159],a[176:179],v[108:111],v[92:95]
v_exp_f32 v47,v243
v_add_f32 v36,v36,v45
mm v[156:159],a[180:183],v[140:143],v[156:159]
dt a[172:173],v27 offset:24576
cv v178,v44,v45
mm v[156:159],a[184:187],v[172:175],v[156:159]
v_sub_f32 v232,v232,v38
v_sub_f32 v233,v233,v38
v_sub_f32 v234,v234,v38
mm v[156:159],a[188:191],v[204:207],v[156:159]
s_waitcnt lgkmcnt(7)
dt a[174:175],v27 offset:28672
v_sub_f32 v235,v235,v38
v_sub_f32 v248,v248,v38
v_sub_f32 v249,v249,v38
v_sub_f32 v250,v250,v38
v_sub_f32 v251,v251,v38
v_exp_f32 v56,v228
v_add_f32 v36,v36,v46
v_exp_f32 v57,v229
v_add_f32 v36,v36,v47
cv v179,v46,v47
v_exp_f32 v58,v230
v_exp_f32 v59,v231
v_add_f32 v37,v56,v57
cv v180,v56,v57
v_exp_f32 v40,v244
v_add_f32 v37,v37,v58
v_exp_f32 v41,v245
v_add_f32 v37,v37,v59
cv v181,v58,v59
v_exp_f32 v42,v246
v_add_f32 v37,v37,v40
v_exp_f32 v43,v247
v_add_f32 v37,v37,v41
cv v182,v40,v41
v_sub_f32 v236,v236,v39
v_sub_f32 v237,v237,v39
v_sub_f32 v238,v238,v39
v_sub_f32 v239,v239,v39
v_sub_f32 v252,v252,v39
v_sub_f32 v253,v253,v39
v_sub_f32 v254,v254,v39
v_sub_f32 v255,v255,v39
v_exp_f32 v44,v232
v_add_f32 v37,v37,v42
v_exp_f32 v45,v233
v_add_f32 v37,v37,v43
cv v183,v42,v43
v_exp_f32 v46,v234
v_exp_f32 v47,v235
v_add_f32 v38,v44,v45
cv v184,v44,v45
v_exp_f32 v56,v248
v_add_f32 v38,v38,v46
v_exp_f32 v57,v249
v_add_f32 v38,v38,v47
cv v185,v46,v47
v_exp_f32 v58,v250
v_add_f32 v38,v38,v56
v_exp_f32 v59,v251
v_add_f32 v38,v38,v57
cv v186,v56,v57
v_exp_f32 v40,v236
v_add_f32 v38,v38,v58
v_exp_f32 v41,v237
v_add_f32 v38,v38,v59
cv v187,v58,v59
v_exp_f32 v42,v238
v_exp_f32 v43,v239
v_add_f32 v39,v40,v41
cv v188,v40,v41
v_exp_f32 v44,v252
v_add_f32 v39,v39,v42
v_exp_f32 v45,v253
v_add_f32 v39,v39,v43
cv v189,v42,v43
v_exp_f32 v46,v254
v_add_f32 v39,v39,v44
v_exp_f32 v47,v255
v_add_f32 v39,v39,v45
cv v190,v44,v45
v_add_f32 v39,v39,v46
v_add_f32 v39,v39,v47
cv v191,v46,v47
s_nop 1
mm v[224:227],a[128:131],v[96:99],v[80:83]
v_exp_f32 v40,v112
mm v[224:227],a[132:135],v[128:131],v[224:227]
ds_read_b128 a[144:147],v20 offset:45056
ds_read_b128 v[60:63],v7 offset:48
v_add_f32 v32,v32,v36
mm v[224:227],a[136:139],v[160:163],v[224:227]
v_exp_f32 v41,v113
mm v[224:227],a[140:143],v[192:195],v[224:227]
v_exp_f32 v42,v114
mm v[228:231],a[128:131],v[100:103],v[84:87]
s_add_u32 m0,s37,17408
v_exp_f32 v43,v115
mm v[228:231],a[132:135],v[132:135],v[228:231]
ds_read_b128 a[148:151],v21 offset:45056
v_exp_f32 v44,v144
mm v[228:231],a[136:139],v[164:167],v[228:231]
bl v19,s[28:31],s57 offen lds
mm v[228:231],a[140:143],v[196:199],v[228:231]
ds_read_b128 v[8:11],v7 offset:16
v_exp_f32 v45,v145
mm v[232:235],a[128:131],v[104:107],v[88:91]
v_exp_f32 v46,v146
mm v[232:235],a[132:135],v[136:139],v[232:235]
ds_read_b128 a[152:155],v22 offset:45056
v_add_f32 v36,v40,v41
mm v[232:235],a[136:139],v[168:171],v[232:235]
v_exp_f32 v47,v147
cv v208,v40,v41
mm v[232:235],a[140:143],v[200:203],v[232:235]
ds_read_b128 v[12:15],v7 offset:32
v_add_f32 v36,v36,v42
mm v[236:239],a[128:131],v[108:111],v[92:95]
v_exp_f32 v56,v116
v_add_f32 v36,v36,v43
mm v[236:239],a[132:135],v[140:143],v[236:239]
ds_read_b128 a[156:159],v23 offset:45056
cv v209,v42,v43
mm v[236:239],a[136:139],v[172:175],v[236:239]
v_exp_f32 v57,v117
v_add_f32 v36,v36,v44
mm v[236:239],a[140:143],v[204:207],v[236:239]
s_waitcnt lgkmcnt(7)
v_exp_f32 v58,v118
mm a[0:3],a[160:163],v[176:179],0
s_add_u32 m0,s37,90112
s_add_u32 s58,s55,65536
ds_read_b128 v[4:7],v7 offset:0
v_add_f32 v36,v36,v45
mm a[4:7],a[160:163],v[180:183],0
dt a[176:177],v28 offset:24576
cv v210,v44,v45
mm a[8:11],a[160:163],v[184:187],0
bl v16,s[24:27],s58 offen lds
mm a[12:15],a[160:163],v[188:191],0
dt a[178:179],v28 offset:28672
v_exp_f32 v59,v119
mm a[16:19],a[164:167],v[176:179],0
v_exp_f32 v40,v148
mm a[20:23],a[164:167],v[180:183],0
dt a[180:181],v29 offset:24576
v_exp_f32 v41,v149
mm a[24:27],a[164:167],v[184:187],0
v_exp_f32 v42,v150
mm a[28:31],a[164:167],v[188:191],0
dt a[182:183],v29 offset:28672
v_exp_f32 v43,v151
mm a[32:35],a[168:171],v[176:179],0
v_exp_f32 v44,v120
mm a[36:39],a[168:171],v[180:183],0
dt a[184:185],v30 offset:24576
v_exp_f32 v45,v121
mm a[40:43],a[168:171],v[184:187],0
v_add_f32 v36,v36,v46
v_add_f32 v36,v36,v47
mm a[44:47],a[168:171],v[188:191],0
dt a[186:187],v30 offset:28672
cv v211,v46,v47
mm a[48:51],a[172:175],v[176:179],0
v_exp_f32 v46,v122
v_add_f32 v33,v33,v37
mm a[52:55],a[172:175],v[180:183],0
dt a[188:189],v31 offset:24576
v_add_f32 v37,v56,v57
mm a[56:59],a[172:175],v[184:187],0
s_add_u32 m0,s37,91136
v_exp_f32 v47,v123
cv v212,v56,v57
mm a[60:63],a[172:175],v[188:191],0
s_waitcnt lgkmcnt(8)
dt a[190:191],v31 offset:28672
v_add_f32 v37,v37,v58
mm v[240:243],a[144:147],v[96:99],v[80:83]
bl v17,s[24:27],s58 offen lds
v_add_f32 v37,v37,v59
mm v[240:243],a[148:151],v[128:131],v[240:243]
ds_read_b128 a[128:131],v20 offset:49152
cv v213,v58,v59
mm v[240:243],a[152:155],v[160:163],v[240:243]
v_exp_f32 v56,v152
v_add_f32 v37,v37,v40
mm v[240:243],a[156:159],v[192:195],v[240:243]
v_exp_f32 v57,v153
mm v[244:247],a[144:147],v[100:103],v[84:87]
v_exp_f32 v58,v154
mm v[244:247],a[148:151],v[132:135],v[244:247]
ds_read_b128 a[132:135],v21 offset:49152
v_exp_f32 v59,v155
mm v[244:247],a[152:155],v[164:167],v[244:247]
v_add_f32 v37,v37,v41
cv v214,v40,v41
mm v[244:247],a[156:159],v[196:199],v[244:247]
v_exp_f32 v40,v124
v_add_f32 v37,v37,v42
mm v[248:251],a[144:147],v[104:107],v[88:91]
v_exp_f32 v41,v125
mm v[248:251],a[148:151],v[136:139],v[248:251]
s_nop 0
ds_read_b128 a[136:139],v22 offset:49152
v_add_f32 v37,v37,v43
cv v215,v42,v43
mm v[248:251],a[152:155],v[168:171],v[248:251]
v_exp_f32 v42,v126
mm v[248:251],a[156:159],v[200:203],v[248:251]
buffer_load_dword v55,v54,s[32:35],s83 offen
v_add_f32 v34,v34,v38
mm v[252:255],a[144:147],v[108:111],v[92:95]
v_exp_f32 v43,v127
mm v[252:255],a[148:151],v[140:143],v[252:255]
ds_read_b128 a[140:143],v23 offset:49152
v_add_f32 v38,v44,v45
mm v[252:255],a[152:155],v[172:175],v[252:255]
cv v216,v44,v45
v_exp_f32 v44,v156
mm v[252:255],a[156:159],v[204:207],v[252:255]
s_waitcnt lgkmcnt(4)
v_exp_f32 v45,v157
mm a[64:67],a[176:179],v[176:179],0
v_add_f32 v38,v38,v46
v_add_f32 v38,v38,v47
cv v217,v46,v47
mm a[68:71],a[176:179],v[180:183],0
dt a[160:161],v24 offset:32768
v_add_f32 v38,v38,v56
mm a[72:75],a[176:179],v[184:187],0
v_exp_f32 v46,v158
v_add_f32 v38,v38,v57
mm a[76:79],a[176:179],v[188:191],0
dt a[162:163],v24 offset:36864
cv v218,v56,v57
mm a[80:83],a[180:183],v[176:179],0
v_exp_f32 v47,v159
v_add_f32 v38,v38,v58
mm a[84:87],a[180:183],v[180:183],0
dt a[164:165],v25 offset:32768
v_add_f32 v38,v38,v59
mm a[88:91],a[180:183],v[184:187],0
s_getpc_b64 s[0:1]
L_cpf9:
s_add_u32 s100,s47,4096
s_min_u32 s100,s100,L_code_end-1024-L_cpf9
s_add_u32 s0,s0,s100
s_addc_u32 s1,s1,0
cv v219,v58,v59
v_add_f32 v35,v35,v39
mm a[92:95],a[180:183],v[188:191],0
dt a[166:167],v25 offset:36864
v_add_f32 v39,v40,v41
cv v220,v40,v41
mm a[96:99],a[184:187],v[176:179],0
global_load_dword v55,v3,s[0:1]
mm a[100:103],a[184:187],v[180:183],0
dt a[168:169],v26 offset:32768
v_add_f32 v39,v39,v42
v_add_f32 v39,v39,v43
mm a[104:107],a[184:187],v[184:187],0
cv v221,v42,v43
v_add_f32 v39,v39,v44
mm a[108:111],a[184:187],v[188:191],0
dt a[170:171],v26 offset:36864
v_add_f32 v39,v39,v45
cv v222,v44,v45
mm a[112:115],a[188:191],v[176:179],0
v_add_f32 v39,v39,v46
v_add_f32 v39,v39,v47
mm a[116:119],a[188:191],v[180:183],0
dt a[172:173],v27 offset:32768
cv v223,v46,v47
v_max3_f32 v48,v36,v37,v38
mm a[120:123],a[188:191],v[184:187],0
v_max_f32 v48,v48,v39
v_cmp_nle_f32 vcc,v48,v49
mm a[124:127],a[188:191],v[188:191],0
s_waitcnt lgkmcnt(7)
dt a[174:175],v27 offset:36864
s_cbranch_vccnz L_rareg1
L_backg1:
mm v[112:115],a[128:131],v[96:99],v[80:83]
v_exp_f32 v40,v224
mm v[112:115],a[132:135],v[128:131],v[112:115]
ds_read_b128 a[144:147],v20 offset:53248
v_exp_f32 v41,v225
mm v[112:115],a[136:139],v[160:163],v[112:115]
v_exp_f32 v42,v226
mm v[112:115],a[140:143],v[192:195],v[112:115]
s_add_u32 s83,s83,8192
v_exp_f32 v43,v227
v_add_f32 v32,v32,v36
mm v[116:119],a[128:131],v[100:103],v[84:87]
v_exp_f32 v44,v240
mm v[116:119],a[132:135],v[132:135],v[116:119]
ds_read_b128 a[148:151],v21 offset:53248
v_add_f32 v36,v40,v41
mm v[116:119],a[136:139],v[164:167],v[116:119]
buffer_load_dword v55,v54,s[32:35],s83 offen
cv v176,v40,v41
mm v[116:119],a[140:143],v[196:199],v[116:119]
v_exp_f32 v45,v241
mm v[120:123],a[128:131],v[104:107],v[88:91]
v_exp_f32 v46,v242
mm v[120:123],a[132:135],v[136:139],v[120:123]
ds_read_b128 a[152:155],v22 offset:53248
v_exp_f32 v47,v243
mm v[120:123],a[136:139],v[168:171],v[120:123]
v_exp_f32 v56,v228
mm v[120:123],a[140:143],v[200:203],v[120:123]
v_exp_f32 v57,v229
v_add_f32 v36,v36,v42
mm v[124:127],a[128:131],v[108:111],v[92:95]
v_exp_f32 v58,v230
mm v[124:127],a[132:135],v[140:143],v[124:127]
ds_read_b128 a[156:159],v23 offset:53248
v_add_f32 v36,v36,v43
mm v[124:127],a[136:139],v[172:175],v[124:127]
v_exp_f32 v59,v231
cv v177,v42,v43
mm v[124:127],a[140:143],v[204:207],v[124:127]
s_waitcnt lgkmcnt(4)
s_add_u32 s83,s83,8192
v_add_f32 v36,v36,v44
mm a[0:3],a[160:163],v[208:211],a[0:3]
v_exp_f32 v40,v244
mm a[4:7],a[160:163],v[212:215],a[4:7]
dt a[176:177],v28 offset:32768
v_exp_f32 v41,v245
mm a[8:11],a[160:163],v[216:219],a[8:11]
buffer_load_dword v55,v54,s[32:35],s83 offen
mm a[12:15],a[160:163],v[220:223],a[12:15]
dt a[178:179],v28 offset:36864
v_add_f32 v36,v36,v45
mm a[16:19],a[164:167],v[208:211],a[16:19]
v_exp_f32 v42,v246
cv v178,v44,v45
mm a[20:23],a[164:167],v[212:215],a[20:23]
dt a[180:181],v29 offset:32768
v_add_f32 v36,v36,v46
mm a[24:27],a[164:167],v[216:219],a[24:27]
v_exp_f32 v43,v247
v_add_f32 v36,v36,v47
mm a[28:31],a[164:167],v[220:223],a[28:31]
dt a[182:183],v29 offset:36864
cv v179,v46,v47
mm a[32:35],a[168:171],v[208:211],a[32:35]
v_exp_f32 v44,v232
mm a[36:39],a[168:171],v[212:215],a[36:39]
dt a[184:185],v30 offset:32768
v_exp_f32 v45,v233
mm a[40:43],a[168:171],v[216:219],a[40:43]
v_exp_f32 v46,v234
mm a[44:47],a[168:171],v[220:223],a[44:47]
dt a[186:187],v30 offset:36864
v_add_f32 v33,v33,v37
mm a[48:51],a[172:175],v[208:211],a[48:51]
v_exp_f32 v47,v235
v_add_f32 v37,v56,v57
mm a[52:55],a[172:175],v[212:215],a[52:55]
dt a[188:189],v31 offset:32768
cv v180,v56,v57
mm a[56:59],a[172:175],v[216:219],a[56:59]
v_exp_f32 v56,v248
mm a[60:63],a[172:175],v[220:223],a[60:63]
s_waitcnt lgkmcnt(7)
s_waitcnt vmcnt(16)
dt a[190:191],v31 offset:36864
v_add_f32 v37,v37,v58
mm v[144:147],a[144:147],v[96:99],v[80:83]
s_barrier
v_exp_f32 v57,v249
mm v[144:147],a[148:151],v[128:131],v[144:147]
s_add_u32 m0,s37,24576
s_add_u32 s59,s55,65536
ds_read_b128 a[128:131],v20 offset:57344
v_add_f32 v37,v37,v59
mm v[144:147],a[152:155],v[160:163],v[144:147]
bl v18,s[28:31],s59 offen lds
mm v[144:147],a[156:159],v[192:195],v[144:147]
cv v181,v58,v59
v_add_f32 v37,v37,v40
mm v[148:151],a[144:147],v[100:103],v[84:87]
v_exp_f32 v58,v250
v_add_f32 v37,v37,v41
mm v[148:151],a[148:151],v[132:135],v[148:151]
ds_read_b128 a[132:135],v21 offset:57344
cv v182,v40,v41
mm v[148:151],a[152:155],v[164:167],v[148:151]
v_exp_f32 v59,v251
mm v[148:151],a[156:159],v[196:199],v[148:151]
v_exp_f32 v40,v236
v_add_f32 v37,v37,v42
mm v[152:155],a[144:147],v[104:107],v[88:91]
v_exp_f32 v41,v237
mm v[152:155],a[148:151],v[136:139],v[152:155]
ds_read_b128 a[136:139],v22 offset:57344
v_add_f32 v37,v37,v43
mm v[152:155],a[152:155],v[168:171],v[152:155]
cv v183,v42,v43
v_exp_f32 v42,v238
mm v[152:155],a[156:159],v[200:203],v[152:155]
v_exp_f32 v43,v239
mm v[156:159],a[144:147],v[108:111],v[92:95]
v_add_f32 v34,v34,v38
v_add_f32 v38,v44,v45
cv v184,v44,v45
mm v[156:159],a[148:151],v[140:143],v[156:159]
ds_read_b128 a[140:143],v23 offset:57344
v_add_f32 v38,v38,v46
mm v[156:159],a[152:155],v[172:175],v[156:159]
v_exp_f32 v44,v252
mm v[156:159],a[156:159],v[204:207],v[156:159]
s_waitcnt lgkmcnt(4)
v_exp_f32 v45,v253
v_add_f32 v38,v38,v47
mm a[64:67],a[176:179],v[208:211],a[64:67]
cv v185,v46,v47
v_add_f32 v38,v38,v56
mm a[68:71],a[176:179],v[212:215],a[68:71]
dt a[160:161],v24 offset:40960
v_add_f32 v38,v38,v57
mm a[72:75],a[176:179],v[216:219],a[72:75]
v_exp_f32 v46,v254
cv v186,v56,v57
mm a[76:79],a[176:179],v[220:223],a[76:79]
dt a[162:163],v24 offset:45056
v_add_f32 v38,v38,v58
mm a[80:83],a[180:183],v[208:211],a[80:83]
v_exp_f32 v47,v255
mm a[84:87],a[180:183],v[212:215],a[84:87]
dt a[164:165],v25 offset:40960
v_add_f32 v38,v38,v59
cv v187,v58,v59
mm a[88:91],a[180:183],v[216:219],a[88:91]
v_add_f32 v35,v35,v39
v_add_f32 v39,v40,v41
mm a[92:95],a[180:183],v[220:223],a[92:95]
s_add_u32 m0,s37,25600
dt a[166:167],v25 offset:45056
cv v188,v40,v41
v_add_f32 v39,v39,v42
mm a[96:99],a[184:187],v[208:211],a[96:99]
v_add_f32 v39,v39,v43
cv v189,v42,v43
mm a[100:103],a[184:187],v[212:215],a[100:103]
dt a[168:169],v26 offset:40960
v_add_f32 v39,v39,v44
mm a[104:107],a[184:187],v[216:219],a[104:107]
bl v19,s[28:31],s59 offen lds
v_add_f32 v39,v39,v45
mm a[108:111],a[184:187],v[220:223],a[108:111]
dt a[170:171],v26 offset:45056
cv v190,v44,v45
mm a[112:115],a[188:191],v[208:211],a[112:115]
v_add_f32 v39,v39,v46
v_add_f32 v39,v39,v47
mm a[116:119],a[188:191],v[212:215],a[116:119]
dt a[172:173],v27 offset:40960
cv v191,v46,v47
v_max3_f32 v48,v36,v37,v38
mm a[120:123],a[188:191],v[216:219],a[120:123]
v_max_f32 v48,v48,v39
v_cmp_nle_f32 vcc,v48,v49
mm a[124:127],a[188:191],v[220:223],a[124:127]
s_waitcnt lgkmcnt(7)
dt a[174:175],v27 offset:45056
s_cbranch_vccnz L_rareg2
L_backg2:
mm v[224:227],a[128:131],v[96:99],v[80:83]
v_exp_f32 v40,v112
mm v[224:227],a[132:135],v[128:131],v[224:227]
ds_read_b128 a[144:147],v20 offset:61440
v_exp_f32 v41,v113
mm v[224:227],a[136:139],v[160:163],v[224:227]
v_exp_f32 v42,v114
mm v[224:227],a[140:143],v[192:195],v[224:227]
v_exp_f32 v43,v115
mm v[228:231],a[128:131],v[100:103],v[84:87]
v_exp_f32 v44,v144
v_add_f32 v32,v32,v36
mm v[228:231],a[132:135],v[132:135],v[228:231]
ds_read_b128 a[148:151],v21 offset:61440
v_add_f32 v36,v40,v41
mm v[228:231],a[136:139],v[164:167],v[228:231]
v_exp_f32 v45,v145
mm v[228:231],a[140:143],v[196:199],v[228:231]
v_exp_f32 v46,v146
mm v[232:235],a[128:131],v[104:107],v[88:91]
v_exp_f32 v47,v147
cv v208,v40,v41
mm v[232:235],a[132:135],v[136:139],v[232:235]
ds_read_b128 a[152:155],v22 offset:61440
v_add_f32 v36,v36,v42
mm v[232:235],a[136:139],v[168:171],v[232:235]
v_exp_f32 v56,v116
mm v[232:235],a[140:143],v[200:203],v[232:235]
v_exp_f32 v57,v117
mm v[236:239],a[128:131],v[108:111],v[92:95]
v_exp_f32 v58,v118
v_add_f32 v36,v36,v43
mm v[236:239],a[132:135],v[140:143],v[236:239]
ds_read_b128 a[156:159],v23 offset:61440
cv v209,v42,v43
mm v[236:239],a[136:139],v[172:175],v[236:239]
v_exp_f32 v59,v119
mm v[236:239],a[140:143],v[204:207],v[236:239]
s_waitcnt lgkmcnt(4)
v_exp_f32 v40,v148
mm a[0:3],a[160:163],v[176:179],a[0:3]
s_add_u32 s83,s83,8192
v_exp_f32 v41,v149
v_add_f32 v36,v36,v44
mm a[4:7],a[160:163],v[180:183],a[4:7]
dt a[176:177],v28 offset:40960
v_add_f32 v36,v36,v45
mm a[8:11],a[160:163],v[184:187],a[8:11]
buffer_load_dword v55,v54,s[32:35],s83 offen
mm a[12:15],a[160:163],v[188:191],a[12:15]
dt a[178:179],v28 offset:45056
cv v210,v44,v45
mm a[16:19],a[164:167],v[176:179],a[16:19]
v_exp_f32 v42,v150
v_add_f32 v36,v36,v46
mm a[20:23],a[164:167],v[180:183],a[20:23]
dt a[180:181],v29 offset:40960
v_add_f32 v36,v36,v47
mm a[24:27],a[164:167],v[184:187],a[24:27]
v_exp_f32 v43,v151
mm a[28:31],a[164:167],v[188:191],a[28:31]
dt a[182:183],v29 offset:45056
cv v211,v46,v47
mm a[32:35],a[168:171],v[176:179],a[32:35]
v_exp_f32 v44,v120
v_add_f32 v33,v33,v37
mm a[36:39],a[168:171],v[180:183],a[36:39]
dt a[184:185],v30 offset:40960
v_add_f32 v37,v56,v57
mm a[40:43],a[168:171],v[184:187],a[40:43]
v_exp_f32 v45,v121
mm a[44:47],a[168:171],v[188:191],a[44:47]
dt a[186:187],v30 offset:45056
cv v212,v56,v57
mm a[48:51],a[172:175],v[176:179],a[48:51]
v_exp_f32 v46,v122
v_add_f32 v37,v37,v58
mm a[52:55],a[172:175],v[180:183],a[52:55]
dt a[188:189],v31 offset:40960
v_add_f32 v37,v37,v59
mm a[56:59],a[172:175],v[184:187],a[56:59]
v_exp_f32 v47,v123
mm a[60:63],a[172:175],v[188:191],a[60:63]
s_waitcnt lgkmcnt(7)
dt a[190:191],v31 offset:45056
cv v213,v58,v59
mm v[240:243],a[144:147],v[96:99],v[80:83]
v_exp_f32 v56,v152
v_add_f32 v37,v37,v40
mm v[240:243],a[148:151],v[128:131],v[240:243]
ds_read_b128 a[128:131],v20 offset:0
v_add_f32 v37,v37,v41
mm v[240:243],a[152:155],v[160:163],v[240:243]
v_exp_f32 v57,v153
mm v[240:243],a[156:159],v[192:195],v[240:243]
v_exp_f32 v58,v154
mm v[244:247],a[144:147],v[100:103],v[84:87]
v_exp_f32 v59,v155
cv v214,v40,v41
mm v[244:247],a[148:151],v[132:135],v[244:247]
ds_read_b128 a[132:135],v21 offset:0
v_add_f32 v37,v37,v42
mm v[244:247],a[152:155],v[164:167],v[244:247]
v_exp_f32 v40,v124
mm v[244:247],a[156:159],v[196:199],v[244:247]
v_exp_f32 v41,v125
mm v[248:251],a[144:147],v[104:107],v[88:91]
v_add_f32 v37,v37,v43
cv v215,v42,v43
v_add_f32 v34,v34,v38
mm v[248:251],a[148:151],v[136:139],v[248:251]
s_add_u32 s83,s83,8192
ds_read_b128 a[136:139],v22 offset:0
v_add_f32 v38,v44,v45
mm v[248:251],a[152:155],v[168:171],v[248:251]
v_exp_f32 v42,v126
mm v[248:251],a[156:159],v[200:203],v[248:251]
buffer_load_dword v55,v54,s[32:35],s83 offen
mm v[252:255],a[144:147],v[108:111],v[92:95]
v_exp_f32 v43,v127
cv v216,v44,v45
mm v[252:255],a[148:151],v[140:143],v[252:255]
ds_read_b128 a[140:143],v23 offset:0
v_add_f32 v38,v38,v46
mm v[252:255],a[152:155],v[172:175],v[252:255]
v_exp_f32 v44,v156
mm v[252:255],a[156:159],v[204:207],v[252:255]
s_waitcnt lgkmcnt(4)
v_exp_f32 v45,v157
mm a[64:67],a[176:179],v[176:179],a[64:67]
v_add_f32 v38,v38,v47
cv v217,v46,v47
v_add_f32 v38,v38,v56
mm a[68:71],a[176:179],v[180:183],a[68:71]
dt a[160:161],v24 offset:49152
v_add_f32 v38,v38,v57
mm a[72:75],a[176:179],v[184:187],a[72:75]
v_exp_f32 v46,v158
mm a[76:79],a[176:179],v[188:191],a[76:79]
dt a[162:163],v24 offset:53248
cv v218,v56,v57
mm a[80:83],a[180:183],v[176:179],a[80:83]
v_exp_f32 v47,v159
v_add_f32 v38,v38,v58
mm a[84:87],a[180:183],v[180:183],a[84:87]
dt a[164:165],v25 offset:49152
v_add_f32 v38,v38,v59
mm a[88:91],a[180:183],v[184:187],a[88:91]
cv v219,v58,v59
v_add_f32 v35,v35,v39
mm a[92:95],a[180:183],v[188:191],a[92:95]
dt a[166:167],v25 offset:53248
v_add_f32 v39,v40,v41
mm a[96:99],a[184:187],v[176:179],a[96:99]
cv v220,v40,v41
v_add_f32 v39,v39,v42
v_add_f32 v39,v39,v43
mm a[100:103],a[184:187],v[180:183],a[100:103]
dt a[168:169],v26 offset:49152
cv v221,v42,v43
mm a[104:107],a[184:187],v[184:187],a[104:107]
v_add_f32 v39,v39,v44
v_add_f32 v39,v39,v45
mm a[108:111],a[184:187],v[188:191],a[108:111]
dt a[170:171],v26 offset:53248
cv v222,v44,v45
mm a[112:115],a[188:191],v[176:179],a[112:115]
v_add_f32 v39,v39,v46
v_add_f32 v39,v39,v47
cv v223,v46,v47
mm a[116:119],a[188:191],v[180:183],a[116:119]
dt a[172:173],v27 offset:49152
v_max3_f32 v48,v36,v37,v38
mm a[120:123],a[188:191],v[184:187],a[120:123]
v_max_f32 v48,v48,v39
v_cmp_nle_f32 vcc,v48,v49
mm a[124:127],a[188:191],v[188:191],a[124:127]
s_waitcnt lgkmcnt(7)
dt a[174:175],v27 offset:53248
s_cbranch_vccnz L_rareg3
L_backg3:
mm v[112:115],a[128:131],v[96:99],v[80:83]
v_exp_f32 v40,v224
mm v[112:115],a[132:135],v[128:131],v[112:115]
ds_read_b128 a[144:147],v20 offset:4096
v_exp_f32 v41,v225
mm v[112:115],a[136:139],v[160:163],v[112:115]
v_exp_f32 v42,v226
mm v[112:115],a[140:143],v[192:195],v[112:115]
s_add_u32 s83,s83,8192
v_exp_f32 v43,v227
mm v[116:119],a[128:131],v[100:103],v[84:87]
v_exp_f32 v44,v240
v_add_f32 v32,v32,v36
mm v[116:119],a[132:135],v[132:135],v[116:119]
ds_read_b128 a[148:151],v21 offset:4096
v_add_f32 v36,v40,v41
mm v[116:119],a[136:139],v[164:167],v[116:119]
buffer_load_dword v55,v54,s[32:35],s83 offen
mm v[116:119],a[140:143],v[196:199],v[116:119]
v_exp_f32 v45,v241
mm v[120:123],a[128:131],v[104:107],v[88:91]
v_exp_f32 v46,v242
cv v176,v40,v41
mm v[120:123],a[132:135],v[136:139],v[120:123]
ds_read_b128 a[152:155],v22 offset:4096
v_add_f32 v36,v36,v42
mm v[120:123],a[136:139],v[168:171],v[120:123]
v_exp_f32 v47,v243
mm v[120:123],a[140:143],v[200:203],v[120:123]
v_exp_f32 v56,v228
mm v[124:127],a[128:131],v[108:111],v[92:95]
v_exp_f32 v57,v229
v_add_f32 v36,v36,v43
mm v[124:127],a[132:135],v[140:143],v[124:127]
ds_read_b128 a[156:159],v23 offset:4096
cv v177,v42,v43
mm v[124:127],a[136:139],v[172:175],v[124:127]
v_exp_f32 v58,v230
mm v[124:127],a[140:143],v[204:207],v[124:127]
s_waitcnt lgkmcnt(4)
v_exp_f32 v59,v231
v_add_f32 v36,v36,v44
mm a[0:3],a[160:163],v[208:211],a[0:3]
v_exp_f32 v40,v244
mm a[4:7],a[160:163],v[212:215],a[4:7]
dt a[176:177],v28 offset:49152
v_add_f32 v36,v36,v45
mm a[8:11],a[160:163],v[216:219],a[8:11]
v_exp_f32 v41,v245
mm a[12:15],a[160:163],v[220:223],a[12:15]
dt a[178:179],v28 offset:53248
v_exp_f32 v42,v246
mm a[16:19],a[164:167],v[208:211],a[16:19]
v_exp_f32 v43,v247
mm a[20:23],a[164:167],v[212:215],a[20:23]
dt a[180:181],v29 offset:49152
cv v178,v44,v45
mm a[24:27],a[164:167],v[216:219],a[24:27]
v_exp_f32 v44,v232
mm a[28:31],a[164:167],v[220:223],a[28:31]
dt a[182:183],v29 offset:53248
v_exp_f32 v45,v233
mm a[32:35],a[168:171],v[208:211],a[32:35]
v_add_f32 v36,v36,v46
v_add_f32 v36,v36,v47
mm a[36:39],a[168:171],v[212:215],a[36:39]
dt a[184:185],v30 offset:49152
cv v179,v46,v47
mm a[40:43],a[168:171],v[216:219],a[40:43]
v_exp_f32 v46,v234
v_add_f32 v33,v33,v37
mm a[44:47],a[168:171],v[220:223],a[44:47]
dt a[186:187],v30 offset:53248
v_add_f32 v37,v56,v57
mm a[48:51],a[172:175],v[208:211],a[48:51]
v_exp_f32 v47,v235
mm a[52:55],a[172:175],v[212:215],a[52:55]
dt a[188:189],v31 offset:49152
cv v180,v56,v57
mm a[56:59],a[172:175],v[216:219],a[56:59]
v_exp_f32 v56,v248
v_add_f32 v37,v37,v58
mm a[60:63],a[172:175],v[220:223],a[60:63]
s_waitcnt lgkmcnt(7)
s_waitcnt vmcnt(13)
dt a[190:191],v31 offset:53248
mm v[144:147],a[144:147],v[96:99],v[80:83]
s_barrier
v_exp_f32 v57,v249
mm v[144:147],a[148:151],v[128:131],v[144:147]
s_add_u32 s83,s83,8192
ds_read_b128 a[128:131],v20 offset:8192
v_add_f32 v37,v37,v59
mm v[144:147],a[152:155],v[160:163],v[144:147]
buffer_load_dword v55,v54,s[32:35],s83 offen
cv v181,v58,v59
mm v[144:147],a[156:159],v[192:195],v[144:147]
v_exp_f32 v58,v250
mm v[148:151],a[144:147],v[100:103],v[84:87]
v_exp_f32 v59,v251
mm v[148:151],a[148:151],v[132:135],v[148:151]
ds_read_b128 a[132:135],v21 offset:8192
v_add_f32 v37,v37,v40
mm v[148:151],a[152:155],v[164:167],v[148:151]
v_add_f32 v37,v37,v41
cv v182,v40,v41
v_add_f32 v37,v37,v42
mm v[148:151],a[156:159],v[196:199],v[148:151]
v_exp_f32 v40,v236
mm v[152:155],a[144:147],v[104:107],v[88:91]
v_exp_f32 v41,v237
mm v[152:155],a[148:151],v[136:139],v[152:155]
ds_read_b128 a[136:139],v22 offset:8192
v_add_f32 v37,v37,v43
cv v183,v42,v43
mm v[152:155],a[152:155],v[168:171],v[152:155]
v_exp_f32 v42,v238
mm v[152:155],a[156:159],v[200:203],v[152:155]
v_exp_f32 v43,v239
mm v[156:159],a[144:147],v[108:111],v[92:95]
v_add_f32 v34,v34,v38
v_add_f32 v38,v44,v45
mm v[156:159],a[148:151],v[140:143],v[156:159]
ds_read_b128 a[140:143],v23 offset:8192
cv v184,v44,v45
v_add_f32 v38,v38,v46
mm v[156:159],a[152:155],v[172:175],v[156:159]
v_exp_f32 v44,v252
mm v[156:159],a[156:159],v[204:207],v[156:159]
s_waitcnt lgkmcnt(4)
v_exp_f32 v45,v253
mm a[64:67],a[176:179],v[208:211],a[64:67]
v_add_f32 v38,v38,v47
cv v185,v46,v47
mm a[68:71],a[176:179],v[212:215],a[68:71]
dt a[160:161],v24 offset:57344
v_exp_f32 v46,v254
mm a[72:75],a[176:179],v[216:219],a[72:75]
v_exp_f32 v47,v255
mm a[76:79],a[176:179],v[220:223],a[76:79]
dt a[162:163],v24 offset:61440
v_add_f32 v38,v38,v56
mm a[80:83],a[180:183],v[208:211],a[80:83]
v_add_f32 v38,v38,v57
cv v186,v56,v57
v_add_f32 v38,v38,v58
mm a[84:87],a[180:183],v[212:215],a[84:87]
dt a[164:165],v25 offset:57344
v_add_f32 v38,v38,v59
mm a[88:91],a[180:183],v[216:219],a[88:91]
cv v187,v58,v59
v_add_f32 v35,v35,v39
mm a[92:95],a[180:183],v[220:223],a[92:95]
dt a[166:167],v25 offset:61440
v_add_f32 v39,v40,v41
mm a[96:99],a[184:187],v[208:211],a[96:99]
cv v188,v40,v41
v_add_f32 v39,v39,v42
v_add_f32 v39,v39,v43
mm a[100:103],a[184:187],v[212:215],a[100:103]
dt a[168:169],v26 offset:57344
cv v189,v42,v43
mm a[104:107],a[184:187],v[216:219],a[104:107]
v_add_f32 v39,v39,v44
v_add_f32 v39,v39,v45
mm a[108:111],a[184:187],v[220:223],a[108:111]
dt a[170:171],v26 offset:61440
cv v190,v44,v45
mm a[112:115],a[188:191],v[208:211],a[112:115]
v_add_f32 v39,v39,v46
v_add_f32 v39,v39,v47
cv v191,v46,v47
mm a[116:119],a[188:191],v[212:215],a[116:119]
dt a[172:173],v27 offset:57344
v_max3_f32 v48,v36,v37,v38
mm a[120:123],a[188:191],v[216:219],a[120:123]
v_max_f32 v48,v48,v39
v_cmp_nle_f32 vcc,v48,v49
mm a[124:127],a[188:191],v[220:223],a[124:127]
s_waitcnt lgkmcnt(7)
dt a[174:175],v27 offset:61440
s_cbranch_vccnz L_rareg4
L_backg4:
mm v[224:227],a[128:131],v[96:99],v[80:83]
v_exp_f32 v40,v112
mm v[224:227],a[132:135],v[128:131],v[224:227]
ds_read_b128 a[144:147],v20 offset:12288
v_exp_f32 v41,v113
mm v[224:227],a[136:139],v[160:163],v[224:227]
v_exp_f32 v42,v114
mm v[224:227],a[140:143],v[192:195],v[224:227]
v_exp_f32 v43,v115
mm v[228:231],a[128:131],v[100:103],v[84:87]
v_exp_f32 v44,v144
v_add_f32 v32,v32,v36
mm v[228:231],a[132:135],v[132:135],v[228:231]
ds_read_b128 a[148:151],v21 offset:12288
v_add_f32 v36,v40,v41
mm v[228:231],a[136:139],v[164:167],v[228:231]
v_exp_f32 v45,v145
mm v[228:231],a[140:143],v[196:199],v[228:231]
v_exp_f32 v46,v146
mm v[232:235],a[128:131],v[104:107],v[88:91]
s_add_u32 s83,s83,8192
v_exp_f32 v47,v147
cv v208,v40,v41
mm v[232:235],a[132:135],v[136:139],v[232:235]
ds_read_b128 a[152:155],v22 offset:12288
v_add_f32 v36,v36,v42
mm v[232:235],a[136:139],v[168:171],v[232:235]
buffer_load_dword v55,v54,s[32:35],s83 offen
mm v[232:235],a[140:143],v[200:203],v[232:235]
v_exp_f32 v56,v116
mm v[236:239],a[128:131],v[108:111],v[92:95]
v_exp_f32 v57,v117
v_add_f32 v36,v36,v43
mm v[236:239],a[132:135],v[140:143],v[236:239]
ds_read_b128 a[156:159],v23 offset:12288
cv v209,v42,v43
mm v[236:239],a[136:139],v[172:175],v[236:239]
v_exp_f32 v58,v118
mm v[236:239],a[140:143],v[204:207],v[236:239]
s_waitcnt lgkmcnt(4)
v_exp_f32 v59,v119
mm a[0:3],a[160:163],v[176:179],a[0:3]
v_exp_f32 v40,v148
v_add_f32 v36,v36,v44
mm a[4:7],a[160:163],v[180:183],a[4:7]
dt a[176:177],v28 offset:57344
v_add_f32 v36,v36,v45
mm a[8:11],a[160:163],v[184:187],a[8:11]
v_exp_f32 v41,v149
mm a[12:15],a[160:163],v[188:191],a[12:15]
dt a[178:179],v28 offset:61440
cv v210,v44,v45
mm a[16:19],a[164:167],v[176:179],a[16:19]
v_exp_f32 v42,v150
v_add_f32 v36,v36,v46
mm a[20:23],a[164:167],v[180:183],a[20:23]
dt a[180:181],v29 offset:57344
v_add_f32 v36,v36,v47
mm a[24:27],a[164:167],v[184:187],a[24:27]
v_exp_f32 v43,v151
mm a[28:31],a[164:167],v[188:191],a[28:31]
dt a[182:183],v29 offset:61440
cv v211,v46,v47
mm a[32:35],a[168:171],v[176:179],a[32:35]
v_exp_f32 v44,v120
v_add_f32 v33,v33,v37
mm a[36:39],a[168:171],v[180:183],a[36:39]
dt a[184:185],v30 offset:57344
v_add_f32 v37,v56,v57
mm a[40:43],a[168:171],v[184:187],a[40:43]
v_exp_f32 v45,v121
mm a[44:47],a[168:171],v[188:191],a[44:47]
dt a[186:187],v30 offset:61440
cv v212,v56,v57
mm a[48:51],a[172:175],v[176:179],a[48:51]
v_exp_f32 v46,v122
v_add_f32 v37,v37,v58
mm a[52:55],a[172:175],v[180:183],a[52:55]
dt a[188:189],v31 offset:57344
v_add_f32 v37,v37,v59
mm a[56:59],a[172:175],v[184:187],a[56:59]
v_exp_f32 v47,v123
mm a[60:63],a[172:175],v[188:191],a[60:63]
s_waitcnt lgkmcnt(7)
dt a[190:191],v31 offset:61440
cv v213,v58,v59
mm v[240:243],a[144:147],v[96:99],v[80:83]
v_exp_f32 v56,v152
v_add_f32 v37,v37,v40
mm v[240:243],a[148:151],v[128:131],v[240:243]
ds_read_b128 a[128:131],v20 offset:16384
v_add_f32 v37,v37,v41
mm v[240:243],a[152:155],v[160:163],v[240:243]
v_exp_f32 v57,v153
mm v[240:243],a[156:159],v[192:195],v[240:243]
v_exp_f32 v58,v154
mm v[244:247],a[144:147],v[100:103],v[84:87]
v_exp_f32 v59,v155
cv v214,v40,v41
mm v[244:247],a[148:151],v[132:135],v[244:247]
ds_read_b128 a[132:135],v21 offset:16384
v_add_f32 v37,v37,v42
mm v[244:247],a[152:155],v[164:167],v[244:247]
v_exp_f32 v40,v124
mm v[244:247],a[156:159],v[196:199],v[244:247]
v_exp_f32 v41,v125
mm v[248:251],a[144:147],v[104:107],v[88:91]
v_add_f32 v37,v37,v43
cv v215,v42,v43
v_add_f32 v34,v34,v38
mm v[248:251],a[148:151],v[136:139],v[248:251]
ds_read_b128 a[136:139],v22 offset:16384
v_add_f32 v38,v44,v45
mm v[248:251],a[152:155],v[168:171],v[248:251]
v_exp_f32 v42,v126
mm v[248:251],a[156:159],v[200:203],v[248:251]
v_exp_f32 v43,v127
mm v[252:255],a[144:147],v[108:111],v[92:95]
cv v216,v44,v45
v_exp_f32 v44,v156
mm v[252:255],a[148:151],v[140:143],v[252:255]
ds_read_b128 a[140:143],v23 offset:16384
v_add_f32 v38,v38,v46
mm v[252:255],a[152:155],v[172:175],v[252:255]
v_exp_f32 v45,v157
mm v[252:255],a[156:159],v[204:207],v[252:255]
s_waitcnt lgkmcnt(4)
v_add_f32 v38,v38,v47
cv v217,v46,v47
mm a[64:67],a[176:179],v[176:179],a[64:67]
v_exp_f32 v46,v158
v_add_f32 v38,v38,v56
mm a[68:71],a[176:179],v[180:183],a[68:71]
dt a[160:161],v24 offset:0
v_add_f32 v38,v38,v57
mm a[72:75],a[176:179],v[184:187],a[72:75]
s_add_u32 s83,s83,8192
v_exp_f32 v47,v159
mm a[76:79],a[176:179],v[188:191],a[76:79]
dt a[162:163],v24 offset:4096
cv v218,v56,v57
mm a[80:83],a[180:183],v[176:179],a[80:83]
buffer_load_dword v55,v54,s[32:35],s83 offen
v_add_f32 v38,v38,v58
mm a[84:87],a[180:183],v[180:183],a[84:87]
dt a[164:165],v25 offset:0
v_add_f32 v38,v38,v59
mm a[88:91],a[180:183],v[184:187],a[88:91]
cv v219,v58,v59
v_add_f32 v35,v35,v39
mm a[92:95],a[180:183],v[188:191],a[92:95]
dt a[166:167],v25 offset:4096
v_add_f32 v39,v40,v41
mm a[96:99],a[184:187],v[176:179],a[96:99]
cv v220,v40,v41
v_add_f32 v39,v39,v42
v_add_f32 v39,v39,v43
mm a[100:103],a[184:187],v[180:183],a[100:103]
dt a[168:169],v26 offset:0
cv v221,v42,v43
mm a[104:107],a[184:187],v[184:187],a[104:107]
v_add_f32 v39,v39,v44
v_add_f32 v39,v39,v45
mm a[108:111],a[184:187],v[188:191],a[108:111]
dt a[170:171],v26 offset:4096
cv v222,v44,v45
mm a[112:115],a[188:191],v[176:179],a[112:115]
v_add_f32 v39,v39,v46
v_add_f32 v39,v39,v47
cv v223,v46,v47
mm a[116:119],a[188:191],v[180:183],a[116:119]
dt a[172:173],v27 offset:0
v_max3_f32 v48,v36,v37,v38
mm a[120:123],a[188:191],v[184:187],a[120:123]
v_max_f32 v48,v48,v39
v_cmp_nle_f32 vcc,v48,v49
mm a[124:127],a[188:191],v[188:191],a[124:127]
s_waitcnt lgkmcnt(7)
dt a[174:175],v27 offset:4096
s_cbranch_vccnz L_rareg5
L_backg5:
mm v[112:115],a[128:131],v[96:99],v[80:83]
v_exp_f32 v40,v224
mm v[112:115],a[132:135],v[128:131],v[112:115]
ds_read_b128 a[144:147],v20 offset:20480
v_exp_f32 v41,v225
mm v[112:115],a[136:139],v[160:163],v[112:115]
v_exp_f32 v42,v226
mm v[112:115],a[140:143],v[192:195],v[112:115]
v_exp_f32 v43,v227
v_add_f32 v32,v32,v36
mm v[116:119],a[128:131],v[100:103],v[84:87]
v_exp_f32 v44,v240
mm v[116:119],a[132:135],v[132:135],v[116:119]
ds_read_b128 a[148:151],v21 offset:20480
v_exp_f32 v45,v241
mm v[116:119],a[136:139],v[164:167],v[116:119]
v_exp_f32 v46,v242
mm v[116:119],a[140:143],v[196:199],v[116:119]
v_exp_f32 v47,v243
v_add_f32 v36,v40,v41
mm v[120:123],a[128:131],v[104:107],v[88:91]
v_exp_f32 v56,v228
mm v[120:123],a[132:135],v[136:139],v[120:123]
ds_read_b128 a[152:155],v22 offset:20480
cv v176,v40,v41
mm v[120:123],a[136:139],v[168:171],v[120:123]
v_exp_f32 v57,v229
v_add_f32 v36,v36,v42
mm v[120:123],a[140:143],v[200:203],v[120:123]
v_exp_f32 v58,v230
mm v[124:127],a[128:131],v[108:111],v[92:95]
v_exp_f32 v59,v231
v_add_f32 v36,v36,v43
mm v[124:127],a[132:135],v[140:143],v[124:127]
ds_read_b128 a[156:159],v23 offset:20480
cv v177,v42,v43
mm v[124:127],a[136:139],v[172:175],v[124:127]
v_exp_f32 v40,v244
v_add_f32 v36,v36,v44
mm v[124:127],a[140:143],v[204:207],v[124:127]
s_waitcnt lgkmcnt(4)
v_exp_f32 v41,v245
mm a[0:3],a[160:163],v[208:211],a[0:3]
v_exp_f32 v42,v246
v_add_f32 v36,v36,v45
mm a[4:7],a[160:163],v[212:215],a[4:7]
dt a[176:177],v28 offset:0
cv v178,v44,v45
mm a[8:11],a[160:163],v[216:219],a[8:11]
v_exp_f32 v43,v247
mm a[12:15],a[160:163],v[220:223],a[12:15]
dt a[178:179],v28 offset:4096
v_exp_f32 v44,v232
mm a[16:19],a[164:167],v[208:211],a[16:19]
v_exp_f32 v45,v233
mm a[20:23],a[164:167],v[212:215],a[20:23]
dt a[180:181],v29 offset:0
v_add_f32 v36,v36,v46
v_add_f32 v36,v36,v47
mm a[24:27],a[164:167],v[216:219],a[24:27]
cv v179,v46,v47
v_add_f32 v33,v33,v37
mm a[28:31],a[164:167],v[220:223],a[28:31]
dt a[182:183],v29 offset:4096
v_exp_f32 v46,v234
mm a[32:35],a[168:171],v[208:211],a[32:35]
v_exp_f32 v47,v235
mm a[36:39],a[168:171],v[212:215],a[36:39]
dt a[184:185],v30 offset:0
v_add_f32 v37,v56,v57
cv v180,v56,v57
mm a[40:43],a[168:171],v[216:219],a[40:43]
v_exp_f32 v56,v248
mm a[44:47],a[168:171],v[220:223],a[44:47]
dt a[186:187],v30 offset:4096
v_add_f32 v37,v37,v58
mm a[48:51],a[172:175],v[208:211],a[48:51]
v_exp_f32 v57,v249
v_add_f32 v37,v37,v59
mm a[52:55],a[172:175],v[212:215],a[52:55]
dt a[188:189],v31 offset:0
cv v181,v58,v59
mm a[56:59],a[172:175],v[216:219],a[56:59]
v_exp_f32 v58,v250
v_add_f32 v37,v37,v40
mm a[60:63],a[172:175],v[220:223],a[60:63]
s_waitcnt lgkmcnt(7)
s_waitcnt vmcnt(12)
dt a[190:191],v31 offset:4096
mm v[144:147],a[144:147],v[96:99],v[80:83]
s_barrier
v_exp_f32 v59,v251
v_add_f32 v37,v37,v41
mm v[144:147],a[148:151],v[128:131],v[144:147]
s_add_u32 m0,s37,65536
s_add_u32 s56,s55,73728
ds_read_b128 a[128:131],v20 offset:24576
mm v[144:147],a[152:155],v[160:163],v[144:147]
bl v16,s[24:27],s56 offen lds
cv v182,v40,v41
mm v[144:147],a[156:159],v[192:195],v[144:147]
v_exp_f32 v40,v236
mm v[148:151],a[144:147],v[100:103],v[84:87]
s_add_u32 m0,s37,66560
v_exp_f32 v41,v237
mm v[148:151],a[148:151],v[132:135],v[148:151]
ds_read_b128 a[132:135],v21 offset:24576
v_add_f32 v37,v37,v42
v_add_f32 v37,v37,v43
mm v[148:151],a[152:155],v[164:167],v[148:151]
bl v17,s[24:27],s56 offen lds
mm v[148:151],a[156:159],v[196:199],v[148:151]
cv v183,v42,v43
v_exp_f32 v42,v238
mm v[152:155],a[144:147],v[104:107],v[88:91]
v_exp_f32 v43,v239
mm v[152:155],a[148:151],v[136:139],v[152:155]
s_add_u32 m0,s37,32768
s_add_u32 s57,s55,73728
ds_read_b128 a[136:139],v22 offset:24576
v_add_f32 v34,v34,v38
mm v[152:155],a[152:155],v[168:171],v[152:155]
v_add_f32 v38,v44,v45
cv v184,v44,v45
mm v[152:155],a[156:159],v[200:203],v[152:155]
bl v18,s[28:31],s57 offen lds
v_add_f32 v38,v38,v46
mm v[156:159],a[144:147],v[108:111],v[92:95]
v_exp_f32 v44,v252
mm v[156:159],a[148:151],v[140:143],v[156:159]
ds_read_b128 a[140:143],v23 offset:24576
v_add_f32 v38,v38,v47
mm v[156:159],a[152:155],v[172:175],v[156:159]
s_add_u32 m0,s37,33792
v_exp_f32 v45,v253
cv v185,v46,v47
mm v[156:159],a[156:159],v[204:207],v[156:159]
s_waitcnt lgkmcnt(4)
v_exp_f32 v46,v254
mm a[64:67],a[176:179],v[208:211],a[64:67]
bl v19,s[28:31],s57 offen lds
v_add_f32 v38,v38,v56
mm a[68:71],a[176:179],v[212:215],a[68:71]
dt a[160:161],v24 offset:8192
v_add_f32 v38,v38,v57
mm a[72:75],a[176:179],v[216:219],a[72:75]
v_exp_f32 v47,v255
cv v186,v56,v57
mm a[76:79],a[176:179],v[220:223],a[76:79]
dt a[162:163],v24 offset:12288
v_add_f32 v38,v38,v58
mm a[80:83],a[180:183],v[208:211],a[80:83]
s_add_u32 m0,s37,73728
s_add_u32 s58,s55,81920
v_add_f32 v38,v38,v59
cv v187,v58,v59
mm a[84:87],a[180:183],v[212:215],a[84:87]
dt a[164:165],v25 offset:8192
v_add_f32 v35,v35,v39
mm a[88:91],a[180:183],v[216:219],a[88:91]
bl v16,s[24:27],s58 offen lds
mm a[92:95],a[180:183],v[220:223],a[92:95]
dt a[166:167],v25 offset:12288
v_add_f32 v39,v40,v41
cv v188,v40,v41
mm a[96:99],a[184:187],v[208:211],a[96:99]
v_add_f32 v39,v39,v42
v_add_f32 v39,v39,v43
mm a[100:103],a[184:187],v[212:215],a[100:103]
dt a[168:169],v26 offset:8192
cv v189,v42,v43
v_add_f32 v39,v39,v44
mm a[104:107],a[184:187],v[216:219],a[104:107]
s_add_u32 m0,s37,74752
v_add_f32 v39,v39,v45
cv v190,v44,v45
mm a[108:111],a[184:187],v[220:223],a[108:111]
dt a[170:171],v26 offset:12288
v_add_f32 v39,v39,v46
v_add_f32 v39,v39,v47
mm a[112:115],a[188:191],v[208:211],a[112:115]
bl v17,s[24:27],s58 offen lds
mm a[116:119],a[188:191],v[212:215],a[116:119]
dt a[172:173],v27 offset:8192
cv v191,v46,v47
v_max3_f32 v48,v36,v37,v38
mm a[120:123],a[188:191],v[216:219],a[120:123]
v_max_f32 v48,v48,v39
v_cmp_nle_f32 vcc,v48,v49
mm a[124:127],a[188:191],v[220:223],a[124:127]
s_waitcnt lgkmcnt(7)
dt a[174:175],v27 offset:12288
s_cbranch_vccnz L_rareg6
L_backg6:
mm v[224:227],a[128:131],v[96:99],v[80:83]
v_exp_f32 v40,v112
mm v[224:227],a[132:135],v[128:131],v[224:227]
s_add_u32 m0,s37,40960
s_add_u32 s59,s55,81920
ds_read_b128 a[144:147],v20 offset:28672
v_add_f32 v32,v32,v36
mm v[224:227],a[136:139],v[160:163],v[224:227]
v_exp_f32 v41,v113
mm v[224:227],a[140:143],v[192:195],v[224:227]
bl v18,s[28:31],s59 offen lds
mm v[228:231],a[128:131],v[100:103],v[84:87]
v_exp_f32 v42,v114
mm v[228:231],a[132:135],v[132:135],v[228:231]
ds_read_b128 a[148:151],v21 offset:28672
v_exp_f32 v43,v115
mm v[228:231],a[136:139],v[164:167],v[228:231]
s_add_u32 m0,s37,41984
v_exp_f32 v44,v144
mm v[228:231],a[140:143],v[196:199],v[228:231]
v_exp_f32 v45,v145
v_add_f32 v36,v40,v41
mm v[232:235],a[128:131],v[104:107],v[88:91]
bl v19,s[28:31],s59 offen lds
mm v[232:235],a[132:135],v[136:139],v[232:235]
ds_read_b128 a[152:155],v22 offset:28672
v_exp_f32 v46,v146
mm v[232:235],a[136:139],v[168:171],v[232:235]
v_exp_f32 v47,v147
mm v[232:235],a[140:143],v[200:203],v[232:235]
s_add_u32 s83,s83,8192
v_exp_f32 v56,v116
cv v208,v40,v41
mm v[236:239],a[128:131],v[108:111],v[92:95]
v_exp_f32 v57,v117
mm v[236:239],a[132:135],v[140:143],v[236:239]
ds_read_b128 a[156:159],v23 offset:28672
v_exp_f32 v58,v118
mm v[236:239],a[136:139],v[172:175],v[236:239]
buffer_load_dword v55,v54,s[32:35],s83 offen
mm v[236:239],a[140:143],v[204:207],v[236:239]
s_waitcnt lgkmcnt(4)
v_exp_f32 v59,v119
v_add_f32 v36,v36,v42
mm a[0:3],a[160:163],v[176:179],a[0:3]
s_getpc_b64 s[0:1]
L_cpf10:
s_add_u32 s100,s47,4096
s_min_u32 s100,s100,L_code_end-1024-L_cpf10
s_add_u32 s0,s0,s100
s_addc_u32 s1,s1,0
v_exp_f32 v40,v148
mm a[4:7],a[160:163],v[180:183],a[4:7]
dt a[176:177],v28 offset:8192
v_exp_f32 v41,v149
mm a[8:11],a[160:163],v[184:187],a[8:11]
global_load_dword v55,v3,s[0:1]
mm a[12:15],a[160:163],v[188:191],a[12:15]
dt a[178:179],v28 offset:12288
v_add_f32 v36,v36,v43
cv v209,v42,v43
mm a[16:19],a[164:167],v[176:179],a[16:19]
v_exp_f32 v42,v150
mm a[20:23],a[164:167],v[180:183],a[20:23]
dt a[180:181],v29 offset:8192
v_exp_f32 v43,v151
mm a[24:27],a[164:167],v[184:187],a[24:27]
s_add_u32 s83,s83,8192
v_add_f32 v36,v36,v44
v_add_f32 v36,v36,v45
mm a[28:31],a[164:167],v[188:191],a[28:31]
dt a[182:183],v29 offset:12288
cv v210,v44,v45
v_add_f32 v36,v36,v46
mm a[32:35],a[168:171],v[176:179],a[32:35]
buffer_load_dword v55,v54,s[32:35],s83 offen
mm a[36:39],a[168:171],v[180:183],a[36:39]
dt a[184:185],v30 offset:8192
v_exp_f32 v44,v120
mm a[40:43],a[168:171],v[184:187],a[40:43]
v_exp_f32 v45,v121
mm a[44:47],a[168:171],v[188:191],a[44:47]
dt a[186:187],v30 offset:12288
v_add_f32 v36,v36,v47
cv v211,v46,v47
mm a[48:51],a[172:175],v[176:179],a[48:51]
v_exp_f32 v46,v122
mm a[52:55],a[172:175],v[180:183],a[52:55]
dt a[188:189],v31 offset:8192
v_exp_f32 v47,v123
mm a[56:59],a[172:175],v[184:187],a[56:59]
v_add_f32 v33,v33,v37
v_add_f32 v37,v56,v57
mm a[60:63],a[172:175],v[188:191],a[60:63]
s_waitcnt lgkmcnt(7)
s_waitcnt vmcnt(9)
dt a[190:191],v31 offset:12288
cv v212,v56,v57
mm v[240:243],a[144:147],v[96:99],v[80:83]
s_barrier
v_exp_f32 v56,v152
mm v[240:243],a[148:151],v[128:131],v[240:243]
s_add_u32 m0,s37,81920
s_add_u32 s56,s55,90112
ds_read_b128 a[128:131],v20 offset:0
v_add_f32 v37,v37,v58
mm v[240:243],a[152:155],v[160:163],v[240:243]
bl v16,s[24:27],s56 offen lds
mm v[240:243],a[156:159],v[192:195],v[240:243]
v_exp_f32 v57,v153
v_add_f32 v37,v37,v59
mm v[244:247],a[144:147],v[100:103],v[84:87]
cv v213,v58,v59
v_add_f32 v37,v37,v40
mm v[244:247],a[148:151],v[132:135],v[244:247]
ds_read_b128 a[132:135],v21 offset:0
v_exp_f32 v58,v154
mm v[244:247],a[152:155],v[164:167],v[244:247]
v_exp_f32 v59,v155
mm v[244:247],a[156:159],v[196:199],v[244:247]
v_add_f32 v37,v37,v41
cv v214,v40,v41
v_add_f32 v37,v37,v42
mm v[248:251],a[144:147],v[104:107],v[88:91]
v_exp_f32 v40,v124
mm v[248:251],a[148:151],v[136:139],v[248:251]
ds_read_b128 a[136:139],v22 offset:0
v_exp_f32 v41,v125
mm v[248:251],a[152:155],v[168:171],v[248:251]
v_add_f32 v37,v37,v43
cv v215,v42,v43
mm v[248:251],a[156:159],v[200:203],v[248:251]
v_exp_f32 v42,v126
v_add_f32 v34,v34,v38
mm v[252:255],a[144:147],v[108:111],v[92:95]
v_exp_f32 v43,v127
mm v[252:255],a[148:151],v[140:143],v[252:255]
s_add_u32 m0,s37,82944
ds_read_b128 a[140:143],v23 offset:0
v_add_f32 v38,v44,v45
cv v216,v44,v45
mm v[252:255],a[152:155],v[172:175],v[252:255]
v_exp_f32 v44,v156
mm v[252:255],a[156:159],v[204:207],v[252:255]
s_waitcnt lgkmcnt(4)
bl v17,s[24:27],s56 offen lds
v_add_f32 v38,v38,v46
mm a[64:67],a[176:179],v[176:179],a[64:67]
v_exp_f32 v45,v157
mm a[68:71],a[176:179],v[180:183],a[68:71]
dt a[160:161],v24 offset:16384
v_add_f32 v38,v38,v47
cv v217,v46,v47
mm a[72:75],a[176:179],v[184:187],a[72:75]
v_exp_f32 v46,v158
mm a[76:79],a[176:179],v[188:191],a[76:79]
dt a[162:163],v24 offset:20480
v_exp_f32 v47,v159
mm a[80:83],a[180:183],v[176:179],a[80:83]
v_add_f32 v38,v38,v56
v_add_f32 v38,v38,v57
mm a[84:87],a[180:183],v[180:183],a[84:87]
dt a[164:165],v25 offset:16384
cv v218,v56,v57
v_add_f32 v38,v38,v58
mm a[88:91],a[180:183],v[184:187],a[88:91]
v_add_f32 v38,v38,v59
cv v219,v58,v59
mm a[92:95],a[180:183],v[188:191],a[92:95]
dt a[166:167],v25 offset:20480
v_add_f32 v35,v35,v39
v_add_f32 v39,v40,v41
mm a[96:99],a[184:187],v[176:179],a[96:99]
cv v220,v40,v41
v_add_f32 v39,v39,v42
mm a[100:103],a[184:187],v[180:183],a[100:103]
dt a[168:169],v26 offset:16384
v_add_f32 v39,v39,v43
cv v221,v42,v43
mm a[104:107],a[184:187],v[184:187],a[104:107]
v_add_f32 v39,v39,v44
v_add_f32 v39,v39,v45
mm a[108:111],a[184:187],v[188:191],a[108:111]
dt a[170:171],v26 offset:20480
cv v222,v44,v45
v_add_f32 v39,v39,v46
mm a[112:115],a[188:191],v[176:179],a[112:115]
v_add_f32 v39,v39,v47
cv v223,v46,v47
mm a[116:119],a[188:191],v[180:183],a[116:119]
dt a[172:173],v27 offset:16384
v_max3_f32 v48,v36,v37,v38
v_max_f32 v48,v48,v39
mm a[120:123],a[188:191],v[184:187],a[120:123]
s_add_u32 m0,s37,49152
s_add_u32 s57,s55,90112
v_cmp_nle_f32 vcc,v48,v49
mm a[124:127],a[188:191],v[188:191],a[124:127]
s_waitcnt lgkmcnt(7)
dt a[174:175],v27 offset:20480
s_cbranch_vccnz L_rareg7
L_backg7:
mm v[112:115],a[128:131],v[96:99],v[80:83]
bl v18,s[28:31],s57 offen lds
mm v[112:115],a[132:135],v[128:131],v[112:115]
ds_read_b128 a[144:147],v20 offset:4096
v_exp_f32 v40,v224
mm v[112:115],a[136:139],v[160:163],v[112:115]
v_exp_f32 v41,v225
mm v[112:115],a[140:143],v[192:195],v[112:115]
v_exp_f32 v42,v226
v_add_f32 v32,v32,v36
mm v[116:119],a[128:131],v[100:103],v[84:87]
v_exp_f32 v43,v227
mm v[116:119],a[132:135],v[132:135],v[116:119]
ds_read_b128 a[148:151],v21 offset:4096
v_exp_f32 v44,v240
mm v[116:119],a[136:139],v[164:167],v[116:119]
v_exp_f32 v45,v241
mm v[116:119],a[140:143],v[196:199],v[116:119]
v_exp_f32 v46,v242
v_add_f32 v36,v40,v41
mm v[120:123],a[128:131],v[104:107],v[88:91]
v_exp_f32 v47,v243
mm v[120:123],a[132:135],v[136:139],v[120:123]
ds_read_b128 a[152:155],v22 offset:4096
v_exp_f32 v56,v228
mm v[120:123],a[136:139],v[168:171],v[120:123]
v_exp_f32 v57,v229
mm v[120:123],a[140:143],v[200:203],v[120:123]
v_exp_f32 v58,v230
cv v176,v40,v41
mm v[124:127],a[128:131],v[108:111],v[92:95]
s_add_u32 m0,s37,50176
v_exp_f32 v59,v231
mm v[124:127],a[132:135],v[140:143],v[124:127]
ds_read_b128 a[156:159],v23 offset:4096
v_add_f32 v36,v36,v42
mm v[124:127],a[136:139],v[172:175],v[124:127]
bl v19,s[28:31],s57 offen lds
v_add_f32 v36,v36,v43
mm v[124:127],a[140:143],v[204:207],v[124:127]
s_waitcnt lgkmcnt(4)
v_exp_f32 v40,v244
mm a[0:3],a[160:163],v[208:211],a[0:3]
v_exp_f32 v41,v245
cv v177,v42,v43
mm a[4:7],a[160:163],v[212:215],a[4:7]
dt a[176:177],v28 offset:16384
v_add_f32 v36,v36,v44
mm a[8:11],a[160:163],v[216:219],a[8:11]
v_exp_f32 v42,v246
v_add_f32 v36,v36,v45
mm a[12:15],a[160:163],v[220:223],a[12:15]
dt a[178:179],v28 offset:20480
cv v178,v44,v45
mm a[16:19],a[164:167],v[208:211],a[16:19]
v_exp_f32 v43,v247
v_add_f32 v36,v36,v46
mm a[20:23],a[164:167],v[212:215],a[20:23]
dt a[180:181],v29 offset:16384
v_add_f32 v36,v36,v47
mm a[24:27],a[164:167],v[216:219],a[24:27]
v_exp_f32 v44,v232
cv v179,v46,v47
mm a[28:31],a[164:167],v[220:223],a[28:31]
dt a[182:183],v29 offset:20480
v_add_f32 v33,v33,v37
mm a[32:35],a[168:171],v[208:211],a[32:35]
v_exp_f32 v45,v233
v_add_f32 v37,v56,v57
mm a[36:39],a[168:171],v[212:215],a[36:39]
dt a[184:185],v30 offset:16384
cv v180,v56,v57
mm a[40:43],a[168:171],v[216:219],a[40:43]
v_exp_f32 v46,v234
mm a[44:47],a[168:171],v[220:223],a[44:47]
dt a[186:187],v30 offset:20480
v_exp_f32 v47,v235
mm a[48:51],a[172:175],v[208:211],a[48:51]
v_exp_f32 v56,v248
mm a[52:55],a[172:175],v[212:215],a[52:55]
dt a[188:189],v31 offset:16384
v_exp_f32 v57,v249
mm a[56:59],a[172:175],v[216:219],a[56:59]
v_add_f32 v37,v37,v58
v_add_f32 v37,v37,v59
mm a[60:63],a[172:175],v[220:223],a[60:63]
s_waitcnt lgkmcnt(7)
s_waitcnt vmcnt(9)
dt a[190:191],v31 offset:20480
cv v181,v58,v59
mm v[144:147],a[144:147],v[96:99],v[80:83]
s_barrier
v_exp_f32 v58,v250
mm v[144:147],a[148:151],v[128:131],v[144:147]
s_mov_b32 s79,s69
s_mul_i32 s79,s79,147456
ds_read_b128 a[128:131],v20 offset:8192
v_add_f32 v37,v37,v40
mm v[144:147],a[152:155],v[160:163],v[144:147]
s_add_u32 s79,s79,s70
s_add_u32 m0,s71,126976
v_add_f32 v37,v37,v41
mm v[144:147],a[156:159],v[192:195],v[144:147]
bl v4,s[32:35],s79 offen lds
cv v182,v40,v41
mm v[148:151],a[144:147],v[100:103],v[84:87]
v_exp_f32 v59,v251
mm v[148:151],a[148:151],v[132:135],v[148:151]
s_add_u32 m0,s71,128000
ds_read_b128 a[132:135],v21 offset:8192
v_exp_f32 v40,v236
mm v[148:151],a[152:155],v[164:167],v[148:151]
v_exp_f32 v41,v237
mm v[148:151],a[156:159],v[196:199],v[148:151]
bl v5,s[32:35],s79 offen lds
mm v[152:155],a[144:147],v[104:107],v[88:91]
v_add_f32 v37,v37,v42
v_add_f32 v37,v37,v43
cv v183,v42,v43
mm v[152:155],a[148:151],v[136:139],v[152:155]
ds_read_b128 a[136:139],v22 offset:8192
v_add_f32 v34,v34,v38
mm v[152:155],a[152:155],v[168:171],v[152:155]
v_exp_f32 v42,v238
v_add_f32 v38,v44,v45
mm v[152:155],a[156:159],v[200:203],v[152:155]
v_exp_f32 v43,v239
mm v[156:159],a[144:147],v[108:111],v[92:95]
s_add_u32 m0,s71,129024
cv v184,v44,v45
v_exp_f32 v44,v252
mm v[156:159],a[148:151],v[140:143],v[156:159]
ds_read_b128 a[140:143],v23 offset:8192
v_add_f32 v38,v38,v46
mm v[156:159],a[152:155],v[172:175],v[156:159]
bl v6,s[32:35],s79 offen lds
v_add_f32 v38,v38,v47
mm v[156:159],a[156:159],v[204:207],v[156:159]
s_waitcnt lgkmcnt(4)
v_exp_f32 v45,v253
mm a[64:67],a[176:179],v[208:211],a[64:67]
cv v185,v46,v47
v_exp_f32 v46,v254
mm a[68:71],a[176:179],v[212:215],a[68:71]
dt a[160:161],v24 offset:24576
v_add_f32 v38,v38,v56
mm a[72:75],a[176:179],v[216:219],a[72:75]
s_add_u32 m0,s71,130048
v_exp_f32 v47,v255
v_add_f32 v38,v38,v57
mm a[76:79],a[176:179],v[220:223],a[76:79]
dt a[162:163],v24 offset:28672
cv v186,v56,v57
mm a[80:83],a[180:183],v[208:211],a[80:83]
bl v7,s[32:35],s79 offen lds
mm a[84:87],a[180:183],v[212:215],a[84:87]
dt a[164:165],v25 offset:24576
v_add_f32 v38,v38,v58
v_add_f32 v38,v38,v59
mm a[88:91],a[180:183],v[216:219],a[88:91]
cv v187,v58,v59
v_add_f32 v35,v35,v39
mm a[92:95],a[180:183],v[220:223],a[92:95]
dt a[166:167],v25 offset:28672
v_add_f32 v39,v40,v41
cv v188,v40,v41
mm a[96:99],a[184:187],v[208:211],a[96:99]
v_add_f32 v39,v39,v42
v_add_f32 v39,v39,v43
mm a[100:103],a[184:187],v[212:215],a[100:103]
dt a[168:169],v26 offset:24576
cv v189,v42,v43
v_add_f32 v39,v39,v44
mm a[104:107],a[184:187],v[216:219],a[104:107]
s_add_u32 m0,s71,131072
v_add_f32 v39,v39,v45
cv v190,v44,v45
mm a[108:111],a[184:187],v[220:223],a[108:111]
dt a[170:171],v26 offset:28672
v_add_f32 v39,v39,v46
v_add_f32 v39,v39,v47
mm a[112:115],a[188:191],v[208:211],a[112:115]
bl v8,s[32:35],s79 offen lds
mm a[116:119],a[188:191],v[212:215],a[116:119]
dt a[172:173],v27 offset:24576
cv v191,v46,v47
v_max3_f32 v48,v36,v37,v38
mm a[120:123],a[188:191],v[216:219],a[120:123]
v_max_f32 v48,v48,v39
v_cmp_nle_f32 vcc,v48,v49
mm a[124:127],a[188:191],v[220:223],a[124:127]
s_waitcnt lgkmcnt(7)
dt a[174:175],v27 offset:28672
s_cbranch_vccnz L_rareg8
L_backg8:
mm v[224:227],a[128:131],v[96:99],v[80:83]
v_exp_f32 v40,v112
mm v[224:227],a[132:135],v[128:131],v[224:227]
s_add_u32 m0,s71,132096
ds_read_b128 a[144:147],v20 offset:12288
v_exp_f32 v41,v113
mm v[224:227],a[136:139],v[160:163],v[224:227]
v_exp_f32 v42,v114
mm v[224:227],a[140:143],v[192:195],v[224:227]
bl v9,s[32:35],s79 offen lds
v_add_f32 v32,v32,v36
mm v[228:231],a[128:131],v[100:103],v[84:87]
v_exp_f32 v43,v115
mm v[228:231],a[132:135],v[132:135],v[228:231]
ds_read_b128 a[148:151],v21 offset:12288
v_exp_f32 v44,v144
mm v[228:231],a[136:139],v[164:167],v[228:231]
v_exp_f32 v45,v145
mm v[228:231],a[140:143],v[196:199],v[228:231]
v_exp_f32 v46,v146
mm v[232:235],a[128:131],v[104:107],v[88:91]
s_add_u32 m0,s71,133120
v_exp_f32 v47,v147
v_add_f32 v36,v40,v41
mm v[232:235],a[132:135],v[136:139],v[232:235]
ds_read_b128 a[152:155],v22 offset:12288
cv v208,v40,v41
mm v[232:235],a[136:139],v[168:171],v[232:235]
bl v10,s[32:35],s79 offen lds
v_add_f32 v36,v36,v42
mm v[232:235],a[140:143],v[200:203],v[232:235]
v_exp_f32 v56,v116
mm v[236:239],a[128:131],v[108:111],v[92:95]
v_exp_f32 v57,v117
v_add_f32 v36,v36,v43
mm v[236:239],a[132:135],v[140:143],v[236:239]
ds_read_b128 a[156:159],v23 offset:12288
cv v209,v42,v43
mm v[236:239],a[136:139],v[172:175],v[236:239]
s_add_u32 m0,s71,134144
v_exp_f32 v58,v118
mm v[236:239],a[140:143],v[204:207],v[236:239]
s_waitcnt lgkmcnt(4)
v_exp_f32 v59,v119
v_add_f32 v36,v36,v44
mm a[0:3],a[160:163],v[176:179],a[0:3]
bl v11,s[32:35],s79 offen lds
mm a[4:7],a[160:163],v[180:183],a[4:7]
dt a[176:177],v28 offset:24576
v_exp_f32 v40,v148
mm a[8:11],a[160:163],v[184:187],a[8:11]
v_exp_f32 v41,v149
mm a[12:15],a[160:163],v[188:191],a[12:15]
dt a[178:179],v28 offset:28672
v_exp_f32 v42,v150
mm a[16:19],a[164:167],v[176:179],a[16:19]
v_exp_f32 v43,v151
mm a[20:23],a[164:167],v[180:183],a[20:23]
s_add_u32 m0,s71,135168
dt a[180:181],v29 offset:24576
v_add_f32 v36,v36,v45
mm a[24:27],a[164:167],v[184:187],a[24:27]
cv v210,v44,v45
v_exp_f32 v44,v120
mm a[28:31],a[164:167],v[188:191],a[28:31]
dt a[182:183],v29 offset:28672
v_add_f32 v36,v36,v46
mm a[32:35],a[168:171],v[176:179],a[32:35]
bl v12,s[32:35],s79 offen lds
v_add_f32 v36,v36,v47
mm a[36:39],a[168:171],v[180:183],a[36:39]
dt a[184:185],v30 offset:24576
cv v211,v46,v47
mm a[40:43],a[168:171],v[184:187],a[40:43]
v_exp_f32 v45,v121
v_add_f32 v33,v33,v37
mm a[44:47],a[168:171],v[188:191],a[44:47]
dt a[186:187],v30 offset:28672
v_add_f32 v37,v56,v57
mm a[48:51],a[172:175],v[176:179],a[48:51]
v_exp_f32 v46,v122
mm a[52:55],a[172:175],v[180:183],a[52:55]
dt a[188:189],v31 offset:24576
v_exp_f32 v47,v123
mm a[56:59],a[172:175],v[184:187],a[56:59]
cv v212,v56,v57
v_add_f32 v37,v37,v58
mm a[60:63],a[172:175],v[188:191],a[60:63]
s_waitcnt lgkmcnt(7)
s_waitcnt vmcnt(11)
dt a[190:191],v31 offset:28672
v_add_f32 v37,v37,v59
mm v[240:243],a[144:147],v[96:99],v[80:83]
s_barrier
v_exp_f32 v56,v152
mm v[240:243],a[148:151],v[128:131],v[240:243]
s_add_u32 m0,s37,65536
s_add_u32 s58,s55,98304
ds_read_b128 a[128:131],v20 offset:16384
cv v213,v58,v59
mm v[240:243],a[152:155],v[160:163],v[240:243]
bl v16,s[24:27],s58 offen lds
mm v[240:243],a[156:159],v[192:195],v[240:243]
v_exp_f32 v57,v153
mm v[244:247],a[144:147],v[100:103],v[84:87]
v_exp_f32 v58,v154
v_add_f32 v37,v37,v40
mm v[244:247],a[148:151],v[132:135],v[244:247]
ds_read_b128 a[132:135],v21 offset:16384
v_add_f32 v37,v37,v41
mm v[244:247],a[152:155],v[164:167],v[244:247]
v_exp_f32 v59,v155
cv v214,v40,v41
mm v[244:247],a[156:159],v[196:199],v[244:247]
v_exp_f32 v40,v124
mm v[248:251],a[144:147],v[104:107],v[88:91]
v_exp_f32 v41,v125
v_add_f32 v37,v37,v42
mm v[248:251],a[148:151],v[136:139],v[248:251]
ds_read_b128 a[136:139],v22 offset:16384
v_add_f32 v37,v37,v43
mm v[248:251],a[152:155],v[168:171],v[248:251]
cv v215,v42,v43
v_add_f32 v34,v34,v38
mm v[248:251],a[156:159],v[200:203],v[248:251]
v_exp_f32 v42,v126
v_add_f32 v38,v44,v45
mm v[252:255],a[144:147],v[108:111],v[92:95]
v_exp_f32 v43,v127
mm v[252:255],a[148:151],v[140:143],v[252:255]
s_add_u32 m0,s37,66560
ds_read_b128 a[140:143],v23 offset:16384
cv v216,v44,v45
v_add_f32 v38,v38,v46
mm v[252:255],a[152:155],v[172:175],v[252:255]
v_exp_f32 v44,v156
mm v[252:255],a[156:159],v[204:207],v[252:255]
s_waitcnt lgkmcnt(4)
bl v17,s[24:27],s58 offen lds
v_add_f32 v38,v38,v47
mm a[64:67],a[176:179],v[176:179],a[64:67]
v_exp_f32 v45,v157
mm a[68:71],a[176:179],v[180:183],a[68:71]
dt a[160:161],v24 offset:32768
cv v217,v46,v47
mm a[72:75],a[176:179],v[184:187],a[72:75]
v_exp_f32 v46,v158
v_add_f32 v38,v38,v56
mm a[76:79],a[176:179],v[188:191],a[76:79]
dt a[162:163],v24 offset:36864
v_add_f32 v38,v38,v57
mm a[80:83],a[180:183],v[176:179],a[80:83]
v_exp_f32 v47,v159
cv v218,v56,v57
mm a[84:87],a[180:183],v[180:183],a[84:87]
dt a[164:165],v25 offset:32768
v_add_f32 v38,v38,v58
mm a[88:91],a[180:183],v[184:187],a[88:91]
v_add_f32 v38,v38,v59
cv v219,v58,v59
v_add_f32 v35,v35,v39
mm a[92:95],a[180:183],v[188:191],a[92:95]
dt a[166:167],v25 offset:36864
v_add_f32 v39,v40,v41
mm a[96:99],a[184:187],v[176:179],a[96:99]
cv v220,v40,v41
v_add_f32 v39,v39,v42
mm a[100:103],a[184:187],v[180:183],a[100:103]
dt a[168:169],v26 offset:32768
v_add_f32 v39,v39,v43
cv v221,v42,v43
mm a[104:107],a[184:187],v[184:187],a[104:107]
v_add_f32 v39,v39,v44
v_add_f32 v39,v39,v45
mm a[108:111],a[184:187],v[188:191],a[108:111]
dt a[170:171],v26 offset:36864
cv v222,v44,v45
v_add_f32 v39,v39,v46
mm a[112:115],a[188:191],v[176:179],a[112:115]
v_add_f32 v39,v39,v47
cv v223,v46,v47
mm a[116:119],a[188:191],v[180:183],a[116:119]
dt a[172:173],v27 offset:32768
v_max3_f32 v48,v36,v37,v38
v_max_f32 v48,v48,v39
mm a[120:123],a[188:191],v[184:187],a[120:123]
s_add_u32 m0,s37,57344
s_add_u32 s59,s55,98304
v_cmp_nle_f32 vcc,v48,v49
mm a[124:127],a[188:191],v[188:191],a[124:127]
s_waitcnt lgkmcnt(7)
dt a[174:175],v27 offset:36864
s_cbranch_vccnz L_rareg9
L_backg9:
mm v[112:115],a[128:131],v[96:99],v[80:83]
bl v18,s[28:31],s59 offen lds
mm v[112:115],a[132:135],v[128:131],v[112:115]
ds_read_b128 a[144:147],v20 offset:20480
v_exp_f32 v40,v224
mm v[112:115],a[136:139],v[160:163],v[112:115]
v_exp_f32 v41,v225
mm v[112:115],a[140:143],v[192:195],v[112:115]
v_exp_f32 v42,v226
v_add_f32 v32,v32,v36
mm v[116:119],a[128:131],v[100:103],v[84:87]
v_exp_f32 v43,v227
mm v[116:119],a[132:135],v[132:135],v[116:119]
ds_read_b128 a[148:151],v21 offset:20480
v_add_f32 v36,v40,v41
mm v[116:119],a[136:139],v[164:167],v[116:119]
v_exp_f32 v44,v240
cv v176,v40,v41
mm v[116:119],a[140:143],v[196:199],v[116:119]
v_exp_f32 v45,v241
mm v[120:123],a[128:131],v[104:107],v[88:91]
v_exp_f32 v46,v242
v_add_f32 v36,v36,v42
mm v[120:123],a[132:135],v[136:139],v[120:123]
ds_read_b128 a[152:155],v22 offset:20480
v_add_f32 v36,v36,v43
mm v[120:123],a[136:139],v[168:171],v[120:123]
v_exp_f32 v47,v243
mm v[120:123],a[140:143],v[200:203],v[120:123]
v_exp_f32 v56,v228
cv v177,v42,v43
mm v[124:127],a[128:131],v[108:111],v[92:95]
s_add_u32 m0,s37,58368
v_exp_f32 v57,v229
mm v[124:127],a[132:135],v[140:143],v[124:127]
ds_read_b128 a[156:159],v23 offset:20480
v_exp_f32 v58,v230
mm v[124:127],a[136:139],v[172:175],v[124:127]
bl v19,s[28:31],s59 offen lds
mm v[124:127],a[140:143],v[204:207],v[124:127]
s_waitcnt lgkmcnt(4)
v_exp_f32 v59,v231
mm a[0:3],a[160:163],v[208:211],a[0:3]
v_exp_f32 v40,v244
v_add_f32 v36,v36,v44
mm a[4:7],a[160:163],v[212:215],a[4:7]
dt a[176:177],v28 offset:32768
v_add_f32 v36,v36,v45
mm a[8:11],a[160:163],v[216:219],a[8:11]
v_exp_f32 v41,v245
cv v178,v44,v45
mm a[12:15],a[160:163],v[220:223],a[12:15]
dt a[178:179],v28 offset:36864
v_add_f32 v36,v36,v46
mm a[16:19],a[164:167],v[208:211],a[16:19]
v_exp_f32 v42,v246
mm a[20:23],a[164:167],v[212:215],a[20:23]
dt a[180:181],v29 offset:32768
v_exp_f32 v43,v247
mm a[24:27],a[164:167],v[216:219],a[24:27]
v_exp_f32 v44,v232
mm a[28:31],a[164:167],v[220:223],a[28:31]
dt a[182:183],v29 offset:36864
v_exp_f32 v45,v233
mm a[32:35],a[168:171],v[208:211],a[32:35]
v_add_f32 v36,v36,v47
cv v179,v46,v47
mm a[36:39],a[168:171],v[212:215],a[36:39]
dt a[184:185],v30 offset:32768
v_add_f32 v33,v33,v37
mm a[40:43],a[168:171],v[216:219],a[40:43]
v_exp_f32 v46,v234
v_add_f32 v37,v56,v57
mm a[44:47],a[168:171],v[220:223],a[44:47]
dt a[186:187],v30 offset:36864
cv v180,v56,v57
mm a[48:51],a[172:175],v[208:211],a[48:51]
v_exp_f32 v47,v235
v_add_f32 v37,v37,v58
mm a[52:55],a[172:175],v[212:215],a[52:55]
dt a[188:189],v31 offset:32768
v_add_f32 v37,v37,v59
mm a[56:59],a[172:175],v[216:219],a[56:59]
v_exp_f32 v56,v248
mm a[60:63],a[172:175],v[220:223],a[60:63]
s_waitcnt lgkmcnt(7)
s_waitcnt vmcnt(2)
dt a[190:191],v31 offset:36864
cv v181,v58,v59
mm v[144:147],a[144:147],v[96:99],v[80:83]
s_barrier
v_exp_f32 v57,v249
mm v[144:147],a[148:151],v[128:131],v[144:147]
s_add_u32 m0,s37,73728
s_add_u32 s56,s55,106496
ds_read_b128 a[128:131],v20 offset:0
v_add_f32 v37,v37,v40
mm v[144:147],a[152:155],v[160:163],v[144:147]
bl v16,s[24:27],s56 offen lds
mm v[144:147],a[156:159],v[192:195],v[144:147]
v_exp_f32 v58,v250
mm v[148:151],a[144:147],v[100:103],v[84:87]
v_exp_f32 v59,v251
v_add_f32 v37,v37,v41
mm v[148:151],a[148:151],v[132:135],v[148:151]
ds_read_b128 a[132:135],v21 offset:0
cv v182,v40,v41
mm v[148:151],a[152:155],v[164:167],v[148:151]
v_exp_f32 v40,v236
v_add_f32 v37,v37,v42
mm v[148:151],a[156:159],v[196:199],v[148:151]
v_exp_f32 v41,v237
mm v[152:155],a[144:147],v[104:107],v[88:91]
v_add_f32 v37,v37,v43
cv v183,v42,v43
mm v[152:155],a[148:151],v[136:139],v[152:155]
ds_read_b128 a[136:139],v22 offset:0
v_exp_f32 v42,v238
mm v[152:155],a[152:155],v[168:171],v[152:155]
s_add_u32 m0,s37,74752
v_exp_f32 v43,v239
mm v[152:155],a[156:159],v[200:203],v[152:155]
v_add_f32 v34,v34,v38
v_add_f32 v38,v44,v45
cv v184,v44,v45
mm v[156:159],a[144:147],v[108:111],v[92:95]
bl v17,s[24:27],s56 offen lds
mm v[156:159],a[148:151],v[140:143],v[156:159]
ds_read_b128 a[140:143],v23 offset:0
v_add_f32 v38,v38,v46
mm v[156:159],a[152:155],v[172:175],v[156:159]
v_exp_f32 v44,v252
v_add_f32 v38,v38,v47
mm v[156:159],a[156:159],v[204:207],v[156:159]
s_waitcnt lgkmcnt(4)
v_exp_f32 v45,v253
mm a[64:67],a[176:179],v[208:211],a[64:67]
cv v185,v46,v47
v_exp_f32 v46,v254
mm a[68:71],a[176:179],v[212:215],a[68:71]
dt a[160:161],v24 offset:40960
v_add_f32 v38,v38,v56
mm a[72:75],a[176:179],v[216:219],a[72:75]
v_exp_f32 v47,v255
mm a[76:79],a[176:179],v[220:223],a[76:79]
dt a[162:163],v24 offset:45056
v_add_f32 v38,v38,v57
cv v186,v56,v57
mm a[80:83],a[180:183],v[208:211],a[80:83]
v_add_f32 v38,v38,v58
v_add_f32 v38,v38,v59
mm a[84:87],a[180:183],v[212:215],a[84:87]
dt a[164:165],v25 offset:40960
cv v187,v58,v59
v_add_f32 v35,v35,v39
mm a[88:91],a[180:183],v[216:219],a[88:91]
s_add_u32 m0,s37,0
s_add_u32 s57,s55,106496
v_add_f32 v39,v40,v41
mm a[92:95],a[180:183],v[220:223],a[92:95]
dt a[166:167],v25 offset:45056
cv v188,v40,v41
mm a[96:99],a[184:187],v[208:211],a[96:99]
bl v18,s[28:31],s57 offen lds
v_add_f32 v39,v39,v42
mm a[100:103],a[184:187],v[212:215],a[100:103]
dt a[168:169],v26 offset:40960
v_add_f32 v39,v39,v43
mm a[104:107],a[184:187],v[216:219],a[104:107]
cv v189,v42,v43
v_add_f32 v39,v39,v44
v_add_f32 v39,v39,v45
mm a[108:111],a[184:187],v[220:223],a[108:111]
dt a[170:171],v26 offset:45056
cv v190,v44,v45
mm a[112:115],a[188:191],v[208:211],a[112:115]
v_add_f32 v39,v39,v46
v_add_f32 v39,v39,v47
mm a[116:119],a[188:191],v[212:215],a[116:119]
dt a[172:173],v27 offset:40960
cv v191,v46,v47
v_max3_f32 v48,v36,v37,v38
mm a[120:123],a[188:191],v[216:219],a[120:123]
v_max_f32 v48,v48,v39
v_cmp_nle_f32 vcc,v48,v49
mm a[124:127],a[188:191],v[220:223],a[124:127]
s_waitcnt lgkmcnt(7)
dt a[174:175],v27 offset:45056
s_cbranch_vccnz L_rareg10
L_backg10:
mm v[224:227],a[128:131],v[96:99],v[80:83]
v_exp_f32 v40,v112
v_add_f32 v32,v32,v36
mm v[224:227],a[132:135],v[128:131],v[224:227]
ds_read_b128 a[144:147],v20 offset:4096
v_exp_f32 v41,v113
mm v[224:227],a[136:139],v[160:163],v[224:227]
v_exp_f32 v42,v114
mm v[224:227],a[140:143],v[192:195],v[224:227]
s_add_u32 m0,s37,1024
v_exp_f32 v43,v115
v_add_f32 v36,v40,v41
mm v[228:231],a[128:131],v[100:103],v[84:87]
v_exp_f32 v44,v144
cv v208,v40,v41
mm v[228:231],a[132:135],v[132:135],v[228:231]
ds_read_b128 a[148:151],v21 offset:4096
v_add_f32 v36,v36,v42
mm v[228:231],a[136:139],v[164:167],v[228:231]
bl v19,s[28:31],s57 offen lds
v_add_f32 v36,v36,v43
mm v[228:231],a[140:143],v[196:199],v[228:231]
v_exp_f32 v45,v145
cv v209,v42,v43
mm v[232:235],a[128:131],v[104:107],v[88:91]
v_exp_f32 v46,v146
mm v[232:235],a[132:135],v[136:139],v[232:235]
ds_read_b128 a[152:155],v22 offset:4096
v_exp_f32 v47,v147
mm v[232:235],a[136:139],v[168:171],v[232:235]
v_exp_f32 v56,v116
mm v[232:235],a[140:143],v[200:203],v[232:235]
v_exp_f32 v57,v117
v_add_f32 v36,v36,v44
mm v[236:239],a[128:131],v[108:111],v[92:95]
v_exp_f32 v58,v118
v_add_f32 v36,v36,v45
mm v[236:239],a[132:135],v[140:143],v[236:239]
ds_read_b128 a[156:159],v23 offset:4096
cv v210,v44,v45
mm v[236:239],a[136:139],v[172:175],v[236:239]
v_exp_f32 v59,v119
v_add_f32 v36,v36,v46
mm v[236:239],a[140:143],v[204:207],v[236:239]
s_waitcnt lgkmcnt(4)
v_exp_f32 v40,v148
v_add_f32 v36,v36,v47
mm a[0:3],a[160:163],v[176:179],a[0:3]
buffer_load_dword v0,v3,s[8:11],s73 offen offset:16 sc1
mm a[4:7],a[160:163],v[180:183],a[4:7]
dt a[176:177],v28 offset:40960
v_exp_f32 v41,v149
mm a[8:11],a[160:163],v[184:187],a[8:11]
v_exp_f32 v42,v150
cv v211,v46,v47
mm a[12:15],a[160:163],v[188:191],a[12:15]
dt a[178:179],v28 offset:45056
v_add_f32 v33,v33,v37
mm a[16:19],a[164:167],v[176:179],a[16:19]
v_exp_f32 v43,v151
v_add_f32 v37,v56,v57
mm a[20:23],a[164:167],v[180:183],a[20:23]
dt a[180:181],v29 offset:40960
cv v212,v56,v57
mm a[24:27],a[164:167],v[184:187],a[24:27]
v_exp_f32 v44,v120
v_add_f32 v37,v37,v58
mm a[28:31],a[164:167],v[188:191],a[28:31]
dt a[182:183],v29 offset:45056
v_exp_f32 v45,v121
mm a[32:35],a[168:171],v[176:179],a[32:35]
v_exp_f32 v46,v122
mm a[36:39],a[168:171],v[180:183],a[36:39]
dt a[184:185],v30 offset:40960
v_exp_f32 v47,v123
mm a[40:43],a[168:171],v[184:187],a[40:43]
v_exp_f32 v56,v152
v_add_f32 v37,v37,v59
mm a[44:47],a[168:171],v[188:191],a[44:47]
dt a[186:187],v30 offset:45056
cv v213,v58,v59
mm a[48:51],a[172:175],v[176:179],a[48:51]
v_exp_f32 v57,v153
v_add_f32 v37,v37,v40
mm a[52:55],a[172:175],v[180:183],a[52:55]
dt a[188:189],v31 offset:40960
v_exp_f32 v58,v154
mm a[56:59],a[172:175],v[184:187],a[56:59]
s_waitcnt vmcnt(0)
v_cmp_ne_u32 vcc,v1,v0
v_add_f32 v37,v37,v41
mm a[60:63],a[172:175],v[188:191],a[60:63]
s_waitcnt lgkmcnt(7)
dt a[190:191],v31 offset:45056
cv v214,v40,v41
mm v[240:243],a[144:147],v[96:99],v[80:83]
s_barrier
s_cbranch_vccnz L_spin_f1
L_ok_f1:
mm v[240:243],a[148:151],v[128:131],v[240:243]
s_add_u32 m0,s37,81920
s_add_u32 s58,s55,114688
ds_read_b128 a[128:131],v20 offset:8192
v_add_f32 v37,v37,v42
mm v[240:243],a[152:155],v[160:163],v[240:243]
bl v16,s[24:27],s58 offen lds
v_add_f32 v37,v37,v43
mm v[240:243],a[156:159],v[192:195],v[240:243]
s_add_u32 m0,s37,82944
v_exp_f32 v59,v155
mm v[244:247],a[144:147],v[100:103],v[84:87]
bl v17,s[24:27],s58 offen lds
cv v215,v42,v43
mm v[244:247],a[148:151],v[132:135],v[244:247]
s_add_u32 m0,s37,8192
s_add_u32 s59,s55,114688
ds_read_b128 a[132:135],v21 offset:8192
v_add_f32 v34,v34,v38
mm v[244:247],a[152:155],v[164:167],v[244:247]
v_exp_f32 v40,v124
mm v[244:247],a[156:159],v[196:199],v[244:247]
bl v18,s[28:31],s59 offen lds
v_add_f32 v38,v44,v45
mm v[248:251],a[144:147],v[104:107],v[88:91]
v_exp_f32 v41,v125
cv v216,v44,v45
mm v[248:251],a[148:151],v[136:139],v[248:251]
s_add_u32 m0,s37,9216
ds_read_b128 a[136:139],v22 offset:8192
v_add_f32 v38,v38,v46
mm v[248:251],a[152:155],v[168:171],v[248:251]
v_exp_f32 v42,v126
v_add_f32 v38,v38,v47
mm v[248:251],a[156:159],v[200:203],v[248:251]
bl v19,s[28:31],s59 offen lds
mm v[252:255],a[144:147],v[108:111],v[92:95]
v_exp_f32 v43,v127
cv v217,v46,v47
mm v[252:255],a[148:151],v[140:143],v[252:255]
ds_read_b128 a[140:143],v23 offset:8192
v_exp_f32 v44,v156
mm v[252:255],a[152:155],v[172:175],v[252:255]
bl a[192:195],v60,s[8:11],s68 offen offset:0 sc1
mm v[252:255],a[156:159],v[204:207],v[252:255]
s_waitcnt lgkmcnt(4)
v_exp_f32 v45,v157
v_add_f32 v38,v38,v56
mm a[64:67],a[176:179],v[176:179],a[64:67]
v_exp_f32 v46,v158
v_add_f32 v38,v38,v57
mm a[68:71],a[176:179],v[180:183],a[68:71]
dt a[160:161],v24 offset:49152
cv v218,v56,v57
mm a[72:75],a[176:179],v[184:187],a[72:75]
bl a[196:199],v61,s[8:11],s68 offen offset:0 sc1
v_add_f32 v38,v38,v58
mm a[76:79],a[176:179],v[188:191],a[76:79]
dt a[162:163],v24 offset:53248
v_exp_f32 v47,v159
mm a[80:83],a[180:183],v[176:179],a[80:83]
v_add_f32 v38,v38,v59
cv v219,v58,v59
mm a[84:87],a[180:183],v[180:183],a[84:87]
dt a[164:165],v25 offset:49152
v_add_f32 v35,v35,v39
v_add_f32 v39,v40,v41
mm a[88:91],a[180:183],v[184:187],a[88:91]
bl a[200:203],v62,s[8:11],s68 offen offset:0 sc1
mm a[92:95],a[180:183],v[188:191],a[92:95]
dt a[166:167],v25 offset:53248
cv v220,v40,v41
v_add_f32 v39,v39,v42
mm a[96:99],a[184:187],v[176:179],a[96:99]
v_add_f32 v39,v39,v43
cv v221,v42,v43
v_add_f32 v39,v39,v44
mm a[100:103],a[184:187],v[180:183],a[100:103]
dt a[168:169],v26 offset:49152
v_add_f32 v39,v39,v45
mm a[104:107],a[184:187],v[184:187],a[104:107]
bl a[204:207],v63,s[8:11],s68 offen offset:0 sc1
cv v222,v44,v45
mm a[108:111],a[184:187],v[188:191],a[108:111]
dt a[170:171],v26 offset:53248
v_add_f32 v39,v39,v46
v_add_f32 v39,v39,v47
mm a[112:115],a[188:191],v[176:179],a[112:115]
cv v223,v46,v47
v_max3_f32 v48,v36,v37,v38
mm a[116:119],a[188:191],v[180:183],a[116:119]
dt a[172:173],v27 offset:49152
v_max_f32 v48,v48,v39
v_cmp_nle_f32 vcc,v48,v49
mm a[120:123],a[188:191],v[184:187],a[120:123]
bl a[208:211],v60,s[8:11],s68 offen offset:1024 sc1
mm a[124:127],a[188:191],v[188:191],a[124:127]
s_waitcnt lgkmcnt(7)
dt a[174:175],v27 offset:53248
s_cbranch_vccnz L_rareg11
L_backg11:
mm v[112:115],a[128:131],v[96:99],v[80:83]
v_exp_f32 v40,v224
v_add_f32 v32,v32,v36
mm v[112:115],a[132:135],v[128:131],v[112:115]
ds_read_b128 a[144:147],v20 offset:12288
v_exp_f32 v41,v225
mm v[112:115],a[136:139],v[160:163],v[112:115]
bl a[212:215],v61,s[8:11],s68 offen offset:1024 sc1
mm v[112:115],a[140:143],v[192:195],v[112:115]
v_exp_f32 v42,v226
v_add_f32 v36,v40,v41
mm v[116:119],a[128:131],v[100:103],v[84:87]
v_exp_f32 v43,v227
cv v176,v40,v41
mm v[116:119],a[132:135],v[132:135],v[116:119]
ds_read_b128 a[148:151],v21 offset:12288
v_exp_f32 v44,v240
mm v[116:119],a[136:139],v[164:167],v[116:119]
bl a[216:219],v62,s[8:11],s68 offen offset:1024 sc1
mm v[116:119],a[140:143],v[196:199],v[116:119]
v_exp_f32 v45,v241
v_add_f32 v36,v36,v42
mm v[120:123],a[128:131],v[104:107],v[88:91]
bl a[220:223],v63,s[8:11],s68 offen offset:1024 sc1
v_add_f32 v36,v36,v43
mm v[120:123],a[132:135],v[136:139],v[120:123]
ds_read_b128 a[152:155],v22 offset:12288
v_exp_f32 v46,v242
mm v[120:123],a[136:139],v[168:171],v[120:123]
v_exp_f32 v47,v243
cv v177,v42,v43
mm v[120:123],a[140:143],v[200:203],v[120:123]
v_exp_f32 v56,v228
v_add_f32 v36,v36,v44
mm v[124:127],a[128:131],v[108:111],v[92:95]
bl a[224:227],v60,s[8:11],s68 offen offset:2048 sc1
mm v[124:127],a[132:135],v[140:143],v[124:127]
ds_read_b128 a[156:159],v23 offset:12288
v_exp_f32 v57,v229
mm v[124:127],a[136:139],v[172:175],v[124:127]
v_exp_f32 v58,v230
v_add_f32 v36,v36,v45
mm v[124:127],a[140:143],v[204:207],v[124:127]
s_waitcnt lgkmcnt(4)
bl a[228:231],v61,s[8:11],s68 offen offset:2048 sc1
cv v178,v44,v45
mm a[0:3],a[160:163],v[208:211],a[0:3]
v_exp_f32 v59,v231
v_add_f32 v36,v36,v46
mm a[4:7],a[160:163],v[212:215],a[4:7]
dt a[176:177],v28 offset:49152
v_exp_f32 v40,v244
mm a[8:11],a[160:163],v[216:219],a[8:11]
v_exp_f32 v41,v245
mm a[12:15],a[160:163],v[220:223],a[12:15]
dt a[178:179],v28 offset:53248
v_exp_f32 v42,v246
mm a[16:19],a[164:167],v[208:211],a[16:19]
bl a[232:235],v62,s[8:11],s68 offen offset:2048 sc1
v_add_f32 v36,v36,v47
mm a[20:23],a[164:167],v[212:215],a[20:23]
dt a[180:181],v29 offset:49152
v_exp_f32 v43,v247
mm a[24:27],a[164:167],v[216:219],a[24:27]
v_exp_f32 v44,v232
cv v179,v46,v47
mm a[28:31],a[164:167],v[220:223],a[28:31]
dt a[182:183],v29 offset:53248
v_exp_f32 v45,v233
mm a[32:35],a[168:171],v[208:211],a[32:35]
bl a[236:239],v63,s[8:11],s68 offen offset:2048 sc1
v_add_f32 v33,v33,v37
mm a[36:39],a[168:171],v[212:215],a[36:39]
s_getpc_b64 s[0:1]
L_cpf11:
s_add_u32 s100,s47,4096
s_min_u32 s100,s100,L_code_end-1024-L_cpf11
s_add_u32 s0,s0,s100
s_addc_u32 s1,s1,0
dt a[184:185],v30 offset:49152
v_add_f32 v37,v56,v57
mm a[40:43],a[168:171],v[216:219],a[40:43]
v_exp_f32 v46,v234
cv v180,v56,v57
mm a[44:47],a[168:171],v[220:223],a[44:47]
dt a[186:187],v30 offset:53248
v_exp_f32 v47,v235
mm a[48:51],a[172:175],v[208:211],a[48:51]
global_load_dword v55,v3,s[0:1]
v_add_f32 v37,v37,v58
mm a[52:55],a[172:175],v[212:215],a[52:55]
dt a[188:189],v31 offset:49152
v_exp_f32 v56,v248
mm a[56:59],a[172:175],v[216:219],a[56:59]
v_exp_f32 v57,v249
v_add_f32 v37,v37,v59
mm a[60:63],a[172:175],v[220:223],a[60:63]
s_waitcnt lgkmcnt(7)
s_waitcnt vmcnt(15)
dt a[190:191],v31 offset:53248
mm v[144:147],a[144:147],v[96:99],v[80:83]
s_barrier
cv v181,v58,v59
v_exp_f32 v58,v250
mm v[144:147],a[148:151],v[128:131],v[144:147]
s_add_u32 m0,s37,65536
s_add_u32 s56,s55,122880
ds_read_b128 a[128:131],v20 offset:16384
v_add_f32 v37,v37,v40
mm v[144:147],a[152:155],v[160:163],v[144:147]
bl v16,s[24:27],s56 offen lds
v_add_f32 v37,v37,v41
mm v[144:147],a[156:159],v[192:195],v[144:147]
s_add_u32 m0,s37,66560
v_exp_f32 v59,v251
cv v182,v40,v41
mm v[148:151],a[144:147],v[100:103],v[84:87]
bl v17,s[24:27],s56 offen lds
v_add_f32 v37,v37,v42
mm v[148:151],a[148:151],v[132:135],v[148:151]
s_add_u32 m0,s37,16384
s_add_u32 s57,s55,122880
ds_read_b128 a[132:135],v21 offset:16384
mm v[148:151],a[152:155],v[164:167],v[148:151]
v_exp_f32 v40,v236
v_add_f32 v37,v37,v43
mm v[148:151],a[156:159],v[196:199],v[148:151]
bl v18,s[28:31],s57 offen lds
cv v183,v42,v43
mm v[152:155],a[144:147],v[104:107],v[88:91]
v_exp_f32 v41,v237
v_add_f32 v34,v34,v38
mm v[152:155],a[148:151],v[136:139],v[152:155]
s_add_u32 m0,s37,17408
ds_read_b128 a[136:139],v22 offset:16384
v_exp_f32 v42,v238
mm v[152:155],a[152:155],v[168:171],v[152:155]
v_exp_f32 v43,v239
v_add_f32 v38,v44,v45
mm v[152:155],a[156:159],v[200:203],v[152:155]
bl v19,s[28:31],s57 offen lds
cv v184,v44,v45
mm v[156:159],a[144:147],v[108:111],v[92:95]
v_exp_f32 v44,v252
mm v[156:159],a[148:151],v[140:143],v[156:159]
ds_read_b128 a[140:143],v23 offset:16384
v_exp_f32 v45,v253
mm v[156:159],a[152:155],v[172:175],v[156:159]
bl a[240:243],v60,s[8:11],s68 offen offset:3072 sc1
v_add_f32 v38,v38,v46
mm v[156:159],a[156:159],v[204:207],v[156:159]
s_waitcnt lgkmcnt(4)
v_add_f32 v38,v38,v47
cv v185,v46,v47
v_add_f32 v38,v38,v56
mm a[64:67],a[176:179],v[208:211],a[64:67]
v_exp_f32 v46,v254
v_add_f32 v38,v38,v57
mm a[68:71],a[176:179],v[212:215],a[68:71]
dt a[160:161],v24 offset:57344
v_exp_f32 v47,v255
mm a[72:75],a[176:179],v[216:219],a[72:75]
bl a[244:247],v61,s[8:11],s68 offen offset:3072 sc1
mm a[76:79],a[176:179],v[220:223],a[76:79]
dt a[162:163],v24 offset:61440
cv v186,v56,v57
v_add_f32 v38,v38,v58
mm a[80:83],a[180:183],v[208:211],a[80:83]
v_add_f32 v38,v38,v59
cv v187,v58,v59
v_add_f32 v35,v35,v39
mm a[84:87],a[180:183],v[212:215],a[84:87]
dt a[164:165],v25 offset:57344
v_add_f32 v39,v40,v41
cv v188,v40,v41
mm a[88:91],a[180:183],v[216:219],a[88:91]
bl a[248:251],v62,s[8:11],s68 offen offset:3072 sc1
v_add_f32 v39,v39,v42
mm a[92:95],a[180:183],v[220:223],a[92:95]
dt a[166:167],v25 offset:61440
v_add_f32 v39,v39,v43
cv v189,v42,v43
mm a[96:99],a[184:187],v[208:211],a[96:99]
v_add_f32 v39,v39,v44
v_add_f32 v39,v39,v45
mm a[100:103],a[184:187],v[212:215],a[100:103]
dt a[168:169],v26 offset:57344
cv v190,v44,v45
v_add_f32 v39,v39,v46
mm a[104:107],a[184:187],v[216:219],a[104:107]
bl a[252:255],v63,s[8:11],s68 offen offset:3072 sc1
v_add_f32 v39,v39,v47
mm a[108:111],a[184:187],v[220:223],a[108:111]
dt a[170:171],v26 offset:61440
cv v191,v46,v47
v_max3_f32 v48,v36,v37,v38
mm a[112:115],a[188:191],v[208:211],a[112:115]
s_bfe_u32 s79,s81,0x40000
s_mul_i32 s79,s79,147456
s_add_u32 s79,s79,s70
v_max_f32 v48,v48,v39
mm a[116:119],a[188:191],v[212:215],a[116:119]
s_add_u32 m0,s71,90112
dt a[172:173],v27 offset:57344
v_cmp_nle_f32 vcc,v48,v49
mm a[120:123],a[188:191],v[216:219],a[120:123]
bl v4,s[32:35],s79 offen lds
mm a[124:127],a[188:191],v[220:223],a[124:127]
s_waitcnt lgkmcnt(7)
dt a[174:175],v27 offset:61440
s_cbranch_vccnz L_rareg12
L_backg12:
mm v[224:227],a[128:131],v[96:99],v[80:83]
s_add_u32 m0,s71,91136
v_exp_f32 v40,v112
mm v[224:227],a[132:135],v[128:131],v[224:227]
ds_read_b128 a[144:147],v20 offset:20480
v_exp_f32 v41,v113
mm v[224:227],a[136:139],v[160:163],v[224:227]
bl v5,s[32:35],s79 offen lds
mm v[224:227],a[140:143],v[192:195],v[224:227]
s_add_u32 m0,s71,92160
v_exp_f32 v42,v114
v_add_f32 v32,v32,v36
mm v[228:231],a[128:131],v[100:103],v[84:87]
v_exp_f32 v43,v115
mm v[228:231],a[132:135],v[132:135],v[228:231]
ds_read_b128 a[148:151],v21 offset:20480
v_exp_f32 v44,v144
mm v[228:231],a[136:139],v[164:167],v[228:231]
bl v6,s[32:35],s79 offen lds
mm v[228:231],a[140:143],v[196:199],v[228:231]
s_add_u32 m0,s71,93184
v_exp_f32 v45,v145
v_add_f32 v36,v40,v41
mm v[232:235],a[128:131],v[104:107],v[88:91]
bl v7,s[32:35],s79 offen lds
mm v[232:235],a[132:135],v[136:139],v[232:235]
ds_read_b128 a[152:155],v22 offset:20480
v_exp_f32 v46,v146
mm v[232:235],a[136:139],v[168:171],v[232:235]
s_add_u32 m0,s71,94208
v_exp_f32 v47,v147
mm v[232:235],a[140:143],v[200:203],v[232:235]
v_exp_f32 v56,v116
cv v208,v40,v41
mm v[236:239],a[128:131],v[108:111],v[92:95]
bl v8,s[32:35],s79 offen lds
mm v[236:239],a[132:135],v[140:143],v[236:239]
s_add_u32 m0,s71,95232
ds_read_b128 a[156:159],v23 offset:20480
v_add_f32 v36,v36,v42
mm v[236:239],a[136:139],v[172:175],v[236:239]
v_exp_f32 v57,v117
v_add_f32 v36,v36,v43
mm v[236:239],a[140:143],v[204:207],v[236:239]
s_waitcnt lgkmcnt(4)
bl v9,s[32:35],s79 offen lds
mm a[0:3],a[160:163],v[176:179],a[0:3]
v_exp_f32 v58,v118
cv v209,v42,v43
mm a[4:7],a[160:163],v[180:183],a[4:7]
s_add_u32 m0,s71,96256
dt a[176:177],v28 offset:57344
v_add_f32 v36,v36,v44
mm a[8:11],a[160:163],v[184:187],a[8:11]
v_exp_f32 v59,v119
v_add_f32 v36,v36,v45
mm a[12:15],a[160:163],v[188:191],a[12:15]
dt a[178:179],v28 offset:61440
cv v210,v44,v45
mm a[16:19],a[164:167],v[176:179],a[16:19]
bl v10,s[32:35],s79 offen lds
v_add_f32 v36,v36,v46
mm a[20:23],a[164:167],v[180:183],a[20:23]
s_add_u32 m0,s71,97280
dt a[180:181],v29 offset:57344
v_add_f32 v36,v36,v47
mm a[24:27],a[164:167],v[184:187],a[24:27]
v_exp_f32 v40,v148
cv v211,v46,v47
mm a[28:31],a[164:167],v[188:191],a[28:31]
dt a[182:183],v29 offset:61440
v_add_f32 v33,v33,v37
mm a[32:35],a[168:171],v[176:179],a[32:35]
bl v11,s[32:35],s79 offen lds
v_add_f32 v37,v56,v57
mm a[36:39],a[168:171],v[180:183],a[36:39]
s_add_u32 m0,s71,98304
dt a[184:185],v30 offset:57344
cv v212,v56,v57
mm a[40:43],a[168:171],v[184:187],a[40:43]
v_exp_f32 v41,v149
mm a[44:47],a[168:171],v[188:191],a[44:47]
dt a[186:187],v30 offset:61440
v_exp_f32 v42,v150
mm a[48:51],a[172:175],v[176:179],a[48:51]
bl v12,s[32:35],s79 offen lds
mm a[52:55],a[172:175],v[180:183],a[52:55]
dt a[188:189],v31 offset:57344
v_exp_f32 v43,v151
mm a[56:59],a[172:175],v[184:187],a[56:59]
v_exp_f32 v44,v120
mm a[60:63],a[172:175],v[188:191],a[60:63]
s_waitcnt lgkmcnt(7)
s_waitcnt vmcnt(15)
dt a[190:191],v31 offset:61440
v_add_f32 v37,v37,v58
mm v[240:243],a[144:147],v[96:99],v[80:83]
s_barrier
v_exp_f32 v45,v121
mm v[240:243],a[148:151],v[128:131],v[240:243]
ds_read_b128 a[128:131],v20 offset:0
v_exp_f32 v46,v122
mm v[240:243],a[152:155],v[160:163],v[240:243]
v_exp_f32 v47,v123
mm v[240:243],a[156:159],v[192:195],v[240:243]
v_exp_f32 v56,v152
v_add_f32 v37,v37,v59
mm v[244:247],a[144:147],v[100:103],v[84:87]
v_exp_f32 v57,v153
mm v[244:247],a[148:151],v[132:135],v[244:247]
ds_read_b128 a[132:135],v21 offset:0
cv v213,v58,v59
v_add_f32 v37,v37,v40
mm v[244:247],a[152:155],v[164:167],v[244:247]
v_exp_f32 v58,v154
mm v[244:247],a[156:159],v[196:199],v[244:247]
v_exp_f32 v59,v155
mm v[248:251],a[144:147],v[104:107],v[88:91]
v_add_f32 v37,v37,v41
cv v214,v40,v41
v_add_f32 v37,v37,v42
mm v[248:251],a[148:151],v[136:139],v[248:251]
ds_read_b128 a[136:139],v22 offset:0
v_add_f32 v37,v37,v43
mm v[248:251],a[152:155],v[168:171],v[248:251]
v_exp_f32 v40,v124
cv v215,v42,v43
mm v[248:251],a[156:159],v[200:203],v[248:251]
v_exp_f32 v41,v125
mm v[252:255],a[144:147],v[108:111],v[92:95]
v_exp_f32 v42,v126
v_add_f32 v34,v34,v38
mm v[252:255],a[148:151],v[140:143],v[252:255]
ds_read_b128 a[140:143],v23 offset:0
v_add_f32 v38,v44,v45
mm v[252:255],a[152:155],v[172:175],v[252:255]
v_exp_f32 v43,v127
cv v216,v44,v45
mm v[252:255],a[156:159],v[204:207],v[252:255]
s_waitcnt lgkmcnt(4)
v_exp_f32 v44,v156
mm a[64:67],a[176:179],v[176:179],a[64:67]
v_exp_f32 v45,v157
v_add_f32 v38,v38,v46
mm a[68:71],a[176:179],v[180:183],a[68:71]
dt a[160:161],v24 offset:0
v_add_f32 v38,v38,v47
mm a[72:75],a[176:179],v[184:187],a[72:75]
cv v217,v46,v47
v_exp_f32 v46,v158
mm a[76:79],a[176:179],v[188:191],a[76:79]
dt a[162:163],v24 offset:4096
v_add_f32 v38,v38,v56
mm a[80:83],a[180:183],v[176:179],a[80:83]
v_exp_f32 v47,v159
mm a[84:87],a[180:183],v[180:183],a[84:87]
dt a[164:165],v25 offset:0
v_add_f32 v38,v38,v57
cv v218,v56,v57
mm a[88:91],a[180:183],v[184:187],a[88:91]
v_add_f32 v38,v38,v58
v_add_f32 v38,v38,v59
mm a[92:95],a[180:183],v[188:191],a[92:95]
dt a[166:167],v25 offset:4096
cv v219,v58,v59
v_add_f32 v35,v35,v39
mm a[96:99],a[184:187],v[176:179],a[96:99]
v_add_f32 v39,v40,v41
cv v220,v40,v41
mm a[100:103],a[184:187],v[180:183],a[100:103]
dt a[168:169],v26 offset:0
v_add_f32 v39,v39,v42
v_add_f32 v39,v39,v43
mm a[104:107],a[184:187],v[184:187],a[104:107]
cv v221,v42,v43
v_add_f32 v39,v39,v44
mm a[108:111],a[184:187],v[188:191],a[108:111]
dt a[170:171],v26 offset:4096
v_add_f32 v39,v39,v45
cv v222,v44,v45
mm a[112:115],a[188:191],v[176:179],a[112:115]
v_add_f32 v39,v39,v46
v_add_f32 v39,v39,v47
mm a[116:119],a[188:191],v[180:183],a[116:119]
dt a[172:173],v27 offset:0
cv v223,v46,v47
v_max3_f32 v48,v36,v37,v38
mm a[120:123],a[188:191],v[184:187],a[120:123]
v_max_f32 v48,v48,v39
v_cmp_nle_f32 vcc,v48,v49
mm a[124:127],a[188:191],v[188:191],a[124:127]
s_waitcnt lgkmcnt(7)
dt a[174:175],v27 offset:4096
s_cbranch_vccnz L_rareg13
L_backg13:
mm v[112:115],a[128:131],v[96:99],v[80:83]
v_exp_f32 v40,v224
mm v[112:115],a[132:135],v[128:131],v[112:115]
ds_read_b128 a[144:147],v20 offset:4096
v_add_f32 v32,v32,v36
mm v[112:115],a[136:139],v[160:163],v[112:115]
v_exp_f32 v41,v225
mm v[112:115],a[140:143],v[192:195],v[112:115]
v_exp_f32 v42,v226
mm v[116:119],a[128:131],v[100:103],v[84:87]
v_exp_f32 v43,v227
mm v[116:119],a[132:135],v[132:135],v[116:119]
ds_read_b128 a[148:151],v21 offset:4096
v_add_f32 v36,v40,v41
mm v[116:119],a[136:139],v[164:167],v[116:119]
v_exp_f32 v44,v240
mm v[116:119],a[140:143],v[196:199],v[116:119]
v_exp_f32 v45,v241
mm v[120:123],a[128:131],v[104:107],v[88:91]
v_exp_f32 v46,v242
mm v[120:123],a[132:135],v[136:139],v[120:123]
ds_read_b128 a[152:155],v22 offset:4096
v_exp_f32 v47,v243
mm v[120:123],a[136:139],v[168:171],v[120:123]
v_exp_f32 v56,v228
mm v[120:123],a[140:143],v[200:203],v[120:123]
v_exp_f32 v57,v229
mm v[124:127],a[128:131],v[108:111],v[92:95]
v_exp_f32 v58,v230
mm v[124:127],a[132:135],v[140:143],v[124:127]
ds_read_b128 a[156:159],v23 offset:4096
cv v176,v40,v41
mm v[124:127],a[136:139],v[172:175],v[124:127]
v_exp_f32 v59,v231
mm v[124:127],a[140:143],v[204:207],v[124:127]
s_waitcnt lgkmcnt(4)
v_exp_f32 v40,v244
v_add_f32 v36,v36,v42
mm a[0:3],a[160:163],v[208:211],a[0:3]
v_exp_f32 v41,v245
mm a[4:7],a[160:163],v[212:215],a[4:7]
dt a[176:177],v28 offset:0
v_add_f32 v36,v36,v43
mm a[8:11],a[160:163],v[216:219],a[8:11]
cv v177,v42,v43
v_add_f32 v36,v36,v44
mm a[12:15],a[160:163],v[220:223],a[12:15]
dt a[178:179],v28 offset:4096
v_add_f32 v36,v36,v45
mm a[16:19],a[164:167],v[208:211],a[16:19]
v_exp_f32 v42,v246
mm a[20:23],a[164:167],v[212:215],a[20:23]
dt a[180:181],v29 offset:0
v_exp_f32 v43,v247
mm a[24:27],a[164:167],v[216:219],a[24:27]
cv v178,v44,v45
v_add_f32 v36,v36,v46
mm a[28:31],a[164:167],v[220:223],a[28:31]
dt a[182:183],v29 offset:4096
v_add_f32 v36,v36,v47
mm a[32:35],a[168:171],v[208:211],a[32:35]
v_exp_f32 v44,v232
mm a[36:39],a[168:171],v[212:215],a[36:39]
dt a[184:185],v30 offset:0
cv v179,v46,v47
mm a[40:43],a[168:171],v[216:219],a[40:43]
v_exp_f32 v45,v233
mm a[44:47],a[168:171],v[220:223],a[44:47]
dt a[186:187],v30 offset:4096
v_add_f32 v33,v33,v37
mm a[48:51],a[172:175],v[208:211],a[48:51]
v_exp_f32 v46,v234
v_add_f32 v37,v56,v57
mm a[52:55],a[172:175],v[212:215],a[52:55]
dt a[188:189],v31 offset:0
cv v180,v56,v57
mm a[56:59],a[172:175],v[216:219],a[56:59]
v_exp_f32 v47,v235
mm a[60:63],a[172:175],v[220:223],a[60:63]
s_waitcnt lgkmcnt(7)
dt a[190:191],v31 offset:4096
v_add_f32 v37,v37,v58
mm v[144:147],a[144:147],v[96:99],v[80:83]
v_exp_f32 v56,v248
mm v[144:147],a[148:151],v[128:131],v[144:147]
dt a[160:161],v24 offset:8192
v_add_f32 v37,v37,v59
mm v[144:147],a[152:155],v[160:163],v[144:147]
v_exp_f32 v57,v249
cv v181,v58,v59
mm v[144:147],a[156:159],v[192:195],v[144:147]
dt a[162:163],v24 offset:12288
v_add_f32 v37,v37,v40
mm v[148:151],a[144:147],v[100:103],v[84:87]
v_exp_f32 v58,v250
mm v[148:151],a[148:151],v[132:135],v[148:151]
dt a[164:165],v25 offset:8192
v_add_f32 v37,v37,v41
mm v[148:151],a[152:155],v[164:167],v[148:151]
v_exp_f32 v59,v251
mm v[148:151],a[156:159],v[196:199],v[148:151]
dt a[166:167],v25 offset:12288
cv v182,v40,v41
mm v[152:155],a[144:147],v[104:107],v[88:91]
v_exp_f32 v40,v236
v_add_f32 v37,v37,v42
mm v[152:155],a[148:151],v[136:139],v[152:155]
dt a[168:169],v26 offset:8192
v_add_f32 v37,v37,v43
mm v[152:155],a[152:155],v[168:171],v[152:155]
v_exp_f32 v41,v237
mm v[152:155],a[156:159],v[200:203],v[152:155]
dt a[170:171],v26 offset:12288
cv v183,v42,v43
mm v[156:159],a[144:147],v[108:111],v[92:95]
v_exp_f32 v42,v238
mm v[156:159],a[148:151],v[140:143],v[156:159]
dt a[172:173],v27 offset:8192
v_add_f32 v34,v34,v38
mm v[156:159],a[152:155],v[172:175],v[156:159]
v_exp_f32 v43,v239
mm v[156:159],a[156:159],v[204:207],v[156:159]
s_waitcnt lgkmcnt(7)
dt a[174:175],v27 offset:12288
v_add_f32 v38,v44,v45
cv v184,v44,v45
mm a[64:67],a[176:179],v[208:211],a[64:67]
v_exp_f32 v44,v252
mm a[68:71],a[176:179],v[212:215],a[68:71]
v_exp_f32 v45,v253
mm a[72:75],a[176:179],v[216:219],a[72:75]
v_add_f32 v38,v38,v46
v_add_f32 v38,v38,v47
mm a[76:79],a[176:179],v[220:223],a[76:79]
cv v185,v46,v47
v_add_f32 v38,v38,v56
mm a[80:83],a[180:183],v[208:211],a[80:83]
v_exp_f32 v46,v254
mm a[84:87],a[180:183],v[212:215],a[84:87]
v_exp_f32 v47,v255
v_add_f32 v38,v38,v57
mm a[88:91],a[180:183],v[216:219],a[88:91]
cv v186,v56,v57
v_add_f32 v38,v38,v58
mm a[92:95],a[180:183],v[220:223],a[92:95]
v_add_f32 v38,v38,v59
cv v187,v58,v59
mm a[96:99],a[184:187],v[208:211],a[96:99]
v_add_f32 v35,v35,v39
v_add_f32 v39,v40,v41
mm a[100:103],a[184:187],v[212:215],a[100:103]
cv v188,v40,v41
v_add_f32 v39,v39,v42
mm a[104:107],a[184:187],v[216:219],a[104:107]
v_add_f32 v39,v39,v43
cv v189,v42,v43
mm a[108:111],a[184:187],v[220:223],a[108:111]
v_add_f32 v39,v39,v44
v_add_f32 v39,v39,v45
cv v190,v44,v45
mm a[112:115],a[188:191],v[208:211],a[112:115]
v_add_f32 v39,v39,v46
v_add_f32 v39,v39,v47
mm a[116:119],a[188:191],v[212:215],a[116:119]
cv v191,v46,v47
v_max3_f32 v48,v36,v37,v38
mm a[120:123],a[188:191],v[216:219],a[120:123]
v_max_f32 v48,v48,v39
v_cmp_nle_f32 vcc,v48,v49
mm a[124:127],a[188:191],v[220:223],a[124:127]
s_waitcnt lgkmcnt(0)
dt a[176:177],v28 offset:8192
s_cbranch_vccnz L_rareg14
L_backg14:
mm a[0:3],a[160:163],v[176:179],a[0:3]
s_bfe_u32 s82,s81,0x40000
s_lshl_b32 s82,s82,12
dt a[178:179],v28 offset:12288
v_exp_f32 v40,v112
v_add_f32 v32,v32,v36
mm a[4:7],a[160:163],v[180:183],a[4:7]
s_add_u32 s82,s82,s68
bl v[160:163],v60,s[8:11],s82 offen offset:0 sc1
v_exp_f32 v41,v113
mm a[8:11],a[160:163],v[184:187],a[8:11]
dt a[180:181],v29 offset:8192
v_exp_f32 v42,v114
v_exp_f32 v43,v115
mm a[12:15],a[160:163],v[188:191],a[12:15]
dt a[182:183],v29 offset:12288
v_exp_f32 v44,v144
v_exp_f32 v45,v145
mm a[16:19],a[164:167],v[176:179],a[16:19]
bl v[164:167],v61,s[8:11],s82 offen offset:0 sc1
v_exp_f32 v46,v146
v_add_f32 v36,v40,v41
mm a[20:23],a[164:167],v[180:183],a[20:23]
dt a[184:185],v30 offset:8192
v_exp_f32 v47,v147
v_exp_f32 v56,v116
mm a[24:27],a[164:167],v[184:187],a[24:27]
bl v[168:171],v62,s[8:11],s82 offen offset:0 sc1
v_exp_f32 v57,v117
cv v208,v40,v41
mm a[28:31],a[164:167],v[188:191],a[28:31]
dt a[186:187],v30 offset:12288
v_exp_f32 v58,v118
v_exp_f32 v59,v119
mm a[32:35],a[168:171],v[176:179],a[32:35]
dt a[188:189],v31 offset:8192
v_exp_f32 v40,v148
v_exp_f32 v41,v149
mm a[36:39],a[168:171],v[180:183],a[36:39]
bl v[172:175],v63,s[8:11],s82 offen offset:0 sc1
v_add_f32 v36,v36,v42
v_add_f32 v36,v36,v43
cv v209,v42,v43
mm a[40:43],a[168:171],v[184:187],a[40:43]
dt a[190:191],v31 offset:12288
v_exp_f32 v42,v150
v_exp_f32 v43,v151
mm a[44:47],a[168:171],v[188:191],a[44:47]
bl v[192:195],v60,s[8:11],s82 offen offset:1024 sc1
v_add_f32 v36,v36,v44
v_add_f32 v36,v36,v45
cv v210,v44,v45
mm a[48:51],a[172:175],v[176:179],a[48:51]
bl v[196:199],v61,s[8:11],s82 offen offset:1024 sc1
v_exp_f32 v44,v120
v_add_f32 v36,v36,v46
mm a[52:55],a[172:175],v[180:183],a[52:55]
bl v[200:203],v62,s[8:11],s82 offen offset:1024 sc1
bl v[204:207],v63,s[8:11],s82 offen offset:1024 sc1
v_add_f32 v36,v36,v47
mm a[56:59],a[172:175],v[184:187],a[56:59]
s_waitcnt vmcnt(21)
v_exp_f32 v45,v121
cv v211,v46,v47
v_exp_f32 v46,v122
mm a[60:63],a[172:175],v[188:191],a[60:63]
s_waitcnt lgkmcnt(0)
s_barrier
dt a[160:161],v24 offset:16384
v_exp_f32 v47,v123
v_add_f32 v33,v33,v37
mm a[64:67],a[176:179],v[176:179],a[64:67]
dt a[162:163],v24 offset:20480
v_add_f32 v37,v56,v57
cv v212,v56,v57
v_exp_f32 v56,v152
mm a[68:71],a[176:179],v[180:183],a[68:71]
v_exp_f32 v57,v153
v_add_f32 v37,v37,v58
v_add_f32 v37,v37,v59
cv v213,v58,v59
mm a[72:75],a[176:179],v[184:187],a[72:75]
dt a[164:165],v25 offset:16384
v_exp_f32 v58,v154
v_exp_f32 v59,v155
mm a[76:79],a[176:179],v[188:191],a[76:79]
dt a[166:167],v25 offset:20480
v_add_f32 v37,v37,v40
v_add_f32 v37,v37,v41
cv v214,v40,v41
v_add_f32 v37,v37,v42
mm a[80:83],a[180:183],v[176:179],a[80:83]
v_exp_f32 v40,v124
v_exp_f32 v41,v125
v_add_f32 v37,v37,v43
mm a[84:87],a[180:183],v[180:183],a[84:87]
dt a[168:169],v26 offset:16384
cv v215,v42,v43
v_exp_f32 v42,v126
v_add_f32 v34,v34,v38
mm a[88:91],a[180:183],v[184:187],a[88:91]
v_exp_f32 v43,v127
v_add_f32 v38,v44,v45
cv v216,v44,v45
v_add_f32 v38,v38,v46
mm a[92:95],a[180:183],v[188:191],a[92:95]
dt a[170:171],v26 offset:20480
v_exp_f32 v44,v156
v_exp_f32 v45,v157
mm a[96:99],a[184:187],v[176:179],a[96:99]
dt a[172:173],v27 offset:16384
v_add_f32 v38,v38,v47
cv v217,v46,v47
v_exp_f32 v46,v158
mm a[100:103],a[184:187],v[180:183],a[100:103]
v_exp_f32 v47,v159
v_add_f32 v38,v38,v56
v_add_f32 v38,v38,v57
mm a[104:107],a[184:187],v[184:187],a[104:107]
dt a[174:175],v27 offset:20480
cv v218,v56,v57
v_add_f32 v38,v38,v58
v_add_f32 v38,v38,v59
mm a[108:111],a[184:187],v[188:191],a[108:111]
cv v219,v58,v59
v_add_f32 v35,v35,v39
v_add_f32 v39,v40,v41
cv v220,v40,v41
mm a[112:115],a[188:191],v[176:179],a[112:115]
v_add_f32 v39,v39,v42
v_add_f32 v39,v39,v43
cv v221,v42,v43
v_add_f32 v39,v39,v44
mm a[116:119],a[188:191],v[180:183],a[116:119]
v_add_f32 v39,v39,v45
cv v222,v44,v45
v_add_f32 v39,v39,v46
v_add_f32 v39,v39,v47
mm a[120:123],a[188:191],v[184:187],a[120:123]
cv v223,v46,v47
v_max3_f32 v48,v36,v37,v38
v_max_f32 v48,v48,v39
v_cmp_nle_f32 vcc,v48,v49
mm a[124:127],a[188:191],v[188:191],a[124:127]
s_waitcnt lgkmcnt(0)
dt a[176:177],v28 offset:16384
s_cbranch_vccnz L_rareg15
L_backg15:
mm a[0:3],a[160:163],v[208:211],a[0:3]
s_bfe_u32 s82,s81,0x40000
s_lshl_b32 s82,s82,12
dt a[178:179],v28 offset:20480
mm a[4:7],a[160:163],v[212:215],a[4:7]
s_add_u32 s82,s82,s68
bl v[224:227],v60,s[8:11],s82 offen offset:2048 sc1
mm a[8:11],a[160:163],v[216:219],a[8:11]
dt a[180:181],v29 offset:16384
v_add_f32 v32,v32,v36
mm a[12:15],a[160:163],v[220:223],a[12:15]
dt a[182:183],v29 offset:20480
v_add_f32 v33,v33,v37
mm a[16:19],a[164:167],v[208:211],a[16:19]
bl v[228:231],v61,s[8:11],s82 offen offset:2048 sc1
mm a[20:23],a[164:167],v[212:215],a[20:23]
dt a[184:185],v30 offset:16384
v_add_f32 v34,v34,v38
mm a[24:27],a[164:167],v[216:219],a[24:27]
v_add_f32 v35,v35,v39
v_mov_b32 v50,v32
mm a[28:31],a[164:167],v[220:223],a[28:31]
dt a[186:187],v30 offset:20480
v_mov_b32 v51,v33
mm a[32:35],a[168:171],v[208:211],a[32:35]
dt a[188:189],v31 offset:16384
v_mov_b32 v52,v34
mm a[36:39],a[168:171],v[212:215],a[36:39]
bl v[232:235],v62,s[8:11],s82 offen offset:2048 sc1
mm a[40:43],a[168:171],v[216:219],a[40:43]
dt a[190:191],v31 offset:20480
v_mov_b32 v53,v35
mm a[44:47],a[168:171],v[220:223],a[44:47]
v_permlane16_swap_b32 v32,v50
v_permlane16_swap_b32 v33,v51
mm a[48:51],a[172:175],v[208:211],a[48:51]
v_permlane16_swap_b32 v34,v52
v_permlane16_swap_b32 v35,v53
mm a[52:55],a[172:175],v[212:215],a[52:55]
bl v[236:239],v63,s[8:11],s82 offen offset:2048 sc1
mm a[56:59],a[172:175],v[216:219],a[56:59]
v_add_f32 v32,v32,v50
v_add_f32 v33,v33,v51
mm a[60:63],a[172:175],v[220:223],a[60:63]
s_waitcnt lgkmcnt(0)
v_add_f32 v34,v34,v52
v_add_f32 v35,v35,v53
mm a[64:67],a[176:179],v[208:211],a[64:67]
s_barrier
bl v[240:243],v60,s[8:11],s82 offen offset:3072 sc1
mm a[68:71],a[176:179],v[212:215],a[68:71]
dt v[64:65],v14 offset:45056
v_mov_b32 v50,v32
v_mov_b32 v51,v33
mm a[72:75],a[176:179],v[216:219],a[72:75]
v_mov_b32 v52,v34
v_mov_b32 v53,v35
mm a[76:79],a[176:179],v[220:223],a[76:79]
bl v[244:247],v61,s[8:11],s82 offen offset:3072 sc1
dt v[66:67],v14 offset:49664
mm a[80:83],a[180:183],v[208:211],a[80:83]
v_permlane32_swap_b32 v32,v50
v_permlane32_swap_b32 v33,v51
mm a[84:87],a[180:183],v[212:215],a[84:87]
dt v[68:69],v14 offset:54272
v_permlane32_swap_b32 v34,v52
v_permlane32_swap_b32 v35,v53
mm a[88:91],a[180:183],v[216:219],a[88:91]
bl v[248:251],v62,s[8:11],s82 offen offset:3072 sc1
mm a[92:95],a[180:183],v[220:223],a[92:95]
dt v[70:71],v14 offset:58880
v_add_f32 v32,v32,v50
v_add_f32 v33,v33,v51
mm a[96:99],a[184:187],v[208:211],a[96:99]
v_add_f32 v34,v34,v52
v_add_f32 v35,v35,v53
mm a[100:103],a[184:187],v[212:215],a[100:103]
bl v[252:255],v63,s[8:11],s82 offen offset:3072 sc1
dt v[72:73],v14 offset:45088
mm a[104:107],a[184:187],v[216:219],a[104:107]
v_rcp_f32 v32,v32
mm a[108:111],a[184:187],v[220:223],a[108:111]
dt v[74:75],v14 offset:49696
v_rcp_f32 v33,v33
mm a[112:115],a[188:191],v[208:211],a[112:115]
v_rcp_f32 v34,v34
mm a[116:119],a[188:191],v[212:215],a[116:119]
dt v[76:77],v14 offset:54304
v_rcp_f32 v35,v35
mm a[120:123],a[188:191],v[216:219],a[120:123]
mm a[124:127],a[188:191],v[220:223],a[124:127]
dt v[78:79],v14 offset:58912
s_barrier
ar v40,a0
ar v41,a1
ar v42,a2
ar v43,a3
ar v44,a16
ar v45,a17
ar v46,a18
ar v47,a19
v_pk_mul_f32 v[40:41],v[40:41],v[32:33] op_sel_hi:[1,0]
v_pk_mul_f32 v[42:43],v[42:43],v[32:33] op_sel_hi:[1,0]
v_pk_mul_f32 v[44:45],v[44:45],v[32:33] op_sel_hi:[1,0]
v_pk_mul_f32 v[46:47],v[46:47],v[32:33] op_sel_hi:[1,0]
cv v96,v40,v41
cv v97,v42,v43
cv v98,v44,v45
cv v99,v46,v47
buffer_store_dwordx4 v[96:99],v2,s[8:11],s48 offen offset:0 sc1
ar v48,a4
ar v49,a5
ar v50,a6
ar v51,a7
ar v52,a20
ar v53,a21
ar v54,a22
ar v55,a23
v_pk_mul_f32 v[48:49],v[48:49],v[32:33] op_sel:[0,1] op_sel_hi:[1,1]
v_pk_mul_f32 v[50:51],v[50:51],v[32:33] op_sel:[0,1] op_sel_hi:[1,1]
v_pk_mul_f32 v[52:53],v[52:53],v[32:33] op_sel:[0,1] op_sel_hi:[1,1]
v_pk_mul_f32 v[54:55],v[54:55],v[32:33] op_sel:[0,1] op_sel_hi:[1,1]
cv v100,v48,v49
cv v101,v50,v51
cv v102,v52,v53
cv v103,v54,v55
buffer_store_dwordx4 v[100:103],v2,s[8:11],s49 offen offset:0 sc1
ar v40,a8
ar v41,a9
ar v42,a10
ar v43,a11
ar v44,a24
ar v45,a25
ar v46,a26
ar v47,a27
v_pk_mul_f32 v[40:41],v[40:41],v[34:35] op_sel_hi:[1,0]
v_pk_mul_f32 v[42:43],v[42:43],v[34:35] op_sel_hi:[1,0]
v_pk_mul_f32 v[44:45],v[44:45],v[34:35] op_sel_hi:[1,0]
v_pk_mul_f32 v[46:47],v[46:47],v[34:35] op_sel_hi:[1,0]
cv v104,v40,v41
cv v105,v42,v43
cv v106,v44,v45
cv v107,v46,v47
buffer_store_dwordx4 v[104:107],v2,s[8:11],s50 offen offset:0 sc1
ar v48,a12
ar v49,a13
ar v50,a14
ar v51,a15
ar v52,a28
ar v53,a29
ar v54,a30
ar v55,a31
v_pk_mul_f32 v[48:49],v[48:49],v[34:35] op_sel:[0,1] op_sel_hi:[1,1]
v_pk_mul_f32 v[50:51],v[50:51],v[34:35] op_sel:[0,1] op_sel_hi:[1,1]
v_pk_mul_f32 v[52:53],v[52:53],v[34:35] op_sel:[0,1] op_sel_hi:[1,1]
v_pk_mul_f32 v[54:55],v[54:55],v[34:35] op_sel:[0,1] op_sel_hi:[1,1]
cv v108,v48,v49
cv v109,v50,v51
cv v110,v52,v53
cv v111,v54,v55
buffer_store_dwordx4 v[108:111],v2,s[8:11],s51 offen offset:0 sc1
ar v40,a32
ar v41,a33
ar v42,a34
ar v43,a35
ar v44,a48
ar v45,a49
ar v46,a50
ar v47,a51
v_pk_mul_f32 v[40:41],v[40:41],v[32:33] op_sel_hi:[1,0]
v_pk_mul_f32 v[42:43],v[42:43],v[32:33] op_sel_hi:[1,0]
v_pk_mul_f32 v[44:45],v[44:45],v[32:33] op_sel_hi:[1,0]
v_pk_mul_f32 v[46:47],v[46:47],v[32:33] op_sel_hi:[1,0]
cv v112,v40,v41
cv v113,v42,v43
cv v114,v44,v45
cv v115,v46,v47
buffer_store_dwordx4 v[112:115],v2,s[8:11],s48 offen offset:1024 sc1
ar v48,a36
ar v49,a37
ar v50,a38
ar v51,a39
ar v52,a52
ar v53,a53
ar v54,a54
ar v55,a55
v_pk_mul_f32 v[48:49],v[48:49],v[32:33] op_sel:[0,1] op_sel_hi:[1,1]
v_pk_mul_f32 v[50:51],v[50:51],v[32:33] op_sel:[0,1] op_sel_hi:[1,1]
v_pk_mul_f32 v[52:53],v[52:53],v[32:33] op_sel:[0,1] op_sel_hi:[1,1]
v_pk_mul_f32 v[54:55],v[54:55],v[32:33] op_sel:[0,1] op_sel_hi:[1,1]
cv v116,v48,v49
cv v117,v50,v51
cv v118,v52,v53
cv v119,v54,v55
buffer_store_dwordx4 v[116:119],v2,s[8:11],s49 offen offset:1024 sc1
ar v40,a40
ar v41,a41
ar v42,a42
ar v43,a43
ar v44,a56
ar v45,a57
ar v46,a58
ar v47,a59
v_pk_mul_f32 v[40:41],v[40:41],v[34:35] op_sel_hi:[1,0]
v_pk_mul_f32 v[42:43],v[42:43],v[34:35] op_sel_hi:[1,0]
v_pk_mul_f32 v[44:45],v[44:45],v[34:35] op_sel_hi:[1,0]
v_pk_mul_f32 v[46:47],v[46:47],v[34:35] op_sel_hi:[1,0]
cv v120,v40,v41
cv v121,v42,v43
cv v122,v44,v45
cv v123,v46,v47
buffer_store_dwordx4 v[120:123],v2,s[8:11],s50 offen offset:1024 sc1
ar v48,a44
ar v49,a45
ar v50,a46
ar v51,a47
ar v52,a60
ar v53,a61
ar v54,a62
ar v55,a63
v_pk_mul_f32 v[48:49],v[48:49],v[34:35] op_sel:[0,1] op_sel_hi:[1,1]
v_pk_mul_f32 v[50:51],v[50:51],v[34:35] op_sel:[0,1] op_sel_hi:[1,1]
v_pk_mul_f32 v[52:53],v[52:53],v[34:35] op_sel:[0,1] op_sel_hi:[1,1]
v_pk_mul_f32 v[54:55],v[54:55],v[34:35] op_sel:[0,1] op_sel_hi:[1,1]
cv v124,v48,v49
cv v125,v50,v51
cv v126,v52,v53
cv v127,v54,v55
buffer_store_dwordx4 v[124:127],v2,s[8:11],s51 offen offset:1024 sc1
ar v40,a64
ar v41,a65
ar v42,a66
ar v43,a67
ar v44,a80
ar v45,a81
ar v46,a82
ar v47,a83
v_pk_mul_f32 v[40:41],v[40:41],v[32:33] op_sel_hi:[1,0]
v_pk_mul_f32 v[42:43],v[42:43],v[32:33] op_sel_hi:[1,0]
v_pk_mul_f32 v[44:45],v[44:45],v[32:33] op_sel_hi:[1,0]
v_pk_mul_f32 v[46:47],v[46:47],v[32:33] op_sel_hi:[1,0]
cv v128,v40,v41
cv v129,v42,v43
cv v130,v44,v45
cv v131,v46,v47
buffer_store_dwordx4 v[128:131],v2,s[8:11],s48 offen offset:2048 sc1
ar v48,a68
ar v49,a69
ar v50,a70
ar v51,a71
ar v52,a84
ar v53,a85
ar v54,a86
ar v55,a87
v_pk_mul_f32 v[48:49],v[48:49],v[32:33] op_sel:[0,1] op_sel_hi:[1,1]
v_pk_mul_f32 v[50:51],v[50:51],v[32:33] op_sel:[0,1] op_sel_hi:[1,1]
v_pk_mul_f32 v[52:53],v[52:53],v[32:33] op_sel:[0,1] op_sel_hi:[1,1]
v_pk_mul_f32 v[54:55],v[54:55],v[32:33] op_sel:[0,1] op_sel_hi:[1,1]
cv v132,v48,v49
cv v133,v50,v51
cv v134,v52,v53
cv v135,v54,v55
buffer_store_dwordx4 v[132:135],v2,s[8:11],s49 offen offset:2048 sc1
ar v40,a72
ar v41,a73
ar v42,a74
ar v43,a75
ar v44,a88
ar v45,a89
ar v46,a90
ar v47,a91
v_pk_mul_f32 v[40:41],v[40:41],v[34:35] op_sel_hi:[1,0]
v_pk_mul_f32 v[42:43],v[42:43],v[34:35] op_sel_hi:[1,0]
v_pk_mul_f32 v[44:45],v[44:45],v[34:35] op_sel_hi:[1,0]
v_pk_mul_f32 v[46:47],v[46:47],v[34:35] op_sel_hi:[1,0]
cv v136,v40,v41
cv v137,v42,v43
cv v138,v44,v45
cv v139,v46,v47
buffer_store_dwordx4 v[136:139],v2,s[8:11],s50 offen offset:2048 sc1
ar v48,a76
ar v49,a77
ar v50,a78
ar v51,a79
ar v52,a92
ar v53,a93
ar v54,a94
ar v55,a95
v_pk_mul_f32 v[48:49],v[48:49],v[34:35] op_sel:[0,1] op_sel_hi:[1,1]
v_pk_mul_f32 v[50:51],v[50:51],v[34:35] op_sel:[0,1] op_sel_hi:[1,1]
v_pk_mul_f32 v[52:53],v[52:53],v[34:35] op_sel:[0,1] op_sel_hi:[1,1]
v_pk_mul_f32 v[54:55],v[54:55],v[34:35] op_sel:[0,1] op_sel_hi:[1,1]
cv v140,v48,v49
cv v141,v50,v51
cv v142,v52,v53
cv v143,v54,v55
buffer_store_dwordx4 v[140:143],v2,s[8:11],s51 offen offset:2048 sc1
ar v40,a96
ar v41,a97
ar v42,a98
ar v43,a99
ar v44,a112
ar v45,a113
ar v46,a114
ar v47,a115
v_pk_mul_f32 v[40:41],v[40:41],v[32:33] op_sel_hi:[1,0]
v_pk_mul_f32 v[42:43],v[42:43],v[32:33] op_sel_hi:[1,0]
v_pk_mul_f32 v[44:45],v[44:45],v[32:33] op_sel_hi:[1,0]
v_pk_mul_f32 v[46:47],v[46:47],v[32:33] op_sel_hi:[1,0]
cv v144,v40,v41
cv v145,v42,v43
cv v146,v44,v45
cv v147,v46,v47
buffer_store_dwordx4 v[144:147],v2,s[8:11],s48 offen offset:3072 sc1
ar v48,a100
ar v49,a101
ar v50,a102
ar v51,a103
ar v52,a116
ar v53,a117
ar v54,a118
ar v55,a119
v_pk_mul_f32 v[48:49],v[48:49],v[32:33] op_sel:[0,1] op_sel_hi:[1,1]
v_pk_mul_f32 v[50:51],v[50:51],v[32:33] op_sel:[0,1] op_sel_hi:[1,1]
v_pk_mul_f32 v[52:53],v[52:53],v[32:33] op_sel:[0,1] op_sel_hi:[1,1]
v_pk_mul_f32 v[54:55],v[54:55],v[32:33] op_sel:[0,1] op_sel_hi:[1,1]
cv v148,v48,v49
cv v149,v50,v51
cv v150,v52,v53
cv v151,v54,v55
buffer_store_dwordx4 v[148:151],v2,s[8:11],s49 offen offset:3072 sc1
ar v40,a104
ar v41,a105
ar v42,a106
ar v43,a107
ar v44,a120
ar v45,a121
ar v46,a122
ar v47,a123
v_pk_mul_f32 v[40:41],v[40:41],v[34:35] op_sel_hi:[1,0]
v_pk_mul_f32 v[42:43],v[42:43],v[34:35] op_sel_hi:[1,0]
v_pk_mul_f32 v[44:45],v[44:45],v[34:35] op_sel_hi:[1,0]
v_pk_mul_f32 v[46:47],v[46:47],v[34:35] op_sel_hi:[1,0]
cv v152,v40,v41
cv v153,v42,v43
cv v154,v44,v45
cv v155,v46,v47
buffer_store_dwordx4 v[152:155],v2,s[8:11],s50 offen offset:3072 sc1
ar v48,a108
ar v49,a109
ar v50,a110
ar v51,a111
ar v52,a124
ar v53,a125
ar v54,a126
ar v55,a127
v_pk_mul_f32 v[48:49],v[48:49],v[34:35] op_sel:[0,1] op_sel_hi:[1,1]
v_pk_mul_f32 v[50:51],v[50:51],v[34:35] op_sel:[0,1] op_sel_hi:[1,1]
v_pk_mul_f32 v[52:53],v[52:53],v[34:35] op_sel:[0,1] op_sel_hi:[1,1]
v_pk_mul_f32 v[54:55],v[54:55],v[34:35] op_sel:[0,1] op_sel_hi:[1,1]
cv v156,v48,v49
cv v157,v50,v51
cv v158,v52,v53
cv v159,v54,v55
buffer_store_dwordx4 v[156:159],v2,s[8:11],s51 offen offset:3072 sc1
s_waitcnt lgkmcnt(4)
mm a[0:3],v[64:67],a[192:195],0
dt v[80:81],v14 offset:45120
mm a[0:3],v[68:71],a[208:211],a[0:3]
mm a[4:7],v[64:67],a[196:199],0
dt v[82:83],v14 offset:49728
mm a[4:7],v[68:71],a[212:215],a[4:7]
mm a[8:11],v[64:67],a[200:203],0
dt v[84:85],v14 offset:54336
mm a[8:11],v[68:71],a[216:219],a[8:11]
mm a[12:15],v[64:67],a[204:207],0
dt v[86:87],v14 offset:58944
mm a[12:15],v[68:71],a[220:223],a[12:15]
s_waitcnt lgkmcnt(4)
mm a[16:19],v[72:75],a[192:195],0
dt v[88:89],v14 offset:45152
mm a[16:19],v[76:79],a[208:211],a[16:19]
mm a[20:23],v[72:75],a[196:199],0
dt v[90:91],v14 offset:49760
mm a[20:23],v[76:79],a[212:215],a[20:23]
mm a[24:27],v[72:75],a[200:203],0
dt v[92:93],v14 offset:54368
mm a[24:27],v[76:79],a[216:219],a[24:27]
mm a[28:31],v[72:75],a[204:207],0
dt v[94:95],v14 offset:58976
mm a[28:31],v[76:79],a[220:223],a[28:31]
s_waitcnt lgkmcnt(4)
mm a[32:35],v[80:83],a[192:195],0
dt v[64:65],v14 offset:45184
mm a[32:35],v[84:87],a[208:211],a[32:35]
mm a[36:39],v[80:83],a[196:199],0
dt v[66:67],v14 offset:49792
mm a[36:39],v[84:87],a[212:215],a[36:39]
mm a[40:43],v[80:83],a[200:203],0
dt v[68:69],v14 offset:54400
mm a[40:43],v[84:87],a[216:219],a[40:43]
mm a[44:47],v[80:83],a[204:207],0
dt v[70:71],v14 offset:59008
mm a[44:47],v[84:87],a[220:223],a[44:47]
s_waitcnt lgkmcnt(4)
mm a[48:51],v[88:91],a[192:195],0
dt v[72:73],v14 offset:45216
mm a[48:51],v[92:95],a[208:211],a[48:51]
mm a[52:55],v[88:91],a[196:199],0
dt v[74:75],v14 offset:49824
mm a[52:55],v[92:95],a[212:215],a[52:55]
mm a[56:59],v[88:91],a[200:203],0
dt v[76:77],v14 offset:54432
mm a[56:59],v[92:95],a[216:219],a[56:59]
mm a[60:63],v[88:91],a[204:207],0
dt v[78:79],v14 offset:59040
mm a[60:63],v[92:95],a[220:223],a[60:63]
s_waitcnt lgkmcnt(4)
mm a[64:67],v[64:67],a[192:195],0
dt v[80:81],v14 offset:45248
mm a[64:67],v[68:71],a[208:211],a[64:67]
mm a[68:71],v[64:67],a[196:199],0
dt v[82:83],v14 offset:49856
mm a[68:71],v[68:71],a[212:215],a[68:71]
mm a[72:75],v[64:67],a[200:203],0
dt v[84:85],v14 offset:54464
mm a[72:75],v[68:71],a[216:219],a[72:75]
mm a[76:79],v[64:67],a[204:207],0
dt v[86:87],v14 offset:59072
mm a[76:79],v[68:71],a[220:223],a[76:79]
s_waitcnt lgkmcnt(4)
s_waitcnt vmcnt(0)
mm a[80:83],v[72:75],a[192:195],0
s_barrier
dt v[88:89],v14 offset:45280
mm a[80:83],v[76:79],a[208:211],a[80:83]
buffer_store_dword v1,off,s[8:11],s74 offset:20 sc1
mm a[84:87],v[72:75],a[196:199],0
dt v[90:91],v14 offset:49888
mm a[84:87],v[76:79],a[212:215],a[84:87]
mm a[88:91],v[72:75],a[200:203],0
dt v[92:93],v14 offset:54496
mm a[88:91],v[76:79],a[216:219],a[88:91]
mm a[92:95],v[72:75],a[204:207],0
dt v[94:95],v14 offset:59104
mm a[92:95],v[76:79],a[220:223],a[92:95]
s_waitcnt lgkmcnt(4)
mm a[96:99],v[80:83],a[192:195],0
dt v[64:65],v14 offset:45312
mm a[96:99],v[84:87],a[208:211],a[96:99]
s_bfe_u32 s82,s81,0x40004
s_lshl_b32 s82,s82,12
s_add_u32 s82,s82,s68
mm a[100:103],v[80:83],a[196:199],0
dt v[66:67],v14 offset:49920
mm a[100:103],v[84:87],a[212:215],a[100:103]
bl a[144:147],v60,s[8:11],s82 offen offset:0 sc1
mm a[104:107],v[80:83],a[200:203],0
dt v[68:69],v14 offset:54528
mm a[104:107],v[84:87],a[216:219],a[104:107]
mm a[108:111],v[80:83],a[204:207],0
dt v[70:71],v14 offset:59136
mm a[108:111],v[84:87],a[220:223],a[108:111]
s_waitcnt lgkmcnt(4)
bl a[148:151],v61,s[8:11],s82 offen offset:0 sc1
mm a[112:115],v[88:91],a[192:195],0
dt v[72:73],v14 offset:63488
mm a[112:115],v[92:95],a[208:211],a[112:115]
mm a[116:119],v[88:91],a[196:199],0
dt v[74:75],v15 offset:2560
mm a[116:119],v[92:95],a[212:215],a[116:119]
mm a[120:123],v[88:91],a[200:203],0
dt v[76:77],v15 offset:7168
mm a[120:123],v[92:95],a[216:219],a[120:123]
bl a[152:155],v62,s[8:11],s82 offen offset:0 sc1
mm a[124:127],v[88:91],a[204:207],0
dt v[78:79],v15 offset:11776
mm a[124:127],v[92:95],a[220:223],a[124:127]
s_waitcnt lgkmcnt(4)
mm a[128:131],v[64:67],a[192:195],0
dt v[80:81],v14 offset:63520
mm a[128:131],v[68:71],a[208:211],a[128:131]
mm a[132:135],v[64:67],a[196:199],0
dt v[82:83],v15 offset:2592
mm a[132:135],v[68:71],a[212:215],a[132:135]
bl a[156:159],v63,s[8:11],s82 offen offset:0 sc1
mm a[136:139],v[64:67],a[200:203],0
dt v[84:85],v15 offset:7200
mm a[136:139],v[68:71],a[216:219],a[136:139]
mm a[140:143],v[64:67],a[204:207],0
dt v[86:87],v15 offset:11808
mm a[140:143],v[68:71],a[220:223],a[140:143]
s_waitcnt lgkmcnt(4)
mm a[0:3],v[72:75],a[224:227],a[0:3]
dt v[88:89],v14 offset:63552
mm a[0:3],v[76:79],a[240:243],a[0:3]
bl a[160:163],v60,s[8:11],s82 offen offset:1024 sc1
mm a[4:7],v[72:75],a[228:231],a[4:7]
dt v[90:91],v15 offset:2624
mm a[4:7],v[76:79],a[244:247],a[4:7]
mm a[8:11],v[72:75],a[232:235],a[8:11]
dt v[92:93],v15 offset:7232
mm a[8:11],v[76:79],a[248:251],a[8:11]
mm a[12:15],v[72:75],a[236:239],a[12:15]
dt v[94:95],v15 offset:11840
mm a[12:15],v[76:79],a[252:255],a[12:15]
s_waitcnt lgkmcnt(4)
bl a[164:167],v61,s[8:11],s82 offen offset:1024 sc1
mm a[16:19],v[80:83],a[224:227],a[16:19]
dt v[64:65],v14 offset:63584
mm a[16:19],v[84:87],a[240:243],a[16:19]
mm a[20:23],v[80:83],a[228:231],a[20:23]
dt v[66:67],v15 offset:2656
mm a[20:23],v[84:87],a[244:247],a[20:23]
mm a[24:27],v[80:83],a[232:235],a[24:27]
dt v[68:69],v15 offset:7264
mm a[24:27],v[84:87],a[248:251],a[24:27]
bl a[168:171],v62,s[8:11],s82 offen offset:1024 sc1
mm a[28:31],v[80:83],a[236:239],a[28:31]
dt v[70:71],v15 offset:11872
mm a[28:31],v[84:87],a[252:255],a[28:31]
s_waitcnt lgkmcnt(4)
mm a[32:35],v[88:91],a[224:227],a[32:35]
dt v[72:73],v14 offset:63616
mm a[32:35],v[92:95],a[240:243],a[32:35]
mm a[36:39],v[88:91],a[228:231],a[36:39]
dt v[74:75],v15 offset:2688
mm a[36:39],v[92:95],a[244:247],a[36:39]
bl a[172:175],v63,s[8:11],s82 offen offset:1024 sc1
mm a[40:43],v[88:91],a[232:235],a[40:43]
dt v[76:77],v15 offset:7296
mm a[40:43],v[92:95],a[248:251],a[40:43]
mm a[44:47],v[88:91],a[236:239],a[44:47]
dt v[78:79],v15 offset:11904
mm a[44:47],v[92:95],a[252:255],a[44:47]
s_waitcnt lgkmcnt(4)
s_bfe_u32 s79,s81,0x40004
s_mul_i32 s79,s79,147456
mm a[48:51],v[64:67],a[224:227],a[48:51]
s_add_u32 s79,s79,s70
s_add_u32 m0,s71,53248
dt v[80:81],v14 offset:63648
mm a[48:51],v[68:71],a[240:243],a[48:51]
bl v4,s[32:35],s79 offen lds
mm a[52:55],v[64:67],a[228:231],a[52:55]
dt v[82:83],v15 offset:2720
mm a[52:55],v[68:71],a[244:247],a[52:55]
mm a[56:59],v[64:67],a[232:235],a[56:59]
dt v[84:85],v15 offset:7328
mm a[56:59],v[68:71],a[248:251],a[56:59]
s_add_u32 m0,s71,54272
mm a[60:63],v[64:67],a[236:239],a[60:63]
dt v[86:87],v15 offset:11936
mm a[60:63],v[68:71],a[252:255],a[60:63]
s_waitcnt lgkmcnt(4)
bl v5,s[32:35],s79 offen lds
mm a[64:67],v[72:75],a[224:227],a[64:67]
dt v[88:89],v14 offset:63680
mm a[64:67],v[76:79],a[240:243],a[64:67]
mm a[68:71],v[72:75],a[228:231],a[68:71]
dt v[90:91],v15 offset:2752
mm a[68:71],v[76:79],a[244:247],a[68:71]
s_add_u32 m0,s71,55296
mm a[72:75],v[72:75],a[232:235],a[72:75]
dt v[92:93],v15 offset:7360
mm a[72:75],v[76:79],a[248:251],a[72:75]
bl v6,s[32:35],s79 offen lds
mm a[76:79],v[72:75],a[236:239],a[76:79]
dt v[94:95],v15 offset:11968
mm a[76:79],v[76:79],a[252:255],a[76:79]
s_waitcnt lgkmcnt(4)
mm a[80:83],v[80:83],a[224:227],a[80:83]
dt v[64:65],v14 offset:63712
mm a[80:83],v[84:87],a[240:243],a[80:83]
s_add_u32 m0,s71,56320
mm a[84:87],v[80:83],a[228:231],a[84:87]
dt v[66:67],v15 offset:2784
mm a[84:87],v[84:87],a[244:247],a[84:87]
bl v7,s[32:35],s79 offen lds
mm a[88:91],v[80:83],a[232:235],a[88:91]
dt v[68:69],v15 offset:7392
mm a[88:91],v[84:87],a[248:251],a[88:91]
mm a[92:95],v[80:83],a[236:239],a[92:95]
dt v[70:71],v15 offset:12000
mm a[92:95],v[84:87],a[252:255],a[92:95]
s_waitcnt lgkmcnt(4)
s_add_u32 m0,s71,57344
mm a[96:99],v[88:91],a[224:227],a[96:99]
dt v[72:73],v14 offset:63744
mm a[96:99],v[92:95],a[240:243],a[96:99]
bl v8,s[32:35],s79 offen lds
mm a[100:103],v[88:91],a[228:231],a[100:103]
dt v[74:75],v15 offset:2816
mm a[100:103],v[92:95],a[244:247],a[100:103]
mm a[104:107],v[88:91],a[232:235],a[104:107]
dt v[76:77],v15 offset:7424
mm a[104:107],v[92:95],a[248:251],a[104:107]
s_add_u32 m0,s71,58368
mm a[108:111],v[88:91],a[236:239],a[108:111]
dt v[78:79],v15 offset:12032
mm a[108:111],v[92:95],a[252:255],a[108:111]
s_waitcnt lgkmcnt(4)
mm a[112:115],v[64:67],a[224:227],a[112:115]
s_barrier
dt v[80:81],v14 offset:8192
mm a[112:115],v[68:71],a[240:243],a[112:115]
bl v9,s[32:35],s79 offen lds
mm a[116:119],v[64:67],a[228:231],a[116:119]
dt v[82:83],v14 offset:12800
mm a[116:119],v[68:71],a[244:247],a[116:119]
s_add_u32 m0,s71,59392
mm a[120:123],v[64:67],a[232:235],a[120:123]
dt v[84:85],v14 offset:17408
mm a[120:123],v[68:71],a[248:251],a[120:123]
bl v10,s[32:35],s79 offen lds
mm a[124:127],v[64:67],a[236:239],a[124:127]
dt v[86:87],v14 offset:22016
mm a[124:127],v[68:71],a[252:255],a[124:127]
s_waitcnt lgkmcnt(4)
mm a[128:131],v[72:75],a[224:227],a[128:131]
dt v[88:89],v14 offset:8224
mm a[128:131],v[76:79],a[240:243],a[128:131]
s_add_u32 m0,s71,60416
mm a[132:135],v[72:75],a[228:231],a[132:135]
dt v[90:91],v14 offset:12832
mm a[132:135],v[76:79],a[244:247],a[132:135]
bl v11,s[32:35],s79 offen lds
mm a[136:139],v[72:75],a[232:235],a[136:139]
dt v[92:93],v14 offset:17440
mm a[136:139],v[76:79],a[248:251],a[136:139]
mm a[140:143],v[72:75],a[236:239],a[140:143]
dt v[94:95],v14 offset:22048
mm a[140:143],v[76:79],a[252:255],a[140:143]
s_waitcnt lgkmcnt(4)
s_add_u32 m0,s71,61440
mm a[0:3],v[80:83],v[160:163],a[0:3]
dt v[64:65],v14 offset:8256
mm a[0:3],v[84:87],v[192:195],a[0:3]
bl v12,s[32:35],s79 offen lds
mm a[4:7],v[80:83],v[164:167],a[4:7]
dt v[66:67],v14 offset:12864
mm a[4:7],v[84:87],v[196:199],a[4:7]
mm a[8:11],v[80:83],v[168:171],a[8:11]
dt v[68:69],v14 offset:17472
mm a[8:11],v[84:87],v[200:203],a[8:11]
s_bfe_u32 s82,s81,0x40004
s_lshl_b32 s82,s82,12
s_add_u32 s82,s82,s68
mm a[12:15],v[80:83],v[172:175],a[12:15]
dt v[70:71],v14 offset:22080
mm a[12:15],v[84:87],v[204:207],a[12:15]
s_waitcnt lgkmcnt(4)
bl a[176:179],v60,s[8:11],s82 offen offset:2048 sc1
mm a[16:19],v[88:91],v[160:163],a[16:19]
dt v[72:73],v14 offset:8288
mm a[16:19],v[92:95],v[192:195],a[16:19]
mm a[20:23],v[88:91],v[164:167],a[20:23]
dt v[74:75],v14 offset:12896
mm a[20:23],v[92:95],v[196:199],a[20:23]
mm a[24:27],v[88:91],v[168:171],a[24:27]
dt v[76:77],v14 offset:17504
mm a[24:27],v[92:95],v[200:203],a[24:27]
bl a[180:183],v61,s[8:11],s82 offen offset:2048 sc1
mm a[28:31],v[88:91],v[172:175],a[28:31]
dt v[78:79],v14 offset:22112
mm a[28:31],v[92:95],v[204:207],a[28:31]
s_waitcnt lgkmcnt(4)
mm a[32:35],v[64:67],v[160:163],a[32:35]
dt v[80:81],v14 offset:8320
mm a[32:35],v[68:71],v[192:195],a[32:35]
mm a[36:39],v[64:67],v[164:167],a[36:39]
dt v[82:83],v14 offset:12928
mm a[36:39],v[68:71],v[196:199],a[36:39]
bl a[184:187],v62,s[8:11],s82 offen offset:2048 sc1
mm a[40:43],v[64:67],v[168:171],a[40:43]
dt v[84:85],v14 offset:17536
mm a[40:43],v[68:71],v[200:203],a[40:43]
mm a[44:47],v[64:67],v[172:175],a[44:47]
dt v[86:87],v14 offset:22144
mm a[44:47],v[68:71],v[204:207],a[44:47]
s_waitcnt lgkmcnt(4)
mm a[48:51],v[72:75],v[160:163],a[48:51]
dt v[88:89],v14 offset:8352
mm a[48:51],v[76:79],v[192:195],a[48:51]
bl a[188:191],v63,s[8:11],s82 offen offset:2048 sc1
mm a[52:55],v[72:75],v[164:167],a[52:55]
dt v[90:91],v14 offset:12960
mm a[52:55],v[76:79],v[196:199],a[52:55]
mm a[56:59],v[72:75],v[168:171],a[56:59]
dt v[92:93],v14 offset:17568
mm a[56:59],v[76:79],v[200:203],a[56:59]
mm a[60:63],v[72:75],v[172:175],a[60:63]
dt v[94:95],v14 offset:22176
mm a[60:63],v[76:79],v[204:207],a[60:63]
s_waitcnt lgkmcnt(4)
bl v[176:179],v60,s[8:11],s82 offen offset:3072 sc1
mm a[64:67],v[80:83],v[160:163],a[64:67]
dt v[64:65],v14 offset:8384
mm a[64:67],v[84:87],v[192:195],a[64:67]
mm a[68:71],v[80:83],v[164:167],a[68:71]
dt v[66:67],v14 offset:12992
mm a[68:71],v[84:87],v[196:199],a[68:71]
mm a[72:75],v[80:83],v[168:171],a[72:75]
dt v[68:69],v14 offset:17600
mm a[72:75],v[84:87],v[200:203],a[72:75]
bl v[180:183],v61,s[8:11],s82 offen offset:3072 sc1
mm a[76:79],v[80:83],v[172:175],a[76:79]
dt v[70:71],v14 offset:22208
mm a[76:79],v[84:87],v[204:207],a[76:79]
s_waitcnt lgkmcnt(4)
mm a[80:83],v[88:91],v[160:163],a[80:83]
dt v[72:73],v14 offset:8416
mm a[80:83],v[92:95],v[192:195],a[80:83]
mm a[84:87],v[88:91],v[164:167],a[84:87]
dt v[74:75],v14 offset:13024
mm a[84:87],v[92:95],v[196:199],a[84:87]
bl v[184:187],v62,s[8:11],s82 offen offset:3072 sc1
mm a[88:91],v[88:91],v[168:171],a[88:91]
dt v[76:77],v14 offset:17632
mm a[88:91],v[92:95],v[200:203],a[88:91]
mm a[92:95],v[88:91],v[172:175],a[92:95]
dt v[78:79],v14 offset:22240
mm a[92:95],v[92:95],v[204:207],a[92:95]
s_waitcnt lgkmcnt(4)
mm a[96:99],v[64:67],v[160:163],a[96:99]
dt v[80:81],v14 offset:8448
mm a[96:99],v[68:71],v[192:195],a[96:99]
bl v[188:191],v63,s[8:11],s82 offen offset:3072 sc1
mm a[100:103],v[64:67],v[164:167],a[100:103]
dt v[82:83],v14 offset:13056
mm a[100:103],v[68:71],v[196:199],a[100:103]
mm a[104:107],v[64:67],v[168:171],a[104:107]
dt v[84:85],v14 offset:17664
mm a[104:107],v[68:71],v[200:203],a[104:107]
mm a[108:111],v[64:67],v[172:175],a[108:111]
dt v[86:87],v14 offset:22272
mm a[108:111],v[68:71],v[204:207],a[108:111]
s_waitcnt lgkmcnt(4)
mm a[112:115],v[72:75],v[160:163],a[112:115]
s_bfe_u32 s79,s81,0x40008
s_mul_i32 s79,s79,147456
dt v[88:89],v14 offset:26624
mm a[112:115],v[76:79],v[192:195],a[112:115]
s_add_u32 s79,s79,s70
s_add_u32 m0,s71,16384
mm a[116:119],v[72:75],v[164:167],a[116:119]
dt v[90:91],v14 offset:31232
mm a[116:119],v[76:79],v[196:199],a[116:119]
bl v4,s[32:35],s79 offen lds
mm a[120:123],v[72:75],v[168:171],a[120:123]
s_add_u32 m0,s71,17408
dt v[92:93],v14 offset:35840
mm a[120:123],v[76:79],v[200:203],a[120:123]
bl v5,s[32:35],s79 offen lds
mm a[124:127],v[72:75],v[172:175],a[124:127]
dt v[94:95],v14 offset:40448
mm a[124:127],v[76:79],v[204:207],a[124:127]
s_waitcnt lgkmcnt(4)
s_add_u32 m0,s71,18432
mm a[128:131],v[80:83],v[160:163],a[128:131]
dt v[64:65],v14 offset:26656
mm a[128:131],v[84:87],v[192:195],a[128:131]
bl v6,s[32:35],s79 offen lds
mm a[132:135],v[80:83],v[164:167],a[132:135]
dt v[66:67],v14 offset:31264
mm a[132:135],v[84:87],v[196:199],a[132:135]
s_add_u32 m0,s71,19456
mm a[136:139],v[80:83],v[168:171],a[136:139]
dt v[68:69],v14 offset:35872
mm a[136:139],v[84:87],v[200:203],a[136:139]
bl v7,s[32:35],s79 offen lds
mm a[140:143],v[80:83],v[172:175],a[140:143]
dt v[70:71],v14 offset:40480
mm a[140:143],v[84:87],v[204:207],a[140:143]
s_waitcnt lgkmcnt(4)
s_add_u32 m0,s71,20480
mm a[0:3],v[88:91],v[224:227],a[0:3]
dt v[72:73],v14 offset:26688
mm a[0:3],v[92:95],v[240:243],a[0:3]
bl v8,s[32:35],s79 offen lds
mm a[4:7],v[88:91],v[228:231],a[4:7]
dt v[74:75],v14 offset:31296
mm a[4:7],v[92:95],v[244:247],a[4:7]
s_add_u32 m0,s71,21504
mm a[8:11],v[88:91],v[232:235],a[8:11]
dt v[76:77],v14 offset:35904
mm a[8:11],v[92:95],v[248:251],a[8:11]
bl v9,s[32:35],s79 offen lds
mm a[12:15],v[88:91],v[236:239],a[12:15]
dt v[78:79],v14 offset:40512
mm a[12:15],v[92:95],v[252:255],a[12:15]
s_waitcnt lgkmcnt(4)
mm a[16:19],v[64:67],v[224:227],a[16:19]
s_add_u32 m0,s71,22528
dt v[80:81],v14 offset:26720
mm a[16:19],v[68:71],v[240:243],a[16:19]
mm a[20:23],v[64:67],v[228:231],a[20:23]
dt v[82:83],v14 offset:31328
mm a[20:23],v[68:71],v[244:247],a[20:23]
bl v10,s[32:35],s79 offen lds
mm a[24:27],v[64:67],v[232:235],a[24:27]
s_add_u32 m0,s71,23552
dt v[84:85],v14 offset:35936
mm a[24:27],v[68:71],v[248:251],a[24:27]
mm a[28:31],v[64:67],v[236:239],a[28:31]
dt v[86:87],v14 offset:40544
mm a[28:31],v[68:71],v[252:255],a[28:31]
s_waitcnt lgkmcnt(4)
bl v11,s[32:35],s79 offen lds
mm a[32:35],v[72:75],v[224:227],a[32:35]
dt v[88:89],v14 offset:26752
mm a[32:35],v[76:79],v[240:243],a[32:35]
s_add_u32 m0,s71,24576
mm a[36:39],v[72:75],v[228:231],a[36:39]
dt v[90:91],v14 offset:31360
mm a[36:39],v[76:79],v[244:247],a[36:39]
bl v12,s[32:35],s79 offen lds
mm a[40:43],v[72:75],v[232:235],a[40:43]
dt v[92:93],v14 offset:35968
mm a[40:43],v[76:79],v[248:251],a[40:43]
s_bfe_u32 s82,s81,0x40008
s_lshl_b32 s82,s82,12
s_add_u32 s82,s82,s68
mm a[44:47],v[72:75],v[236:239],a[44:47]
dt v[94:95],v14 offset:40576
mm a[44:47],v[76:79],v[252:255],a[44:47]
s_waitcnt lgkmcnt(4)
bl v[208:211],v60,s[8:11],s82 offen offset:0 sc1
mm a[48:51],v[80:83],v[224:227],a[48:51]
dt v[64:65],v14 offset:26784
mm a[48:51],v[84:87],v[240:243],a[48:51]
mm a[52:55],v[80:83],v[228:231],a[52:55]
dt v[66:67],v14 offset:31392
mm a[52:55],v[84:87],v[244:247],a[52:55]
bl v[212:215],v61,s[8:11],s82 offen offset:0 sc1
mm a[56:59],v[80:83],v[232:235],a[56:59]
dt v[68:69],v14 offset:36000
mm a[56:59],v[84:87],v[248:251],a[56:59]
mm a[60:63],v[80:83],v[236:239],a[60:63]
dt v[70:71],v14 offset:40608
mm a[60:63],v[84:87],v[252:255],a[60:63]
s_waitcnt lgkmcnt(4)
mm a[64:67],v[88:91],v[224:227],a[64:67]
dt v[72:73],v14 offset:26816
mm a[64:67],v[92:95],v[240:243],a[64:67]
bl v[216:219],v62,s[8:11],s82 offen offset:0 sc1
mm a[68:71],v[88:91],v[228:231],a[68:71]
dt v[74:75],v14 offset:31424
mm a[68:71],v[92:95],v[244:247],a[68:71]
mm a[72:75],v[88:91],v[232:235],a[72:75]
dt v[76:77],v14 offset:36032
mm a[72:75],v[92:95],v[248:251],a[72:75]
bl v[220:223],v63,s[8:11],s82 offen offset:0 sc1
mm a[76:79],v[88:91],v[236:239],a[76:79]
dt v[78:79],v14 offset:40640
mm a[76:79],v[92:95],v[252:255],a[76:79]
s_waitcnt lgkmcnt(4)
mm a[80:83],v[64:67],v[224:227],a[80:83]
dt v[80:81],v14 offset:26848
mm a[80:83],v[68:71],v[240:243],a[80:83]
bl a[192:195],v60,s[8:11],s82 offen offset:1024 sc1
mm a[84:87],v[64:67],v[228:231],a[84:87]
dt v[82:83],v14 offset:31456
mm a[84:87],v[68:71],v[244:247],a[84:87]
mm a[88:91],v[64:67],v[232:235],a[88:91]
dt v[84:85],v14 offset:36064
mm a[88:91],v[68:71],v[248:251],a[88:91]
bl a[196:199],v61,s[8:11],s82 offen offset:1024 sc1
mm a[92:95],v[64:67],v[236:239],a[92:95]
dt v[86:87],v14 offset:40672
mm a[92:95],v[68:71],v[252:255],a[92:95]
s_waitcnt lgkmcnt(4)
mm a[96:99],v[72:75],v[224:227],a[96:99]
dt v[88:89],v14 offset:26880
mm a[96:99],v[76:79],v[240:243],a[96:99]
bl a[200:203],v62,s[8:11],s82 offen offset:1024 sc1
mm a[100:103],v[72:75],v[228:231],a[100:103]
dt v[90:91],v14 offset:31488
mm a[100:103],v[76:79],v[244:247],a[100:103]
mm a[104:107],v[72:75],v[232:235],a[104:107]
dt v[92:93],v14 offset:36096
mm a[104:107],v[76:79],v[248:251],a[104:107]
bl a[204:207],v63,s[8:11],s82 offen offset:1024 sc1
mm a[108:111],v[72:75],v[236:239],a[108:111]
dt v[94:95],v14 offset:40704
mm a[108:111],v[76:79],v[252:255],a[108:111]
s_waitcnt lgkmcnt(4)
s_waitcnt vmcnt(25)
mm a[112:115],v[80:83],v[224:227],a[112:115]
s_barrier
dt v[64:65],v13 offset:36864
mm a[112:115],v[84:87],v[240:243],a[112:115]
mm a[116:119],v[80:83],v[228:231],a[116:119]
dt v[66:67],v13 offset:41472
mm a[116:119],v[84:87],v[244:247],a[116:119]
bl a[208:211],v60,s[8:11],s82 offen offset:2048 sc1
mm a[120:123],v[80:83],v[232:235],a[120:123]
dt v[68:69],v13 offset:46080
mm a[120:123],v[84:87],v[248:251],a[120:123]
mm a[124:127],v[80:83],v[236:239],a[124:127]
dt v[70:71],v13 offset:50688
mm a[124:127],v[84:87],v[252:255],a[124:127]
s_waitcnt lgkmcnt(4)
bl a[212:215],v61,s[8:11],s82 offen offset:2048 sc1
mm a[128:131],v[88:91],v[224:227],a[128:131]
dt v[72:73],v13 offset:36896
mm a[128:131],v[92:95],v[240:243],a[128:131]
mm a[132:135],v[88:91],v[228:231],a[132:135]
dt v[74:75],v13 offset:41504
mm a[132:135],v[92:95],v[244:247],a[132:135]
bl a[216:219],v62,s[8:11],s82 offen offset:2048 sc1
mm a[136:139],v[88:91],v[232:235],a[136:139]
dt v[76:77],v13 offset:46112
mm a[136:139],v[92:95],v[248:251],a[136:139]
mm a[140:143],v[88:91],v[236:239],a[140:143]
dt v[78:79],v13 offset:50720
mm a[140:143],v[92:95],v[252:255],a[140:143]
s_waitcnt lgkmcnt(4)
mm a[0:3],v[64:67],a[144:147],a[0:3]
dt v[80:81],v13 offset:36928
mm a[0:3],v[68:71],a[160:163],a[0:3]
bl a[220:223],v63,s[8:11],s82 offen offset:2048 sc1
mm a[4:7],v[64:67],a[148:151],a[4:7]
dt v[82:83],v13 offset:41536
mm a[4:7],v[68:71],a[164:167],a[4:7]
mm a[8:11],v[64:67],a[152:155],a[8:11]
dt v[84:85],v13 offset:46144
mm a[8:11],v[68:71],a[168:171],a[8:11]
bl a[224:227],v60,s[8:11],s82 offen offset:3072 sc1
mm a[12:15],v[64:67],a[156:159],a[12:15]
dt v[86:87],v13 offset:50752
mm a[12:15],v[68:71],a[172:175],a[12:15]
s_waitcnt lgkmcnt(4)
mm a[16:19],v[72:75],a[144:147],a[16:19]
dt v[88:89],v13 offset:36960
mm a[16:19],v[76:79],a[160:163],a[16:19]
bl a[228:231],v61,s[8:11],s82 offen offset:3072 sc1
mm a[20:23],v[72:75],a[148:151],a[20:23]
dt v[90:91],v13 offset:41568
mm a[20:23],v[76:79],a[164:167],a[20:23]
mm a[24:27],v[72:75],a[152:155],a[24:27]
dt v[92:93],v13 offset:46176
mm a[24:27],v[76:79],a[168:171],a[24:27]
bl a[232:235],v62,s[8:11],s82 offen offset:3072 sc1
mm a[28:31],v[72:75],a[156:159],a[28:31]
dt v[94:95],v13 offset:50784
mm a[28:31],v[76:79],a[172:175],a[28:31]
s_waitcnt lgkmcnt(4)
mm a[32:35],v[80:83],a[144:147],a[32:35]
dt v[64:65],v13 offset:36992
mm a[32:35],v[84:87],a[160:163],a[32:35]
bl a[236:239],v63,s[8:11],s82 offen offset:3072 sc1
mm a[36:39],v[80:83],a[148:151],a[36:39]
dt v[66:67],v13 offset:41600
mm a[36:39],v[84:87],a[164:167],a[36:39]
mm a[40:43],v[80:83],a[152:155],a[40:43]
dt v[68:69],v13 offset:46208
mm a[40:43],v[84:87],a[168:171],a[40:43]
mm a[44:47],v[80:83],a[156:159],a[44:47]
s_bfe_u32 s82,s81,0x4000c
s_lshl_b32 s82,s82,12
dt v[70:71],v13 offset:50816
mm a[44:47],v[84:87],a[172:175],a[44:47]
s_waitcnt lgkmcnt(4)
s_add_u32 s82,s82,s68
mm a[48:51],v[88:91],a[144:147],a[48:51]
dt v[72:73],v13 offset:37024
mm a[48:51],v[92:95],a[160:163],a[48:51]
bl a[240:243],v60,s[8:11],s82 offen offset:0 sc1
mm a[52:55],v[88:91],a[148:151],a[52:55]
dt v[74:75],v13 offset:41632
mm a[52:55],v[92:95],a[164:167],a[52:55]
bl a[244:247],v61,s[8:11],s82 offen offset:0 sc1
mm a[56:59],v[88:91],a[152:155],a[56:59]
dt v[76:77],v13 offset:46240
mm a[56:59],v[92:95],a[168:171],a[56:59]
mm a[60:63],v[88:91],a[156:159],a[60:63]
dt v[78:79],v13 offset:50848
mm a[60:63],v[92:95],a[172:175],a[60:63]
s_waitcnt lgkmcnt(4)
bl a[248:251],v62,s[8:11],s82 offen offset:0 sc1
mm a[64:67],v[64:67],a[144:147],a[64:67]
dt v[80:81],v13 offset:37056
mm a[64:67],v[68:71],a[160:163],a[64:67]
mm a[68:71],v[64:67],a[148:151],a[68:71]
dt v[82:83],v13 offset:41664
mm a[68:71],v[68:71],a[164:167],a[68:71]
bl a[252:255],v63,s[8:11],s82 offen offset:0 sc1
mm a[72:75],v[64:67],a[152:155],a[72:75]
dt v[84:85],v13 offset:46272
mm a[72:75],v[68:71],a[168:171],a[72:75]
mm a[76:79],v[64:67],a[156:159],a[76:79]
dt v[86:87],v13 offset:50880
mm a[76:79],v[68:71],a[172:175],a[76:79]
s_waitcnt lgkmcnt(4)
bl v[160:163],v60,s[8:11],s82 offen offset:1024 sc1
mm a[80:83],v[72:75],a[144:147],a[80:83]
dt v[88:89],v13 offset:37088
mm a[80:83],v[76:79],a[160:163],a[80:83]
mm a[84:87],v[72:75],a[148:151],a[84:87]
dt v[90:91],v13 offset:41696
mm a[84:87],v[76:79],a[164:167],a[84:87]
bl v[164:167],v61,s[8:11],s82 offen offset:1024 sc1
mm a[88:91],v[72:75],a[152:155],a[88:91]
dt v[92:93],v13 offset:46304
mm a[88:91],v[76:79],a[168:171],a[88:91]
mm a[92:95],v[72:75],a[156:159],a[92:95]
dt v[94:95],v13 offset:50912
mm a[92:95],v[76:79],a[172:175],a[92:95]
s_waitcnt lgkmcnt(4)
bl v[168:171],v62,s[8:11],s82 offen offset:1024 sc1
mm a[96:99],v[80:83],a[144:147],a[96:99]
dt v[64:65],v13 offset:37120
mm a[96:99],v[84:87],a[160:163],a[96:99]
mm a[100:103],v[80:83],a[148:151],a[100:103]
dt v[66:67],v13 offset:41728
mm a[100:103],v[84:87],a[164:167],a[100:103]
bl v[172:175],v63,s[8:11],s82 offen offset:1024 sc1
mm a[104:107],v[80:83],a[152:155],a[104:107]
dt v[68:69],v13 offset:46336
mm a[104:107],v[84:87],a[168:171],a[104:107]
s_bfe_u32 s79,s81,0x4000c
s_mul_i32 s79,s79,147456
s_add_u32 s79,s79,s70
mm a[108:111],v[80:83],a[156:159],a[108:111]
s_add_u32 m0,s71,126976
dt v[70:71],v13 offset:50944
mm a[108:111],v[84:87],a[172:175],a[108:111]
s_waitcnt lgkmcnt(4)
bl v4,s[32:35],s79 offen lds
mm a[112:115],v[88:91],a[144:147],a[112:115]
dt v[72:73],v13 offset:55296
mm a[112:115],v[92:95],a[160:163],a[112:115]
s_add_u32 m0,s71,128000
mm a[116:119],v[88:91],a[148:151],a[116:119]
dt v[74:75],v13 offset:59904
mm a[116:119],v[92:95],a[164:167],a[116:119]
bl v5,s[32:35],s79 offen lds
mm a[120:123],v[88:91],a[152:155],a[120:123]
dt v[76:77],v13 offset:64512
mm a[120:123],v[92:95],a[168:171],a[120:123]
s_add_u32 m0,s71,129024
mm a[124:127],v[88:91],a[156:159],a[124:127]
dt v[78:79],v14 offset:3584
mm a[124:127],v[92:95],a[172:175],a[124:127]
s_waitcnt lgkmcnt(4)
bl v6,s[32:35],s79 offen lds
mm a[128:131],v[64:67],a[144:147],a[128:131]
dt v[80:81],v13 offset:55328
mm a[128:131],v[68:71],a[160:163],a[128:131]
s_add_u32 m0,s71,130048
mm a[132:135],v[64:67],a[148:151],a[132:135]
dt v[82:83],v13 offset:59936
mm a[132:135],v[68:71],a[164:167],a[132:135]
bl v7,s[32:35],s79 offen lds
mm a[136:139],v[64:67],a[152:155],a[136:139]
dt v[84:85],v13 offset:64544
mm a[136:139],v[68:71],a[168:171],a[136:139]
s_add_u32 m0,s71,131072
mm a[140:143],v[64:67],a[156:159],a[140:143]
dt v[86:87],v14 offset:3616
mm a[140:143],v[68:71],a[172:175],a[140:143]
s_waitcnt vmcnt(37) lgkmcnt(4)
bl v8,s[32:35],s79 offen lds
mm a[0:3],v[72:75],a[176:179],a[0:3]
dt v[88:89],v13 offset:55360
mm a[0:3],v[76:79],v[176:179],a[0:3]
mm a[4:7],v[72:75],a[180:183],a[4:7]
s_add_u32 m0,s71,132096
dt v[90:91],v13 offset:59968
mm a[4:7],v[76:79],v[180:183],a[4:7]
mm a[8:11],v[72:75],a[184:187],a[8:11]
dt v[92:93],v13 offset:64576
mm a[8:11],v[76:79],v[184:187],a[8:11]
bl v9,s[32:35],s79 offen lds
mm a[12:15],v[72:75],a[188:191],a[12:15]
s_add_u32 m0,s71,133120
dt v[94:95],v14 offset:3648
mm a[12:15],v[76:79],v[188:191],a[12:15]
s_waitcnt lgkmcnt(4)
mm a[16:19],v[80:83],a[176:179],a[16:19]
dt v[64:65],v13 offset:55392
mm a[16:19],v[84:87],v[176:179],a[16:19]
bl v10,s[32:35],s79 offen lds
mm a[20:23],v[80:83],a[180:183],a[20:23]
s_add_u32 m0,s71,134144
dt v[66:67],v13 offset:60000
mm a[20:23],v[84:87],v[180:183],a[20:23]
mm a[24:27],v[80:83],a[184:187],a[24:27]
dt v[68:69],v13 offset:64608
mm a[24:27],v[84:87],v[184:187],a[24:27]
bl v11,s[32:35],s79 offen lds
mm a[28:31],v[80:83],a[188:191],a[28:31]
s_add_u32 m0,s71,135168
dt v[70:71],v14 offset:3680
mm a[28:31],v[84:87],v[188:191],a[28:31]
s_waitcnt lgkmcnt(4)
mm a[32:35],v[88:91],a[176:179],a[32:35]
dt v[72:73],v13 offset:55424
mm a[32:35],v[92:95],v[176:179],a[32:35]
bl v12,s[32:35],s79 offen lds
mm a[36:39],v[88:91],a[180:183],a[36:39]
dt v[74:75],v13 offset:60032
mm a[36:39],v[92:95],v[180:183],a[36:39]
s_bfe_u32 s82,s81,0x4000c
s_lshl_b32 s82,s82,12
s_add_u32 s82,s82,s68
mm a[40:43],v[88:91],a[184:187],a[40:43]
dt v[76:77],v13 offset:64640
mm a[40:43],v[92:95],v[184:187],a[40:43]
bl v[192:195],v60,s[8:11],s82 offen offset:2048 sc1
mm a[44:47],v[88:91],a[188:191],a[44:47]
dt v[78:79],v14 offset:3712
mm a[44:47],v[92:95],v[188:191],a[44:47]
s_waitcnt lgkmcnt(4)
mm a[48:51],v[64:67],a[176:179],a[48:51]
dt v[80:81],v13 offset:55456
mm a[48:51],v[68:71],v[176:179],a[48:51]
bl v[196:199],v61,s[8:11],s82 offen offset:2048 sc1
mm a[52:55],v[64:67],a[180:183],a[52:55]
dt v[82:83],v13 offset:60064
mm a[52:55],v[68:71],v[180:183],a[52:55]
mm a[56:59],v[64:67],a[184:187],a[56:59]
dt v[84:85],v13 offset:64672
mm a[56:59],v[68:71],v[184:187],a[56:59]
bl v[200:203],v62,s[8:11],s82 offen offset:2048 sc1
mm a[60:63],v[64:67],a[188:191],a[60:63]
dt v[86:87],v14 offset:3744
mm a[60:63],v[68:71],v[188:191],a[60:63]
s_waitcnt lgkmcnt(4)
mm a[64:67],v[72:75],a[176:179],a[64:67]
dt v[88:89],v13 offset:55488
mm a[64:67],v[76:79],v[176:179],a[64:67]
bl v[204:207],v63,s[8:11],s82 offen offset:2048 sc1
mm a[68:71],v[72:75],a[180:183],a[68:71]
dt v[90:91],v13 offset:60096
mm a[68:71],v[76:79],v[180:183],a[68:71]
mm a[72:75],v[72:75],a[184:187],a[72:75]
dt v[92:93],v13 offset:64704
mm a[72:75],v[76:79],v[184:187],a[72:75]
bl v[224:227],v60,s[8:11],s82 offen offset:3072 sc1
mm a[76:79],v[72:75],a[188:191],a[76:79]
dt v[94:95],v14 offset:3776
mm a[76:79],v[76:79],v[188:191],a[76:79]
s_waitcnt lgkmcnt(4)
mm a[80:83],v[80:83],a[176:179],a[80:83]
dt v[64:65],v13 offset:55520
mm a[80:83],v[84:87],v[176:179],a[80:83]
bl v[228:231],v61,s[8:11],s82 offen offset:3072 sc1
mm a[84:87],v[80:83],a[180:183],a[84:87]
dt v[66:67],v13 offset:60128
mm a[84:87],v[84:87],v[180:183],a[84:87]
mm a[88:91],v[80:83],a[184:187],a[88:91]
dt v[68:69],v13 offset:64736
mm a[88:91],v[84:87],v[184:187],a[88:91]
bl v[232:235],v62,s[8:11],s82 offen offset:3072 sc1
mm a[92:95],v[80:83],a[188:191],a[92:95]
dt v[70:71],v14 offset:3808
mm a[92:95],v[84:87],v[188:191],a[92:95]
s_waitcnt lgkmcnt(4)
mm a[96:99],v[88:91],a[176:179],a[96:99]
dt v[72:73],v13 offset:55552
mm a[96:99],v[92:95],v[176:179],a[96:99]
bl v[236:239],v63,s[8:11],s82 offen offset:3072 sc1
mm a[100:103],v[88:91],a[180:183],a[100:103]
dt v[74:75],v13 offset:60160
mm a[100:103],v[92:95],v[180:183],a[100:103]
mm a[104:107],v[88:91],a[184:187],a[104:107]
dt v[76:77],v13 offset:64768
mm a[104:107],v[92:95],v[184:187],a[104:107]
mm a[108:111],v[88:91],a[188:191],a[108:111]
dt v[78:79],v14 offset:3840
mm a[108:111],v[92:95],v[188:191],a[108:111]
s_waitcnt lgkmcnt(4)
s_waitcnt vmcnt(41)
mm a[112:115],v[64:67],a[176:179],a[112:115]
s_barrier
dt v[80:81],v13 offset:0
mm a[112:115],v[68:71],v[176:179],a[112:115]
mm a[116:119],v[64:67],a[180:183],a[116:119]
dt v[82:83],v13 offset:4608
mm a[116:119],v[68:71],v[180:183],a[116:119]
mm a[120:123],v[64:67],a[184:187],a[120:123]
dt v[84:85],v13 offset:9216
mm a[120:123],v[68:71],v[184:187],a[120:123]
mm a[124:127],v[64:67],a[188:191],a[124:127]
dt v[86:87],v13 offset:13824
mm a[124:127],v[68:71],v[188:191],a[124:127]
s_waitcnt lgkmcnt(4)
mm a[128:131],v[72:75],a[176:179],a[128:131]
dt v[88:89],v13 offset:32
mm a[128:131],v[76:79],v[176:179],a[128:131]
mm a[132:135],v[72:75],a[180:183],a[132:135]
dt v[90:91],v13 offset:4640
mm a[132:135],v[76:79],v[180:183],a[132:135]
mm a[136:139],v[72:75],a[184:187],a[136:139]
dt v[92:93],v13 offset:9248
mm a[136:139],v[76:79],v[184:187],a[136:139]
mm a[140:143],v[72:75],a[188:191],a[140:143]
dt v[94:95],v13 offset:13856
mm a[140:143],v[76:79],v[188:191],a[140:143]
L_p2_join:
s_waitcnt vmcnt(33) lgkmcnt(4)
mm a[0:3],v[80:83],v[208:211],a[0:3]
s_bfe_u32 s82,s81,0x40010
s_lshl_b32 s82,s82,12
dt v[64:65],v13 offset:64
mm a[0:3],v[84:87],a[192:195],a[0:3]
s_add_u32 s82,s82,s68
bl v[240:243],v60,s[8:11],s82 offen offset:0 sc1
mm a[4:7],v[80:83],v[212:215],a[4:7]
dt v[66:67],v13 offset:4672
mm a[4:7],v[84:87],a[196:199],a[4:7]
s_bfe_u32 s79,s81,0x40010
s_mul_i32 s79,s79,147456
s_add_u32 s79,s79,s70
mm a[8:11],v[80:83],v[216:219],a[8:11]
s_add_u32 m0,s71,90112
dt v[68:69],v13 offset:9280
mm a[8:11],v[84:87],a[200:203],a[8:11]
bl v4,s[32:35],s79 offen lds
mm a[12:15],v[80:83],v[220:223],a[12:15]
dt v[70:71],v13 offset:13888
mm a[12:15],v[84:87],a[204:207],a[12:15]
s_waitcnt lgkmcnt(4)
mm a[16:19],v[88:91],v[208:211],a[16:19]
dt v[72:73],v13 offset:96
mm a[16:19],v[92:95],a[192:195],a[16:19]
bl v[244:247],v61,s[8:11],s82 offen offset:0 sc1
mm a[20:23],v[88:91],v[212:215],a[20:23]
dt v[74:75],v13 offset:4704
mm a[20:23],v[92:95],a[196:199],a[20:23]
mm a[24:27],v[88:91],v[216:219],a[24:27]
dt v[76:77],v13 offset:9312
mm a[24:27],v[92:95],a[200:203],a[24:27]
s_add_u32 m0,s71,91136
mm a[28:31],v[88:91],v[220:223],a[28:31]
dt v[78:79],v13 offset:13920
mm a[28:31],v[92:95],a[204:207],a[28:31]
s_waitcnt lgkmcnt(4)
bl v5,s[32:35],s79 offen lds
mm a[32:35],v[64:67],v[208:211],a[32:35]
dt v[80:81],v13 offset:128
mm a[32:35],v[68:71],a[192:195],a[32:35]
mm a[36:39],v[64:67],v[212:215],a[36:39]
dt v[82:83],v13 offset:4736
mm a[36:39],v[68:71],a[196:199],a[36:39]
bl v[248:251],v62,s[8:11],s82 offen offset:0 sc1
mm a[40:43],v[64:67],v[216:219],a[40:43]
dt v[84:85],v13 offset:9344
mm a[40:43],v[68:71],a[200:203],a[40:43]
mm a[44:47],v[64:67],v[220:223],a[44:47]
dt v[86:87],v13 offset:13952
mm a[44:47],v[68:71],a[204:207],a[44:47]
s_waitcnt lgkmcnt(4)
mm a[48:51],v[72:75],v[208:211],a[48:51]
dt v[88:89],v13 offset:160
mm a[48:51],v[76:79],a[192:195],a[48:51]
bl v[252:255],v63,s[8:11],s82 offen offset:0 sc1
mm a[52:55],v[72:75],v[212:215],a[52:55]
dt v[90:91],v13 offset:4768
mm a[52:55],v[76:79],a[196:199],a[52:55]
s_add_u32 m0,s71,92160
mm a[56:59],v[72:75],v[216:219],a[56:59]
dt v[92:93],v13 offset:9376
mm a[56:59],v[76:79],a[200:203],a[56:59]
bl v6,s[32:35],s79 offen lds
mm a[60:63],v[72:75],v[220:223],a[60:63]
dt v[94:95],v13 offset:13984
mm a[60:63],v[76:79],a[204:207],a[60:63]
s_waitcnt lgkmcnt(4)
mm a[64:67],v[80:83],v[208:211],a[64:67]
dt v[64:65],v13 offset:192
mm a[64:67],v[84:87],a[192:195],a[64:67]
mm a[68:71],v[80:83],v[212:215],a[68:71]
dt v[66:67],v13 offset:4800
mm a[68:71],v[84:87],a[196:199],a[68:71]
bl a[144:147],v60,s[8:11],s82 offen offset:1024 sc1
mm a[72:75],v[80:83],v[216:219],a[72:75]
dt v[68:69],v13 offset:9408
mm a[72:75],v[84:87],a[200:203],a[72:75]
mm a[76:79],v[80:83],v[220:223],a[76:79]
dt v[70:71],v13 offset:14016
mm a[76:79],v[84:87],a[204:207],a[76:79]
s_waitcnt lgkmcnt(4)
bl a[148:151],v61,s[8:11],s82 offen offset:1024 sc1
mm a[80:83],v[88:91],v[208:211],a[80:83]
dt v[72:73],v13 offset:224
mm a[80:83],v[92:95],a[192:195],a[80:83]
mm a[84:87],v[88:91],v[212:215],a[84:87]
dt v[74:75],v13 offset:4832
mm a[84:87],v[92:95],a[196:199],a[84:87]
s_add_u32 m0,s71,93184
mm a[88:91],v[88:91],v[216:219],a[88:91]
dt v[76:77],v13 offset:9440
mm a[88:91],v[92:95],a[200:203],a[88:91]
bl v7,s[32:35],s79 offen lds
mm a[92:95],v[88:91],v[220:223],a[92:95]
dt v[78:79],v13 offset:14048
mm a[92:95],v[92:95],a[204:207],a[92:95]
s_waitcnt lgkmcnt(4)
mm a[96:99],v[64:67],v[208:211],a[96:99]
dt v[80:81],v13 offset:256
mm a[96:99],v[68:71],a[192:195],a[96:99]
bl a[152:155],v62,s[8:11],s82 offen offset:1024 sc1
mm a[100:103],v[64:67],v[212:215],a[100:103]
dt v[82:83],v13 offset:4864
mm a[100:103],v[68:71],a[196:199],a[100:103]
mm a[104:107],v[64:67],v[216:219],a[104:107]
dt v[84:85],v13 offset:9472
mm a[104:107],v[68:71],a[200:203],a[104:107]
mm a[108:111],v[64:67],v[220:223],a[108:111]
dt v[86:87],v13 offset:14080
mm a[108:111],v[68:71],a[204:207],a[108:111]
s_waitcnt lgkmcnt(4)
bl a[156:159],v63,s[8:11],s82 offen offset:1024 sc1
mm a[112:115],v[72:75],v[208:211],a[112:115]
dt v[88:89],v13 offset:18432
mm a[112:115],v[76:79],a[192:195],a[112:115]
s_add_u32 m0,s71,94208
mm a[116:119],v[72:75],v[212:215],a[116:119]
dt v[90:91],v13 offset:23040
mm a[116:119],v[76:79],a[196:199],a[116:119]
bl v8,s[32:35],s79 offen lds
mm a[120:123],v[72:75],v[216:219],a[120:123]
dt v[92:93],v13 offset:27648
mm a[120:123],v[76:79],a[200:203],a[120:123]
mm a[124:127],v[72:75],v[220:223],a[124:127]
dt v[94:95],v13 offset:32256
mm a[124:127],v[76:79],a[204:207],a[124:127]
s_waitcnt lgkmcnt(4)
mm a[128:131],v[80:83],v[208:211],a[128:131]
dt v[64:65],v13 offset:18464
mm a[128:131],v[84:87],a[192:195],a[128:131]
bl a[160:163],v60,s[8:11],s82 offen offset:2048 sc1
mm a[132:135],v[80:83],v[212:215],a[132:135]
dt v[66:67],v13 offset:23072
mm a[132:135],v[84:87],a[196:199],a[132:135]
s_add_u32 m0,s71,95232
mm a[136:139],v[80:83],v[216:219],a[136:139]
dt v[68:69],v13 offset:27680
mm a[136:139],v[84:87],a[200:203],a[136:139]
bl v9,s[32:35],s79 offen lds
mm a[140:143],v[80:83],v[220:223],a[140:143]
dt v[70:71],v13 offset:32288
mm a[140:143],v[84:87],a[204:207],a[140:143]
s_waitcnt vmcnt(40) lgkmcnt(4)
mm a[0:3],v[88:91],a[208:211],a[0:3]
dt v[72:73],v13 offset:18496
mm a[0:3],v[92:95],a[224:227],a[0:3]
mm a[4:7],v[88:91],a[212:215],a[4:7]
dt v[74:75],v13 offset:23104
mm a[4:7],v[92:95],a[228:231],a[4:7]
bl a[164:167],v61,s[8:11],s82 offen offset:2048 sc1
mm a[8:11],v[88:91],a[216:219],a[8:11]
dt v[76:77],v13 offset:27712
mm a[8:11],v[92:95],a[232:235],a[8:11]
buffer_load_dword v0,v3,s[8:11],s76 offen offset:0 sc1
mm a[12:15],v[88:91],a[220:223],a[12:15]
dt v[78:79],v13 offset:32320
mm a[12:15],v[92:95],a[236:239],a[12:15]
s_waitcnt lgkmcnt(4)
mm a[16:19],v[64:67],a[208:211],a[16:19]
dt v[80:81],v13 offset:18528
mm a[16:19],v[68:71],a[224:227],a[16:19]
bl a[168:171],v62,s[8:11],s82 offen offset:2048 sc1
mm a[20:23],v[64:67],a[212:215],a[20:23]
dt v[82:83],v13 offset:23136
mm a[20:23],v[68:71],a[228:231],a[20:23]
mm a[24:27],v[64:67],a[216:219],a[24:27]
s_add_u32 m0,s71,96256
dt v[84:85],v13 offset:27744
mm a[24:27],v[68:71],a[232:235],a[24:27]
mm a[28:31],v[64:67],a[220:223],a[28:31]
dt v[86:87],v13 offset:32352
mm a[28:31],v[68:71],a[236:239],a[28:31]
s_waitcnt lgkmcnt(4)
bl v10,s[32:35],s79 offen lds
mm a[32:35],v[72:75],a[208:211],a[32:35]
dt v[88:89],v13 offset:18560
mm a[32:35],v[76:79],a[224:227],a[32:35]
mm a[36:39],v[72:75],a[212:215],a[36:39]
dt v[90:91],v13 offset:23168
mm a[36:39],v[76:79],a[228:231],a[36:39]
bl a[172:175],v63,s[8:11],s82 offen offset:2048 sc1
mm a[40:43],v[72:75],a[216:219],a[40:43]
dt v[92:93],v13 offset:27776
mm a[40:43],v[76:79],a[232:235],a[40:43]
mm a[44:47],v[72:75],a[220:223],a[44:47]
dt v[94:95],v13 offset:32384
mm a[44:47],v[76:79],a[236:239],a[44:47]
s_waitcnt lgkmcnt(4)
mm a[48:51],v[80:83],a[208:211],a[48:51]
dt v[64:65],v13 offset:18592
mm a[48:51],v[84:87],a[224:227],a[48:51]
bl a[176:179],v60,s[8:11],s82 offen offset:3072 sc1
mm a[52:55],v[80:83],a[212:215],a[52:55]
dt v[66:67],v13 offset:23200
mm a[52:55],v[84:87],a[228:231],a[52:55]
s_add_u32 m0,s71,97280
mm a[56:59],v[80:83],a[216:219],a[56:59]
dt v[68:69],v13 offset:27808
mm a[56:59],v[84:87],a[232:235],a[56:59]
bl v11,s[32:35],s79 offen lds
mm a[60:63],v[80:83],a[220:223],a[60:63]
dt v[70:71],v13 offset:32416
mm a[60:63],v[84:87],a[236:239],a[60:63]
s_waitcnt lgkmcnt(4)
mm a[64:67],v[88:91],a[208:211],a[64:67]
dt v[72:73],v13 offset:18624
mm a[64:67],v[92:95],a[224:227],a[64:67]
mm a[68:71],v[88:91],a[212:215],a[68:71]
dt v[74:75],v13 offset:23232
mm a[68:71],v[92:95],a[228:231],a[68:71]
bl a[180:183],v61,s[8:11],s82 offen offset:3072 sc1
mm a[72:75],v[88:91],a[216:219],a[72:75]
dt v[76:77],v13 offset:27840
mm a[72:75],v[92:95],a[232:235],a[72:75]
mm a[76:79],v[88:91],a[220:223],a[76:79]
dt v[78:79],v13 offset:32448
mm a[76:79],v[92:95],a[236:239],a[76:79]
s_waitcnt lgkmcnt(4)
bl a[184:187],v62,s[8:11],s82 offen offset:3072 sc1
mm a[80:83],v[64:67],a[208:211],a[80:83]
dt v[80:81],v13 offset:18656
mm a[80:83],v[68:71],a[224:227],a[80:83]
mm a[84:87],v[64:67],a[212:215],a[84:87]
s_add_u32 m0,s71,98304
dt v[82:83],v13 offset:23264
mm a[84:87],v[68:71],a[228:231],a[84:87]
mm a[88:91],v[64:67],a[216:219],a[88:91]
dt v[84:85],v13 offset:27872
mm a[88:91],v[68:71],a[232:235],a[88:91]
bl v12,s[32:35],s79 offen lds
mm a[92:95],v[64:67],a[220:223],a[92:95]
dt v[86:87],v13 offset:32480
mm a[92:95],v[68:71],a[236:239],a[92:95]
s_waitcnt lgkmcnt(4)
mm a[96:99],v[72:75],a[208:211],a[96:99]
dt v[88:89],v13 offset:18688
mm a[96:99],v[76:79],a[224:227],a[96:99]
bl a[188:191],v63,s[8:11],s82 offen offset:3072 sc1
mm a[100:103],v[72:75],a[212:215],a[100:103]
dt v[90:91],v13 offset:23296
mm a[100:103],v[76:79],a[228:231],a[100:103]
mm a[104:107],v[72:75],a[216:219],a[104:107]
dt v[92:93],v13 offset:27904
mm a[104:107],v[76:79],a[232:235],a[104:107]
mm a[108:111],v[72:75],a[220:223],a[108:111]
dt v[94:95],v13 offset:32512
mm a[108:111],v[76:79],a[236:239],a[108:111]
s_waitcnt lgkmcnt(4)
s_waitcnt vmcnt(34)
mm a[112:115],v[80:83],a[208:211],a[112:115]
s_barrier
dt v[64:65],v14 offset:45056
mm a[112:115],v[84:87],a[224:227],a[112:115]
mm a[116:119],v[80:83],a[212:215],a[116:119]
dt v[66:67],v14 offset:49664
mm a[116:119],v[84:87],a[228:231],a[116:119]
mm a[120:123],v[80:83],a[216:219],a[120:123]
dt v[68:69],v14 offset:54272
mm a[120:123],v[84:87],a[232:235],a[120:123]
mm a[124:127],v[80:83],a[220:223],a[124:127]
dt v[70:71],v14 offset:58880
mm a[124:127],v[84:87],a[236:239],a[124:127]
s_waitcnt lgkmcnt(4)
mm a[128:131],v[88:91],a[208:211],a[128:131]
dt v[72:73],v14 offset:45088
mm a[128:131],v[92:95],a[224:227],a[128:131]
mm a[132:135],v[88:91],a[212:215],a[132:135]
dt v[74:75],v14 offset:49696
mm a[132:135],v[92:95],a[228:231],a[132:135]
mm a[136:139],v[88:91],a[216:219],a[136:139]
s_waitcnt vmcnt(9)
dt v[76:77],v14 offset:54304
v_cmp_ne_u32 vcc,v1,v0
mm a[136:139],v[92:95],a[232:235],a[136:139]
mm a[140:143],v[88:91],a[220:223],a[140:143]
s_cbranch_vccnz L_spin_fo2
L_ok_fo2:
dt v[78:79],v14 offset:58912
mm a[140:143],v[92:95],a[236:239],a[140:143]
s_waitcnt lgkmcnt(4)
mm a[0:3],v[64:67],a[240:243],a[0:3]
s_bfe_u32 s82,s81,0x40014
s_lshl_b32 s82,s82,12
dt v[80:81],v14 offset:45120
mm a[0:3],v[68:71],v[160:163],a[0:3]
s_add_u32 s82,s82,s68
bl v[176:179],v60,s[8:11],s82 offen offset:0 sc1
mm a[4:7],v[64:67],a[244:247],a[4:7]
dt v[82:83],v14 offset:49728
mm a[4:7],v[68:71],v[164:167],a[4:7]
s_bfe_u32 s79,s81,0x40014
s_mul_i32 s79,s79,147456
s_add_u32 s79,s79,s70
mm a[8:11],v[64:67],a[248:251],a[8:11]
s_add_u32 m0,s71,53248
dt v[84:85],v14 offset:54336
mm a[8:11],v[68:71],v[168:171],a[8:11]
bl v4,s[32:35],s79 offen lds
mm a[12:15],v[64:67],a[252:255],a[12:15]
dt v[86:87],v14 offset:58944
mm a[12:15],v[68:71],v[172:175],a[12:15]
s_waitcnt lgkmcnt(4)
mm a[16:19],v[72:75],a[240:243],a[16:19]
dt v[88:89],v14 offset:45152
mm a[16:19],v[76:79],v[160:163],a[16:19]
mm a[20:23],v[72:75],a[244:247],a[20:23]
dt v[90:91],v14 offset:49760
mm a[20:23],v[76:79],v[164:167],a[20:23]
bl v[180:183],v61,s[8:11],s82 offen offset:0 sc1
mm a[24:27],v[72:75],a[248:251],a[24:27]
dt v[92:93],v14 offset:54368
mm a[24:27],v[76:79],v[168:171],a[24:27]
s_add_u32 m0,s71,54272
mm a[28:31],v[72:75],a[252:255],a[28:31]
dt v[94:95],v14 offset:58976
mm a[28:31],v[76:79],v[172:175],a[28:31]
s_waitcnt lgkmcnt(4)
bl v5,s[32:35],s79 offen lds
mm a[32:35],v[80:83],a[240:243],a[32:35]
dt v[64:65],v14 offset:45184
mm a[32:35],v[84:87],v[160:163],a[32:35]
mm a[36:39],v[80:83],a[244:247],a[36:39]
dt v[66:67],v14 offset:49792
mm a[36:39],v[84:87],v[164:167],a[36:39]
mm a[40:43],v[80:83],a[248:251],a[40:43]
dt v[68:69],v14 offset:54400
mm a[40:43],v[84:87],v[168:171],a[40:43]
bl v[184:187],v62,s[8:11],s82 offen offset:0 sc1
mm a[44:47],v[80:83],a[252:255],a[44:47]
dt v[70:71],v14 offset:59008
mm a[44:47],v[84:87],v[172:175],a[44:47]
s_waitcnt lgkmcnt(4)
mm a[48:51],v[88:91],a[240:243],a[48:51]
dt v[72:73],v14 offset:45216
mm a[48:51],v[92:95],v[160:163],a[48:51]
bl v[188:191],v63,s[8:11],s82 offen offset:0 sc1
mm a[52:55],v[88:91],a[244:247],a[52:55]
dt v[74:75],v14 offset:49824
mm a[52:55],v[92:95],v[164:167],a[52:55]
mm a[56:59],v[88:91],a[248:251],a[56:59]
s_add_u32 m0,s71,55296
dt v[76:77],v14 offset:54432
mm a[56:59],v[92:95],v[168:171],a[56:59]
mm a[60:63],v[88:91],a[252:255],a[60:63]
dt v[78:79],v14 offset:59040
mm a[60:63],v[92:95],v[172:175],a[60:63]
s_waitcnt lgkmcnt(4)
bl v6,s[32:35],s79 offen lds
mm a[64:67],v[64:67],a[240:243],a[64:67]
dt v[80:81],v14 offset:45248
mm a[64:67],v[68:71],v[160:163],a[64:67]
mm a[68:71],v[64:67],a[244:247],a[68:71]
dt v[82:83],v14 offset:49856
mm a[68:71],v[68:71],v[164:167],a[68:71]
bl v[208:211],v60,s[8:11],s82 offen offset:1024 sc1
mm a[72:75],v[64:67],a[248:251],a[72:75]
dt v[84:85],v14 offset:54464
mm a[72:75],v[68:71],v[168:171],a[72:75]
mm a[76:79],v[64:67],a[252:255],a[76:79]
dt v[86:87],v14 offset:59072
mm a[76:79],v[68:71],v[172:175],a[76:79]
s_waitcnt lgkmcnt(4)
mm a[80:83],v[72:75],a[240:243],a[80:83]
dt v[88:89],v14 offset:45280
mm a[80:83],v[76:79],v[160:163],a[80:83]
bl v[212:215],v61,s[8:11],s82 offen offset:1024 sc1
mm a[84:87],v[72:75],a[244:247],a[84:87]
dt v[90:91],v14 offset:49888
mm a[84:87],v[76:79],v[164:167],a[84:87]
s_add_u32 m0,s71,56320
mm a[88:91],v[72:75],a[248:251],a[88:91]
dt v[92:93],v14 offset:54496
mm a[88:91],v[76:79],v[168:171],a[88:91]
bl v7,s[32:35],s79 offen lds
mm a[92:95],v[72:75],a[252:255],a[92:95]
dt v[94:95],v14 offset:59104
mm a[92:95],v[76:79],v[172:175],a[92:95]
s_waitcnt lgkmcnt(4)
mm a[96:99],v[80:83],a[240:243],a[96:99]
dt v[64:65],v14 offset:45312
mm a[96:99],v[84:87],v[160:163],a[96:99]
mm a[100:103],v[80:83],a[244:247],a[100:103]
dt v[66:67],v14 offset:49920
mm a[100:103],v[84:87],v[164:167],a[100:103]
bl v[216:219],v62,s[8:11],s82 offen offset:1024 sc1
mm a[104:107],v[80:83],a[248:251],a[104:107]
dt v[68:69],v14 offset:54528
mm a[104:107],v[84:87],v[168:171],a[104:107]
mm a[108:111],v[80:83],a[252:255],a[108:111]
dt v[70:71],v14 offset:59136
mm a[108:111],v[84:87],v[172:175],a[108:111]
s_waitcnt lgkmcnt(4)
bl v[220:223],v63,s[8:11],s82 offen offset:1024 sc1
mm a[112:115],v[88:91],a[240:243],a[112:115]
dt v[72:73],v14 offset:63488
mm a[112:115],v[92:95],v[160:163],a[112:115]
mm a[116:119],v[88:91],a[244:247],a[116:119]
s_add_u32 m0,s71,57344
dt v[74:75],v15 offset:2560
mm a[116:119],v[92:95],v[164:167],a[116:119]
mm a[120:123],v[88:91],a[248:251],a[120:123]
dt v[76:77],v15 offset:7168
mm a[120:123],v[92:95],v[168:171],a[120:123]
bl v8,s[32:35],s79 offen lds
mm a[124:127],v[88:91],a[252:255],a[124:127]
dt v[78:79],v15 offset:11776
mm a[124:127],v[92:95],v[172:175],a[124:127]
s_waitcnt lgkmcnt(4)
mm a[128:131],v[64:67],a[240:243],a[128:131]
dt v[80:81],v14 offset:63520
mm a[128:131],v[68:71],v[160:163],a[128:131]
bl a[192:195],v60,s[8:11],s82 offen offset:2048 sc1
mm a[132:135],v[64:67],a[244:247],a[132:135]
dt v[82:83],v15 offset:2592
mm a[132:135],v[68:71],v[164:167],a[132:135]
mm a[136:139],v[64:67],a[248:251],a[136:139]
s_add_u32 m0,s71,58368
dt v[84:85],v15 offset:7200
mm a[136:139],v[68:71],v[168:171],a[136:139]
mm a[140:143],v[64:67],a[252:255],a[140:143]
dt v[86:87],v15 offset:11808
mm a[140:143],v[68:71],v[172:175],a[140:143]
s_waitcnt lgkmcnt(4)
bl v9,s[32:35],s79 offen lds
mm a[0:3],v[72:75],v[192:195],a[0:3]
dt v[88:89],v14 offset:63552
mm a[0:3],v[76:79],v[224:227],a[0:3]
mm a[4:7],v[72:75],v[196:199],a[4:7]
dt v[90:91],v15 offset:2624
mm a[4:7],v[76:79],v[228:231],a[4:7]
bl a[196:199],v61,s[8:11],s82 offen offset:2048 sc1
mm a[8:11],v[72:75],v[200:203],a[8:11]
dt v[92:93],v15 offset:7232
mm a[8:11],v[76:79],v[232:235],a[8:11]
mm a[12:15],v[72:75],v[204:207],a[12:15]
dt v[94:95],v15 offset:11840
mm a[12:15],v[76:79],v[236:239],a[12:15]
s_waitcnt lgkmcnt(4)
mm a[16:19],v[80:83],v[192:195],a[16:19]
dt v[64:65],v14 offset:63584
mm a[16:19],v[84:87],v[224:227],a[16:19]
bl a[200:203],v62,s[8:11],s82 offen offset:2048 sc1
mm a[20:23],v[80:83],v[196:199],a[20:23]
dt v[66:67],v15 offset:2656
mm a[20:23],v[84:87],v[228:231],a[20:23]
s_add_u32 m0,s71,59392
mm a[24:27],v[80:83],v[200:203],a[24:27]
dt v[68:69],v15 offset:7264
mm a[24:27],v[84:87],v[232:235],a[24:27]
bl v10,s[32:35],s79 offen lds
mm a[28:31],v[80:83],v[204:207],a[28:31]
dt v[70:71],v15 offset:11872
mm a[28:31],v[84:87],v[236:239],a[28:31]
s_waitcnt lgkmcnt(4)
mm a[32:35],v[88:91],v[192:195],a[32:35]
dt v[72:73],v14 offset:63616
mm a[32:35],v[92:95],v[224:227],a[32:35]
mm a[36:39],v[88:91],v[196:199],a[36:39]
dt v[74:75],v15 offset:2688
mm a[36:39],v[92:95],v[228:231],a[36:39]
bl a[204:207],v63,s[8:11],s82 offen offset:2048 sc1
mm a[40:43],v[88:91],v[200:203],a[40:43]
dt v[76:77],v15 offset:7296
mm a[40:43],v[92:95],v[232:235],a[40:43]
mm a[44:47],v[88:91],v[204:207],a[44:47]
dt v[78:79],v15 offset:11904
mm a[44:47],v[92:95],v[236:239],a[44:47]
s_waitcnt lgkmcnt(4)
bl a[208:211],v60,s[8:11],s82 offen offset:3072 sc1
mm a[48:51],v[64:67],v[192:195],a[48:51]
dt v[80:81],v14 offset:63648
mm a[48:51],v[68:71],v[224:227],a[48:51]
mm a[52:55],v[64:67],v[196:199],a[52:55]
dt v[82:83],v15 offset:2720
mm a[52:55],v[68:71],v[228:231],a[52:55]
s_add_u32 m0,s71,60416
mm a[56:59],v[64:67],v[200:203],a[56:59]
dt v[84:85],v15 offset:7328
mm a[56:59],v[68:71],v[232:235],a[56:59]
bl v11,s[32:35],s79 offen lds
mm a[60:63],v[64:67],v[204:207],a[60:63]
dt v[86:87],v15 offset:11936
mm a[60:63],v[68:71],v[236:239],a[60:63]
s_waitcnt lgkmcnt(4)
mm a[64:67],v[72:75],v[192:195],a[64:67]
dt v[88:89],v14 offset:63680
mm a[64:67],v[76:79],v[224:227],a[64:67]
bl a[212:215],v61,s[8:11],s82 offen offset:3072 sc1
mm a[68:71],v[72:75],v[196:199],a[68:71]
dt v[90:91],v15 offset:2752
mm a[68:71],v[76:79],v[228:231],a[68:71]
mm a[72:75],v[72:75],v[200:203],a[72:75]
dt v[92:93],v15 offset:7360
mm a[72:75],v[76:79],v[232:235],a[72:75]
mm a[76:79],v[72:75],v[204:207],a[76:79]
dt v[94:95],v15 offset:11968
mm a[76:79],v[76:79],v[236:239],a[76:79]
s_waitcnt lgkmcnt(4)
bl a[216:219],v62,s[8:11],s82 offen offset:3072 sc1
mm a[80:83],v[80:83],v[192:195],a[80:83]
dt v[64:65],v14 offset:63712
mm a[80:83],v[84:87],v[224:227],a[80:83]
s_add_u32 m0,s71,61440
mm a[84:87],v[80:83],v[196:199],a[84:87]
dt v[66:67],v15 offset:2784
mm a[84:87],v[84:87],v[228:231],a[84:87]
bl v12,s[32:35],s79 offen lds
mm a[88:91],v[80:83],v[200:203],a[88:91]
dt v[68:69],v15 offset:7392
mm a[88:91],v[84:87],v[232:235],a[88:91]
mm a[92:95],v[80:83],v[204:207],a[92:95]
dt v[70:71],v15 offset:12000
mm a[92:95],v[84:87],v[236:239],a[92:95]
s_waitcnt lgkmcnt(4)
mm a[96:99],v[88:91],v[192:195],a[96:99]
dt v[72:73],v14 offset:63744
mm a[96:99],v[92:95],v[224:227],a[96:99]
bl a[220:223],v63,s[8:11],s82 offen offset:3072 sc1
mm a[100:103],v[88:91],v[196:199],a[100:103]
dt v[74:75],v15 offset:2816
mm a[100:103],v[92:95],v[228:231],a[100:103]
mm a[104:107],v[88:91],v[200:203],a[104:107]
dt v[76:77],v15 offset:7424
mm a[104:107],v[92:95],v[232:235],a[104:107]
mm a[108:111],v[88:91],v[204:207],a[108:111]
s_getpc_b64 s[0:1]
L_cpf0:
s_add_u32 s100,s47,4096
s_min_u32 s100,s100,L_code_end-1024-L_cpf0
s_add_u32 s0,s0,s100
s_addc_u32 s1,s1,0
dt v[78:79],v15 offset:12032
mm a[108:111],v[92:95],v[236:239],a[108:111]
s_waitcnt lgkmcnt(4)
s_waitcnt vmcnt(26)
mm a[112:115],v[64:67],v[192:195],a[112:115]
s_barrier
dt v[80:81],v14 offset:8192
mm a[112:115],v[68:71],v[224:227],a[112:115]
global_load_dword v57,v3,s[0:1]
mm a[116:119],v[64:67],v[196:199],a[116:119]
dt v[82:83],v14 offset:12800
mm a[116:119],v[68:71],v[228:231],a[116:119]
mm a[120:123],v[64:67],v[200:203],a[120:123]
dt v[84:85],v14 offset:17408
mm a[120:123],v[68:71],v[232:235],a[120:123]
mm a[124:127],v[64:67],v[204:207],a[124:127]
dt v[86:87],v14 offset:22016
mm a[124:127],v[68:71],v[236:239],a[124:127]
s_waitcnt lgkmcnt(4)
mm a[128:131],v[72:75],v[192:195],a[128:131]
dt v[88:89],v14 offset:8224
mm a[128:131],v[76:79],v[224:227],a[128:131]
mm a[132:135],v[72:75],v[196:199],a[132:135]
dt v[90:91],v14 offset:12832
mm a[132:135],v[76:79],v[228:231],a[132:135]
mm a[136:139],v[72:75],v[200:203],a[136:139]
dt v[92:93],v14 offset:17440
mm a[136:139],v[76:79],v[232:235],a[136:139]
mm a[140:143],v[72:75],v[204:207],a[140:143]
dt v[94:95],v14 offset:22048
mm a[140:143],v[76:79],v[236:239],a[140:143]
s_waitcnt lgkmcnt(4)
mm a[0:3],v[80:83],v[240:243],a[0:3]
s_bfe_u32 s82,s81,0x40018
s_lshl_b32 s82,s82,12
dt v[64:65],v14 offset:8256
mm a[0:3],v[84:87],a[144:147],a[0:3]
s_add_u32 s82,s82,s68
bl a[224:227],v60,s[8:11],s82 offen offset:0 sc1
mm a[4:7],v[80:83],v[244:247],a[4:7]
dt v[66:67],v14 offset:12864
mm a[4:7],v[84:87],a[148:151],a[4:7]
s_bfe_u32 s79,s81,0x40018
s_mul_i32 s79,s79,147456
s_add_u32 s79,s79,s70
mm a[8:11],v[80:83],v[248:251],a[8:11]
s_add_u32 m0,s71,16384
dt v[68:69],v14 offset:17472
mm a[8:11],v[84:87],a[152:155],a[8:11]
bl v4,s[32:35],s79 offen lds
mm a[12:15],v[80:83],v[252:255],a[12:15]
dt v[70:71],v14 offset:22080
mm a[12:15],v[84:87],a[156:159],a[12:15]
s_waitcnt lgkmcnt(4)
mm a[16:19],v[88:91],v[240:243],a[16:19]
dt v[72:73],v14 offset:8288
mm a[16:19],v[92:95],a[144:147],a[16:19]
mm a[20:23],v[88:91],v[244:247],a[20:23]
dt v[74:75],v14 offset:12896
mm a[20:23],v[92:95],a[148:151],a[20:23]
bl a[228:231],v61,s[8:11],s82 offen offset:0 sc1
mm a[24:27],v[88:91],v[248:251],a[24:27]
dt v[76:77],v14 offset:17504
mm a[24:27],v[92:95],a[152:155],a[24:27]
s_add_u32 m0,s71,17408
mm a[28:31],v[88:91],v[252:255],a[28:31]
dt v[78:79],v14 offset:22112
mm a[28:31],v[92:95],a[156:159],a[28:31]
s_waitcnt lgkmcnt(4)
bl v5,s[32:35],s79 offen lds
mm a[32:35],v[64:67],v[240:243],a[32:35]
dt v[80:81],v14 offset:8320
mm a[32:35],v[68:71],a[144:147],a[32:35]
mm a[36:39],v[64:67],v[244:247],a[36:39]
dt v[82:83],v14 offset:12928
mm a[36:39],v[68:71],a[148:151],a[36:39]
mm a[40:43],v[64:67],v[248:251],a[40:43]
dt v[84:85],v14 offset:17536
mm a[40:43],v[68:71],a[152:155],a[40:43]
bl a[232:235],v62,s[8:11],s82 offen offset:0 sc1
mm a[44:47],v[64:67],v[252:255],a[44:47]
dt v[86:87],v14 offset:22144
mm a[44:47],v[68:71],a[156:159],a[44:47]
s_waitcnt lgkmcnt(4)
mm a[48:51],v[72:75],v[240:243],a[48:51]
dt v[88:89],v14 offset:8352
mm a[48:51],v[76:79],a[144:147],a[48:51]
bl a[236:239],v63,s[8:11],s82 offen offset:0 sc1
mm a[52:55],v[72:75],v[244:247],a[52:55]
dt v[90:91],v14 offset:12960
mm a[52:55],v[76:79],a[148:151],a[52:55]
mm a[56:59],v[72:75],v[248:251],a[56:59]
s_add_u32 m0,s71,18432
dt v[92:93],v14 offset:17568
mm a[56:59],v[76:79],a[152:155],a[56:59]
mm a[60:63],v[72:75],v[252:255],a[60:63]
dt v[94:95],v14 offset:22176
mm a[60:63],v[76:79],a[156:159],a[60:63]
s_waitcnt lgkmcnt(4)
bl v6,s[32:35],s79 offen lds
mm a[64:67],v[80:83],v[240:243],a[64:67]
dt v[64:65],v14 offset:8384
mm a[64:67],v[84:87],a[144:147],a[64:67]
mm a[68:71],v[80:83],v[244:247],a[68:71]
dt v[66:67],v14 offset:12992
mm a[68:71],v[84:87],a[148:151],a[68:71]
bl a[240:243],v60,s[8:11],s82 offen offset:1024 sc1
mm a[72:75],v[80:83],v[248:251],a[72:75]
dt v[68:69],v14 offset:17600
mm a[72:75],v[84:87],a[152:155],a[72:75]
mm a[76:79],v[80:83],v[252:255],a[76:79]
dt v[70:71],v14 offset:22208
mm a[76:79],v[84:87],a[156:159],a[76:79]
s_waitcnt lgkmcnt(4)
mm a[80:83],v[88:91],v[240:243],a[80:83]
dt v[72:73],v14 offset:8416
mm a[80:83],v[92:95],a[144:147],a[80:83]
bl a[244:247],v61,s[8:11],s82 offen offset:1024 sc1
mm a[84:87],v[88:91],v[244:247],a[84:87]
dt v[74:75],v14 offset:13024
mm a[84:87],v[92:95],a[148:151],a[84:87]
s_add_u32 m0,s71,19456
mm a[88:91],v[88:91],v[248:251],a[88:91]
dt v[76:77],v14 offset:17632
mm a[88:91],v[92:95],a[152:155],a[88:91]
bl v7,s[32:35],s79 offen lds
mm a[92:95],v[88:91],v[252:255],a[92:95]
dt v[78:79],v14 offset:22240
mm a[92:95],v[92:95],a[156:159],a[92:95]
s_waitcnt lgkmcnt(4)
mm a[96:99],v[64:67],v[240:243],a[96:99]
dt v[80:81],v14 offset:8448
mm a[96:99],v[68:71],a[144:147],a[96:99]
mm a[100:103],v[64:67],v[244:247],a[100:103]
dt v[82:83],v14 offset:13056
mm a[100:103],v[68:71],a[148:151],a[100:103]
bl a[248:251],v62,s[8:11],s82 offen offset:1024 sc1
mm a[104:107],v[64:67],v[248:251],a[104:107]
dt v[84:85],v14 offset:17664
mm a[104:107],v[68:71],a[152:155],a[104:107]
mm a[108:111],v[64:67],v[252:255],a[108:111]
dt v[86:87],v14 offset:22272
mm a[108:111],v[68:71],a[156:159],a[108:111]
s_waitcnt lgkmcnt(4)
bl a[252:255],v63,s[8:11],s82 offen offset:1024 sc1
mm a[112:115],v[72:75],v[240:243],a[112:115]
dt v[88:89],v14 offset:26624
mm a[112:115],v[76:79],a[144:147],a[112:115]
mm a[116:119],v[72:75],v[244:247],a[116:119]
s_add_u32 m0,s71,20480
dt v[90:91],v14 offset:31232
mm a[116:119],v[76:79],a[148:151],a[116:119]
mm a[120:123],v[72:75],v[248:251],a[120:123]
dt v[92:93],v14 offset:35840
mm a[120:123],v[76:79],a[152:155],a[120:123]
bl v8,s[32:35],s79 offen lds
mm a[124:127],v[72:75],v[252:255],a[124:127]
dt v[94:95],v14 offset:40448
mm a[124:127],v[76:79],a[156:159],a[124:127]
s_waitcnt lgkmcnt(4)
mm a[128:131],v[80:83],v[240:243],a[128:131]
dt v[64:65],v14 offset:26656
mm a[128:131],v[84:87],a[144:147],a[128:131]
bl v[160:163],v60,s[8:11],s82 offen offset:2048 sc1
mm a[132:135],v[80:83],v[244:247],a[132:135]
dt v[66:67],v14 offset:31264
mm a[132:135],v[84:87],a[148:151],a[132:135]
mm a[136:139],v[80:83],v[248:251],a[136:139]
s_add_u32 m0,s71,21504
dt v[68:69],v14 offset:35872
mm a[136:139],v[84:87],a[152:155],a[136:139]
mm a[140:143],v[80:83],v[252:255],a[140:143]
dt v[70:71],v14 offset:40480
mm a[140:143],v[84:87],a[156:159],a[140:143]
s_waitcnt vmcnt(40) lgkmcnt(4)
bl v9,s[32:35],s79 offen lds
mm a[0:3],v[88:91],a[160:163],a[0:3]
dt v[72:73],v14 offset:26688
mm a[0:3],v[92:95],a[176:179],a[0:3]
mm a[4:7],v[88:91],a[164:167],a[4:7]
dt v[74:75],v14 offset:31296
mm a[4:7],v[92:95],a[180:183],a[4:7]
bl v[164:167],v61,s[8:11],s82 offen offset:2048 sc1
mm a[8:11],v[88:91],a[168:171],a[8:11]
dt v[76:77],v14 offset:35904
mm a[8:11],v[92:95],a[184:187],a[8:11]
mm a[12:15],v[88:91],a[172:175],a[12:15]
dt v[78:79],v14 offset:40512
mm a[12:15],v[92:95],a[188:191],a[12:15]
s_waitcnt lgkmcnt(4)
mm a[16:19],v[64:67],a[160:163],a[16:19]
dt v[80:81],v14 offset:26720
mm a[16:19],v[68:71],a[176:179],a[16:19]
bl v[168:171],v62,s[8:11],s82 offen offset:2048 sc1
mm a[20:23],v[64:67],a[164:167],a[20:23]
dt v[82:83],v14 offset:31328
mm a[20:23],v[68:71],a[180:183],a[20:23]
s_add_u32 m0,s71,22528
mm a[24:27],v[64:67],a[168:171],a[24:27]
dt v[84:85],v14 offset:35936
mm a[24:27],v[68:71],a[184:187],a[24:27]
bl v10,s[32:35],s79 offen lds
mm a[28:31],v[64:67],a[172:175],a[28:31]
dt v[86:87],v14 offset:40544
mm a[28:31],v[68:71],a[188:191],a[28:31]
s_waitcnt lgkmcnt(4)
mm a[32:35],v[72:75],a[160:163],a[32:35]
dt v[88:89],v14 offset:26752
mm a[32:35],v[76:79],a[176:179],a[32:35]
mm a[36:39],v[72:75],a[164:167],a[36:39]
dt v[90:91],v14 offset:31360
mm a[36:39],v[76:79],a[180:183],a[36:39]
bl v[172:175],v63,s[8:11],s82 offen offset:2048 sc1
mm a[40:43],v[72:75],a[168:171],a[40:43]
dt v[92:93],v14 offset:35968
mm a[40:43],v[76:79],a[184:187],a[40:43]
mm a[44:47],v[72:75],a[172:175],a[44:47]
dt v[94:95],v14 offset:40576
mm a[44:47],v[76:79],a[188:191],a[44:47]
s_waitcnt lgkmcnt(4)
bl v[192:195],v60,s[8:11],s82 offen offset:3072 sc1
mm a[48:51],v[80:83],a[160:163],a[48:51]
dt v[64:65],v14 offset:26784
mm a[48:51],v[84:87],a[176:179],a[48:51]
mm a[52:55],v[80:83],a[164:167],a[52:55]
dt v[66:67],v14 offset:31392
mm a[52:55],v[84:87],a[180:183],a[52:55]
s_add_u32 m0,s71,23552
mm a[56:59],v[80:83],a[168:171],a[56:59]
dt v[68:69],v14 offset:36000
mm a[56:59],v[84:87],a[184:187],a[56:59]
bl v11,s[32:35],s79 offen lds
mm a[60:63],v[80:83],a[172:175],a[60:63]
dt v[70:71],v14 offset:40608
mm a[60:63],v[84:87],a[188:191],a[60:63]
s_waitcnt lgkmcnt(4)
mm a[64:67],v[88:91],a[160:163],a[64:67]
dt v[72:73],v14 offset:26816
mm a[64:67],v[92:95],a[176:179],a[64:67]
bl v[196:199],v61,s[8:11],s82 offen offset:3072 sc1
mm a[68:71],v[88:91],a[164:167],a[68:71]
dt v[74:75],v14 offset:31424
mm a[68:71],v[92:95],a[180:183],a[68:71]
mm a[72:75],v[88:91],a[168:171],a[72:75]
dt v[76:77],v14 offset:36032
mm a[72:75],v[92:95],a[184:187],a[72:75]
mm a[76:79],v[88:91],a[172:175],a[76:79]
dt v[78:79],v14 offset:40640
mm a[76:79],v[92:95],a[188:191],a[76:79]
s_waitcnt lgkmcnt(4)
bl v[200:203],v62,s[8:11],s82 offen offset:3072 sc1
mm a[80:83],v[64:67],a[160:163],a[80:83]
dt v[80:81],v14 offset:26848
mm a[80:83],v[68:71],a[176:179],a[80:83]
s_add_u32 m0,s71,24576
mm a[84:87],v[64:67],a[164:167],a[84:87]
dt v[82:83],v14 offset:31456
mm a[84:87],v[68:71],a[180:183],a[84:87]
bl v12,s[32:35],s79 offen lds
mm a[88:91],v[64:67],a[168:171],a[88:91]
dt v[84:85],v14 offset:36064
mm a[88:91],v[68:71],a[184:187],a[88:91]
mm a[92:95],v[64:67],a[172:175],a[92:95]
dt v[86:87],v14 offset:40672
mm a[92:95],v[68:71],a[188:191],a[92:95]
s_waitcnt lgkmcnt(4)
mm a[96:99],v[72:75],a[160:163],a[96:99]
dt v[88:89],v14 offset:26880
mm a[96:99],v[76:79],a[176:179],a[96:99]
bl v[204:207],v63,s[8:11],s82 offen offset:3072 sc1
mm a[100:103],v[72:75],a[164:167],a[100:103]
dt v[90:91],v14 offset:31488
mm a[100:103],v[76:79],a[180:183],a[100:103]
mm a[104:107],v[72:75],a[168:171],a[104:107]
dt v[92:93],v14 offset:36096
mm a[104:107],v[76:79],a[184:187],a[104:107]
mm a[108:111],v[72:75],a[172:175],a[108:111]
dt v[94:95],v14 offset:40704
mm a[108:111],v[76:79],a[188:191],a[108:111]
s_waitcnt lgkmcnt(4)
s_waitcnt vmcnt(27)
mm a[112:115],v[80:83],a[160:163],a[112:115]
s_barrier
dt v[64:65],v13 offset:36864
mm a[112:115],v[84:87],a[176:179],a[112:115]
mm a[116:119],v[80:83],a[164:167],a[116:119]
dt v[66:67],v13 offset:41472
mm a[116:119],v[84:87],a[180:183],a[116:119]
mm a[120:123],v[80:83],a[168:171],a[120:123]
dt v[68:69],v13 offset:46080
mm a[120:123],v[84:87],a[184:187],a[120:123]
mm a[124:127],v[80:83],a[172:175],a[124:127]
dt v[70:71],v13 offset:50688
mm a[124:127],v[84:87],a[188:191],a[124:127]
s_waitcnt lgkmcnt(4)
mm a[128:131],v[88:91],a[160:163],a[128:131]
dt v[72:73],v13 offset:36896
mm a[128:131],v[92:95],a[176:179],a[128:131]
mm a[132:135],v[88:91],a[164:167],a[132:135]
dt v[74:75],v13 offset:41504
mm a[132:135],v[92:95],a[180:183],a[132:135]
mm a[136:139],v[88:91],a[168:171],a[136:139]
dt v[76:77],v13 offset:46112
mm a[136:139],v[92:95],a[184:187],a[136:139]
mm a[140:143],v[88:91],a[172:175],a[140:143]
dt v[78:79],v13 offset:50720
mm a[140:143],v[92:95],a[188:191],a[140:143]
s_waitcnt lgkmcnt(4)
mm a[0:3],v[64:67],v[176:179],a[0:3]
s_bfe_u32 s79,s81,0x4001c
s_mul_i32 s79,s79,147456
dt v[80:81],v13 offset:36928
mm a[0:3],v[68:71],v[208:211],a[0:3]
s_add_u32 s79,s79,s70
s_add_u32 m0,s71,126976
mm a[4:7],v[64:67],v[180:183],a[4:7]
dt v[82:83],v13 offset:41536
mm a[4:7],v[68:71],v[212:215],a[4:7]
bl v4,s[32:35],s79 offen lds
mm a[8:11],v[64:67],v[184:187],a[8:11]
s_add_u32 m0,s71,128000
dt v[84:85],v13 offset:46144
mm a[8:11],v[68:71],v[216:219],a[8:11]
bl v5,s[32:35],s79 offen lds
mm a[12:15],v[64:67],v[188:191],a[12:15]
dt v[86:87],v13 offset:50752
mm a[12:15],v[68:71],v[220:223],a[12:15]
s_waitcnt lgkmcnt(4)
s_add_u32 m0,s71,129024
mm a[16:19],v[72:75],v[176:179],a[16:19]
dt v[88:89],v13 offset:36960
mm a[16:19],v[76:79],v[208:211],a[16:19]
bl v6,s[32:35],s79 offen lds
mm a[20:23],v[72:75],v[180:183],a[20:23]
dt v[90:91],v13 offset:41568
mm a[20:23],v[76:79],v[212:215],a[20:23]
s_add_u32 m0,s71,130048
mm a[24:27],v[72:75],v[184:187],a[24:27]
dt v[92:93],v13 offset:46176
mm a[24:27],v[76:79],v[216:219],a[24:27]
bl v7,s[32:35],s79 offen lds
mm a[28:31],v[72:75],v[188:191],a[28:31]
dt v[94:95],v13 offset:50784
mm a[28:31],v[76:79],v[220:223],a[28:31]
s_waitcnt lgkmcnt(4)
s_add_u32 m0,s71,131072
mm a[32:35],v[80:83],v[176:179],a[32:35]
dt v[64:65],v13 offset:36992
mm a[32:35],v[84:87],v[208:211],a[32:35]
bl v8,s[32:35],s79 offen lds
mm a[36:39],v[80:83],v[180:183],a[36:39]
dt v[66:67],v13 offset:41600
mm a[36:39],v[84:87],v[212:215],a[36:39]
s_add_u32 m0,s71,132096
mm a[40:43],v[80:83],v[184:187],a[40:43]
dt v[68:69],v13 offset:46208
mm a[40:43],v[84:87],v[216:219],a[40:43]
bl v9,s[32:35],s79 offen lds
mm a[44:47],v[80:83],v[188:191],a[44:47]
dt v[70:71],v13 offset:50816
mm a[44:47],v[84:87],v[220:223],a[44:47]
s_waitcnt lgkmcnt(4)
mm a[48:51],v[88:91],v[176:179],a[48:51]
s_add_u32 m0,s71,133120
dt v[72:73],v13 offset:37024
mm a[48:51],v[92:95],v[208:211],a[48:51]
mm a[52:55],v[88:91],v[180:183],a[52:55]
dt v[74:75],v13 offset:41632
mm a[52:55],v[92:95],v[212:215],a[52:55]
bl v10,s[32:35],s79 offen lds
mm a[56:59],v[88:91],v[184:187],a[56:59]
dt v[76:77],v13 offset:46240
mm a[56:59],v[92:95],v[216:219],a[56:59]
s_add_u32 m0,s71,134144
mm a[60:63],v[88:91],v[188:191],a[60:63]
dt v[78:79],v13 offset:50848
mm a[60:63],v[92:95],v[220:223],a[60:63]
s_waitcnt lgkmcnt(4)
bl v11,s[32:35],s79 offen lds
mm a[64:67],v[64:67],v[176:179],a[64:67]
dt v[80:81],v13 offset:37056
mm a[64:67],v[68:71],v[208:211],a[64:67]
s_add_u32 m0,s71,135168
mm a[68:71],v[64:67],v[180:183],a[68:71]
dt v[82:83],v13 offset:41664
mm a[68:71],v[68:71],v[212:215],a[68:71]
bl v12,s[32:35],s79 offen lds
mm a[72:75],v[64:67],v[184:187],a[72:75]
dt v[84:85],v13 offset:46272
mm a[72:75],v[68:71],v[216:219],a[72:75]
s_bfe_u32 s82,s81,0x4001c
s_lshl_b32 s82,s82,12
s_add_u32 s82,s82,s68
mm a[76:79],v[64:67],v[188:191],a[76:79]
dt v[86:87],v13 offset:50880
mm a[76:79],v[68:71],v[220:223],a[76:79]
s_waitcnt lgkmcnt(4)
bl v[224:227],v60,s[8:11],s82 offen offset:0 sc1
mm a[80:83],v[72:75],v[176:179],a[80:83]
dt v[88:89],v13 offset:37088
mm a[80:83],v[76:79],v[208:211],a[80:83]
mm a[84:87],v[72:75],v[180:183],a[84:87]
dt v[90:91],v13 offset:41696
mm a[84:87],v[76:79],v[212:215],a[84:87]
bl v[228:231],v61,s[8:11],s82 offen offset:0 sc1
mm a[88:91],v[72:75],v[184:187],a[88:91]
dt v[92:93],v13 offset:46304
mm a[88:91],v[76:79],v[216:219],a[88:91]
mm a[92:95],v[72:75],v[188:191],a[92:95]
dt v[94:95],v13 offset:50912
mm a[92:95],v[76:79],v[220:223],a[92:95]
s_waitcnt lgkmcnt(4)
mm a[96:99],v[80:83],v[176:179],a[96:99]
dt v[64:65],v13 offset:37120
mm a[96:99],v[84:87],v[208:211],a[96:99]
bl v[232:235],v62,s[8:11],s82 offen offset:0 sc1
mm a[100:103],v[80:83],v[180:183],a[100:103]
dt v[66:67],v13 offset:41728
mm a[100:103],v[84:87],v[212:215],a[100:103]
mm a[104:107],v[80:83],v[184:187],a[104:107]
dt v[68:69],v13 offset:46336
mm a[104:107],v[84:87],v[216:219],a[104:107]
bl v[236:239],v63,s[8:11],s82 offen offset:0 sc1
mm a[108:111],v[80:83],v[188:191],a[108:111]
dt v[70:71],v13 offset:50944
mm a[108:111],v[84:87],v[220:223],a[108:111]
s_waitcnt lgkmcnt(4)
mm a[112:115],v[88:91],v[176:179],a[112:115]
dt v[72:73],v13 offset:55296
mm a[112:115],v[92:95],v[208:211],a[112:115]
bl v[240:243],v60,s[8:11],s82 offen offset:1024 sc1
mm a[116:119],v[88:91],v[180:183],a[116:119]
dt v[74:75],v13 offset:59904
mm a[116:119],v[92:95],v[212:215],a[116:119]
mm a[120:123],v[88:91],v[184:187],a[120:123]
dt v[76:77],v13 offset:64512
mm a[120:123],v[92:95],v[216:219],a[120:123]
bl v[244:247],v61,s[8:11],s82 offen offset:1024 sc1
mm a[124:127],v[88:91],v[188:191],a[124:127]
dt v[78:79],v14 offset:3584
mm a[124:127],v[92:95],v[220:223],a[124:127]
s_waitcnt lgkmcnt(4)
mm a[128:131],v[64:67],v[176:179],a[128:131]
dt v[80:81],v13 offset:55328
mm a[128:131],v[68:71],v[208:211],a[128:131]
bl v[248:251],v62,s[8:11],s82 offen offset:1024 sc1
mm a[132:135],v[64:67],v[180:183],a[132:135]
dt v[82:83],v13 offset:59936
mm a[132:135],v[68:71],v[212:215],a[132:135]
mm a[136:139],v[64:67],v[184:187],a[136:139]
dt v[84:85],v13 offset:64544
mm a[136:139],v[68:71],v[216:219],a[136:139]
mm a[140:143],v[64:67],v[188:191],a[140:143]
dt v[86:87],v14 offset:3616
mm a[140:143],v[68:71],v[220:223],a[140:143]
s_waitcnt vmcnt(42) lgkmcnt(4)
bl v[252:255],v63,s[8:11],s82 offen offset:1024 sc1
mm a[0:3],v[72:75],a[192:195],a[0:3]
dt v[88:89],v13 offset:55360
mm a[0:3],v[76:79],a[208:211],a[0:3]
mm a[4:7],v[72:75],a[196:199],a[4:7]
dt v[90:91],v13 offset:59968
mm a[4:7],v[76:79],a[212:215],a[4:7]
bl a[144:147],v60,s[8:11],s82 offen offset:2048 sc1
mm a[8:11],v[72:75],a[200:203],a[8:11]
dt v[92:93],v13 offset:64576
mm a[8:11],v[76:79],a[216:219],a[8:11]
mm a[12:15],v[72:75],a[204:207],a[12:15]
dt v[94:95],v14 offset:3648
mm a[12:15],v[76:79],a[220:223],a[12:15]
s_waitcnt lgkmcnt(4)
bl a[148:151],v61,s[8:11],s82 offen offset:2048 sc1
mm a[16:19],v[80:83],a[192:195],a[16:19]
dt v[64:65],v13 offset:55392
mm a[16:19],v[84:87],a[208:211],a[16:19]
mm a[20:23],v[80:83],a[196:199],a[20:23]
dt v[66:67],v13 offset:60000
mm a[20:23],v[84:87],a[212:215],a[20:23]
bl a[152:155],v62,s[8:11],s82 offen offset:2048 sc1
mm a[24:27],v[80:83],a[200:203],a[24:27]
dt v[68:69],v13 offset:64608
mm a[24:27],v[84:87],a[216:219],a[24:27]
mm a[28:31],v[80:83],a[204:207],a[28:31]
dt v[70:71],v14 offset:3680
mm a[28:31],v[84:87],a[220:223],a[28:31]
s_waitcnt lgkmcnt(4)
bl a[156:159],v63,s[8:11],s82 offen offset:2048 sc1
mm a[32:35],v[88:91],a[192:195],a[32:35]
dt v[72:73],v13 offset:55424
mm a[32:35],v[92:95],a[208:211],a[32:35]
mm a[36:39],v[88:91],a[196:199],a[36:39]
dt v[74:75],v13 offset:60032
mm a[36:39],v[92:95],a[212:215],a[36:39]
mm a[40:43],v[88:91],a[200:203],a[40:43]
dt v[76:77],v13 offset:64640
mm a[40:43],v[92:95],a[216:219],a[40:43]
bl a[160:163],v60,s[8:11],s82 offen offset:3072 sc1
mm a[44:47],v[88:91],a[204:207],a[44:47]
dt v[78:79],v14 offset:3712
mm a[44:47],v[92:95],a[220:223],a[44:47]
s_waitcnt lgkmcnt(4)
mm a[48:51],v[64:67],a[192:195],a[48:51]
dt v[80:81],v13 offset:55456
mm a[48:51],v[68:71],a[208:211],a[48:51]
bl a[164:167],v61,s[8:11],s82 offen offset:3072 sc1
mm a[52:55],v[64:67],a[196:199],a[52:55]
dt v[82:83],v13 offset:60064
mm a[52:55],v[68:71],a[212:215],a[52:55]
mm a[56:59],v[64:67],a[200:203],a[56:59]
dt v[84:85],v13 offset:64672
mm a[56:59],v[68:71],a[216:219],a[56:59]
bl a[168:171],v62,s[8:11],s82 offen offset:3072 sc1
mm a[60:63],v[64:67],a[204:207],a[60:63]
dt v[86:87],v14 offset:3744
mm a[60:63],v[68:71],a[220:223],a[60:63]
s_waitcnt lgkmcnt(4)
mm a[64:67],v[72:75],a[192:195],a[64:67]
dt v[88:89],v13 offset:55488
mm a[64:67],v[76:79],a[208:211],a[64:67]
bl a[172:175],v63,s[8:11],s82 offen offset:3072 sc1
mm a[68:71],v[72:75],a[196:199],a[68:71]
dt v[90:91],v13 offset:60096
mm a[68:71],v[76:79],a[212:215],a[68:71]
mm a[72:75],v[72:75],a[200:203],a[72:75]
dt v[92:93],v13 offset:64704
mm a[72:75],v[76:79],a[216:219],a[72:75]
mm a[76:79],v[72:75],a[204:207],a[76:79]
dt v[94:95],v14 offset:3776
mm a[76:79],v[76:79],a[220:223],a[76:79]
s_waitcnt lgkmcnt(4)
mm a[80:83],v[80:83],a[192:195],a[80:83]
dt v[64:65],v13 offset:55520
mm a[80:83],v[84:87],a[208:211],a[80:83]
mm a[84:87],v[80:83],a[196:199],a[84:87]
dt v[66:67],v13 offset:60128
mm a[84:87],v[84:87],a[212:215],a[84:87]
mm a[88:91],v[80:83],a[200:203],a[88:91]
dt v[68:69],v13 offset:64736
mm a[88:91],v[84:87],a[216:219],a[88:91]
mm a[92:95],v[80:83],a[204:207],a[92:95]
dt v[70:71],v14 offset:3808
mm a[92:95],v[84:87],a[220:223],a[92:95]
s_waitcnt lgkmcnt(4)
mm a[96:99],v[88:91],a[192:195],a[96:99]
dt v[72:73],v13 offset:55552
mm a[96:99],v[92:95],a[208:211],a[96:99]
mm a[100:103],v[88:91],a[196:199],a[100:103]
dt v[74:75],v13 offset:60160
mm a[100:103],v[92:95],a[212:215],a[100:103]
mm a[104:107],v[88:91],a[200:203],a[104:107]
dt v[76:77],v13 offset:64768
mm a[104:107],v[92:95],a[216:219],a[104:107]
mm a[108:111],v[88:91],a[204:207],a[108:111]
dt v[78:79],v14 offset:3840
mm a[108:111],v[92:95],a[220:223],a[108:111]
s_waitcnt lgkmcnt(4)
s_waitcnt vmcnt(16)
mm a[112:115],v[64:67],a[192:195],a[112:115]
s_barrier
dt v[80:81],v13 offset:0
mm a[112:115],v[68:71],a[208:211],a[112:115]
mm a[116:119],v[64:67],a[196:199],a[116:119]
dt v[82:83],v13 offset:4608
mm a[116:119],v[68:71],a[212:215],a[116:119]
mm a[120:123],v[64:67],a[200:203],a[120:123]
dt v[84:85],v13 offset:9216
mm a[120:123],v[68:71],a[216:219],a[120:123]
mm a[124:127],v[64:67],a[204:207],a[124:127]
dt v[86:87],v13 offset:13824
mm a[124:127],v[68:71],a[220:223],a[124:127]
s_waitcnt lgkmcnt(4)
mm a[128:131],v[72:75],a[192:195],a[128:131]
dt v[88:89],v13 offset:18432
mm a[128:131],v[76:79],a[208:211],a[128:131]
mm a[132:135],v[72:75],a[196:199],a[132:135]
dt v[90:91],v13 offset:23040
mm a[132:135],v[76:79],a[212:215],a[132:135]
mm a[136:139],v[72:75],a[200:203],a[136:139]
dt v[92:93],v13 offset:27648
mm a[136:139],v[76:79],a[216:219],a[136:139]
mm a[140:143],v[72:75],a[204:207],a[140:143]
dt v[94:95],v13 offset:32256
mm a[140:143],v[76:79],a[220:223],a[140:143]
s_waitcnt lgkmcnt(4)
mm a[0:3],v[80:83],a[224:227],a[0:3]
dt v[64:65],v14 offset:45056
mm a[0:3],v[84:87],a[240:243],a[0:3]
mm a[4:7],v[80:83],a[228:231],a[4:7]
dt v[66:67],v14 offset:49664
v_bfe_u32 v18,v2,4,2
mm a[4:7],v[84:87],a[244:247],a[4:7]
mm a[8:11],v[80:83],a[232:235],a[8:11]
dt v[68:69],v14 offset:54272
mm a[8:11],v[84:87],a[248:251],a[8:11]
v_bfe_u32 v19,v2,6,1
mm a[12:15],v[80:83],a[236:239],a[12:15]
dt v[70:71],v14 offset:58880
mm a[12:15],v[84:87],a[252:255],a[12:15]
s_waitcnt lgkmcnt(4)
mm a[0:3],v[88:91],v[160:163],a[0:3]
dt v[72:73],v14 offset:63488
mm a[0:3],v[92:95],v[192:195],a[0:3]
v_lshlrev_b32 v18,10,v18
mm a[4:7],v[88:91],v[164:167],a[4:7]
dt v[74:75],v15 offset:2560
mm a[4:7],v[92:95],v[196:199],a[4:7]
mm a[8:11],v[88:91],v[168:171],a[8:11]
dt v[76:77],v15 offset:7168
mm a[8:11],v[92:95],v[200:203],a[8:11]
v_lshl_add_u32 v3,v19,7,v18
mm a[12:15],v[88:91],v[172:175],a[12:15]
dt v[78:79],v15 offset:11776
mm a[12:15],v[92:95],v[204:207],a[12:15]
s_waitcnt vmcnt(8) lgkmcnt(4)
s_mov_b32 s12,s64
s_and_b32 s13,s65,0xffff
mm a[0:3],v[64:67],v[224:227],a[0:3]
s_mov_b32 s14,2359296
s_mov_b32 s15,0x20000
dt v[80:81],v13 offset:32
mm a[0:3],v[68:71],v[240:243],a[0:3]
s_mov_b32 s16,s66
s_and_b32 s17,s67,0xffff
s_mov_b32 s18,2359296
mm a[4:7],v[64:67],v[228:231],a[4:7]
s_mov_b32 s19,0x20000
dt v[82:83],v13 offset:4640
v_lshrrev_b32 v18,4,v2
mm a[4:7],v[68:71],v[244:247],a[4:7]
mm a[8:11],v[64:67],v[232:235],a[8:11]
dt v[84:85],v13 offset:9248
mm a[8:11],v[68:71],v[248:251],a[8:11]
v_and_b32 v19,15,v18
mm a[12:15],v[64:67],v[236:239],a[12:15]
dt v[86:87],v13 offset:13856
mm a[12:15],v[68:71],v[252:255],a[12:15]
s_waitcnt vmcnt(0) lgkmcnt(4)
s_movk_i32 s44,1152
mm a[0:3],v[72:75],a[144:147],a[0:3]
dt v[88:89],v13 offset:18464
mm a[0:3],v[76:79],a[160:163],a[0:3]
v_mul_lo_u32 v19,v19,s44
mm a[4:7],v[72:75],a[148:151],a[4:7]
dt v[90:91],v13 offset:23072
mm a[4:7],v[76:79],a[164:167],a[4:7]
mm a[8:11],v[72:75],a[152:155],a[8:11]
dt v[92:93],v13 offset:27680
v_lshrrev_b32 v18,4,v18
mm a[8:11],v[76:79],a[168:171],a[8:11]
mm a[12:15],v[72:75],a[156:159],a[12:15]
dt v[94:95],v13 offset:32288
mm a[12:15],v[76:79],a[172:175],a[12:15]
s_waitcnt lgkmcnt(4)
mm a[16:19],v[80:83],a[224:227],a[16:19]
dt v[64:65],v14 offset:45088
v_lshl_add_u32 v16,v18,3,v19
mm a[16:19],v[84:87],a[240:243],a[16:19]
mm a[20:23],v[80:83],a[228:231],a[20:23]
dt v[66:67],v14 offset:49696
mm a[20:23],v[84:87],a[244:247],a[20:23]
mm a[24:27],v[80:83],a[232:235],a[24:27]
dt v[68:69],v14 offset:54304
v_add_u32 v17,18432,v16
mm a[24:27],v[84:87],a[248:251],a[24:27]
ar v32,a0
ar v33,a1
mm a[28:31],v[80:83],a[236:239],a[28:31]
dt v[70:71],v14 offset:58912
ar v34,a2
mm a[28:31],v[84:87],a[252:255],a[28:31]
s_waitcnt lgkmcnt(4)
ar v35,a3
mm a[16:19],v[88:91],v[160:163],a[16:19]
dt v[72:73],v14 offset:63520
ar v36,a4
mm a[16:19],v[92:95],v[192:195],a[16:19]
ar v37,a5
mm a[20:23],v[88:91],v[164:167],a[20:23]
dt v[74:75],v15 offset:2592
ar v38,a6
mm a[20:23],v[92:95],v[196:199],a[20:23]
ar v39,a7
mm a[24:27],v[88:91],v[168:171],a[24:27]
dt v[76:77],v15 offset:7200
cv v40,v32,v33
mm a[24:27],v[92:95],v[200:203],a[24:27]
s_mul_i32 s45,s80,576
s_lshr_b32 s46,s7,1
cv v41,v34,v35
mm a[28:31],v[88:91],v[172:175],a[28:31]
s_mul_i32 s46,s46,18
dt v[78:79],v15 offset:11808
cv v42,v36,v37
mm a[28:31],v[92:95],v[204:207],a[28:31]
s_waitcnt lgkmcnt(4)
s_add_u32 s45,s45,s46
cv v43,v38,v39
mm a[16:19],v[64:67],v[224:227],a[16:19]
s_and_b32 s46,s7,1
s_add_u32 s45,s45,s46
dt v[80:81],v13 offset:64
mm a[16:19],v[68:71],v[240:243],a[16:19]
s_lshl_b32 s46,s3,1
buffer_store_dwordx4 v[40:43],v2,s[8:11],s77 offen offset:0 sc1
mm a[20:23],v[64:67],v[228:231],a[20:23]
s_add_u32 s45,s45,s46
dt v[82:83],v13 offset:4672
ar v44,a8
mm a[20:23],v[68:71],v[244:247],a[20:23]
s_lshl_b32 s45,s45,10
s_add_u32 s38,s45,46137344
ar v45,a9
mm a[24:27],v[64:67],v[232:235],a[24:27]
s_lshl_b32 s45,s4,3
dt v[84:85],v13 offset:9280
ar v46,a10
mm a[24:27],v[68:71],v[248:251],a[24:27]
s_add_u32 s45,s45,s7
s_mul_i32 s45,s45,36864
ar v47,a11
mm a[28:31],v[64:67],v[236:239],a[28:31]
s_and_b32 s46,s80,3
dt v[86:87],v13 offset:13888
ar v48,a12
mm a[28:31],v[68:71],v[252:255],a[28:31]
s_waitcnt lgkmcnt(4)
s_mul_i32 s46,s46,288
ar v49,a13
mm a[16:19],v[72:75],a[144:147],a[16:19]
s_add_u32 s45,s45,s46
dt v[88:89],v13 offset:18496
ar v50,a14
mm a[16:19],v[76:79],a[160:163],a[16:19]
s_lshl_b32 s46,s3,5
s_add_u32 s41,s45,s46
ar v51,a15
mm a[20:23],v[72:75],a[148:151],a[20:23]
s_cmp_eq_u32 s3,0
s_cselect_b32 s46,0,0x10000000
dt v[90:91],v13 offset:23104
cv v52,v44,v45
mm a[20:23],v[76:79],a[164:167],a[20:23]
s_add_u32 s39,s38,s46
s_add_u32 s39,s39,16384
cv v53,v46,v47
mm a[24:27],v[72:75],a[152:155],a[24:27]
s_add_u32 s42,s41,s46
dt v[92:93],v13 offset:27712
cv v54,v48,v49
mm a[24:27],v[76:79],a[168:171],a[24:27]
s_add_u32 s42,s42,256
s_add_u32 s40,s38,8192
cv v55,v50,v51
mm a[28:31],v[72:75],a[156:159],a[28:31]
s_add_u32 s43,s41,128
dt v[94:95],v13 offset:32320
mm a[28:31],v[76:79],a[172:175],a[28:31]
s_waitcnt lgkmcnt(4)
buffer_store_dwordx4 v[52:55],v2,s[8:11],s78 offen offset:0 sc1
mm a[32:35],v[80:83],a[224:227],a[32:35]
dt v[64:65],v14 offset:45120
mm a[32:35],v[84:87],a[240:243],a[32:35]
buffer_load_dwordx2 v[20:21],v16,s[12:15],s41 offen
mm a[36:39],v[80:83],a[228:231],a[36:39]
dt v[66:67],v14 offset:49728
mm a[36:39],v[84:87],a[244:247],a[36:39]
buffer_load_dwordx2 v[22:23],v17,s[12:15],s41 offen
mm a[40:43],v[80:83],a[232:235],a[40:43]
dt v[68:69],v14 offset:54336
mm a[40:43],v[84:87],a[248:251],a[40:43]
ar v32,a16
ar v33,a17
mm a[44:47],v[80:83],a[236:239],a[44:47]
dt v[70:71],v14 offset:58944
ar v34,a18
mm a[44:47],v[84:87],a[252:255],a[44:47]
s_waitcnt lgkmcnt(4)
ar v35,a19
mm a[32:35],v[88:91],v[160:163],a[32:35]
dt v[72:73],v14 offset:63552
ar v36,a20
mm a[32:35],v[92:95],v[192:195],a[32:35]
ar v37,a21
mm a[36:39],v[88:91],v[164:167],a[36:39]
dt v[74:75],v15 offset:2624
ar v38,a22
mm a[36:39],v[92:95],v[196:199],a[36:39]
ar v39,a23
mm a[40:43],v[88:91],v[168:171],a[40:43]
dt v[76:77],v15 offset:7232
cv v40,v32,v33
mm a[40:43],v[92:95],v[200:203],a[40:43]
cv v41,v34,v35
mm a[44:47],v[88:91],v[172:175],a[44:47]
dt v[78:79],v15 offset:11840
cv v42,v36,v37
mm a[44:47],v[92:95],v[204:207],a[44:47]
s_waitcnt lgkmcnt(4)
cv v43,v38,v39
mm a[32:35],v[64:67],v[224:227],a[32:35]
dt v[80:81],v13 offset:96
mm a[32:35],v[68:71],v[240:243],a[32:35]
buffer_store_dwordx4 v[40:43],v2,s[8:11],s77 offen offset:2048 sc1
mm a[36:39],v[64:67],v[228:231],a[36:39]
dt v[82:83],v13 offset:4704
ar v44,a24
mm a[36:39],v[68:71],v[244:247],a[36:39]
ar v45,a25
mm a[40:43],v[64:67],v[232:235],a[40:43]
dt v[84:85],v13 offset:9312
ar v46,a26
mm a[40:43],v[68:71],v[248:251],a[40:43]
buffer_load_dwordx2 v[24:25],v16,s[12:15],s42 offen
ar v47,a27
mm a[44:47],v[64:67],v[236:239],a[44:47]
dt v[86:87],v13 offset:13920
ar v48,a28
mm a[44:47],v[68:71],v[252:255],a[44:47]
s_waitcnt lgkmcnt(4)
ar v49,a29
mm a[32:35],v[72:75],a[144:147],a[32:35]
dt v[88:89],v13 offset:18528
ar v50,a30
mm a[32:35],v[76:79],a[160:163],a[32:35]
ar v51,a31
mm a[36:39],v[72:75],a[148:151],a[36:39]
dt v[90:91],v13 offset:23136
cv v52,v44,v45
mm a[36:39],v[76:79],a[164:167],a[36:39]
cv v53,v46,v47
mm a[40:43],v[72:75],a[152:155],a[40:43]
dt v[92:93],v13 offset:27744
cv v54,v48,v49
mm a[40:43],v[76:79],a[168:171],a[40:43]
cv v55,v50,v51
mm a[44:47],v[72:75],a[156:159],a[44:47]
dt v[94:95],v13 offset:32352
mm a[44:47],v[76:79],a[172:175],a[44:47]
s_waitcnt lgkmcnt(4)
buffer_store_dwordx4 v[52:55],v2,s[8:11],s78 offen offset:2048 sc1
mm a[48:51],v[80:83],a[224:227],a[48:51]
dt v[64:65],v14 offset:45152
mm a[48:51],v[84:87],a[240:243],a[48:51]
mm a[52:55],v[80:83],a[228:231],a[52:55]
dt v[66:67],v14 offset:49760
mm a[52:55],v[84:87],a[244:247],a[52:55]
buffer_load_dwordx2 v[26:27],v17,s[12:15],s42 offen
mm a[56:59],v[80:83],a[232:235],a[56:59]
dt v[68:69],v14 offset:54368
mm a[56:59],v[84:87],a[248:251],a[56:59]
ar v32,a32
ar v33,a33
mm a[60:63],v[80:83],a[236:239],a[60:63]
dt v[70:71],v14 offset:58976
ar v34,a34
mm a[60:63],v[84:87],a[252:255],a[60:63]
s_waitcnt lgkmcnt(4)
ar v35,a35
mm a[48:51],v[88:91],v[160:163],a[48:51]
dt v[72:73],v14 offset:63584
ar v36,a36
mm a[48:51],v[92:95],v[192:195],a[48:51]
ar v37,a37
mm a[52:55],v[88:91],v[164:167],a[52:55]
dt v[74:75],v15 offset:2656
ar v38,a38
mm a[52:55],v[92:95],v[196:199],a[52:55]
ar v39,a39
mm a[56:59],v[88:91],v[168:171],a[56:59]
dt v[76:77],v15 offset:7264
cv v40,v32,v33
mm a[56:59],v[92:95],v[200:203],a[56:59]
cv v41,v34,v35
mm a[60:63],v[88:91],v[172:175],a[60:63]
dt v[78:79],v15 offset:11872
cv v42,v36,v37
mm a[60:63],v[92:95],v[204:207],a[60:63]
s_waitcnt lgkmcnt(4)
cv v43,v38,v39
mm a[48:51],v[64:67],v[224:227],a[48:51]
s_add_u32 s77,s77,4096
dt v[80:81],v13 offset:128
mm a[48:51],v[68:71],v[240:243],a[48:51]
buffer_store_dwordx4 v[40:43],v2,s[8:11],s77 offen offset:0 sc1
mm a[52:55],v[64:67],v[228:231],a[52:55]
dt v[82:83],v13 offset:4736
ar v44,a40
mm a[52:55],v[68:71],v[244:247],a[52:55]
ar v45,a41
mm a[56:59],v[64:67],v[232:235],a[56:59]
dt v[84:85],v13 offset:9344
ar v46,a42
mm a[56:59],v[68:71],v[248:251],a[56:59]
ar v47,a43
mm a[60:63],v[64:67],v[236:239],a[60:63]
dt v[86:87],v13 offset:13952
ar v48,a44
mm a[60:63],v[68:71],v[252:255],a[60:63]
s_waitcnt lgkmcnt(4)
ar v49,a45
mm a[48:51],v[72:75],a[144:147],a[48:51]
dt v[88:89],v13 offset:18560
ar v50,a46
mm a[48:51],v[76:79],a[160:163],a[48:51]
ar v51,a47
mm a[52:55],v[72:75],a[148:151],a[52:55]
dt v[90:91],v13 offset:23168
cv v52,v44,v45
mm a[52:55],v[76:79],a[164:167],a[52:55]
cv v53,v46,v47
mm a[56:59],v[72:75],a[152:155],a[56:59]
dt v[92:93],v13 offset:27776
cv v54,v48,v49
mm a[56:59],v[76:79],a[168:171],a[56:59]
cv v55,v50,v51
mm a[60:63],v[72:75],a[156:159],a[60:63]
s_add_u32 s78,s78,4096
dt v[94:95],v13 offset:32384
mm a[60:63],v[76:79],a[172:175],a[60:63]
s_waitcnt lgkmcnt(4)
buffer_store_dwordx4 v[52:55],v2,s[8:11],s78 offen offset:0 sc1
mm a[64:67],v[80:83],a[224:227],a[64:67]
dt v[64:65],v14 offset:45184
mm a[64:67],v[84:87],a[240:243],a[64:67]
buffer_load_dwordx2 v[28:29],v16,s[12:15],s43 offen
mm a[68:71],v[80:83],a[228:231],a[68:71]
dt v[66:67],v14 offset:49792
mm a[68:71],v[84:87],a[244:247],a[68:71]
mm a[72:75],v[80:83],a[232:235],a[72:75]
dt v[68:69],v14 offset:54400
mm a[72:75],v[84:87],a[248:251],a[72:75]
ar v32,a48
ar v33,a49
mm a[76:79],v[80:83],a[236:239],a[76:79]
dt v[70:71],v14 offset:59008
ar v34,a50
mm a[76:79],v[84:87],a[252:255],a[76:79]
s_waitcnt lgkmcnt(4)
ar v35,a51
mm a[64:67],v[88:91],v[160:163],a[64:67]
dt v[72:73],v14 offset:63616
ar v36,a52
mm a[64:67],v[92:95],v[192:195],a[64:67]
buffer_load_dwordx2 v[30:31],v17,s[12:15],s43 offen
ar v37,a53
mm a[68:71],v[88:91],v[164:167],a[68:71]
dt v[74:75],v15 offset:2688
ar v38,a54
mm a[68:71],v[92:95],v[196:199],a[68:71]
ar v39,a55
mm a[72:75],v[88:91],v[168:171],a[72:75]
dt v[76:77],v15 offset:7296
cv v40,v32,v33
mm a[72:75],v[92:95],v[200:203],a[72:75]
cv v41,v34,v35
mm a[76:79],v[88:91],v[172:175],a[76:79]
dt v[78:79],v15 offset:11904
cv v42,v36,v37
mm a[76:79],v[92:95],v[204:207],a[76:79]
s_waitcnt lgkmcnt(4)
cv v43,v38,v39
mm a[64:67],v[64:67],v[224:227],a[64:67]
dt v[80:81],v13 offset:160
mm a[64:67],v[68:71],v[240:243],a[64:67]
buffer_store_dwordx4 v[40:43],v2,s[8:11],s77 offen offset:2048 sc1
mm a[68:71],v[64:67],v[228:231],a[68:71]
dt v[82:83],v13 offset:4768
ar v44,a56
mm a[68:71],v[68:71],v[244:247],a[68:71]
ar v45,a57
mm a[72:75],v[64:67],v[232:235],a[72:75]
dt v[84:85],v13 offset:9376
ar v46,a58
mm a[72:75],v[68:71],v[248:251],a[72:75]
ar v47,a59
mm a[76:79],v[64:67],v[236:239],a[76:79]
dt v[86:87],v13 offset:13984
ar v48,a60
mm a[76:79],v[68:71],v[252:255],a[76:79]
s_waitcnt lgkmcnt(4)
ar v49,a61
mm a[64:67],v[72:75],a[144:147],a[64:67]
dt v[88:89],v13 offset:18592
ar v50,a62
mm a[64:67],v[76:79],a[160:163],a[64:67]
ar v51,a63
mm a[68:71],v[72:75],a[148:151],a[68:71]
dt v[90:91],v13 offset:23200
cv v52,v44,v45
mm a[68:71],v[76:79],a[164:167],a[68:71]
cv v53,v46,v47
mm a[72:75],v[72:75],a[152:155],a[72:75]
dt v[92:93],v13 offset:27808
cv v54,v48,v49
mm a[72:75],v[76:79],a[168:171],a[72:75]
cv v55,v50,v51
mm a[76:79],v[72:75],a[156:159],a[76:79]
dt v[94:95],v13 offset:32416
mm a[76:79],v[76:79],a[172:175],a[76:79]
s_waitcnt lgkmcnt(4)
buffer_store_dwordx4 v[52:55],v2,s[8:11],s78 offen offset:2048 sc1
mm a[80:83],v[80:83],a[224:227],a[80:83]
dt v[64:65],v14 offset:45216
mm a[80:83],v[84:87],a[240:243],a[80:83]
mm a[84:87],v[80:83],a[228:231],a[84:87]
dt v[66:67],v14 offset:49824
mm a[84:87],v[84:87],a[244:247],a[84:87]
mm a[88:91],v[80:83],a[232:235],a[88:91]
dt v[68:69],v14 offset:54432
mm a[88:91],v[84:87],a[248:251],a[88:91]
ar v32,a64
ar v33,a65
mm a[92:95],v[80:83],a[236:239],a[92:95]
dt v[70:71],v14 offset:59040
ar v34,a66
mm a[92:95],v[84:87],a[252:255],a[92:95]
s_waitcnt lgkmcnt(4)
ar v35,a67
mm a[80:83],v[88:91],v[160:163],a[80:83]
dt v[72:73],v14 offset:63648
ar v36,a68
mm a[80:83],v[92:95],v[192:195],a[80:83]
ar v37,a69
mm a[84:87],v[88:91],v[164:167],a[84:87]
dt v[74:75],v15 offset:2720
ar v38,a70
mm a[84:87],v[92:95],v[196:199],a[84:87]
ar v39,a71
mm a[88:91],v[88:91],v[168:171],a[88:91]
dt v[76:77],v15 offset:7328
cv v40,v32,v33
mm a[88:91],v[92:95],v[200:203],a[88:91]
cv v41,v34,v35
mm a[92:95],v[88:91],v[172:175],a[92:95]
dt v[78:79],v15 offset:11936
cv v42,v36,v37
mm a[92:95],v[92:95],v[204:207],a[92:95]
s_waitcnt lgkmcnt(4)
s_waitcnt vmcnt(0)
cv v43,v38,v39
mm a[80:83],v[64:67],v[224:227],a[80:83]
s_add_u32 s77,s77,4096
s_barrier
dt v[80:81],v13 offset:192
mm a[80:83],v[68:71],v[240:243],a[80:83]
buffer_store_dwordx4 v[40:43],v2,s[8:11],s77 offen offset:0 sc1
buffer_store_dword v1,off,s[8:11],s74 offset:24 sc1
mm a[84:87],v[64:67],v[228:231],a[84:87]
dt v[82:83],v13 offset:4800
ar v44,a72
mm a[84:87],v[68:71],v[244:247],a[84:87]
ar v45,a73
mm a[88:91],v[64:67],v[232:235],a[88:91]
dt v[84:85],v13 offset:9408
ar v46,a74
mm a[88:91],v[68:71],v[248:251],a[88:91]
ar v47,a75
mm a[92:95],v[64:67],v[236:239],a[92:95]
dt v[86:87],v13 offset:14016
ar v48,a76
mm a[92:95],v[68:71],v[252:255],a[92:95]
s_waitcnt lgkmcnt(4)
ar v49,a77
mm a[80:83],v[72:75],a[144:147],a[80:83]
dt v[88:89],v13 offset:18624
ar v50,a78
mm a[80:83],v[76:79],a[160:163],a[80:83]
ar v51,a79
mm a[84:87],v[72:75],a[148:151],a[84:87]
dt v[90:91],v13 offset:23232
cv v52,v44,v45
mm a[84:87],v[76:79],a[164:167],a[84:87]
cv v53,v46,v47
mm a[88:91],v[72:75],a[152:155],a[88:91]
dt v[92:93],v13 offset:27840
cv v54,v48,v49
mm a[88:91],v[76:79],a[168:171],a[88:91]
cv v55,v50,v51
mm a[92:95],v[72:75],a[156:159],a[92:95]
s_add_u32 s78,s78,4096
dt v[94:95],v13 offset:32448
mm a[92:95],v[76:79],a[172:175],a[92:95]
s_waitcnt lgkmcnt(4)
buffer_store_dwordx4 v[52:55],v2,s[8:11],s78 offen offset:0 sc1
mm a[96:99],v[80:83],a[224:227],a[96:99]
dt v[64:65],v14 offset:45248
mm a[96:99],v[84:87],a[240:243],a[96:99]
mm a[100:103],v[80:83],a[228:231],a[100:103]
dt v[66:67],v14 offset:49856
mm a[100:103],v[84:87],a[244:247],a[100:103]
mm a[104:107],v[80:83],a[232:235],a[104:107]
dt v[68:69],v14 offset:54464
mm a[104:107],v[84:87],a[248:251],a[104:107]
ar v32,a80
ar v33,a81
mm a[108:111],v[80:83],a[236:239],a[108:111]
dt v[70:71],v14 offset:59072
ar v34,a82
mm a[108:111],v[84:87],a[252:255],a[108:111]
s_waitcnt lgkmcnt(4)
ar v35,a83
mm a[96:99],v[88:91],v[160:163],a[96:99]
dt v[72:73],v14 offset:63680
ar v36,a84
mm a[96:99],v[92:95],v[192:195],a[96:99]
ar v37,a85
mm a[100:103],v[88:91],v[164:167],a[100:103]
dt v[74:75],v15 offset:2752
ar v38,a86
mm a[100:103],v[92:95],v[196:199],a[100:103]
ar v39,a87
mm a[104:107],v[88:91],v[168:171],a[104:107]
dt v[76:77],v15 offset:7360
buffer_load_dword v0,v3,s[8:11],s75 offen offset:24 sc1
cv v40,v32,v33
mm a[104:107],v[92:95],v[200:203],a[104:107]
cv v41,v34,v35
mm a[108:111],v[88:91],v[172:175],a[108:111]
dt v[78:79],v15 offset:11968
cv v42,v36,v37
mm a[108:111],v[92:95],v[204:207],a[108:111]
s_waitcnt lgkmcnt(4)
cv v43,v38,v39
mm a[96:99],v[64:67],v[224:227],a[96:99]
dt v[80:81],v13 offset:224
mm a[96:99],v[68:71],v[240:243],a[96:99]
buffer_store_dwordx4 v[40:43],v2,s[8:11],s77 offen offset:2048 sc1
mm a[100:103],v[64:67],v[228:231],a[100:103]
dt v[82:83],v13 offset:4832
ar v44,a88
mm a[100:103],v[68:71],v[244:247],a[100:103]
ar v45,a89
mm a[104:107],v[64:67],v[232:235],a[104:107]
dt v[84:85],v13 offset:9440
ar v46,a90
mm a[104:107],v[68:71],v[248:251],a[104:107]
ar v47,a91
mm a[108:111],v[64:67],v[236:239],a[108:111]
dt v[86:87],v13 offset:14048
ar v48,a92
mm a[108:111],v[68:71],v[252:255],a[108:111]
s_waitcnt lgkmcnt(4)
ar v49,a93
mm a[96:99],v[72:75],a[144:147],a[96:99]
dt v[88:89],v13 offset:18656
ar v50,a94
mm a[96:99],v[76:79],a[160:163],a[96:99]
ar v51,a95
mm a[100:103],v[72:75],a[148:151],a[100:103]
dt v[90:91],v13 offset:23264
cv v52,v44,v45
mm a[100:103],v[76:79],a[164:167],a[100:103]
cv v53,v46,v47
mm a[104:107],v[72:75],a[152:155],a[104:107]
dt v[92:93],v13 offset:27872
cv v54,v48,v49
mm a[104:107],v[76:79],a[168:171],a[104:107]
cv v55,v50,v51
mm a[108:111],v[72:75],a[156:159],a[108:111]
dt v[94:95],v13 offset:32480
mm a[108:111],v[76:79],a[172:175],a[108:111]
s_waitcnt lgkmcnt(4)
buffer_store_dwordx4 v[52:55],v2,s[8:11],s78 offen offset:2048 sc1
mm a[112:115],v[80:83],a[224:227],a[112:115]
dt v[64:65],v14 offset:45280
mm a[112:115],v[84:87],a[240:243],a[112:115]
mm a[116:119],v[80:83],a[228:231],a[116:119]
dt v[66:67],v14 offset:49888
mm a[116:119],v[84:87],a[244:247],a[116:119]
mm a[120:123],v[80:83],a[232:235],a[120:123]
dt v[68:69],v14 offset:54496
mm a[120:123],v[84:87],a[248:251],a[120:123]
ar v32,a96
ar v33,a97
mm a[124:127],v[80:83],a[236:239],a[124:127]
dt v[70:71],v14 offset:59104
ar v34,a98
mm a[124:127],v[84:87],a[252:255],a[124:127]
s_waitcnt lgkmcnt(4)
ar v35,a99
mm a[112:115],v[88:91],v[160:163],a[112:115]
dt v[72:73],v14 offset:63712
ar v36,a100
mm a[112:115],v[92:95],v[192:195],a[112:115]
ar v37,a101
mm a[116:119],v[88:91],v[164:167],a[116:119]
dt v[74:75],v15 offset:2784
ar v38,a102
mm a[116:119],v[92:95],v[196:199],a[116:119]
ar v39,a103
mm a[120:123],v[88:91],v[168:171],a[120:123]
dt v[76:77],v15 offset:7392
cv v40,v32,v33
mm a[120:123],v[92:95],v[200:203],a[120:123]
cv v41,v34,v35
mm a[124:127],v[88:91],v[172:175],a[124:127]
dt v[78:79],v15 offset:12000
cv v42,v36,v37
mm a[124:127],v[92:95],v[204:207],a[124:127]
s_waitcnt lgkmcnt(4)
cv v43,v38,v39
mm a[112:115],v[64:67],v[224:227],a[112:115]
s_add_u32 s77,s77,4096
dt v[80:81],v13 offset:256
mm a[112:115],v[68:71],v[240:243],a[112:115]
buffer_store_dwordx4 v[40:43],v2,s[8:11],s77 offen offset:0 sc1
mm a[116:119],v[64:67],v[228:231],a[116:119]
dt v[82:83],v13 offset:4864
ar v44,a104
mm a[116:119],v[68:71],v[244:247],a[116:119]
ar v45,a105
mm a[120:123],v[64:67],v[232:235],a[120:123]
dt v[84:85],v13 offset:9472
ar v46,a106
mm a[120:123],v[68:71],v[248:251],a[120:123]
ar v47,a107
mm a[124:127],v[64:67],v[236:239],a[124:127]
dt v[86:87],v13 offset:14080
ar v48,a108
mm a[124:127],v[68:71],v[252:255],a[124:127]
s_waitcnt lgkmcnt(4)
ar v49,a109
mm a[112:115],v[72:75],a[144:147],a[112:115]
dt v[88:89],v13 offset:18688
ar v50,a110
mm a[112:115],v[76:79],a[160:163],a[112:115]
ar v51,a111
mm a[116:119],v[72:75],a[148:151],a[116:119]
dt v[90:91],v13 offset:23296
cv v52,v44,v45
mm a[116:119],v[76:79],a[164:167],a[116:119]
cv v53,v46,v47
mm a[120:123],v[72:75],a[152:155],a[120:123]
dt v[92:93],v13 offset:27904
cv v54,v48,v49
mm a[120:123],v[76:79],a[168:171],a[120:123]
cv v55,v50,v51
mm a[124:127],v[72:75],a[156:159],a[124:127]
s_add_u32 s78,s78,4096
dt v[94:95],v13 offset:32512
mm a[124:127],v[76:79],a[172:175],a[124:127]
s_waitcnt lgkmcnt(4)
buffer_store_dwordx4 v[52:55],v2,s[8:11],s78 offen offset:0 sc1
mm a[128:131],v[80:83],a[224:227],a[128:131]
dt v[64:65],v14 offset:45312
mm a[128:131],v[84:87],a[240:243],a[128:131]
mm a[132:135],v[80:83],a[228:231],a[132:135]
dt v[66:67],v14 offset:49920
mm a[132:135],v[84:87],a[244:247],a[132:135]
mm a[136:139],v[80:83],a[232:235],a[136:139]
dt v[68:69],v14 offset:54528
mm a[136:139],v[84:87],a[248:251],a[136:139]
ar v32,a112
ar v33,a113
mm a[140:143],v[80:83],a[236:239],a[140:143]
dt v[70:71],v14 offset:59136
mm a[140:143],v[84:87],a[252:255],a[140:143]
s_waitcnt lgkmcnt(4)
ar v34,a114
mm a[128:131],v[88:91],v[160:163],a[128:131]
s_waitcnt vmcnt(4)
dt v[72:73],v14 offset:63744
ar v35,a115
v_cmp_ne_u32 vcc,v1,v0
mm a[128:131],v[92:95],v[192:195],a[128:131]
ar v36,a116
mm a[132:135],v[88:91],v[164:167],a[132:135]
s_cmp_eq_u64 vcc,0
s_cselect_b32 s47,0,0x10000000
s_add_u32 s45,s38,s47
dt v[74:75],v15 offset:2816
ar v37,a117
mm a[132:135],v[92:95],v[196:199],a[132:135]
bl v[96:99],v2,s[8:11],s45 offen sc1
ar v38,a118
mm a[136:139],v[88:91],v[168:171],a[136:139]
s_add_u32 s45,s45,73728
dt v[76:77],v15 offset:7424
bl v[100:103],v2,s[8:11],s45 offen sc1
mm a[136:139],v[92:95],v[200:203],a[136:139]
s_add_u32 s45,s45,73728
ar v39,a119
cv v40,v32,v33
mm a[140:143],v[88:91],v[172:175],a[140:143]
dt v[78:79],v15 offset:12032
mm a[140:143],v[92:95],v[204:207],a[140:143]
s_waitcnt lgkmcnt(4)
bl v[104:107],v2,s[8:11],s45 offen sc1
cv v41,v34,v35
mm a[128:131],v[64:67],v[224:227],a[128:131]
s_add_u32 s45,s45,73728
cv v42,v36,v37
mm a[128:131],v[68:71],v[240:243],a[128:131]
bl v[108:111],v2,s[8:11],s45 offen sc1
cv v43,v38,v39
mm a[132:135],v[64:67],v[228:231],a[132:135]
s_add_u32 s45,s45,73728
buffer_store_dwordx4 v[40:43],v2,s[8:11],s77 offen offset:2048 sc1
mm a[132:135],v[68:71],v[244:247],a[132:135]
ar v44,a120
mm a[136:139],v[64:67],v[232:235],a[136:139]
bl v[112:115],v2,s[8:11],s45 offen sc1
ar v45,a121
mm a[136:139],v[68:71],v[248:251],a[136:139]
s_add_u32 s45,s45,73728
ar v46,a122
mm a[140:143],v[64:67],v[236:239],a[140:143]
bl v[116:119],v2,s[8:11],s45 offen sc1
ar v47,a123
mm a[140:143],v[68:71],v[252:255],a[140:143]
s_waitcnt lgkmcnt(0)
s_add_u32 s45,s45,73728
ar v48,a124
mm a[128:131],v[72:75],a[144:147],a[128:131]
ar v49,a125
ar v50,a126
mm a[128:131],v[76:79],a[160:163],a[128:131]
bl v[120:123],v2,s[8:11],s45 offen sc1
ar v51,a127
mm a[132:135],v[72:75],a[148:151],a[132:135]
s_add_u32 s45,s45,73728
cv v52,v44,v45
mm a[132:135],v[76:79],a[164:167],a[132:135]
bl v[124:127],v2,s[8:11],s45 offen sc1
cv v53,v46,v47
mm a[136:139],v[72:75],a[152:155],a[136:139]
cv v54,v48,v49
mm a[136:139],v[76:79],a[168:171],a[136:139]
cv v55,v50,v51
mm a[140:143],v[72:75],a[156:159],a[140:143]
buffer_store_dwordx4 v[52:55],v2,s[8:11],s78 offen offset:2048 sc1
mm a[140:143],v[76:79],a[172:175],a[140:143]
s_nop 7
ar v32,a128
ar v33,a129
ar v34,a130
ar v35,a131
ar v36,a132
ar v37,a133
ar v38,a134
ar v39,a135
cv v40,v32,v33
cv v41,v34,v35
cv v42,v36,v37
cv v43,v38,v39
s_add_u32 s77,s77,4096
buffer_store_dwordx4 v[40:43],v2,s[8:11],s77 offen offset:0 sc1
ar v44,a136
ar v45,a137
ar v46,a138
ar v47,a139
ar v48,a140
ar v49,a141
ar v50,a142
ar v51,a143
cv v52,v44,v45
cv v53,v46,v47
cv v54,v48,v49
cv v55,v50,v51
s_add_u32 s78,s78,4096
buffer_store_dwordx4 v[52:55],v2,s[8:11],s78 offen offset:0 sc1
s_add_u32 s74,s74,4096
s_add_u32 s76,s75,4096
s_waitcnt vmcnt(0)
s_barrier
buffer_store_dword v1,off,s[8:11],s74 offset:28 sc1
s_cmp_eq_u32 s47,0
s_cbranch_scc1 L_have
s_branch L_spin_pa
L_ok_pa:
bl v[96:99],v2,s[8:11],s38 offen sc1
s_add_u32 s38,s38,73728
bl v[100:103],v2,s[8:11],s38 offen sc1
s_add_u32 s38,s38,73728
bl v[104:107],v2,s[8:11],s38 offen sc1
s_add_u32 s38,s38,73728
bl v[108:111],v2,s[8:11],s38 offen sc1
s_add_u32 s38,s38,73728
bl v[112:115],v2,s[8:11],s38 offen sc1
s_add_u32 s38,s38,73728
bl v[116:119],v2,s[8:11],s38 offen sc1
s_add_u32 s38,s38,73728
bl v[120:123],v2,s[8:11],s38 offen sc1
s_add_u32 s38,s38,73728
bl v[124:127],v2,s[8:11],s38 offen sc1
L_have:
s_cmp_eq_u32 s3,3
s_cselect_b32 s46,1,s47
s_cbranch_scc1 L_spin_pb
s_cmp_lg_u32 s47,0
s_cbranch_scc1 L_ok_pb
s_waitcnt vmcnt(6)
v_lshlrev_b32 v64,16,v96
v_and_b32 v65,0xffff0000,v96
v_lshlrev_b32 v66,16,v97
v_and_b32 v67,0xffff0000,v97
v_lshlrev_b32 v68,16,v98
v_and_b32 v69,0xffff0000,v98
v_lshlrev_b32 v70,16,v99
v_and_b32 v71,0xffff0000,v99
v_lshlrev_b32 v80,16,v100
v_and_b32 v81,0xffff0000,v100
v_lshlrev_b32 v82,16,v101
v_and_b32 v83,0xffff0000,v101
v_lshlrev_b32 v84,16,v102
v_and_b32 v85,0xffff0000,v102
v_lshlrev_b32 v86,16,v103
v_and_b32 v87,0xffff0000,v103
v_pk_add_f32 v[64:65],v[64:65],v[80:81]
v_pk_add_f32 v[66:67],v[66:67],v[82:83]
v_pk_add_f32 v[68:69],v[68:69],v[84:85]
v_pk_add_f32 v[70:71],v[70:71],v[86:87]
s_waitcnt vmcnt(4)
v_lshlrev_b32 v80,16,v104
v_and_b32 v81,0xffff0000,v104
v_lshlrev_b32 v82,16,v105
v_and_b32 v83,0xffff0000,v105
v_lshlrev_b32 v84,16,v106
v_and_b32 v85,0xffff0000,v106
v_lshlrev_b32 v86,16,v107
v_and_b32 v87,0xffff0000,v107
v_pk_add_f32 v[64:65],v[64:65],v[80:81]
v_pk_add_f32 v[66:67],v[66:67],v[82:83]
v_pk_add_f32 v[68:69],v[68:69],v[84:85]
v_pk_add_f32 v[70:71],v[70:71],v[86:87]
v_lshlrev_b32 v80,16,v108
v_and_b32 v81,0xffff0000,v108
v_lshlrev_b32 v82,16,v109
v_and_b32 v83,0xffff0000,v109
v_lshlrev_b32 v84,16,v110
v_and_b32 v85,0xffff0000,v110
v_lshlrev_b32 v86,16,v111
v_and_b32 v87,0xffff0000,v111
v_pk_add_f32 v[64:65],v[64:65],v[80:81]
v_pk_add_f32 v[66:67],v[66:67],v[82:83]
v_pk_add_f32 v[68:69],v[68:69],v[84:85]
v_pk_add_f32 v[70:71],v[70:71],v[86:87]
s_waitcnt vmcnt(2)
v_lshlrev_b32 v72,16,v112
v_and_b32 v73,0xffff0000,v112
v_lshlrev_b32 v74,16,v113
v_and_b32 v75,0xffff0000,v113
v_lshlrev_b32 v76,16,v114
v_and_b32 v77,0xffff0000,v114
v_lshlrev_b32 v78,16,v115
v_and_b32 v79,0xffff0000,v115
v_lshlrev_b32 v80,16,v116
v_and_b32 v81,0xffff0000,v116
v_lshlrev_b32 v82,16,v117
v_and_b32 v83,0xffff0000,v117
v_lshlrev_b32 v84,16,v118
v_and_b32 v85,0xffff0000,v118
v_lshlrev_b32 v86,16,v119
v_and_b32 v87,0xffff0000,v119
v_pk_add_f32 v[72:73],v[72:73],v[80:81]
v_pk_add_f32 v[74:75],v[74:75],v[82:83]
v_pk_add_f32 v[76:77],v[76:77],v[84:85]
v_pk_add_f32 v[78:79],v[78:79],v[86:87]
s_waitcnt vmcnt(0)
v_lshlrev_b32 v80,16,v120
v_and_b32 v81,0xffff0000,v120
v_lshlrev_b32 v82,16,v121
v_and_b32 v83,0xffff0000,v121
v_lshlrev_b32 v84,16,v122
v_and_b32 v85,0xffff0000,v122
v_lshlrev_b32 v86,16,v123
v_and_b32 v87,0xffff0000,v123
v_pk_add_f32 v[72:73],v[72:73],v[80:81]
v_pk_add_f32 v[74:75],v[74:75],v[82:83]
v_pk_add_f32 v[76:77],v[76:77],v[84:85]
v_pk_add_f32 v[78:79],v[78:79],v[86:87]
v_lshlrev_b32 v80,16,v124
v_and_b32 v81,0xffff0000,v124
v_lshlrev_b32 v82,16,v125
v_and_b32 v83,0xffff0000,v125
v_lshlrev_b32 v84,16,v126
v_and_b32 v85,0xffff0000,v126
v_lshlrev_b32 v86,16,v127
v_and_b32 v87,0xffff0000,v127
v_pk_add_f32 v[72:73],v[72:73],v[80:81]
v_pk_add_f32 v[74:75],v[74:75],v[82:83]
v_pk_add_f32 v[76:77],v[76:77],v[84:85]
v_pk_add_f32 v[78:79],v[78:79],v[86:87]
v_mul_f32 v80,s61,v72
v_mul_f32 v81,s61,v73
v_mul_f32 v82,s61,v74
v_mul_f32 v83,s61,v75
v_mul_f32 v84,s61,v76
v_mul_f32 v85,s61,v77
v_mul_f32 v86,s61,v78
v_mul_f32 v87,s61,v79
v_exp_f32 v80,v80
v_exp_f32 v81,v81
v_exp_f32 v82,v82
v_exp_f32 v83,v83
v_exp_f32 v84,v84
v_exp_f32 v85,v85
v_exp_f32 v86,v86
v_exp_f32 v87,v87
v_pk_mul_f32 v[64:65],v[64:65],v[72:73]
v_pk_mul_f32 v[66:67],v[66:67],v[74:75]
v_pk_mul_f32 v[68:69],v[68:69],v[76:77]
v_pk_mul_f32 v[70:71],v[70:71],v[78:79]
v_add_f32 v80,1.0,v80
v_add_f32 v81,1.0,v81
v_add_f32 v82,1.0,v82
v_add_f32 v83,1.0,v83
v_add_f32 v84,1.0,v84
v_add_f32 v85,1.0,v85
v_add_f32 v86,1.0,v86
v_add_f32 v87,1.0,v87
v_rcp_f32 v80,v80
v_rcp_f32 v81,v81
v_rcp_f32 v82,v82
v_rcp_f32 v83,v83
v_rcp_f32 v84,v84
v_rcp_f32 v85,v85
v_rcp_f32 v86,v86
v_rcp_f32 v87,v87
v_lshlrev_b32 v88,16,v20
v_and_b32 v89,0xffff0000,v20
v_lshlrev_b32 v90,16,v21
v_and_b32 v91,0xffff0000,v21
v_lshlrev_b32 v92,16,v22
v_and_b32 v93,0xffff0000,v22
v_lshlrev_b32 v94,16,v23
v_and_b32 v95,0xffff0000,v23
v_pk_fma_f32 v[88:89],v[64:65],v[80:81],v[88:89]
v_pk_fma_f32 v[90:91],v[66:67],v[82:83],v[90:91]
v_pk_fma_f32 v[92:93],v[68:69],v[84:85],v[92:93]
v_pk_fma_f32 v[94:95],v[70:71],v[86:87],v[94:95]
cv v192,v88,v89
cv v193,v90,v91
cv v194,v92,v93
cv v195,v94,v95
buffer_store_dwordx2 v[192:193],v16,s[16:19],s41 offen
buffer_store_dwordx2 v[194:195],v17,s[16:19],s41 offen
L_ok_pb:
s_barrier
bl v[160:163],v2,s[8:11],s40 offen sc1
s_add_u32 s40,s40,73728
bl v[164:167],v2,s[8:11],s40 offen sc1
s_add_u32 s40,s40,73728
bl v[168:171],v2,s[8:11],s40 offen sc1
s_add_u32 s40,s40,73728
bl v[172:175],v2,s[8:11],s40 offen sc1
s_add_u32 s40,s40,73728
bl v[176:179],v2,s[8:11],s40 offen sc1
s_add_u32 s40,s40,73728
bl v[180:183],v2,s[8:11],s40 offen sc1
s_add_u32 s40,s40,73728
bl v[184:187],v2,s[8:11],s40 offen sc1
s_add_u32 s40,s40,73728
bl v[188:191],v2,s[8:11],s40 offen sc1
bl v[128:131],v2,s[8:11],s39 offen sc1
s_add_u32 s39,s39,73728
bl v[132:135],v2,s[8:11],s39 offen sc1
s_add_u32 s39,s39,73728
bl v[136:139],v2,s[8:11],s39 offen sc1
s_add_u32 s39,s39,73728
bl v[140:143],v2,s[8:11],s39 offen sc1
s_add_u32 s39,s39,73728
bl v[144:147],v2,s[8:11],s39 offen sc1
s_add_u32 s39,s39,73728
bl v[148:151],v2,s[8:11],s39 offen sc1
s_add_u32 s39,s39,73728
bl v[152:155],v2,s[8:11],s39 offen sc1
s_add_u32 s39,s39,73728
bl v[156:159],v2,s[8:11],s39 offen sc1
s_cmp_eq_u32 s46,0
s_cbranch_scc1 L_last
s_waitcnt vmcnt(22)
v_lshlrev_b32 v64,16,v96
v_and_b32 v65,0xffff0000,v96
v_lshlrev_b32 v66,16,v97
v_and_b32 v67,0xffff0000,v97
v_lshlrev_b32 v68,16,v98
v_and_b32 v69,0xffff0000,v98
v_lshlrev_b32 v70,16,v99
v_and_b32 v71,0xffff0000,v99
v_lshlrev_b32 v80,16,v100
v_and_b32 v81,0xffff0000,v100
v_lshlrev_b32 v82,16,v101
v_and_b32 v83,0xffff0000,v101
v_lshlrev_b32 v84,16,v102
v_and_b32 v85,0xffff0000,v102
v_lshlrev_b32 v86,16,v103
v_and_b32 v87,0xffff0000,v103
v_pk_add_f32 v[64:65],v[64:65],v[80:81]
v_pk_add_f32 v[66:67],v[66:67],v[82:83]
v_pk_add_f32 v[68:69],v[68:69],v[84:85]
v_pk_add_f32 v[70:71],v[70:71],v[86:87]
s_waitcnt vmcnt(20)
v_lshlrev_b32 v80,16,v104
v_and_b32 v81,0xffff0000,v104
v_lshlrev_b32 v82,16,v105
v_and_b32 v83,0xffff0000,v105
v_lshlrev_b32 v84,16,v106
v_and_b32 v85,0xffff0000,v106
v_lshlrev_b32 v86,16,v107
v_and_b32 v87,0xffff0000,v107
v_pk_add_f32 v[64:65],v[64:65],v[80:81]
v_pk_add_f32 v[66:67],v[66:67],v[82:83]
v_pk_add_f32 v[68:69],v[68:69],v[84:85]
v_pk_add_f32 v[70:71],v[70:71],v[86:87]
v_lshlrev_b32 v80,16,v108
v_and_b32 v81,0xffff0000,v108
v_lshlrev_b32 v82,16,v109
v_and_b32 v83,0xffff0000,v109
v_lshlrev_b32 v84,16,v110
v_and_b32 v85,0xffff0000,v110
v_lshlrev_b32 v86,16,v111
v_and_b32 v87,0xffff0000,v111
v_pk_add_f32 v[64:65],v[64:65],v[80:81]
v_pk_add_f32 v[66:67],v[66:67],v[82:83]
v_pk_add_f32 v[68:69],v[68:69],v[84:85]
v_pk_add_f32 v[70:71],v[70:71],v[86:87]
s_waitcnt vmcnt(18)
v_lshlrev_b32 v72,16,v112
v_and_b32 v73,0xffff0000,v112
v_lshlrev_b32 v74,16,v113
v_and_b32 v75,0xffff0000,v113
v_lshlrev_b32 v76,16,v114
v_and_b32 v77,0xffff0000,v114
v_lshlrev_b32 v78,16,v115
v_and_b32 v79,0xffff0000,v115
v_lshlrev_b32 v80,16,v116
v_and_b32 v81,0xffff0000,v116
v_lshlrev_b32 v82,16,v117
v_and_b32 v83,0xffff0000,v117
v_lshlrev_b32 v84,16,v118
v_and_b32 v85,0xffff0000,v118
v_lshlrev_b32 v86,16,v119
v_and_b32 v87,0xffff0000,v119
v_pk_add_f32 v[72:73],v[72:73],v[80:81]
v_pk_add_f32 v[74:75],v[74:75],v[82:83]
v_pk_add_f32 v[76:77],v[76:77],v[84:85]
v_pk_add_f32 v[78:79],v[78:79],v[86:87]
s_waitcnt vmcnt(16)
v_lshlrev_b32 v80,16,v120
v_and_b32 v81,0xffff0000,v120
v_lshlrev_b32 v82,16,v121
v_and_b32 v83,0xffff0000,v121
v_lshlrev_b32 v84,16,v122
v_and_b32 v85,0xffff0000,v122
v_lshlrev_b32 v86,16,v123
v_and_b32 v87,0xffff0000,v123
v_pk_add_f32 v[72:73],v[72:73],v[80:81]
v_pk_add_f32 v[74:75],v[74:75],v[82:83]
v_pk_add_f32 v[76:77],v[76:77],v[84:85]
v_pk_add_f32 v[78:79],v[78:79],v[86:87]
v_lshlrev_b32 v80,16,v124
v_and_b32 v81,0xffff0000,v124
v_lshlrev_b32 v82,16,v125
v_and_b32 v83,0xffff0000,v125
v_lshlrev_b32 v84,16,v126
v_and_b32 v85,0xffff0000,v126
v_lshlrev_b32 v86,16,v127
v_and_b32 v87,0xffff0000,v127
v_pk_add_f32 v[72:73],v[72:73],v[80:81]
v_pk_add_f32 v[74:75],v[74:75],v[82:83]
v_pk_add_f32 v[76:77],v[76:77],v[84:85]
v_pk_add_f32 v[78:79],v[78:79],v[86:87]
v_mul_f32 v80,s61,v72
v_mul_f32 v81,s61,v73
v_mul_f32 v82,s61,v74
v_mul_f32 v83,s61,v75
v_mul_f32 v84,s61,v76
v_mul_f32 v85,s61,v77
v_mul_f32 v86,s61,v78
v_mul_f32 v87,s61,v79
v_exp_f32 v80,v80
v_exp_f32 v81,v81
v_exp_f32 v82,v82
v_exp_f32 v83,v83
v_exp_f32 v84,v84
v_exp_f32 v85,v85
v_exp_f32 v86,v86
v_exp_f32 v87,v87
v_pk_mul_f32 v[64:65],v[64:65],v[72:73]
v_pk_mul_f32 v[66:67],v[66:67],v[74:75]
v_pk_mul_f32 v[68:69],v[68:69],v[76:77]
v_pk_mul_f32 v[70:71],v[70:71],v[78:79]
v_add_f32 v80,1.0,v80
v_add_f32 v81,1.0,v81
v_add_f32 v82,1.0,v82
v_add_f32 v83,1.0,v83
v_add_f32 v84,1.0,v84
v_add_f32 v85,1.0,v85
v_add_f32 v86,1.0,v86
v_add_f32 v87,1.0,v87
v_rcp_f32 v80,v80
v_rcp_f32 v81,v81
v_rcp_f32 v82,v82
v_rcp_f32 v83,v83
v_rcp_f32 v84,v84
v_rcp_f32 v85,v85
v_rcp_f32 v86,v86
v_rcp_f32 v87,v87
v_lshlrev_b32 v88,16,v20
v_and_b32 v89,0xffff0000,v20
v_lshlrev_b32 v90,16,v21
v_and_b32 v91,0xffff0000,v21
v_lshlrev_b32 v92,16,v22
v_and_b32 v93,0xffff0000,v22
v_lshlrev_b32 v94,16,v23
v_and_b32 v95,0xffff0000,v23
v_pk_fma_f32 v[88:89],v[64:65],v[80:81],v[88:89]
v_pk_fma_f32 v[90:91],v[66:67],v[82:83],v[90:91]
v_pk_fma_f32 v[92:93],v[68:69],v[84:85],v[92:93]
v_pk_fma_f32 v[94:95],v[70:71],v[86:87],v[94:95]
cv v192,v88,v89
cv v193,v90,v91
cv v194,v92,v93
cv v195,v94,v95
buffer_store_dwordx2 v[192:193],v16,s[16:19],s41 offen
buffer_store_dwordx2 v[194:195],v17,s[16:19],s41 offen
L_last:
s_waitcnt vmcnt(14)
v_lshlrev_b32 v64,16,v160
v_and_b32 v65,0xffff0000,v160
v_lshlrev_b32 v66,16,v161
v_and_b32 v67,0xffff0000,v161
v_lshlrev_b32 v68,16,v162
v_and_b32 v69,0xffff0000,v162
v_lshlrev_b32 v70,16,v163
v_and_b32 v71,0xffff0000,v163
v_lshlrev_b32 v80,16,v164
v_and_b32 v81,0xffff0000,v164
v_lshlrev_b32 v82,16,v165
v_and_b32 v83,0xffff0000,v165
v_lshlrev_b32 v84,16,v166
v_and_b32 v85,0xffff0000,v166
v_lshlrev_b32 v86,16,v167
v_and_b32 v87,0xffff0000,v167
v_pk_add_f32 v[64:65],v[64:65],v[80:81]
v_pk_add_f32 v[66:67],v[66:67],v[82:83]
v_pk_add_f32 v[68:69],v[68:69],v[84:85]
v_pk_add_f32 v[70:71],v[70:71],v[86:87]
s_waitcnt vmcnt(12)
v_lshlrev_b32 v80,16,v168
v_and_b32 v81,0xffff0000,v168
v_lshlrev_b32 v82,16,v169
v_and_b32 v83,0xffff0000,v169
v_lshlrev_b32 v84,16,v170
v_and_b32 v85,0xffff0000,v170
v_lshlrev_b32 v86,16,v171
v_and_b32 v87,0xffff0000,v171
v_pk_add_f32 v[64:65],v[64:65],v[80:81]
v_pk_add_f32 v[66:67],v[66:67],v[82:83]
v_pk_add_f32 v[68:69],v[68:69],v[84:85]
v_pk_add_f32 v[70:71],v[70:71],v[86:87]
v_lshlrev_b32 v80,16,v172
v_and_b32 v81,0xffff0000,v172
v_lshlrev_b32 v82,16,v173
v_and_b32 v83,0xffff0000,v173
v_lshlrev_b32 v84,16,v174
v_and_b32 v85,0xffff0000,v174
v_lshlrev_b32 v86,16,v175
v_and_b32 v87,0xffff0000,v175
v_pk_add_f32 v[64:65],v[64:65],v[80:81]
v_pk_add_f32 v[66:67],v[66:67],v[82:83]
v_pk_add_f32 v[68:69],v[68:69],v[84:85]
v_pk_add_f32 v[70:71],v[70:71],v[86:87]
s_waitcnt vmcnt(10)
v_lshlrev_b32 v72,16,v176
v_and_b32 v73,0xffff0000,v176
v_lshlrev_b32 v74,16,v177
v_and_b32 v75,0xffff0000,v177
v_lshlrev_b32 v76,16,v178
v_and_b32 v77,0xffff0000,v178
v_lshlrev_b32 v78,16,v179
v_and_b32 v79,0xffff0000,v179
v_lshlrev_b32 v80,16,v180
v_and_b32 v81,0xffff0000,v180
v_lshlrev_b32 v82,16,v181
v_and_b32 v83,0xffff0000,v181
v_lshlrev_b32 v84,16,v182
v_and_b32 v85,0xffff0000,v182
v_lshlrev_b32 v86,16,v183
v_and_b32 v87,0xffff0000,v183
v_pk_add_f32 v[72:73],v[72:73],v[80:81]
v_pk_add_f32 v[74:75],v[74:75],v[82:83]
v_pk_add_f32 v[76:77],v[76:77],v[84:85]
v_pk_add_f32 v[78:79],v[78:79],v[86:87]
s_waitcnt vmcnt(8)
v_lshlrev_b32 v80,16,v184
v_and_b32 v81,0xffff0000,v184
v_lshlrev_b32 v82,16,v185
v_and_b32 v83,0xffff0000,v185
v_lshlrev_b32 v84,16,v186
v_and_b32 v85,0xffff0000,v186
v_lshlrev_b32 v86,16,v187
v_and_b32 v87,0xffff0000,v187
v_pk_add_f32 v[72:73],v[72:73],v[80:81]
v_pk_add_f32 v[74:75],v[74:75],v[82:83]
v_pk_add_f32 v[76:77],v[76:77],v[84:85]
v_pk_add_f32 v[78:79],v[78:79],v[86:87]
v_lshlrev_b32 v80,16,v188
v_and_b32 v81,0xffff0000,v188
v_lshlrev_b32 v82,16,v189
v_and_b32 v83,0xffff0000,v189
v_lshlrev_b32 v84,16,v190
v_and_b32 v85,0xffff0000,v190
v_lshlrev_b32 v86,16,v191
v_and_b32 v87,0xffff0000,v191
v_pk_add_f32 v[72:73],v[72:73],v[80:81]
v_pk_add_f32 v[74:75],v[74:75],v[82:83]
v_pk_add_f32 v[76:77],v[76:77],v[84:85]
v_pk_add_f32 v[78:79],v[78:79],v[86:87]
v_mul_f32 v80,s61,v72
v_mul_f32 v81,s61,v73
v_mul_f32 v82,s61,v74
v_mul_f32 v83,s61,v75
v_mul_f32 v84,s61,v76
v_mul_f32 v85,s61,v77
v_mul_f32 v86,s61,v78
v_mul_f32 v87,s61,v79
v_exp_f32 v80,v80
v_exp_f32 v81,v81
v_exp_f32 v82,v82
v_exp_f32 v83,v83
v_exp_f32 v84,v84
v_exp_f32 v85,v85
v_exp_f32 v86,v86
v_exp_f32 v87,v87
v_pk_mul_f32 v[64:65],v[64:65],v[72:73]
v_pk_mul_f32 v[66:67],v[66:67],v[74:75]
v_pk_mul_f32 v[68:69],v[68:69],v[76:77]
v_pk_mul_f32 v[70:71],v[70:71],v[78:79]
v_add_f32 v80,1.0,v80
v_add_f32 v81,1.0,v81
v_add_f32 v82,1.0,v82
v_add_f32 v83,1.0,v83
v_add_f32 v84,1.0,v84
v_add_f32 v85,1.0,v85
v_add_f32 v86,1.0,v86
v_add_f32 v87,1.0,v87
v_rcp_f32 v80,v80
v_rcp_f32 v81,v81
v_rcp_f32 v82,v82
v_rcp_f32 v83,v83
v_rcp_f32 v84,v84
v_rcp_f32 v85,v85
v_rcp_f32 v86,v86
v_rcp_f32 v87,v87
v_lshlrev_b32 v88,16,v28
v_and_b32 v89,0xffff0000,v28
v_lshlrev_b32 v90,16,v29
v_and_b32 v91,0xffff0000,v29
v_lshlrev_b32 v92,16,v30
v_and_b32 v93,0xffff0000,v30
v_lshlrev_b32 v94,16,v31
v_and_b32 v95,0xffff0000,v31
v_pk_fma_f32 v[88:89],v[64:65],v[80:81],v[88:89]
v_pk_fma_f32 v[90:91],v[66:67],v[82:83],v[90:91]
v_pk_fma_f32 v[92:93],v[68:69],v[84:85],v[92:93]
v_pk_fma_f32 v[94:95],v[70:71],v[86:87],v[94:95]
cv v200,v88,v89
cv v201,v90,v91
cv v202,v92,v93
cv v203,v94,v95
buffer_store_dwordx2 v[200:201],v16,s[16:19],s43 offen
buffer_store_dwordx2 v[202:203],v17,s[16:19],s43 offen
s_cmp_eq_u32 s3,0
s_cbranch_scc0 L_fin
s_waitcnt vmcnt(8)
v_lshlrev_b32 v64,16,v128
v_and_b32 v65,0xffff0000,v128
v_lshlrev_b32 v66,16,v129
v_and_b32 v67,0xffff0000,v129
v_lshlrev_b32 v68,16,v130
v_and_b32 v69,0xffff0000,v130
v_lshlrev_b32 v70,16,v131
v_and_b32 v71,0xffff0000,v131
v_lshlrev_b32 v80,16,v132
v_and_b32 v81,0xffff0000,v132
v_lshlrev_b32 v82,16,v133
v_and_b32 v83,0xffff0000,v133
v_lshlrev_b32 v84,16,v134
v_and_b32 v85,0xffff0000,v134
v_lshlrev_b32 v86,16,v135
v_and_b32 v87,0xffff0000,v135
v_pk_add_f32 v[64:65],v[64:65],v[80:81]
v_pk_add_f32 v[66:67],v[66:67],v[82:83]
v_pk_add_f32 v[68:69],v[68:69],v[84:85]
v_pk_add_f32 v[70:71],v[70:71],v[86:87]
s_waitcnt vmcnt(6)
v_lshlrev_b32 v80,16,v136
v_and_b32 v81,0xffff0000,v136
v_lshlrev_b32 v82,16,v137
v_and_b32 v83,0xffff0000,v137
v_lshlrev_b32 v84,16,v138
v_and_b32 v85,0xffff0000,v138
v_lshlrev_b32 v86,16,v139
v_and_b32 v87,0xffff0000,v139
v_pk_add_f32 v[64:65],v[64:65],v[80:81]
v_pk_add_f32 v[66:67],v[66:67],v[82:83]
v_pk_add_f32 v[68:69],v[68:69],v[84:85]
v_pk_add_f32 v[70:71],v[70:71],v[86:87]
v_lshlrev_b32 v80,16,v140
v_and_b32 v81,0xffff0000,v140
v_lshlrev_b32 v82,16,v141
v_and_b32 v83,0xffff0000,v141
v_lshlrev_b32 v84,16,v142
v_and_b32 v85,0xffff0000,v142
v_lshlrev_b32 v86,16,v143
v_and_b32 v87,0xffff0000,v143
v_pk_add_f32 v[64:65],v[64:65],v[80:81]
v_pk_add_f32 v[66:67],v[66:67],v[82:83]
v_pk_add_f32 v[68:69],v[68:69],v[84:85]
v_pk_add_f32 v[70:71],v[70:71],v[86:87]
s_waitcnt vmcnt(4)
v_lshlrev_b32 v72,16,v144
v_and_b32 v73,0xffff0000,v144
v_lshlrev_b32 v74,16,v145
v_and_b32 v75,0xffff0000,v145
v_lshlrev_b32 v76,16,v146
v_and_b32 v77,0xffff0000,v146
v_lshlrev_b32 v78,16,v147
v_and_b32 v79,0xffff0000,v147
v_lshlrev_b32 v80,16,v148
v_and_b32 v81,0xffff0000,v148
v_lshlrev_b32 v82,16,v149
v_and_b32 v83,0xffff0000,v149
v_lshlrev_b32 v84,16,v150
v_and_b32 v85,0xffff0000,v150
v_lshlrev_b32 v86,16,v151
v_and_b32 v87,0xffff0000,v151
v_pk_add_f32 v[72:73],v[72:73],v[80:81]
v_pk_add_f32 v[74:75],v[74:75],v[82:83]
v_pk_add_f32 v[76:77],v[76:77],v[84:85]
v_pk_add_f32 v[78:79],v[78:79],v[86:87]
s_waitcnt vmcnt(2)
v_lshlrev_b32 v80,16,v152
v_and_b32 v81,0xffff0000,v152
v_lshlrev_b32 v82,16,v153
v_and_b32 v83,0xffff0000,v153
v_lshlrev_b32 v84,16,v154
v_and_b32 v85,0xffff0000,v154
v_lshlrev_b32 v86,16,v155
v_and_b32 v87,0xffff0000,v155
v_pk_add_f32 v[72:73],v[72:73],v[80:81]
v_pk_add_f32 v[74:75],v[74:75],v[82:83]
v_pk_add_f32 v[76:77],v[76:77],v[84:85]
v_pk_add_f32 v[78:79],v[78:79],v[86:87]
v_lshlrev_b32 v80,16,v156
v_and_b32 v81,0xffff0000,v156
v_lshlrev_b32 v82,16,v157
v_and_b32 v83,0xffff0000,v157
v_lshlrev_b32 v84,16,v158
v_and_b32 v85,0xffff0000,v158
v_lshlrev_b32 v86,16,v159
v_and_b32 v87,0xffff0000,v159
v_pk_add_f32 v[72:73],v[72:73],v[80:81]
v_pk_add_f32 v[74:75],v[74:75],v[82:83]
v_pk_add_f32 v[76:77],v[76:77],v[84:85]
v_pk_add_f32 v[78:79],v[78:79],v[86:87]
v_mul_f32 v80,s61,v72
v_mul_f32 v81,s61,v73
v_mul_f32 v82,s61,v74
v_mul_f32 v83,s61,v75
v_mul_f32 v84,s61,v76
v_mul_f32 v85,s61,v77
v_mul_f32 v86,s61,v78
v_mul_f32 v87,s61,v79
v_exp_f32 v80,v80
v_exp_f32 v81,v81
v_exp_f32 v82,v82
v_exp_f32 v83,v83
v_exp_f32 v84,v84
v_exp_f32 v85,v85
v_exp_f32 v86,v86
v_exp_f32 v87,v87
v_pk_mul_f32 v[64:65],v[64:65],v[72:73]
v_pk_mul_f32 v[66:67],v[66:67],v[74:75]
v_pk_mul_f32 v[68:69],v[68:69],v[76:77]
v_pk_mul_f32 v[70:71],v[70:71],v[78:79]
v_add_f32 v80,1.0,v80
v_add_f32 v81,1.0,v81
v_add_f32 v82,1.0,v82
v_add_f32 v83,1.0,v83
v_add_f32 v84,1.0,v84
v_add_f32 v85,1.0,v85
v_add_f32 v86,1.0,v86
v_add_f32 v87,1.0,v87
v_rcp_f32 v80,v80
v_rcp_f32 v81,v81
v_rcp_f32 v82,v82
v_rcp_f32 v83,v83
v_rcp_f32 v84,v84
v_rcp_f32 v85,v85
v_rcp_f32 v86,v86
v_rcp_f32 v87,v87
v_lshlrev_b32 v88,16,v24
v_and_b32 v89,0xffff0000,v24
v_lshlrev_b32 v90,16,v25
v_and_b32 v91,0xffff0000,v25
v_lshlrev_b32 v92,16,v26
v_and_b32 v93,0xffff0000,v26
v_lshlrev_b32 v94,16,v27
v_and_b32 v95,0xffff0000,v27
v_pk_fma_f32 v[88:89],v[64:65],v[80:81],v[88:89]
v_pk_fma_f32 v[90:91],v[66:67],v[82:83],v[90:91]
v_pk_fma_f32 v[92:93],v[68:69],v[84:85],v[92:93]
v_pk_fma_f32 v[94:95],v[70:71],v[86:87],v[94:95]
cv v196,v88,v89
cv v197,v90,v91
cv v198,v92,v93
cv v199,v94,v95
buffer_store_dwordx2 v[196:197],v16,s[16:19],s42 offen
buffer_store_dwordx2 v[198:199],v17,s[16:19],s42 offen
L_fin:
L_main_end:
s_endpgm
L_spin_fo2:
s_mov_b32 s63,0x40000
L_spin2_fo2:
buffer_load_dword v0,v3,s[8:11],s76 offen offset:0 sc1
s_waitcnt vmcnt(0)
v_cmp_ne_u32 vcc,v1,v0
s_sub_u32 s63,s63,1
s_cbranch_scc1 L_ok_fo2
s_nop 0
s_cbranch_vccz L_ok_fo2
s_sleep 8
s_branch L_spin2_fo2
L_spin_pa:
s_mov_b32 s63,0x40000
L_spin2_pa:
buffer_load_dword v0,v3,s[8:11],s75 offen offset:24 sc1
s_waitcnt vmcnt(0)
v_cmp_ne_u32 vcc,v1,v0
s_sub_u32 s63,s63,1
s_cbranch_scc1 L_ok_pa
s_nop 0
s_cbranch_vccz L_ok_pa
s_sleep 4
s_branch L_spin2_pa
L_spin_pb:
s_mov_b32 s63,0x40000
buffer_load_dword v56,v3,s[8:11],s76 offen offset:28 sc1
s_sleep 4
buffer_load_dword v57,v3,s[8:11],s76 offen offset:28 sc1
s_sleep 4
buffer_load_dword v60,v3,s[8:11],s76 offen offset:28 sc1
L_spin2_pb:
s_waitcnt vmcnt(2)
v_cmp_ne_u32 vcc,v1,v56
s_nop 1
s_cbranch_vccz L_ok_pb
buffer_load_dword v56,v3,s[8:11],s76 offen offset:28 sc1
s_waitcnt vmcnt(2)
v_cmp_ne_u32 vcc,v1,v57
s_nop 1
s_cbranch_vccz L_ok_pb
buffer_load_dword v57,v3,s[8:11],s76 offen offset:28 sc1
s_waitcnt vmcnt(2)
v_cmp_ne_u32 vcc,v1,v60
s_nop 1
s_cbranch_vccz L_ok_pb
buffer_load_dword v60,v3,s[8:11],s76 offen offset:28 sc1
s_sub_u32 s63,s63,1
s_cbranch_scc0 L_spin2_pb
s_branch L_ok_pb
L_code_end:
.fill 64, 4, 0xBF800000
s_endpgm
.section .rodata,"a"
.p2align 6
.amdhsa_kernel recurrent_scan__sliding_block_cached__swiglu_ffn__prompt_kernel
  .amdhsa_next_free_vgpr 512
  .amdhsa_next_free_sgpr 102
  .amdhsa_accum_offset 256
  .amdhsa_group_segment_fixed_size 0
  .amdhsa_kernarg_size 96
  .amdhsa_user_sgpr_count 2
  .amdhsa_user_sgpr_kernarg_segment_ptr 1
  .amdhsa_system_sgpr_workgroup_id_x 1
  .amdhsa_float_denorm_mode_32 3
.end_amdhsa_kernel
.text
```
